```python
import torch

def _softmax(x, axis=-1):
    return torch.softmax(x, dim=axis)
def _gelu(x):
    return torch.nn.functional.gelu(x, approximate="tanh")
def _silu(x):
    return torch.nn.functional.silu(x)
def _sigmoid(x):
    return torch.sigmoid(x)
def _layernorm(x, axis=-1, eps=1e-5):
    m = x.mean(dim=axis, keepdim=True)
    v = x.var(dim=axis, keepdim=True, unbiased=False)
    return (x - m) / torch.sqrt(v + eps)
def _scatter_add(tgt, idx, src, axis=0):
    return tgt.clone().index_add_(axis, idx, src)
def _segment_sum(src, seg, n):
    out = torch.zeros((n,) + src.shape[1:], dtype=src.dtype)
    return out.index_add_(0, seg, src)
def _pad(x, pw):
    flat = tuple(v for pair in reversed(pw) for v in pair)
    return torch.nn.functional.pad(x, flat)

kernel_name = 'recurrent_scan__mha_block_cached__glu_gated_bilinear__prompt'

def setup_inputs():

    _w = (lambda a: (lambda t: t.to(torch.bfloat16) if t.is_floating_point() else t)(torch.as_tensor(a)))
    def _A_setup():
        B, Sq, D = 1, 2048, 512
        H, Sk, Dh = 32, 2048, 128
        return {
            "x": _w((lambda *s: torch.randn(*s, dtype=torch.bfloat16) * 0.05)(B, Sq, D)),
            "k_cache": _w((lambda *s: torch.randn(*s, dtype=torch.bfloat16) * 1.6)(B, H, Sk, Dh)),
            "v_cache": _w((lambda *s: torch.randn(*s, dtype=torch.bfloat16) * 1.6)(B, H, Sk, Dh)),
            "wq": _w((lambda *s: torch.randn(*s, dtype=torch.bfloat16) * 1.6)(D, H * Dh) * (D ** -0.5)),
            "wo": _w((lambda *s: torch.randn(*s, dtype=torch.bfloat16) * 1.6)(H * Dh, D) * ((H * Dh) ** -0.5)),
        }
    _A_in = _A_setup()

    def _B_setup():
        B, S, D, F = 1, 2048, 512, 1792
        return {
            "x": _w((lambda *s: torch.randn(*s, dtype=torch.bfloat16) * 0.05)(B, S, D)),
            "w_gate": _w((lambda *s: torch.randn(*s, dtype=torch.bfloat16) * 0.2)(D, F) * (D ** -0.5)),
            "w_up": _w((lambda *s: torch.randn(*s, dtype=torch.bfloat16) * 0.2)(D, F) * (D ** -0.5)),
            "w_down": _w((lambda *s: torch.randn(*s, dtype=torch.bfloat16) * 0.2)(F, D) * (F ** -0.5)),
        }
    _B_in = _B_setup()

    return {
        "A_x": _A_in["x"],
        "A_k_cache": _A_in["k_cache"],
        "A_v_cache": _A_in["v_cache"],
        "A_wq": _A_in["wq"],
        "A_wo": _A_in["wo"],
        "B_x": _B_in["x"],
        "B_w_gate": _B_in["w_gate"],
        "B_w_up": _B_in["w_up"],
        "B_w_down": _B_in["w_down"],
    }

def reference(A_x, A_k_cache, A_v_cache, A_wq, A_wo, B_x, B_w_gate, B_w_up, B_w_down):
    def _A_ref(x, k_cache, v_cache, wq, wo):
        B, Sq, D = x.shape
        H, Dh = 32, 128
        q = (lambda x, *d: x.permute(*d))((x @ wq).reshape(B, Sq, H, Dh), 0, 2, 1, 3)
        scores = torch.einsum("bhqd,bhkd->bhqk", q, k_cache) * (Dh ** -0.5)
        p = _softmax(scores, axis=-1)
        o = torch.einsum("bhqk,bhkd->bhqd", p, v_cache)
        return (lambda x, *d: x.permute(*d))(o, 0, 2, 1, 3).reshape(B, Sq, H * Dh) @ wo

    def _B_ref(x, w_gate, w_up, w_down):
        g = torch.einsum("bsd,df->bsf", x, w_gate)
        u = torch.einsum("bsd,df->bsf", x, w_up)
        h = g * u
        return torch.einsum("bsf,fd->bsd", h, w_down)

    x = A_x
    xn = _layernorm(x, axis=-1)
    s = _A_ref(xn, A_k_cache, A_v_cache, A_wq, A_wo)
    g = _silu(_B_ref(xn, B_w_gate, B_w_up, B_w_down))
    return x + s * g
```

```asm
; @launch grid=(256,1,1) block=(256,1,1) lds=163840
.amdgcn_target "amdgcn-amd-amdhsa--gfx950"
.text
.globl recurrent_scan__mha_block_cached__glu_gated_bilinear__prompt_kernel
.p2align 8
.type recurrent_scan__mha_block_cached__glu_gated_bilinear__prompt_kernel,@function
recurrent_scan__mha_block_cached__glu_gated_bilinear__prompt_kernel:
m_a:
 s_cmp_ge_u32 s2, 256
 s_cbranch_scc1 m_end
 s_load_dwordx16 s[64:79], s[0:1], 0
 s_load_dwordx8 s[80:87], s[0:1], 64
 s_memrealtime s[100:101]
 v_lshrrev_b32 v1, 6, v0
 v_and_b32 v2, 63, v0
 s_and_b32 s3, s2, 7
 v_readfirstlane_b32 s44, v1
 v_lshlrev_b32 v18, 4, v2
 s_getpc_b64 s[8:9]
m_pc:
 s_mov_b32 s10, mq_z-m_pc
 s_mov_b32 s11, 0x00020000
 s_lshr_b32 s4, s2, 3
 s_lshl_b32 s5, s4, 2
 s_add_u32 s5, s5, s44
 s_mul_i32 s6, s5, 384
 s_lshl_b32 s5, s5, 7
 s_add_u32 s5, s5, mq_pre-m_pc
 v_cmp_gt_u32 vcc, 3, v2
 v_lshlrev_b32 v1, 7, v2
 v_mov_b32 v3, 0x7ff00000
 v_cndmask_b32 v1, v3, v1, vcc
 v_lshlrev_b32 v3, 24, v2
 buffer_load_dword a130, v1, s[8:11], s6 offen
 buffer_load_dword a131, v3, s[8:11], s5 offen
 s_and_b32 s5, s4, 3
 s_lshl_b32 s3, s3, 2
 s_add_u32 s45, s3, s5
 s_lshr_b32 s46, s4, 2
 s_mov_b32 s57, 0
 s_and_b32 s3, s2, 7
 s_mul_i32 s6, s3, 3
 s_add_u32 s6, s6, s5
 s_lshr_b32 s7, s3, 1
 s_add_u32 s7, s7, 24
 s_xor_b32 s3, s3, s46
 s_and_b32 s3, s3, 1
 s_cselect_b32 s7, s7, 28
 s_cmp_lt_u32 s5, 3
 s_cselect_b32 s63, s6, s7
m_restart:
 s_lshl_b32 s47, s44, 12
 s_lshl_b32 s48, s44, 11
 v_lshrrev_b32 v46, 4, v18
 v_lshrrev_b32 v37, 8, v18
 v_and_b32 v38, 15, v46
 v_lshlrev_b32 v39, 1, v37
 v_xor_b32 v39, v39, v38
 v_xor_b32 v40, 0, v39
 v_lshlrev_b32 v40, 4, v40
 v_lshl_add_u32 v1, v37, 8, v40
 v_lshl_add_u32 v19, v37, 13, v40
 v_xor_b32 v40, 8, v39
 v_lshlrev_b32 v40, 4, v40
 v_lshl_add_u32 v2, v37, 8, v40
 v_lshl_add_u32 v20, v37, 13, v40
 v_add_u32 v20, 31744, v20
 v_xor_b32 v40, 9, v39
 v_lshlrev_b32 v40, 4, v40
 v_lshl_add_u32 v3, v37, 8, v40
 v_lshl_add_u32 v21, v37, 13, v40
 v_add_u32 v21, 63488, v21
 v_xor_b32 v40, 1, v39
 v_lshlrev_b32 v40, 4, v40
 v_lshl_add_u32 v4, v37, 8, v40
 v_lshl_add_u32 v22, v37, 13, v40
 v_add_u32 v22, 95232, v22
 v_lshrrev_b32 v40, 3, v46
 v_and_b32 v41, 7, v46
 v_and_b32 v42, 6, v40
 v_xor_b32 v41, v41, v42
 v_lshlrev_b32 v41, 4, v41
 v_mul_u32_u24 v40, 3584, v40
 v_add_u32 v23, v40, v41
 v_add_u32 v24, 27648, v23
 v_add_u32 v25, 0, v18
 v_add_u32 v26, 16384, v18
 v_add_u32 v27, 32768, v18
 v_add_u32 v28, 49152, v18
 s_mul_i32 s51, s44, 131072
 s_mul_i32 s52, s44, 57344
 s_lshl_b32 s3, s46, 2
 s_add_u32 s3, s3, s44
 s_lshl_b32 s53, s3, 16
 s_lshl_b32 s3, s45, 8
 s_sub_u32 s4, 0x400000, s3
 s_lshl_b32 s5, s63, 7
 s_sub_u32 s6, 1835008, s5
 s_waitcnt lgkmcnt(0)
 s_mov_b32 s92, s84
 s_mov_b32 s93, s85
 s_mov_b32 s94, 256
 s_mov_b32 s95, 0x00020000
 s_mov_b32 s8, s64
 s_mov_b32 s9, s65
 s_mov_b32 s10, 2097152
 s_mov_b32 s11, 0x00020000
 s_lshl_b32 s7, s46, 5
 s_add_u32 s7, s7, s45
 s_lshl_b32 s7, s7, 13
 s_add_u32 s7, s7, s48
 v_and_b32 v128, 31, v46
 v_lshrrev_b32 v129, 5, v46
 v_lshlrev_b32 v130, 4, v128
 v_lshl_add_u32 v130, v129, 10, v130
 buffer_load_dwordx4 v[136:139], v130, s[8:11], s7 offen
 buffer_load_dwordx4 v[140:143], v130, s[8:11], s7 offen offset:512
 s_or_b32 s100, s100, 1
 s_or_b32 s7, s2, s44
 s_or_b32 s7, s7, s57
 s_lshl_b32 s7, s7, 8
 v_mov_b32 v162, s100
 v_mov_b32 v163, s101
 v_lshlrev_b32 v161, 4, v18
 buffer_store_dwordx2 v[162:163], v161, s[92:95], s7 offen offset:128 sc1
 s_add_u32 s16, s70, s3
 s_addc_u32 s17, s71, 0
 s_mov_b32 s18, s4
 s_mov_b32 s19, 0x00020000
 s_mov_b32 s28, s86
 s_mov_b32 s29, s87
 s_mov_b32 s30, 2097152
 s_mov_b32 s31, 0x00020000
 s_add_u32 s20, s76, s5
 s_addc_u32 s21, s77, 0
 s_mov_b32 s22, s6
 s_mov_b32 s23, 0x00020000
 s_add_u32 s24, s78, s5
 s_addc_u32 s25, s79, 0
 s_mov_b32 s26, s6
 s_mov_b32 s27, 0x00020000
 s_cmp_ge_u32 s63, 28
 s_cbranch_scc1 mq_pre
 s_cmp_lg_u32 s57, 0
 s_cbranch_scc1 mq_pre
mg_pre:
 s_add_u32 m0, s47, 16384
 s_nop 0
 buffer_load_dwordx4 v19, s[16:19], s51 offen offset:0 lds
 buffer_load_dwordx4 v20, s[16:19], s51 offen offset:1024 lds
 buffer_load_dwordx4 v21, s[16:19], s51 offen offset:2048 lds
 buffer_load_dwordx4 v22, s[16:19], s51 offen offset:3072 lds
 s_add_u32 s51, s51, 524288
 s_add_u32 m0, s48, 98304
 s_nop 0
 buffer_load_dwordx4 v23, s[20:23], s52 offen offset:0 lds
 buffer_load_dwordx4 v24, s[20:23], s52 offen offset:1024 lds
 s_add_u32 m0, s48, 106496
 s_nop 0
 buffer_load_dwordx4 v23, s[24:27], s52 offen offset:0 lds
 buffer_load_dwordx4 v24, s[24:27], s52 offen offset:1024 lds
 s_add_u32 s52, s52, 229376
 v_lshrrev_b32 v131, 2, v128
 v_lshlrev_b32 v131, 9, v131
 v_and_b32 v132, 1, v128
 v_lshl_add_u32 v131, v132, 8, v131
 v_bfe_u32 v132, v128, 1, 1
 v_lshl_add_u32 v131, v132, 3, v131
 v_lshl_add_u32 v131, v129, 4, v131
 s_lshl_b32 s3, s44, 5
 v_add_u32 v131, s3, v131
 v_add_u32 v132, s48, v18
 v_lshrrev_b32 v133, 3, v46
 v_lshlrev_b32 v133, 8, v133
 v_and_b32 v130, 7, v46
 v_lshl_add_u32 v133, v130, 4, v133
 s_lshl_b32 s3, s46, 4
 s_lshr_b32 s4, s45, 1
 s_add_u32 s3, s3, s4
 s_lshl_b32 s3, s3, 14
 s_add_u32 s3, s3, s47
 s_and_b32 s4, s45, 1
 s_lshl_b32 s4, s4, 7
 s_add_u32 s3, s3, s4
 s_add_u32 s12, s86, 42467328
 s_addc_u32 s13, s87, 0
 s_mov_b32 s14, 8192
 s_mov_b32 s15, 0x00020000
 s_lshl_b32 s4, s44, 16
 s_mul_i32 s5, s46, 1024
 s_add_u32 s89, s4, s5
 s_mul_i32 s4, s45, 32
 s_add_u32 s88, s89, s4
 v_mov_b32 v161, 128
 s_waitcnt vmcnt(9)
 v_lshlrev_b32 v144, 16, v136
 v_and_b32 v145, 0xffff0000, v136
 v_lshlrev_b32 v146, 16, v137
 v_and_b32 v147, 0xffff0000, v137
 v_lshlrev_b32 v148, 16, v138
 v_and_b32 v149, 0xffff0000, v138
 v_lshlrev_b32 v150, 16, v139
 v_and_b32 v151, 0xffff0000, v139
 v_lshlrev_b32 v152, 16, v140
 v_and_b32 v153, 0xffff0000, v140
 v_lshlrev_b32 v154, 16, v141
 v_and_b32 v155, 0xffff0000, v141
 v_lshlrev_b32 v156, 16, v142
 v_and_b32 v157, 0xffff0000, v142
 v_lshlrev_b32 v158, 16, v143
 v_and_b32 v159, 0xffff0000, v143
 v_pk_add_f32 v[168:169], v[144:145], v[146:147]
 v_pk_add_f32 v[170:171], v[148:149], v[150:151]
 v_pk_add_f32 v[172:173], v[152:153], v[154:155]
 v_pk_add_f32 v[174:175], v[156:157], v[158:159]
 v_pk_add_f32 v[168:169], v[168:169], v[170:171]
 v_pk_add_f32 v[172:173], v[172:173], v[174:175]
 v_pk_add_f32 v[134:135], v[168:169], v[172:173]
 v_add_f32 v134, v134, v135
 s_nop 1
 v_add_f32_dpp v134, v134, v134 quad_perm:[1,0,3,2] row_mask:0xf bank_mask:0xf
 s_nop 1
 v_add_f32_dpp v134, v134, v134 quad_perm:[2,3,0,1] row_mask:0xf bank_mask:0xf
 s_nop 1
 v_add_f32_dpp v134, v134, v134 row_half_mirror row_mask:0xf bank_mask:0xf
 s_nop 1
 v_add_f32_dpp v134, v134, v134 row_mirror row_mask:0xf bank_mask:0xf
 v_mov_b32 v135, v134
 s_nop 1
 v_permlane16_swap_b32 v134, v135
 v_add_f32 v134, v134, v135
 v_mul_f32 v134, 0xbb000000, v134
 v_pk_add_f32 v[144:145], v[144:145], v[134:135] op_sel_hi:[1,0]
 v_pk_add_f32 v[146:147], v[146:147], v[134:135] op_sel_hi:[1,0]
 v_pk_add_f32 v[148:149], v[148:149], v[134:135] op_sel_hi:[1,0]
 v_pk_add_f32 v[150:151], v[150:151], v[134:135] op_sel_hi:[1,0]
 v_pk_add_f32 v[152:153], v[152:153], v[134:135] op_sel_hi:[1,0]
 v_pk_add_f32 v[154:155], v[154:155], v[134:135] op_sel_hi:[1,0]
 v_pk_add_f32 v[156:157], v[156:157], v[134:135] op_sel_hi:[1,0]
 v_pk_add_f32 v[158:159], v[158:159], v[134:135] op_sel_hi:[1,0]
 v_pk_mul_f32 v[168:169], v[144:145], v[144:145]
 v_pk_mul_f32 v[170:171], v[146:147], v[146:147]
 v_pk_mul_f32 v[172:173], v[148:149], v[148:149]
 v_pk_mul_f32 v[174:175], v[150:151], v[150:151]
 v_pk_fma_f32 v[168:169], v[152:153], v[152:153], v[168:169]
 v_pk_fma_f32 v[170:171], v[154:155], v[154:155], v[170:171]
 v_pk_fma_f32 v[172:173], v[156:157], v[156:157], v[172:173]
 v_pk_fma_f32 v[174:175], v[158:159], v[158:159], v[174:175]
 v_pk_add_f32 v[168:169], v[168:169], v[170:171]
 v_pk_add_f32 v[172:173], v[172:173], v[174:175]
 v_pk_add_f32 v[134:135], v[168:169], v[172:173]
 v_add_f32 v134, v134, v135
 s_nop 1
 v_add_f32_dpp v134, v134, v134 quad_perm:[1,0,3,2] row_mask:0xf bank_mask:0xf
 s_nop 1
 v_add_f32_dpp v134, v134, v134 quad_perm:[2,3,0,1] row_mask:0xf bank_mask:0xf
 s_nop 1
 v_add_f32_dpp v134, v134, v134 row_half_mirror row_mask:0xf bank_mask:0xf
 s_nop 1
 v_add_f32_dpp v134, v134, v134 row_mirror row_mask:0xf bank_mask:0xf
 v_mov_b32 v135, v134
 s_nop 1
 v_permlane16_swap_b32 v134, v135
 v_add_f32 v134, v134, v135
 v_mov_b32 v135, 0x3727c5ac
 v_fmac_f32 v135, 0x3b000000, v134
 v_rsq_f32 v135, v135
 s_nop 0
 v_mul_f32 v134, 0x3e0293ee, v135
 v_pk_mul_f32 v[144:145], v[144:145], v[134:135] op_sel_hi:[1,0]
 v_pk_mul_f32 v[146:147], v[146:147], v[134:135] op_sel_hi:[1,0]
 v_pk_mul_f32 v[148:149], v[148:149], v[134:135] op_sel_hi:[1,0]
 v_pk_mul_f32 v[150:151], v[150:151], v[134:135] op_sel_hi:[1,0]
 v_pk_mul_f32 v[152:153], v[152:153], v[134:135] op_sel_hi:[1,0]
 v_pk_mul_f32 v[154:155], v[154:155], v[134:135] op_sel_hi:[1,0]
 v_pk_mul_f32 v[156:157], v[156:157], v[134:135] op_sel_hi:[1,0]
 v_pk_mul_f32 v[158:159], v[158:159], v[134:135] op_sel_hi:[1,0]
 v_cvt_pk_bf16_f32 v136, v144, v145
 v_cvt_pk_bf16_f32 v137, v146, v147
 v_cvt_pk_bf16_f32 v138, v148, v149
 v_cvt_pk_bf16_f32 v139, v150, v151
 v_cvt_pk_bf16_f32 v140, v152, v153
 v_cvt_pk_bf16_f32 v141, v154, v155
 v_cvt_pk_bf16_f32 v142, v156, v157
 v_cvt_pk_bf16_f32 v143, v158, v159
 ds_write_b64 v131, v[136:137] offset:0
 ds_write_b64 v131, v[138:139] offset:128
 ds_write_b64 v131, v[140:141] offset:4096
 ds_write_b64 v131, v[142:143] offset:4224
 s_waitcnt lgkmcnt(0)
 s_barrier
 ds_read_b128 v[136:139], v132
 ds_read_b128 v[140:143], v132 offset:1024
 s_waitcnt lgkmcnt(0)
 buffer_store_dwordx4 v[136:139], v133, s[28:31], s3 offen offset:0 sc1
 buffer_store_dwordx4 v[140:143], v133, s[28:31], s3 offen offset:2048 sc1
 buffer_load_dwordx2 a[128:129], v161, s[92:95], 0 offen sc1
 v_lshlrev_b32 v160, 12, v18
 s_mov_b32 s4, 0
 s_waitcnt vmcnt(0)
 v_accvgpr_read_b32 v164, a128
 v_accvgpr_read_b32 v165, a129
mg_nonce:
 v_readfirstlane_b32 s100, v164
 v_readfirstlane_b32 s101, v165
 s_add_u32 s4, s4, 1
 s_cmp_ge_u32 s4, 0x40000
 s_cbranch_scc1 mg_go
 s_cmp_lg_u32 s100, 0
 s_cbranch_scc1 mg_go
mg_n1:
 buffer_load_dwordx2 v[164:165], v161, s[92:95], 0 offen sc1
 s_waitcnt vmcnt(0)
 s_branch mg_nonce
mg_go:
 s_barrier
 buffer_store_dwordx2 v[164:165], v160, s[12:15], s88 offen sc1
 s_add_u32 m0, s47, 32768
 s_nop 0
 buffer_load_dwordx4 v19, s[16:19], s51 offen offset:0 lds
 buffer_load_dwordx4 v20, s[16:19], s51 offen offset:1024 lds
 buffer_load_dwordx4 v21, s[16:19], s51 offen offset:2048 lds
 buffer_load_dwordx4 v22, s[16:19], s51 offen offset:3072 lds
 s_add_u32 s51, s51, 524288
 s_add_u32 m0, s48, 114688
 s_nop 0
 buffer_load_dwordx4 v23, s[20:23], s52 offen offset:0 lds
 buffer_load_dwordx4 v24, s[20:23], s52 offen offset:1024 lds
 s_add_u32 m0, s48, 122880
 s_nop 0
 buffer_load_dwordx4 v23, s[24:27], s52 offen offset:0 lds
 buffer_load_dwordx4 v24, s[24:27], s52 offen offset:1024 lds
 s_add_u32 s52, s52, 229376
 s_mov_b32 s49, s47
 s_mov_b32 s50, s47
 s_add_u32 s32, s86, 4194304
 s_addc_u32 s33, s87, 0
 s_mov_b32 s34, 7340032
 s_mov_b32 s35, 0x00020000
 s_add_u32 s36, s86, 16777216
 s_addc_u32 s37, s87, 0
 s_mov_b32 s38, 16777216
 s_mov_b32 s39, 0x00020000
 s_add_u32 s40, s86, 41943040
 s_addc_u32 s41, s87, 0
 s_mov_b32 s42, 83968
 s_mov_b32 s43, 0x00020000
 s_mov_b32 s54, s47
 s_add_u32 s55, s48, 81920
 v_and_b32 v39, 7, v38
 v_lshlrev_b32 v39, 1, v39
 v_lshrrev_b32 v40, 3, v38
 v_mul_u32_u24 v40, 9, v40
 v_xor_b32 v39, v39, v40
 v_xor_b32 v39, v39, v37
 v_lshlrev_b32 v40, 8, v38
 v_add_u32 v40, 16384, v40
 v_xor_b32 v41, 0, v39
 v_lshl_add_u32 v5, v41, 4, v40
 v_xor_b32 v41, 4, v39
 v_lshl_add_u32 v6, v41, 4, v40
 v_xor_b32 v41, 8, v39
 v_lshl_add_u32 v7, v41, 4, v40
 v_xor_b32 v41, 12, v39
 v_lshl_add_u32 v8, v41, 4, v40
 v_lshrrev_b32 v39, 2, v46
 v_and_b32 v40, 7, v39
 v_lshlrev_b32 v40, 1, v40
 v_lshrrev_b32 v41, 3, v39
 v_mul_u32_u24 v41, 9, v41
 v_xor_b32 v40, v40, v41
 v_and_b32 v41, 3, v46
 v_xor_b32 v42, v40, v41
 v_lshlrev_b32 v43, 8, v39
 v_xor_b32 v44, 0, v42
 v_lshl_add_u32 v29, v44, 4, v43
 v_xor_b32 v44, 4, v42
 v_lshl_add_u32 v30, v44, 4, v43
 v_xor_b32 v44, 8, v42
 v_lshl_add_u32 v31, v44, 4, v43
 v_xor_b32 v44, 12, v42
 v_lshl_add_u32 v32, v44, 4, v43
 v_bfe_u32 v41, v46, 1, 1
 v_xor_b32 v42, v40, v41
 v_and_b32 v44, 1, v46
 v_lshl_add_u32 v43, v44, 3, v43
 v_add_u32 v43, 98304, v43
 v_xor_b32 v45, 0, v42
 v_lshl_add_u32 v9, v45, 4, v43
 v_xor_b32 v45, 2, v42
 v_lshl_add_u32 v10, v45, 4, v43
 v_xor_b32 v45, 4, v42
 v_lshl_add_u32 v11, v45, 4, v43
 v_xor_b32 v45, 6, v42
 v_lshl_add_u32 v12, v45, 4, v43
 v_xor_b32 v45, 8, v42
 v_lshl_add_u32 v13, v45, 4, v43
 v_xor_b32 v45, 10, v42
 v_lshl_add_u32 v14, v45, 4, v43
 v_xor_b32 v45, 12, v42
 v_lshl_add_u32 v15, v45, 4, v43
 v_xor_b32 v45, 14, v42
 v_lshl_add_u32 v16, v45, 4, v43
 v_and_b32 v40, 6, v39
 v_xor_b32 v42, v40, v41
 v_lshlrev_b32 v43, 7, v39
 v_lshl_add_u32 v43, v44, 3, v43
 v_add_u32 v43, 81920, v43
 v_xor_b32 v45, 0, v42
 v_lshl_add_u32 v33, v45, 4, v43
 v_xor_b32 v45, 2, v42
 v_lshl_add_u32 v34, v45, 4, v43
 v_xor_b32 v45, 4, v42
 v_lshl_add_u32 v35, v45, 4, v43
 v_xor_b32 v45, 6, v42
 v_lshl_add_u32 v36, v45, 4, v43
 v_mov_b32 v41, 0xaaaaaaaa
 v_mul_lo_u32 v40, v44, v41
 v_add_u32 v17, 0x44444444, v40
 v_mov_b32 v41, 0x3f803f80
 v_cmp_gt_u32 vcc, 2, v38
 s_nop 1
 v_cndmask_b32 v41, 0, v41, vcc
 v_accvgpr_write_b32 a224, v41
 v_accvgpr_write_b32 a225, v41
 v_accvgpr_write_b32 a226, v41
 v_accvgpr_write_b32 a227, v41
 v_mov_b32 v48, 0
 v_mov_b32 v49, 0
 v_mov_b32 v50, 0
 v_mov_b32 v51, 0
 v_mov_b32 v52, 0
 v_mov_b32 v53, 0
 v_mov_b32 v54, 0
 v_mov_b32 v55, 0
 v_mov_b32 v56, 0
 v_mov_b32 v57, 0
 v_mov_b32 v58, 0
 v_mov_b32 v59, 0
 v_mov_b32 v60, 0
 v_mov_b32 v61, 0
 v_mov_b32 v62, 0
 v_mov_b32 v63, 0
 v_pk_mov_b32 v[128:129], v[48:49], v[48:49]
 v_pk_mov_b32 v[130:131], v[48:49], v[48:49]
 v_pk_mov_b32 v[132:133], v[48:49], v[48:49]
 v_pk_mov_b32 v[134:135], v[48:49], v[48:49]
 v_pk_mov_b32 v[136:137], v[48:49], v[48:49]
 v_pk_mov_b32 v[138:139], v[48:49], v[48:49]
 v_pk_mov_b32 v[140:141], v[48:49], v[48:49]
 v_pk_mov_b32 v[142:143], v[48:49], v[48:49]
 v_pk_mov_b32 v[144:145], v[48:49], v[48:49]
 v_pk_mov_b32 v[146:147], v[48:49], v[48:49]
 v_pk_mov_b32 v[148:149], v[48:49], v[48:49]
 v_pk_mov_b32 v[150:151], v[48:49], v[48:49]
 v_pk_mov_b32 v[152:153], v[48:49], v[48:49]
 v_pk_mov_b32 v[154:155], v[48:49], v[48:49]
 v_pk_mov_b32 v[156:157], v[48:49], v[48:49]
 v_pk_mov_b32 v[158:159], v[48:49], v[48:49]
 v_pk_mov_b32 v[160:161], v[48:49], v[48:49]
 v_pk_mov_b32 v[162:163], v[48:49], v[48:49]
 v_pk_mov_b32 v[164:165], v[48:49], v[48:49]
 v_pk_mov_b32 v[166:167], v[48:49], v[48:49]
 v_pk_mov_b32 v[168:169], v[48:49], v[48:49]
 v_pk_mov_b32 v[170:171], v[48:49], v[48:49]
 v_pk_mov_b32 v[172:173], v[48:49], v[48:49]
 v_pk_mov_b32 v[174:175], v[48:49], v[48:49]
 v_pk_mov_b32 v[176:177], v[48:49], v[48:49]
 v_pk_mov_b32 v[178:179], v[48:49], v[48:49]
 v_pk_mov_b32 v[180:181], v[48:49], v[48:49]
 v_pk_mov_b32 v[182:183], v[48:49], v[48:49]
 v_pk_mov_b32 v[184:185], v[48:49], v[48:49]
 v_pk_mov_b32 v[186:187], v[48:49], v[48:49]
 v_pk_mov_b32 v[188:189], v[48:49], v[48:49]
 v_pk_mov_b32 v[190:191], v[48:49], v[48:49]
 v_pk_mov_b32 v[192:193], v[48:49], v[48:49]
 v_pk_mov_b32 v[194:195], v[48:49], v[48:49]
 v_pk_mov_b32 v[196:197], v[48:49], v[48:49]
 v_pk_mov_b32 v[198:199], v[48:49], v[48:49]
 v_pk_mov_b32 v[200:201], v[48:49], v[48:49]
 v_pk_mov_b32 v[202:203], v[48:49], v[48:49]
 v_pk_mov_b32 v[204:205], v[48:49], v[48:49]
 v_pk_mov_b32 v[206:207], v[48:49], v[48:49]
 v_pk_mov_b32 v[208:209], v[48:49], v[48:49]
 v_pk_mov_b32 v[210:211], v[48:49], v[48:49]
 v_pk_mov_b32 v[212:213], v[48:49], v[48:49]
 v_pk_mov_b32 v[214:215], v[48:49], v[48:49]
 v_pk_mov_b32 v[216:217], v[48:49], v[48:49]
 v_pk_mov_b32 v[218:219], v[48:49], v[48:49]
 v_pk_mov_b32 v[220:221], v[48:49], v[48:49]
 v_pk_mov_b32 v[222:223], v[48:49], v[48:49]
 v_pk_mov_b32 v[224:225], v[48:49], v[48:49]
 v_pk_mov_b32 v[226:227], v[48:49], v[48:49]
 v_pk_mov_b32 v[228:229], v[48:49], v[48:49]
 v_pk_mov_b32 v[230:231], v[48:49], v[48:49]
 v_pk_mov_b32 v[232:233], v[48:49], v[48:49]
 v_pk_mov_b32 v[234:235], v[48:49], v[48:49]
 v_pk_mov_b32 v[236:237], v[48:49], v[48:49]
 v_pk_mov_b32 v[238:239], v[48:49], v[48:49]
 v_pk_mov_b32 v[240:241], v[48:49], v[48:49]
 v_pk_mov_b32 v[242:243], v[48:49], v[48:49]
 v_pk_mov_b32 v[244:245], v[48:49], v[48:49]
 v_pk_mov_b32 v[246:247], v[48:49], v[48:49]
 v_pk_mov_b32 v[248:249], v[48:49], v[48:49]
 v_pk_mov_b32 v[250:251], v[48:49], v[48:49]
 v_pk_mov_b32 v[252:253], v[48:49], v[48:49]
 v_pk_mov_b32 v[254:255], v[48:49], v[48:49]
 v_pk_mov_b32 v[64:65], v[48:49], v[48:49]
 v_pk_mov_b32 v[66:67], v[48:49], v[48:49]
 v_pk_mov_b32 v[68:69], v[48:49], v[48:49]
 v_pk_mov_b32 v[70:71], v[48:49], v[48:49]
 v_pk_mov_b32 v[72:73], v[48:49], v[48:49]
 v_pk_mov_b32 v[74:75], v[48:49], v[48:49]
 v_pk_mov_b32 v[76:77], v[48:49], v[48:49]
 v_pk_mov_b32 v[78:79], v[48:49], v[48:49]
 v_pk_mov_b32 v[80:81], v[48:49], v[48:49]
 v_pk_mov_b32 v[82:83], v[48:49], v[48:49]
 v_pk_mov_b32 v[84:85], v[48:49], v[48:49]
 v_pk_mov_b32 v[86:87], v[48:49], v[48:49]
 v_pk_mov_b32 v[88:89], v[48:49], v[48:49]
 v_pk_mov_b32 v[90:91], v[48:49], v[48:49]
 v_pk_mov_b32 v[92:93], v[48:49], v[48:49]
 v_pk_mov_b32 v[94:95], v[48:49], v[48:49]
 v_pk_mov_b32 v[96:97], v[48:49], v[48:49]
 v_pk_mov_b32 v[98:99], v[48:49], v[48:49]
 v_pk_mov_b32 v[100:101], v[48:49], v[48:49]
 v_pk_mov_b32 v[102:103], v[48:49], v[48:49]
 v_pk_mov_b32 v[104:105], v[48:49], v[48:49]
 v_pk_mov_b32 v[106:107], v[48:49], v[48:49]
 v_pk_mov_b32 v[108:109], v[48:49], v[48:49]
 v_pk_mov_b32 v[110:111], v[48:49], v[48:49]
 v_pk_mov_b32 v[112:113], v[48:49], v[48:49]
 v_pk_mov_b32 v[114:115], v[48:49], v[48:49]
 v_pk_mov_b32 v[116:117], v[48:49], v[48:49]
 v_pk_mov_b32 v[118:119], v[48:49], v[48:49]
 v_pk_mov_b32 v[120:121], v[48:49], v[48:49]
 v_pk_mov_b32 v[122:123], v[48:49], v[48:49]
 v_pk_mov_b32 v[124:125], v[48:49], v[48:49]
 v_pk_mov_b32 v[126:127], v[48:49], v[48:49]
 v_mfma_f32_16x16x32_bf16 a[64:67], v[48:51], v[48:51], 0
 v_mfma_f32_16x16x32_bf16 a[68:71], v[48:51], v[48:51], 0
 v_mfma_f32_16x16x32_bf16 a[72:75], v[48:51], v[48:51], 0
 v_mfma_f32_16x16x32_bf16 a[76:79], v[48:51], v[48:51], 0
 v_mfma_f32_16x16x32_bf16 a[80:83], v[48:51], v[48:51], 0
 v_mfma_f32_16x16x32_bf16 a[84:87], v[48:51], v[48:51], 0
 v_mfma_f32_16x16x32_bf16 a[88:91], v[48:51], v[48:51], 0
 v_mfma_f32_16x16x32_bf16 a[92:95], v[48:51], v[48:51], 0
 v_mfma_f32_16x16x32_bf16 a[96:99], v[48:51], v[48:51], 0
 v_mfma_f32_16x16x32_bf16 a[100:103], v[48:51], v[48:51], 0
 v_mfma_f32_16x16x32_bf16 a[104:107], v[48:51], v[48:51], 0
 v_mfma_f32_16x16x32_bf16 a[108:111], v[48:51], v[48:51], 0
 v_mfma_f32_16x16x32_bf16 a[112:115], v[48:51], v[48:51], 0
 v_mfma_f32_16x16x32_bf16 a[116:119], v[48:51], v[48:51], 0
 v_mfma_f32_16x16x32_bf16 a[120:123], v[48:51], v[48:51], 0
 v_mfma_f32_16x16x32_bf16 a[124:127], v[48:51], v[48:51], 0
 v_bfe_u32 v40, v18, 4, 5
 v_mul_u32_u24 v40, 32, v40
 s_mov_b32 s4, 0
 s_cmp_lg_u32 s44, 0
 s_cbranch_scc1 mg_seen
mg_poll:
 buffer_load_dwordx2 v[38:39], v40, s[12:15], s89 offen sc1
 s_add_u32 s4, s4, 1
 s_cmp_ge_u32 s4, 0x40000
 s_waitcnt vmcnt(0)
 s_cbranch_scc1 mg_seen
 v_cmp_ne_u64 vcc, s[100:101], v[38:39]
 s_nop 0
 s_cbranch_vccnz mg_poll
mg_seen:
 s_barrier
 s_lshl_b32 s3, s45, 19
 s_add_u32 s8, s66, s3
 s_addc_u32 s9, s67, 0
 s_mov_b32 s10, 524288
 s_mov_b32 s11, 0x00020000
 s_add_u32 s12, s68, s3
 s_addc_u32 s13, s69, 0
 s_mov_b32 s14, 524288
 s_mov_b32 s15, 0x00020000
 buffer_load_dwordx4 a[0:3], v25, s[28:31], s53 offen offset:0 sc1
 buffer_load_dwordx4 a[4:7], v25, s[28:31], s53 offen offset:1024 sc1
 buffer_load_dwordx4 a[8:11], v26, s[28:31], s53 offen offset:0 sc1
 buffer_load_dwordx4 a[12:15], v26, s[28:31], s53 offen offset:1024 sc1
 buffer_load_dwordx4 a[16:19], v27, s[28:31], s53 offen offset:0 sc1
 buffer_load_dwordx4 a[20:23], v27, s[28:31], s53 offen offset:1024 sc1
 buffer_load_dwordx4 a[24:27], v28, s[28:31], s53 offen offset:0 sc1
 buffer_load_dwordx4 a[28:31], v28, s[28:31], s53 offen offset:1024 sc1
 s_add_u32 s53, s53, 2048
 s_add_u32 m0, s47, 49152
 s_nop 0
 buffer_load_dwordx4 v19, s[16:19], s51 offen offset:0 lds
 buffer_load_dwordx4 v20, s[16:19], s51 offen offset:1024 lds
 buffer_load_dwordx4 v21, s[16:19], s51 offen offset:2048 lds
 buffer_load_dwordx4 v22, s[16:19], s51 offen offset:3072 lds
 s_add_u32 s51, s51, 524288
 s_add_u32 m0, s48, 131072
 s_nop 0
 buffer_load_dwordx4 v23, s[20:23], s52 offen offset:0 lds
 buffer_load_dwordx4 v24, s[20:23], s52 offen offset:1024 lds
 s_add_u32 m0, s48, 139264
 s_nop 0
 buffer_load_dwordx4 v23, s[24:27], s52 offen offset:0 lds
 buffer_load_dwordx4 v24, s[24:27], s52 offen offset:1024 lds
 s_add_u32 s52, s52, 229376
 ds_read_b64_tr_b16 a[192:193], v33 offset:16384
 ds_read_b64_tr_b16 a[194:195], v33 offset:18432
 ds_read_b64_tr_b16 a[196:197], v33 offset:20480
 ds_read_b64_tr_b16 a[198:199], v33 offset:22528
 ds_read_b64_tr_b16 a[200:201], v33 offset:24576
 ds_read_b64_tr_b16 a[202:203], v33 offset:26624
 ds_read_b64_tr_b16 a[204:205], v33 offset:28672
 ds_read_b64_tr_b16 a[206:207], v33 offset:30720
 s_mov_b32 s56, 0
 s_waitcnt lgkmcnt(4)
 s_waitcnt vmcnt(8)
.p2align 3
mg_loop:
mg_loop_:
 v_mfma_f32_16x16x32_bf16 a[64:67], a[192:195], a[0:3], a[64:67]
 ds_read_b64_tr_b16 a[208:209], v34 offset:16384
 ds_read_b64_tr_b16 a[210:211], v34 offset:18432
 v_mfma_f32_16x16x32_bf16 a[64:67], a[196:199], a[4:7], a[64:67]
 buffer_load_dwordx4 a[32:35], v25, s[28:31], s53 offen offset:0 sc1
 v_mfma_f32_16x16x32_bf16 a[68:71], a[196:199], a[12:15], a[68:71]
 ds_read_b64_tr_b16 a[212:213], v34 offset:20480
 ds_read_b64_tr_b16 a[214:215], v34 offset:22528
 v_mfma_f32_16x16x32_bf16 a[68:71], a[192:195], a[8:11], a[68:71]
 v_xor_b32 v33, 0x8000, v33
 v_mfma_f32_16x16x32_bf16 a[72:75], a[192:195], a[16:19], a[72:75]
 v_mfma_f32_16x16x32_bf16 a[72:75], a[196:199], a[20:23], a[72:75]
 v_mfma_f32_16x16x32_bf16 a[76:79], a[196:199], a[28:31], a[76:79]
 buffer_load_dwordx4 a[36:39], v25, s[28:31], s53 offen offset:1024 sc1
 v_mfma_f32_16x16x32_bf16 a[76:79], a[192:195], a[24:27], a[76:79]
 s_waitcnt lgkmcnt(4)
 v_mfma_f32_16x16x32_bf16 v[76:79], a[200:203], a[24:27], v[76:79]
 ds_read_b64_tr_b16 a[216:217], v34 offset:24576
 ds_read_b64_tr_b16 a[218:219], v34 offset:26624
 v_mfma_f32_16x16x32_bf16 v[76:79], a[204:207], a[28:31], v[76:79]
 v_mfma_f32_16x16x32_bf16 v[72:75], a[204:207], a[20:23], v[72:75]
 ds_read_b64_tr_b16 a[220:221], v34 offset:28672
 ds_read_b64_tr_b16 a[222:223], v34 offset:30720
 v_mfma_f32_16x16x32_bf16 v[72:75], a[200:203], a[16:19], v[72:75]
 v_xor_b32 v34, 0x8000, v34
 v_mfma_f32_16x16x32_bf16 v[68:71], a[200:203], a[8:11], v[68:71]
 buffer_load_dwordx4 a[40:43], v26, s[28:31], s53 offen offset:0 sc1
 v_mfma_f32_16x16x32_bf16 v[68:71], a[204:207], a[12:15], v[68:71]
 v_mfma_f32_16x16x32_bf16 v[64:67], a[204:207], a[4:7], v[64:67]
 v_mfma_f32_16x16x32_bf16 v[64:67], a[200:203], a[0:3], v[64:67]
 s_waitcnt lgkmcnt(4)
 v_mfma_f32_16x16x32_bf16 a[80:83], a[208:211], a[0:3], a[80:83]
 ds_read_b64_tr_b16 a[192:193], v35 offset:16384
 ds_read_b64_tr_b16 a[194:195], v35 offset:18432
 v_mfma_f32_16x16x32_bf16 a[80:83], a[212:215], a[4:7], a[80:83]
 buffer_load_dwordx4 a[44:47], v26, s[28:31], s53 offen offset:1024 sc1
 v_mfma_f32_16x16x32_bf16 a[84:87], a[212:215], a[12:15], a[84:87]
 ds_read_b64_tr_b16 a[196:197], v35 offset:20480
 ds_read_b64_tr_b16 a[198:199], v35 offset:22528
 v_mfma_f32_16x16x32_bf16 a[84:87], a[208:211], a[8:11], a[84:87]
 v_mfma_f32_16x16x32_bf16 a[88:91], a[208:211], a[16:19], a[88:91]
 v_mfma_f32_16x16x32_bf16 a[88:91], a[212:215], a[20:23], a[88:91]
 v_mfma_f32_16x16x32_bf16 a[92:95], a[212:215], a[28:31], a[92:95]
 buffer_load_dwordx4 a[48:51], v27, s[28:31], s53 offen offset:0 sc1
 v_mfma_f32_16x16x32_bf16 a[92:95], a[208:211], a[24:27], a[92:95]
 s_waitcnt lgkmcnt(4)
 v_mfma_f32_16x16x32_bf16 v[92:95], a[216:219], a[24:27], v[92:95]
 ds_read_b64_tr_b16 a[200:201], v35 offset:24576
 ds_read_b64_tr_b16 a[202:203], v35 offset:26624
 v_mfma_f32_16x16x32_bf16 v[92:95], a[220:223], a[28:31], v[92:95]
 v_mfma_f32_16x16x32_bf16 v[88:91], a[220:223], a[20:23], v[88:91]
 ds_read_b64_tr_b16 a[204:205], v35 offset:28672
 ds_read_b64_tr_b16 a[206:207], v35 offset:30720
 v_mfma_f32_16x16x32_bf16 v[88:91], a[216:219], a[16:19], v[88:91]
 v_xor_b32 v35, 0x8000, v35
 v_mfma_f32_16x16x32_bf16 v[84:87], a[216:219], a[8:11], v[84:87]
 buffer_load_dwordx4 a[52:55], v27, s[28:31], s53 offen offset:1024 sc1
 v_mfma_f32_16x16x32_bf16 v[84:87], a[220:223], a[12:15], v[84:87]
 v_mfma_f32_16x16x32_bf16 v[80:83], a[220:223], a[4:7], v[80:83]
 v_mfma_f32_16x16x32_bf16 v[80:83], a[216:219], a[0:3], v[80:83]
 s_waitcnt lgkmcnt(4)
 v_mfma_f32_16x16x32_bf16 a[96:99], a[192:195], a[0:3], a[96:99]
 ds_read_b64_tr_b16 a[208:209], v36 offset:16384
 ds_read_b64_tr_b16 a[210:211], v36 offset:18432
 v_mfma_f32_16x16x32_bf16 a[96:99], a[196:199], a[4:7], a[96:99]
 buffer_load_dwordx4 a[56:59], v28, s[28:31], s53 offen offset:0 sc1
 v_mfma_f32_16x16x32_bf16 a[100:103], a[196:199], a[12:15], a[100:103]
 ds_read_b64_tr_b16 a[212:213], v36 offset:20480
 ds_read_b64_tr_b16 a[214:215], v36 offset:22528
 v_mfma_f32_16x16x32_bf16 a[100:103], a[192:195], a[8:11], a[100:103]
 v_mfma_f32_16x16x32_bf16 a[104:107], a[192:195], a[16:19], a[104:107]
 v_mfma_f32_16x16x32_bf16 a[104:107], a[196:199], a[20:23], a[104:107]
 v_mfma_f32_16x16x32_bf16 a[108:111], a[196:199], a[28:31], a[108:111]
 buffer_load_dwordx4 a[60:63], v28, s[28:31], s53 offen offset:1024 sc1
 v_mfma_f32_16x16x32_bf16 a[108:111], a[192:195], a[24:27], a[108:111]
 s_waitcnt lgkmcnt(4)
 s_add_u32 s53, s53, 2048
 v_mfma_f32_16x16x32_bf16 v[108:111], a[200:203], a[24:27], v[108:111]
 ds_read_b64_tr_b16 a[216:217], v36 offset:24576
 ds_read_b64_tr_b16 a[218:219], v36 offset:26624
 v_mfma_f32_16x16x32_bf16 v[108:111], a[204:207], a[28:31], v[108:111]
 v_mfma_f32_16x16x32_bf16 v[104:107], a[204:207], a[20:23], v[104:107]
 ds_read_b64_tr_b16 a[220:221], v36 offset:28672
 ds_read_b64_tr_b16 a[222:223], v36 offset:30720
 v_mfma_f32_16x16x32_bf16 v[104:107], a[200:203], a[16:19], v[104:107]
 v_xor_b32 v36, 0x8000, v36
 v_mfma_f32_16x16x32_bf16 v[100:103], a[200:203], a[8:11], v[100:103]
 v_mfma_f32_16x16x32_bf16 v[100:103], a[204:207], a[12:15], v[100:103]
 v_mfma_f32_16x16x32_bf16 v[96:99], a[204:207], a[4:7], v[96:99]
 v_mfma_f32_16x16x32_bf16 v[96:99], a[200:203], a[0:3], v[96:99]
 s_waitcnt lgkmcnt(4)
 v_mfma_f32_16x16x32_bf16 a[112:115], a[208:211], a[0:3], a[112:115]
 ds_read_b64_tr_b16 a[192:193], v29 offset:16384
 ds_read_b64_tr_b16 a[194:195], v29 offset:20480
 v_mfma_f32_16x16x32_bf16 a[112:115], a[212:215], a[4:7], a[112:115]
 v_mfma_f32_16x16x32_bf16 a[116:119], a[212:215], a[12:15], a[116:119]
 ds_read_b64_tr_b16 a[196:197], v29 offset:24576
 ds_read_b64_tr_b16 a[198:199], v29 offset:28672
 v_mfma_f32_16x16x32_bf16 a[116:119], a[208:211], a[8:11], a[116:119]
 v_mfma_f32_16x16x32_bf16 a[120:123], a[208:211], a[16:19], a[120:123]
 v_mfma_f32_16x16x32_bf16 a[120:123], a[212:215], a[20:23], a[120:123]
 v_mfma_f32_16x16x32_bf16 a[124:127], a[212:215], a[28:31], a[124:127]
 v_mfma_f32_16x16x32_bf16 a[124:127], a[208:211], a[24:27], a[124:127]
 s_waitcnt lgkmcnt(4)
 v_mfma_f32_16x16x32_bf16 v[124:127], a[216:219], a[24:27], v[124:127]
 ds_read_b64_tr_b16 a[200:201], v29 offset:16392
 ds_read_b64_tr_b16 a[202:203], v29 offset:20488
 v_mfma_f32_16x16x32_bf16 v[124:127], a[220:223], a[28:31], v[124:127]
 v_mfma_f32_16x16x32_bf16 v[120:123], a[220:223], a[20:23], v[120:123]
 ds_read_b64_tr_b16 a[204:205], v29 offset:24584
 ds_read_b64_tr_b16 a[206:207], v29 offset:28680
 v_mfma_f32_16x16x32_bf16 v[120:123], a[216:219], a[16:19], v[120:123]
 v_xor_b32 v29, 0x8000, v29
 v_mfma_f32_16x16x32_bf16 v[116:119], a[216:219], a[8:11], v[116:119]
 v_mfma_f32_16x16x32_bf16 v[116:119], a[220:223], a[12:15], v[116:119]
 v_mfma_f32_16x16x32_bf16 v[112:115], a[220:223], a[4:7], v[112:115]
 v_mfma_f32_16x16x32_bf16 v[112:115], a[216:219], a[0:3], v[112:115]
 s_waitcnt lgkmcnt(4)
 v_mfma_f32_16x16x32_bf16 v[192:195], a[192:195], a[0:3], v[192:195]
 s_barrier
 ds_read_b64_tr_b16 a[208:209], v30 offset:16384
 ds_read_b64_tr_b16 a[210:211], v30 offset:20480
 v_mfma_f32_16x16x32_bf16 v[192:195], a[196:199], a[4:7], v[192:195]
 v_mfma_f32_16x16x32_bf16 v[196:199], a[196:199], a[12:15], v[196:199]
 ds_read_b64_tr_b16 a[212:213], v30 offset:24576
 ds_read_b64_tr_b16 a[214:215], v30 offset:28672
 v_mfma_f32_16x16x32_bf16 v[196:199], a[192:195], a[8:11], v[196:199]
 s_mov_b32 m0, s54
 v_mfma_f32_16x16x32_bf16 v[200:203], a[192:195], a[16:19], v[200:203]
 buffer_load_dwordx4 v19, s[16:19], s51 offen offset:0 lds
 v_mfma_f32_16x16x32_bf16 v[200:203], a[196:199], a[20:23], v[200:203]
 v_mfma_f32_16x16x32_bf16 v[204:207], a[196:199], a[28:31], v[204:207]
 v_mfma_f32_16x16x32_bf16 v[204:207], a[192:195], a[24:27], v[204:207]
 s_waitcnt lgkmcnt(4)
 v_mfma_f32_16x16x32_bf16 v[140:143], a[200:203], a[24:27], v[140:143]
 ds_read_b64_tr_b16 a[216:217], v30 offset:16392
 ds_read_b64_tr_b16 a[218:219], v30 offset:20488
 v_mfma_f32_16x16x32_bf16 v[140:143], a[204:207], a[28:31], v[140:143]
 v_mfma_f32_16x16x32_bf16 v[136:139], a[204:207], a[20:23], v[136:139]
 ds_read_b64_tr_b16 a[220:221], v30 offset:24584
 ds_read_b64_tr_b16 a[222:223], v30 offset:28680
 v_mfma_f32_16x16x32_bf16 v[136:139], a[200:203], a[16:19], v[136:139]
 buffer_load_dwordx4 v20, s[16:19], s51 offen offset:1024 lds
 v_mfma_f32_16x16x32_bf16 v[132:135], a[200:203], a[8:11], v[132:135]
 v_xor_b32 v30, 0x8000, v30
 v_mfma_f32_16x16x32_bf16 v[132:135], a[204:207], a[12:15], v[132:135]
 v_mfma_f32_16x16x32_bf16 v[128:131], a[204:207], a[4:7], v[128:131]
 v_mfma_f32_16x16x32_bf16 v[128:131], a[200:203], a[0:3], v[128:131]
 s_waitcnt lgkmcnt(4)
 v_mfma_f32_16x16x32_bf16 v[208:211], a[208:211], a[0:3], v[208:211]
 ds_read_b64_tr_b16 a[192:193], v31 offset:16384
 ds_read_b64_tr_b16 a[194:195], v31 offset:20480
 v_mfma_f32_16x16x32_bf16 v[208:211], a[212:215], a[4:7], v[208:211]
 v_mfma_f32_16x16x32_bf16 v[212:215], a[212:215], a[12:15], v[212:215]
 ds_read_b64_tr_b16 a[196:197], v31 offset:24576
 ds_read_b64_tr_b16 a[198:199], v31 offset:28672
 v_mfma_f32_16x16x32_bf16 v[212:215], a[208:211], a[8:11], v[212:215]
 buffer_load_dwordx4 v21, s[16:19], s51 offen offset:2048 lds
 v_mfma_f32_16x16x32_bf16 v[216:219], a[208:211], a[16:19], v[216:219]
 v_mfma_f32_16x16x32_bf16 v[216:219], a[212:215], a[20:23], v[216:219]
 v_mfma_f32_16x16x32_bf16 v[220:223], a[212:215], a[28:31], v[220:223]
 v_mfma_f32_16x16x32_bf16 v[220:223], a[208:211], a[24:27], v[220:223]
 s_waitcnt lgkmcnt(4)
 v_mfma_f32_16x16x32_bf16 v[156:159], a[216:219], a[24:27], v[156:159]
 ds_read_b64_tr_b16 a[200:201], v31 offset:16392
 ds_read_b64_tr_b16 a[202:203], v31 offset:20488
 v_mfma_f32_16x16x32_bf16 v[156:159], a[220:223], a[28:31], v[156:159]
 buffer_load_dwordx4 v22, s[16:19], s51 offen offset:3072 lds
 v_mfma_f32_16x16x32_bf16 v[152:155], a[220:223], a[20:23], v[152:155]
 s_add_u32 s51, s51, 524288
 s_mov_b32 m0, s55
 ds_read_b64_tr_b16 a[204:205], v31 offset:24584
 ds_read_b64_tr_b16 a[206:207], v31 offset:28680
 v_mfma_f32_16x16x32_bf16 v[152:155], a[216:219], a[16:19], v[152:155]
 v_xor_b32 v31, 0x8000, v31
 v_mfma_f32_16x16x32_bf16 v[148:151], a[216:219], a[8:11], v[148:151]
 v_mfma_f32_16x16x32_bf16 v[148:151], a[220:223], a[12:15], v[148:151]
 v_mfma_f32_16x16x32_bf16 v[144:147], a[220:223], a[4:7], v[144:147]
 v_mfma_f32_16x16x32_bf16 v[144:147], a[216:219], a[0:3], v[144:147]
 s_waitcnt lgkmcnt(4)
 v_mfma_f32_16x16x32_bf16 v[224:227], a[192:195], a[0:3], v[224:227]
 ds_read_b64_tr_b16 a[208:209], v32 offset:16384
 ds_read_b64_tr_b16 a[210:211], v32 offset:20480
 v_mfma_f32_16x16x32_bf16 v[224:227], a[196:199], a[4:7], v[224:227]
 buffer_load_dwordx4 v23, s[20:23], s52 offen offset:0 lds
 v_mfma_f32_16x16x32_bf16 v[228:231], a[196:199], a[12:15], v[228:231]
 ds_read_b64_tr_b16 a[212:213], v32 offset:24576
 ds_read_b64_tr_b16 a[214:215], v32 offset:28672
 v_mfma_f32_16x16x32_bf16 v[228:231], a[192:195], a[8:11], v[228:231]
 v_mfma_f32_16x16x32_bf16 v[232:235], a[192:195], a[16:19], v[232:235]
 v_mfma_f32_16x16x32_bf16 v[232:235], a[196:199], a[20:23], v[232:235]
 v_mfma_f32_16x16x32_bf16 v[236:239], a[196:199], a[28:31], v[236:239]
 v_mfma_f32_16x16x32_bf16 v[236:239], a[192:195], a[24:27], v[236:239]
 s_waitcnt lgkmcnt(4)
 buffer_load_dwordx4 v24, s[20:23], s52 offen offset:1024 lds
 v_mfma_f32_16x16x32_bf16 v[172:175], a[200:203], a[24:27], v[172:175]
 s_add_u32 m0, s55, 8192
 ds_read_b64_tr_b16 a[216:217], v32 offset:16392
 ds_read_b64_tr_b16 a[218:219], v32 offset:20488
 v_mfma_f32_16x16x32_bf16 v[172:175], a[204:207], a[28:31], v[172:175]
 v_mfma_f32_16x16x32_bf16 v[168:171], a[204:207], a[20:23], v[168:171]
 ds_read_b64_tr_b16 a[220:221], v32 offset:24584
 ds_read_b64_tr_b16 a[222:223], v32 offset:28680
 v_mfma_f32_16x16x32_bf16 v[168:171], a[200:203], a[16:19], v[168:171]
 v_xor_b32 v32, 0x8000, v32
 v_mfma_f32_16x16x32_bf16 v[164:167], a[200:203], a[8:11], v[164:167]
 v_mfma_f32_16x16x32_bf16 v[164:167], a[204:207], a[12:15], v[164:167]
 v_mfma_f32_16x16x32_bf16 v[160:163], a[204:207], a[4:7], v[160:163]
 buffer_load_dwordx4 v23, s[24:27], s52 offen offset:0 lds
 v_mfma_f32_16x16x32_bf16 v[160:163], a[200:203], a[0:3], v[160:163]
 s_waitcnt lgkmcnt(4)
 v_mfma_f32_16x16x32_bf16 v[240:243], a[208:211], a[0:3], v[240:243]
 ds_read_b64_tr_b16 a[192:193], v33 offset:0
 ds_read_b64_tr_b16 a[194:195], v33 offset:2048
 v_mfma_f32_16x16x32_bf16 v[240:243], a[212:215], a[4:7], v[240:243]
 v_mfma_f32_16x16x32_bf16 v[244:247], a[212:215], a[12:15], v[244:247]
 ds_read_b64_tr_b16 a[196:197], v33 offset:4096
 ds_read_b64_tr_b16 a[198:199], v33 offset:6144
 v_mfma_f32_16x16x32_bf16 v[244:247], a[208:211], a[8:11], v[244:247]
 v_mfma_f32_16x16x32_bf16 v[248:251], a[208:211], a[16:19], v[248:251]
 v_mfma_f32_16x16x32_bf16 v[248:251], a[212:215], a[20:23], v[248:251]
 buffer_load_dwordx4 v24, s[24:27], s52 offen offset:1024 lds
 v_mfma_f32_16x16x32_bf16 v[252:255], a[212:215], a[28:31], v[252:255]
 s_add_u32 s52, s52, 229376
 s_add_u32 s54, s54, 16384
 s_and_b32 s54, s54, 0xffff
 s_sub_u32 s58, s54, s48
 s_add_u32 s55, s58, 81920
 v_mfma_f32_16x16x32_bf16 v[252:255], a[208:211], a[24:27], v[252:255]
 s_waitcnt lgkmcnt(4)
 v_mfma_f32_16x16x32_bf16 v[188:191], a[216:219], a[24:27], v[188:191]
 ds_read_b64_tr_b16 a[200:201], v33 offset:8192
 ds_read_b64_tr_b16 a[202:203], v33 offset:10240
 v_mfma_f32_16x16x32_bf16 v[188:191], a[220:223], a[28:31], v[188:191]
 v_mfma_f32_16x16x32_bf16 v[184:187], a[220:223], a[20:23], v[184:187]
 ds_read_b64_tr_b16 a[204:205], v33 offset:12288
 ds_read_b64_tr_b16 a[206:207], v33 offset:14336
 v_mfma_f32_16x16x32_bf16 v[184:187], a[216:219], a[16:19], v[184:187]
 v_mfma_f32_16x16x32_bf16 v[180:183], a[216:219], a[8:11], v[180:183]
 v_mfma_f32_16x16x32_bf16 v[180:183], a[220:223], a[12:15], v[180:183]
 v_mfma_f32_16x16x32_bf16 v[176:179], a[220:223], a[4:7], v[176:179]
 s_waitcnt vmcnt(8)
 v_mfma_f32_16x16x32_bf16 v[176:179], a[216:219], a[0:3], v[176:179]
 s_waitcnt lgkmcnt(4)
 v_mfma_f32_16x16x32_bf16 a[64:67], a[192:195], a[32:35], a[64:67]
 ds_read_b64_tr_b16 a[208:209], v34 offset:0
 ds_read_b64_tr_b16 a[210:211], v34 offset:2048
 v_mfma_f32_16x16x32_bf16 a[64:67], a[196:199], a[36:39], a[64:67]
 buffer_load_dwordx4 a[0:3], v25, s[28:31], s53 offen offset:0 sc1
 v_mfma_f32_16x16x32_bf16 a[68:71], a[196:199], a[44:47], a[68:71]
 ds_read_b64_tr_b16 a[212:213], v34 offset:4096
 ds_read_b64_tr_b16 a[214:215], v34 offset:6144
 v_mfma_f32_16x16x32_bf16 a[68:71], a[192:195], a[40:43], a[68:71]
 v_mfma_f32_16x16x32_bf16 a[72:75], a[192:195], a[48:51], a[72:75]
 v_mfma_f32_16x16x32_bf16 a[72:75], a[196:199], a[52:55], a[72:75]
 v_mfma_f32_16x16x32_bf16 a[76:79], a[196:199], a[60:63], a[76:79]
 buffer_load_dwordx4 a[4:7], v25, s[28:31], s53 offen offset:1024 sc1
 v_mfma_f32_16x16x32_bf16 a[76:79], a[192:195], a[56:59], a[76:79]
 s_waitcnt lgkmcnt(4)
 v_mfma_f32_16x16x32_bf16 v[76:79], a[200:203], a[56:59], v[76:79]
 s_add_u32 s56, s56, 1
 ds_read_b64_tr_b16 a[216:217], v34 offset:8192
 ds_read_b64_tr_b16 a[218:219], v34 offset:10240
 v_mfma_f32_16x16x32_bf16 v[76:79], a[204:207], a[60:63], v[76:79]
 v_mfma_f32_16x16x32_bf16 v[72:75], a[204:207], a[52:55], v[72:75]
 ds_read_b64_tr_b16 a[220:221], v34 offset:12288
 ds_read_b64_tr_b16 a[222:223], v34 offset:14336
 v_mfma_f32_16x16x32_bf16 v[72:75], a[200:203], a[48:51], v[72:75]
 v_mfma_f32_16x16x32_bf16 v[68:71], a[200:203], a[40:43], v[68:71]
 buffer_load_dwordx4 a[8:11], v26, s[28:31], s53 offen offset:0 sc1
 v_mfma_f32_16x16x32_bf16 v[68:71], a[204:207], a[44:47], v[68:71]
 v_mfma_f32_16x16x32_bf16 v[64:67], a[204:207], a[36:39], v[64:67]
 v_mfma_f32_16x16x32_bf16 v[64:67], a[200:203], a[32:35], v[64:67]
 s_waitcnt lgkmcnt(4)
 v_mfma_f32_16x16x32_bf16 a[80:83], a[208:211], a[32:35], a[80:83]
 ds_read_b64_tr_b16 a[192:193], v35 offset:0
 ds_read_b64_tr_b16 a[194:195], v35 offset:2048
 v_mfma_f32_16x16x32_bf16 a[80:83], a[212:215], a[36:39], a[80:83]
 buffer_load_dwordx4 a[12:15], v26, s[28:31], s53 offen offset:1024 sc1
 v_mfma_f32_16x16x32_bf16 a[84:87], a[212:215], a[44:47], a[84:87]
 ds_read_b64_tr_b16 a[196:197], v35 offset:4096
 ds_read_b64_tr_b16 a[198:199], v35 offset:6144
 v_mfma_f32_16x16x32_bf16 a[84:87], a[208:211], a[40:43], a[84:87]
 v_mfma_f32_16x16x32_bf16 a[88:91], a[208:211], a[48:51], a[88:91]
 v_mfma_f32_16x16x32_bf16 a[88:91], a[212:215], a[52:55], a[88:91]
 v_mfma_f32_16x16x32_bf16 a[92:95], a[212:215], a[60:63], a[92:95]
 buffer_load_dwordx4 a[16:19], v27, s[28:31], s53 offen offset:0 sc1
 v_mfma_f32_16x16x32_bf16 a[92:95], a[208:211], a[56:59], a[92:95]
 s_waitcnt lgkmcnt(4)
 v_mfma_f32_16x16x32_bf16 v[92:95], a[216:219], a[56:59], v[92:95]
 ds_read_b64_tr_b16 a[200:201], v35 offset:8192
 ds_read_b64_tr_b16 a[202:203], v35 offset:10240
 v_mfma_f32_16x16x32_bf16 v[92:95], a[220:223], a[60:63], v[92:95]
 v_mfma_f32_16x16x32_bf16 v[88:91], a[220:223], a[52:55], v[88:91]
 ds_read_b64_tr_b16 a[204:205], v35 offset:12288
 ds_read_b64_tr_b16 a[206:207], v35 offset:14336
 v_mfma_f32_16x16x32_bf16 v[88:91], a[216:219], a[48:51], v[88:91]
 v_mfma_f32_16x16x32_bf16 v[84:87], a[216:219], a[40:43], v[84:87]
 buffer_load_dwordx4 a[20:23], v27, s[28:31], s53 offen offset:1024 sc1
 v_mfma_f32_16x16x32_bf16 v[84:87], a[220:223], a[44:47], v[84:87]
 v_mfma_f32_16x16x32_bf16 v[80:83], a[220:223], a[36:39], v[80:83]
 v_mfma_f32_16x16x32_bf16 v[80:83], a[216:219], a[32:35], v[80:83]
 s_waitcnt lgkmcnt(4)
 v_mfma_f32_16x16x32_bf16 a[96:99], a[192:195], a[32:35], a[96:99]
 ds_read_b64_tr_b16 a[208:209], v36 offset:0
 ds_read_b64_tr_b16 a[210:211], v36 offset:2048
 v_mfma_f32_16x16x32_bf16 a[96:99], a[196:199], a[36:39], a[96:99]
 buffer_load_dwordx4 a[24:27], v28, s[28:31], s53 offen offset:0 sc1
 v_mfma_f32_16x16x32_bf16 a[100:103], a[196:199], a[44:47], a[100:103]
 ds_read_b64_tr_b16 a[212:213], v36 offset:4096
 ds_read_b64_tr_b16 a[214:215], v36 offset:6144
 v_mfma_f32_16x16x32_bf16 a[100:103], a[192:195], a[40:43], a[100:103]
 v_mfma_f32_16x16x32_bf16 a[104:107], a[192:195], a[48:51], a[104:107]
 v_mfma_f32_16x16x32_bf16 a[104:107], a[196:199], a[52:55], a[104:107]
 v_mfma_f32_16x16x32_bf16 a[108:111], a[196:199], a[60:63], a[108:111]
 buffer_load_dwordx4 a[28:31], v28, s[28:31], s53 offen offset:1024 sc1
 v_mfma_f32_16x16x32_bf16 a[108:111], a[192:195], a[56:59], a[108:111]
 s_waitcnt lgkmcnt(4)
 s_add_u32 s53, s53, 2048
 v_mfma_f32_16x16x32_bf16 v[108:111], a[200:203], a[56:59], v[108:111]
 ds_read_b64_tr_b16 a[216:217], v36 offset:8192
 ds_read_b64_tr_b16 a[218:219], v36 offset:10240
 v_mfma_f32_16x16x32_bf16 v[108:111], a[204:207], a[60:63], v[108:111]
 v_mfma_f32_16x16x32_bf16 v[104:107], a[204:207], a[52:55], v[104:107]
 ds_read_b64_tr_b16 a[220:221], v36 offset:12288
 ds_read_b64_tr_b16 a[222:223], v36 offset:14336
 v_mfma_f32_16x16x32_bf16 v[104:107], a[200:203], a[48:51], v[104:107]
 v_mfma_f32_16x16x32_bf16 v[100:103], a[200:203], a[40:43], v[100:103]
 v_mfma_f32_16x16x32_bf16 v[100:103], a[204:207], a[44:47], v[100:103]
 v_mfma_f32_16x16x32_bf16 v[96:99], a[204:207], a[36:39], v[96:99]
 v_mfma_f32_16x16x32_bf16 v[96:99], a[200:203], a[32:35], v[96:99]
 s_waitcnt lgkmcnt(4)
 v_mfma_f32_16x16x32_bf16 a[112:115], a[208:211], a[32:35], a[112:115]
 ds_read_b64_tr_b16 a[192:193], v29 offset:0
 ds_read_b64_tr_b16 a[194:195], v29 offset:4096
 v_mfma_f32_16x16x32_bf16 a[112:115], a[212:215], a[36:39], a[112:115]
 v_mfma_f32_16x16x32_bf16 a[116:119], a[212:215], a[44:47], a[116:119]
 ds_read_b64_tr_b16 a[196:197], v29 offset:8192
 ds_read_b64_tr_b16 a[198:199], v29 offset:12288
 v_mfma_f32_16x16x32_bf16 a[116:119], a[208:211], a[40:43], a[116:119]
 v_mfma_f32_16x16x32_bf16 a[120:123], a[208:211], a[48:51], a[120:123]
 v_mfma_f32_16x16x32_bf16 a[120:123], a[212:215], a[52:55], a[120:123]
 v_mfma_f32_16x16x32_bf16 a[124:127], a[212:215], a[60:63], a[124:127]
 v_mfma_f32_16x16x32_bf16 a[124:127], a[208:211], a[56:59], a[124:127]
 s_waitcnt lgkmcnt(4)
 v_mfma_f32_16x16x32_bf16 v[124:127], a[216:219], a[56:59], v[124:127]
 ds_read_b64_tr_b16 a[200:201], v29 offset:8
 ds_read_b64_tr_b16 a[202:203], v29 offset:4104
 v_mfma_f32_16x16x32_bf16 v[124:127], a[220:223], a[60:63], v[124:127]
 v_mfma_f32_16x16x32_bf16 v[120:123], a[220:223], a[52:55], v[120:123]
 ds_read_b64_tr_b16 a[204:205], v29 offset:8200
 ds_read_b64_tr_b16 a[206:207], v29 offset:12296
 v_mfma_f32_16x16x32_bf16 v[120:123], a[216:219], a[48:51], v[120:123]
 v_mfma_f32_16x16x32_bf16 v[116:119], a[216:219], a[40:43], v[116:119]
 v_mfma_f32_16x16x32_bf16 v[116:119], a[220:223], a[44:47], v[116:119]
 v_mfma_f32_16x16x32_bf16 v[112:115], a[220:223], a[36:39], v[112:115]
 v_mfma_f32_16x16x32_bf16 v[112:115], a[216:219], a[32:35], v[112:115]
 s_waitcnt lgkmcnt(4)
 v_mfma_f32_16x16x32_bf16 v[192:195], a[192:195], a[32:35], v[192:195]
 s_barrier
 ds_read_b64_tr_b16 a[208:209], v30 offset:0
 ds_read_b64_tr_b16 a[210:211], v30 offset:4096
 v_mfma_f32_16x16x32_bf16 v[192:195], a[196:199], a[36:39], v[192:195]
 v_mfma_f32_16x16x32_bf16 v[196:199], a[196:199], a[44:47], v[196:199]
 ds_read_b64_tr_b16 a[212:213], v30 offset:8192
 ds_read_b64_tr_b16 a[214:215], v30 offset:12288
 v_mfma_f32_16x16x32_bf16 v[196:199], a[192:195], a[40:43], v[196:199]
 s_mov_b32 m0, s54
 v_mfma_f32_16x16x32_bf16 v[200:203], a[192:195], a[48:51], v[200:203]
 buffer_load_dwordx4 v19, s[16:19], s51 offen offset:0 lds
 v_mfma_f32_16x16x32_bf16 v[200:203], a[196:199], a[52:55], v[200:203]
 v_mfma_f32_16x16x32_bf16 v[204:207], a[196:199], a[60:63], v[204:207]
 v_mfma_f32_16x16x32_bf16 v[204:207], a[192:195], a[56:59], v[204:207]
 s_waitcnt lgkmcnt(4)
 v_mfma_f32_16x16x32_bf16 v[140:143], a[200:203], a[56:59], v[140:143]
 ds_read_b64_tr_b16 a[216:217], v30 offset:8
 ds_read_b64_tr_b16 a[218:219], v30 offset:4104
 v_mfma_f32_16x16x32_bf16 v[140:143], a[204:207], a[60:63], v[140:143]
 v_mfma_f32_16x16x32_bf16 v[136:139], a[204:207], a[52:55], v[136:139]
 ds_read_b64_tr_b16 a[220:221], v30 offset:8200
 ds_read_b64_tr_b16 a[222:223], v30 offset:12296
 v_mfma_f32_16x16x32_bf16 v[136:139], a[200:203], a[48:51], v[136:139]
 buffer_load_dwordx4 v20, s[16:19], s51 offen offset:1024 lds
 v_mfma_f32_16x16x32_bf16 v[132:135], a[200:203], a[40:43], v[132:135]
 v_mfma_f32_16x16x32_bf16 v[132:135], a[204:207], a[44:47], v[132:135]
 v_mfma_f32_16x16x32_bf16 v[128:131], a[204:207], a[36:39], v[128:131]
 v_mfma_f32_16x16x32_bf16 v[128:131], a[200:203], a[32:35], v[128:131]
 s_waitcnt lgkmcnt(4)
 v_mfma_f32_16x16x32_bf16 v[208:211], a[208:211], a[32:35], v[208:211]
 ds_read_b64_tr_b16 a[192:193], v31 offset:0
 ds_read_b64_tr_b16 a[194:195], v31 offset:4096
 v_mfma_f32_16x16x32_bf16 v[208:211], a[212:215], a[36:39], v[208:211]
 v_mfma_f32_16x16x32_bf16 v[212:215], a[212:215], a[44:47], v[212:215]
 ds_read_b64_tr_b16 a[196:197], v31 offset:8192
 ds_read_b64_tr_b16 a[198:199], v31 offset:12288
 v_mfma_f32_16x16x32_bf16 v[212:215], a[208:211], a[40:43], v[212:215]
 buffer_load_dwordx4 v21, s[16:19], s51 offen offset:2048 lds
 v_mfma_f32_16x16x32_bf16 v[216:219], a[208:211], a[48:51], v[216:219]
 v_mfma_f32_16x16x32_bf16 v[216:219], a[212:215], a[52:55], v[216:219]
 v_mfma_f32_16x16x32_bf16 v[220:223], a[212:215], a[60:63], v[220:223]
 v_mfma_f32_16x16x32_bf16 v[220:223], a[208:211], a[56:59], v[220:223]
 s_waitcnt lgkmcnt(4)
 v_mfma_f32_16x16x32_bf16 v[156:159], a[216:219], a[56:59], v[156:159]
 ds_read_b64_tr_b16 a[200:201], v31 offset:8
 ds_read_b64_tr_b16 a[202:203], v31 offset:4104
 v_mfma_f32_16x16x32_bf16 v[156:159], a[220:223], a[60:63], v[156:159]
 buffer_load_dwordx4 v22, s[16:19], s51 offen offset:3072 lds
 v_mfma_f32_16x16x32_bf16 v[152:155], a[220:223], a[52:55], v[152:155]
 s_add_u32 s51, s51, 524288
 s_mov_b32 m0, s55
 ds_read_b64_tr_b16 a[204:205], v31 offset:8200
 ds_read_b64_tr_b16 a[206:207], v31 offset:12296
 v_mfma_f32_16x16x32_bf16 v[152:155], a[216:219], a[48:51], v[152:155]
 v_mfma_f32_16x16x32_bf16 v[148:151], a[216:219], a[40:43], v[148:151]
 v_mfma_f32_16x16x32_bf16 v[148:151], a[220:223], a[44:47], v[148:151]
 v_mfma_f32_16x16x32_bf16 v[144:147], a[220:223], a[36:39], v[144:147]
 v_mfma_f32_16x16x32_bf16 v[144:147], a[216:219], a[32:35], v[144:147]
 s_waitcnt lgkmcnt(4)
 v_mfma_f32_16x16x32_bf16 v[224:227], a[192:195], a[32:35], v[224:227]
 ds_read_b64_tr_b16 a[208:209], v32 offset:0
 ds_read_b64_tr_b16 a[210:211], v32 offset:4096
 v_mfma_f32_16x16x32_bf16 v[224:227], a[196:199], a[36:39], v[224:227]
 buffer_load_dwordx4 v23, s[20:23], s52 offen offset:0 lds
 v_mfma_f32_16x16x32_bf16 v[228:231], a[196:199], a[44:47], v[228:231]
 ds_read_b64_tr_b16 a[212:213], v32 offset:8192
 ds_read_b64_tr_b16 a[214:215], v32 offset:12288
 v_mfma_f32_16x16x32_bf16 v[228:231], a[192:195], a[40:43], v[228:231]
 v_mfma_f32_16x16x32_bf16 v[232:235], a[192:195], a[48:51], v[232:235]
 v_mfma_f32_16x16x32_bf16 v[232:235], a[196:199], a[52:55], v[232:235]
 v_mfma_f32_16x16x32_bf16 v[236:239], a[196:199], a[60:63], v[236:239]
 v_mfma_f32_16x16x32_bf16 v[236:239], a[192:195], a[56:59], v[236:239]
 s_waitcnt lgkmcnt(4)
 buffer_load_dwordx4 v24, s[20:23], s52 offen offset:1024 lds
 v_mfma_f32_16x16x32_bf16 v[172:175], a[200:203], a[56:59], v[172:175]
 s_add_u32 m0, s55, 8192
 ds_read_b64_tr_b16 a[216:217], v32 offset:8
 ds_read_b64_tr_b16 a[218:219], v32 offset:4104
 v_mfma_f32_16x16x32_bf16 v[172:175], a[204:207], a[60:63], v[172:175]
 v_mfma_f32_16x16x32_bf16 v[168:171], a[204:207], a[52:55], v[168:171]
 ds_read_b64_tr_b16 a[220:221], v32 offset:8200
 ds_read_b64_tr_b16 a[222:223], v32 offset:12296
 v_mfma_f32_16x16x32_bf16 v[168:171], a[200:203], a[48:51], v[168:171]
 v_mfma_f32_16x16x32_bf16 v[164:167], a[200:203], a[40:43], v[164:167]
 v_mfma_f32_16x16x32_bf16 v[164:167], a[204:207], a[44:47], v[164:167]
 v_mfma_f32_16x16x32_bf16 v[160:163], a[204:207], a[36:39], v[160:163]
 buffer_load_dwordx4 v23, s[24:27], s52 offen offset:0 lds
 v_mfma_f32_16x16x32_bf16 v[160:163], a[200:203], a[32:35], v[160:163]
 s_waitcnt lgkmcnt(4)
 v_mfma_f32_16x16x32_bf16 v[240:243], a[208:211], a[32:35], v[240:243]
 ds_read_b64_tr_b16 a[192:193], v33 offset:16384
 ds_read_b64_tr_b16 a[194:195], v33 offset:18432
 v_mfma_f32_16x16x32_bf16 v[240:243], a[212:215], a[36:39], v[240:243]
 v_mfma_f32_16x16x32_bf16 v[244:247], a[212:215], a[44:47], v[244:247]
 ds_read_b64_tr_b16 a[196:197], v33 offset:20480
 ds_read_b64_tr_b16 a[198:199], v33 offset:22528
 v_mfma_f32_16x16x32_bf16 v[244:247], a[208:211], a[40:43], v[244:247]
 v_mfma_f32_16x16x32_bf16 v[248:251], a[208:211], a[48:51], v[248:251]
 v_mfma_f32_16x16x32_bf16 v[248:251], a[212:215], a[52:55], v[248:251]
 buffer_load_dwordx4 v24, s[24:27], s52 offen offset:1024 lds
 v_mfma_f32_16x16x32_bf16 v[252:255], a[212:215], a[60:63], v[252:255]
 s_add_u32 s52, s52, 229376
 s_add_u32 s54, s54, 16384
 s_and_b32 s54, s54, 0xffff
 s_sub_u32 s58, s54, s48
 s_add_u32 s55, s58, 81920
 v_mfma_f32_16x16x32_bf16 v[252:255], a[208:211], a[56:59], v[252:255]
 s_waitcnt lgkmcnt(4)
 v_mfma_f32_16x16x32_bf16 v[188:191], a[216:219], a[56:59], v[188:191]
 ds_read_b64_tr_b16 a[200:201], v33 offset:24576
 ds_read_b64_tr_b16 a[202:203], v33 offset:26624
 v_mfma_f32_16x16x32_bf16 v[188:191], a[220:223], a[60:63], v[188:191]
 v_mfma_f32_16x16x32_bf16 v[184:187], a[220:223], a[52:55], v[184:187]
 ds_read_b64_tr_b16 a[204:205], v33 offset:28672
 ds_read_b64_tr_b16 a[206:207], v33 offset:30720
 v_mfma_f32_16x16x32_bf16 v[184:187], a[216:219], a[48:51], v[184:187]
 v_mfma_f32_16x16x32_bf16 v[180:183], a[216:219], a[40:43], v[180:183]
 v_mfma_f32_16x16x32_bf16 v[180:183], a[220:223], a[44:47], v[180:183]
 v_mfma_f32_16x16x32_bf16 v[176:179], a[220:223], a[36:39], v[176:179]
 s_waitcnt vmcnt(8)
 v_mfma_f32_16x16x32_bf16 v[176:179], a[216:219], a[32:35], v[176:179]
 s_waitcnt lgkmcnt(4)
 s_cmp_lt_u32 s56, 2
 s_cbranch_scc1 mg_loop
mg_tail:
 v_mfma_f32_16x16x32_bf16 a[64:67], a[192:195], a[0:3], a[64:67]
 ds_read_b64_tr_b16 a[208:209], v34 offset:16384
 ds_read_b64_tr_b16 a[210:211], v34 offset:18432
 v_mfma_f32_16x16x32_bf16 a[64:67], a[196:199], a[4:7], a[64:67]
 buffer_load_dwordx4 a[32:35], v25, s[28:31], s53 offen offset:0 sc1
 v_mfma_f32_16x16x32_bf16 a[68:71], a[196:199], a[12:15], a[68:71]
 ds_read_b64_tr_b16 a[212:213], v34 offset:20480
 ds_read_b64_tr_b16 a[214:215], v34 offset:22528
 v_mfma_f32_16x16x32_bf16 a[68:71], a[192:195], a[8:11], a[68:71]
 v_xor_b32 v33, 0x8000, v33
 v_mfma_f32_16x16x32_bf16 a[72:75], a[192:195], a[16:19], a[72:75]
 v_mfma_f32_16x16x32_bf16 a[72:75], a[196:199], a[20:23], a[72:75]
 v_mfma_f32_16x16x32_bf16 a[76:79], a[196:199], a[28:31], a[76:79]
 buffer_load_dwordx4 a[36:39], v25, s[28:31], s53 offen offset:1024 sc1
 v_mfma_f32_16x16x32_bf16 a[76:79], a[192:195], a[24:27], a[76:79]
 s_waitcnt lgkmcnt(4)
 v_mfma_f32_16x16x32_bf16 v[76:79], a[200:203], a[24:27], v[76:79]
 ds_read_b64_tr_b16 a[216:217], v34 offset:24576
 ds_read_b64_tr_b16 a[218:219], v34 offset:26624
 v_mfma_f32_16x16x32_bf16 v[76:79], a[204:207], a[28:31], v[76:79]
 v_mfma_f32_16x16x32_bf16 v[72:75], a[204:207], a[20:23], v[72:75]
 ds_read_b64_tr_b16 a[220:221], v34 offset:28672
 ds_read_b64_tr_b16 a[222:223], v34 offset:30720
 v_mfma_f32_16x16x32_bf16 v[72:75], a[200:203], a[16:19], v[72:75]
 v_xor_b32 v34, 0x8000, v34
 v_mfma_f32_16x16x32_bf16 v[68:71], a[200:203], a[8:11], v[68:71]
 buffer_load_dwordx4 a[40:43], v26, s[28:31], s53 offen offset:0 sc1
 v_mfma_f32_16x16x32_bf16 v[68:71], a[204:207], a[12:15], v[68:71]
 v_mfma_f32_16x16x32_bf16 v[64:67], a[204:207], a[4:7], v[64:67]
 v_mfma_f32_16x16x32_bf16 v[64:67], a[200:203], a[0:3], v[64:67]
 s_waitcnt lgkmcnt(4)
 v_mfma_f32_16x16x32_bf16 a[80:83], a[208:211], a[0:3], a[80:83]
 ds_read_b64_tr_b16 a[192:193], v35 offset:16384
 ds_read_b64_tr_b16 a[194:195], v35 offset:18432
 v_mfma_f32_16x16x32_bf16 a[80:83], a[212:215], a[4:7], a[80:83]
 buffer_load_dwordx4 a[44:47], v26, s[28:31], s53 offen offset:1024 sc1
 v_mfma_f32_16x16x32_bf16 a[84:87], a[212:215], a[12:15], a[84:87]
 ds_read_b64_tr_b16 a[196:197], v35 offset:20480
 ds_read_b64_tr_b16 a[198:199], v35 offset:22528
 v_mfma_f32_16x16x32_bf16 a[84:87], a[208:211], a[8:11], a[84:87]
 v_mfma_f32_16x16x32_bf16 a[88:91], a[208:211], a[16:19], a[88:91]
 v_mfma_f32_16x16x32_bf16 a[88:91], a[212:215], a[20:23], a[88:91]
 v_mfma_f32_16x16x32_bf16 a[92:95], a[212:215], a[28:31], a[92:95]
 buffer_load_dwordx4 a[48:51], v27, s[28:31], s53 offen offset:0 sc1
 v_mfma_f32_16x16x32_bf16 a[92:95], a[208:211], a[24:27], a[92:95]
 s_waitcnt lgkmcnt(4)
 v_mfma_f32_16x16x32_bf16 v[92:95], a[216:219], a[24:27], v[92:95]
 ds_read_b64_tr_b16 a[200:201], v35 offset:24576
 ds_read_b64_tr_b16 a[202:203], v35 offset:26624
 v_mfma_f32_16x16x32_bf16 v[92:95], a[220:223], a[28:31], v[92:95]
 v_mfma_f32_16x16x32_bf16 v[88:91], a[220:223], a[20:23], v[88:91]
 ds_read_b64_tr_b16 a[204:205], v35 offset:28672
 ds_read_b64_tr_b16 a[206:207], v35 offset:30720
 v_mfma_f32_16x16x32_bf16 v[88:91], a[216:219], a[16:19], v[88:91]
 v_xor_b32 v35, 0x8000, v35
 v_mfma_f32_16x16x32_bf16 v[84:87], a[216:219], a[8:11], v[84:87]
 buffer_load_dwordx4 a[52:55], v27, s[28:31], s53 offen offset:1024 sc1
 v_mfma_f32_16x16x32_bf16 v[84:87], a[220:223], a[12:15], v[84:87]
 v_mfma_f32_16x16x32_bf16 v[80:83], a[220:223], a[4:7], v[80:83]
 v_mfma_f32_16x16x32_bf16 v[80:83], a[216:219], a[0:3], v[80:83]
 s_waitcnt lgkmcnt(4)
 v_mfma_f32_16x16x32_bf16 a[96:99], a[192:195], a[0:3], a[96:99]
 ds_read_b64_tr_b16 a[208:209], v36 offset:16384
 ds_read_b64_tr_b16 a[210:211], v36 offset:18432
 v_mfma_f32_16x16x32_bf16 a[96:99], a[196:199], a[4:7], a[96:99]
 buffer_load_dwordx4 a[56:59], v28, s[28:31], s53 offen offset:0 sc1
 v_mfma_f32_16x16x32_bf16 a[100:103], a[196:199], a[12:15], a[100:103]
 ds_read_b64_tr_b16 a[212:213], v36 offset:20480
 ds_read_b64_tr_b16 a[214:215], v36 offset:22528
 v_mfma_f32_16x16x32_bf16 a[100:103], a[192:195], a[8:11], a[100:103]
 v_mfma_f32_16x16x32_bf16 a[104:107], a[192:195], a[16:19], a[104:107]
 v_mfma_f32_16x16x32_bf16 a[104:107], a[196:199], a[20:23], a[104:107]
 v_mfma_f32_16x16x32_bf16 a[108:111], a[196:199], a[28:31], a[108:111]
 buffer_load_dwordx4 a[60:63], v28, s[28:31], s53 offen offset:1024 sc1
 v_mfma_f32_16x16x32_bf16 a[108:111], a[192:195], a[24:27], a[108:111]
 s_waitcnt lgkmcnt(4)
 s_add_u32 s53, s53, 2048
 v_mfma_f32_16x16x32_bf16 v[108:111], a[200:203], a[24:27], v[108:111]
 s_add_u32 m0, s47, 65536
 ds_read_b64_tr_b16 a[216:217], v36 offset:24576
 ds_read_b64_tr_b16 a[218:219], v36 offset:26624
 v_mfma_f32_16x16x32_bf16 v[108:111], a[204:207], a[28:31], v[108:111]
 buffer_load_dwordx4 v1, s[8:11], s49 offen offset:0 lds
 v_mfma_f32_16x16x32_bf16 v[104:107], a[204:207], a[20:23], v[104:107]
 ds_read_b64_tr_b16 a[220:221], v36 offset:28672
 ds_read_b64_tr_b16 a[222:223], v36 offset:30720
 v_mfma_f32_16x16x32_bf16 v[104:107], a[200:203], a[16:19], v[104:107]
 v_xor_b32 v36, 0x8000, v36
 v_mfma_f32_16x16x32_bf16 v[100:103], a[200:203], a[8:11], v[100:103]
 buffer_load_dwordx4 v2, s[8:11], s49 offen offset:1024 lds
 v_mfma_f32_16x16x32_bf16 v[100:103], a[204:207], a[12:15], v[100:103]
 v_mfma_f32_16x16x32_bf16 v[96:99], a[204:207], a[4:7], v[96:99]
 buffer_load_dwordx4 v3, s[8:11], s49 offen offset:2048 lds
 v_mfma_f32_16x16x32_bf16 v[96:99], a[200:203], a[0:3], v[96:99]
 s_waitcnt lgkmcnt(4)
 v_mfma_f32_16x16x32_bf16 a[112:115], a[208:211], a[0:3], a[112:115]
 ds_read_b64_tr_b16 a[192:193], v29 offset:16384
 ds_read_b64_tr_b16 a[194:195], v29 offset:20480
 v_mfma_f32_16x16x32_bf16 a[112:115], a[212:215], a[4:7], a[112:115]
 buffer_load_dwordx4 v4, s[8:11], s49 offen offset:3072 lds
 v_mfma_f32_16x16x32_bf16 a[116:119], a[212:215], a[12:15], a[116:119]
 s_add_u32 s49, s49, 16384
 s_add_u32 m0, s47, 147456
 ds_read_b64_tr_b16 a[196:197], v29 offset:24576
 ds_read_b64_tr_b16 a[198:199], v29 offset:28672
 v_mfma_f32_16x16x32_bf16 a[116:119], a[208:211], a[8:11], a[116:119]
 v_mfma_f32_16x16x32_bf16 a[120:123], a[208:211], a[16:19], a[120:123]
 buffer_load_dwordx4 v1, s[12:15], s50 offen offset:0 lds
 v_mfma_f32_16x16x32_bf16 a[120:123], a[212:215], a[20:23], a[120:123]
 v_mfma_f32_16x16x32_bf16 a[124:127], a[212:215], a[28:31], a[124:127]
 buffer_load_dwordx4 v2, s[12:15], s50 offen offset:1024 lds
 v_mfma_f32_16x16x32_bf16 a[124:127], a[208:211], a[24:27], a[124:127]
 s_waitcnt lgkmcnt(4)
 v_mfma_f32_16x16x32_bf16 v[124:127], a[216:219], a[24:27], v[124:127]
 ds_read_b64_tr_b16 a[200:201], v29 offset:16392
 ds_read_b64_tr_b16 a[202:203], v29 offset:20488
 v_mfma_f32_16x16x32_bf16 v[124:127], a[220:223], a[28:31], v[124:127]
 buffer_load_dwordx4 v3, s[12:15], s50 offen offset:2048 lds
 v_mfma_f32_16x16x32_bf16 v[120:123], a[220:223], a[20:23], v[120:123]
 ds_read_b64_tr_b16 a[204:205], v29 offset:24584
 ds_read_b64_tr_b16 a[206:207], v29 offset:28680
 v_mfma_f32_16x16x32_bf16 v[120:123], a[216:219], a[16:19], v[120:123]
 v_xor_b32 v29, 0x8000, v29
 v_mfma_f32_16x16x32_bf16 v[116:119], a[216:219], a[8:11], v[116:119]
 buffer_load_dwordx4 v4, s[12:15], s50 offen offset:3072 lds
 v_mfma_f32_16x16x32_bf16 v[116:119], a[220:223], a[12:15], v[116:119]
 s_add_u32 s50, s50, 16384
 v_mfma_f32_16x16x32_bf16 v[112:115], a[220:223], a[4:7], v[112:115]
 v_mfma_f32_16x16x32_bf16 v[112:115], a[216:219], a[0:3], v[112:115]
 s_waitcnt lgkmcnt(4)
 v_mfma_f32_16x16x32_bf16 v[192:195], a[192:195], a[0:3], v[192:195]
 s_barrier
 ds_read_b64_tr_b16 a[208:209], v30 offset:16384
 ds_read_b64_tr_b16 a[210:211], v30 offset:20480
 v_mfma_f32_16x16x32_bf16 v[192:195], a[196:199], a[4:7], v[192:195]
 v_mfma_f32_16x16x32_bf16 v[196:199], a[196:199], a[12:15], v[196:199]
 ds_read_b64_tr_b16 a[212:213], v30 offset:24576
 ds_read_b64_tr_b16 a[214:215], v30 offset:28672
 v_mfma_f32_16x16x32_bf16 v[196:199], a[192:195], a[8:11], v[196:199]
 s_mov_b32 m0, s54
 v_mfma_f32_16x16x32_bf16 v[200:203], a[192:195], a[16:19], v[200:203]
 buffer_load_dwordx4 v19, s[16:19], s51 offen offset:0 lds
 v_mfma_f32_16x16x32_bf16 v[200:203], a[196:199], a[20:23], v[200:203]
 v_mfma_f32_16x16x32_bf16 v[204:207], a[196:199], a[28:31], v[204:207]
 v_mfma_f32_16x16x32_bf16 v[204:207], a[192:195], a[24:27], v[204:207]
 s_waitcnt lgkmcnt(4)
 v_mfma_f32_16x16x32_bf16 v[140:143], a[200:203], a[24:27], v[140:143]
 ds_read_b64_tr_b16 a[216:217], v30 offset:16392
 ds_read_b64_tr_b16 a[218:219], v30 offset:20488
 v_mfma_f32_16x16x32_bf16 v[140:143], a[204:207], a[28:31], v[140:143]
 v_mfma_f32_16x16x32_bf16 v[136:139], a[204:207], a[20:23], v[136:139]
 ds_read_b64_tr_b16 a[220:221], v30 offset:24584
 ds_read_b64_tr_b16 a[222:223], v30 offset:28680
 v_mfma_f32_16x16x32_bf16 v[136:139], a[200:203], a[16:19], v[136:139]
 buffer_load_dwordx4 v20, s[16:19], s51 offen offset:1024 lds
 v_mfma_f32_16x16x32_bf16 v[132:135], a[200:203], a[8:11], v[132:135]
 v_xor_b32 v30, 0x8000, v30
 v_mfma_f32_16x16x32_bf16 v[132:135], a[204:207], a[12:15], v[132:135]
 v_mfma_f32_16x16x32_bf16 v[128:131], a[204:207], a[4:7], v[128:131]
 v_mfma_f32_16x16x32_bf16 v[128:131], a[200:203], a[0:3], v[128:131]
 s_waitcnt lgkmcnt(4)
 v_mfma_f32_16x16x32_bf16 v[208:211], a[208:211], a[0:3], v[208:211]
 ds_read_b64_tr_b16 a[192:193], v31 offset:16384
 ds_read_b64_tr_b16 a[194:195], v31 offset:20480
 v_mfma_f32_16x16x32_bf16 v[208:211], a[212:215], a[4:7], v[208:211]
 v_mfma_f32_16x16x32_bf16 v[212:215], a[212:215], a[12:15], v[212:215]
 ds_read_b64_tr_b16 a[196:197], v31 offset:24576
 ds_read_b64_tr_b16 a[198:199], v31 offset:28672
 v_mfma_f32_16x16x32_bf16 v[212:215], a[208:211], a[8:11], v[212:215]
 buffer_load_dwordx4 v21, s[16:19], s51 offen offset:2048 lds
 v_mfma_f32_16x16x32_bf16 v[216:219], a[208:211], a[16:19], v[216:219]
 v_mfma_f32_16x16x32_bf16 v[216:219], a[212:215], a[20:23], v[216:219]
 v_mfma_f32_16x16x32_bf16 v[220:223], a[212:215], a[28:31], v[220:223]
 v_mfma_f32_16x16x32_bf16 v[220:223], a[208:211], a[24:27], v[220:223]
 s_waitcnt lgkmcnt(4)
 v_mfma_f32_16x16x32_bf16 v[156:159], a[216:219], a[24:27], v[156:159]
 ds_read_b64_tr_b16 a[200:201], v31 offset:16392
 ds_read_b64_tr_b16 a[202:203], v31 offset:20488
 v_mfma_f32_16x16x32_bf16 v[156:159], a[220:223], a[28:31], v[156:159]
 buffer_load_dwordx4 v22, s[16:19], s51 offen offset:3072 lds
 v_mfma_f32_16x16x32_bf16 v[152:155], a[220:223], a[20:23], v[152:155]
 s_add_u32 s51, s51, 524288
 s_mov_b32 m0, s55
 ds_read_b64_tr_b16 a[204:205], v31 offset:24584
 ds_read_b64_tr_b16 a[206:207], v31 offset:28680
 v_mfma_f32_16x16x32_bf16 v[152:155], a[216:219], a[16:19], v[152:155]
 v_xor_b32 v31, 0x8000, v31
 v_mfma_f32_16x16x32_bf16 v[148:151], a[216:219], a[8:11], v[148:151]
 v_mfma_f32_16x16x32_bf16 v[148:151], a[220:223], a[12:15], v[148:151]
 v_mfma_f32_16x16x32_bf16 v[144:147], a[220:223], a[4:7], v[144:147]
 v_mfma_f32_16x16x32_bf16 v[144:147], a[216:219], a[0:3], v[144:147]
 s_waitcnt lgkmcnt(4)
 v_mfma_f32_16x16x32_bf16 v[224:227], a[192:195], a[0:3], v[224:227]
 ds_read_b64_tr_b16 a[208:209], v32 offset:16384
 ds_read_b64_tr_b16 a[210:211], v32 offset:20480
 v_mfma_f32_16x16x32_bf16 v[224:227], a[196:199], a[4:7], v[224:227]
 buffer_load_dwordx4 v23, s[20:23], s52 offen offset:0 lds
 v_mfma_f32_16x16x32_bf16 v[228:231], a[196:199], a[12:15], v[228:231]
 ds_read_b64_tr_b16 a[212:213], v32 offset:24576
 ds_read_b64_tr_b16 a[214:215], v32 offset:28672
 v_mfma_f32_16x16x32_bf16 v[228:231], a[192:195], a[8:11], v[228:231]
 v_mfma_f32_16x16x32_bf16 v[232:235], a[192:195], a[16:19], v[232:235]
 v_mfma_f32_16x16x32_bf16 v[232:235], a[196:199], a[20:23], v[232:235]
 v_mfma_f32_16x16x32_bf16 v[236:239], a[196:199], a[28:31], v[236:239]
 v_mfma_f32_16x16x32_bf16 v[236:239], a[192:195], a[24:27], v[236:239]
 s_waitcnt lgkmcnt(4)
 buffer_load_dwordx4 v24, s[20:23], s52 offen offset:1024 lds
 v_mfma_f32_16x16x32_bf16 v[172:175], a[200:203], a[24:27], v[172:175]
 s_add_u32 m0, s55, 8192
 ds_read_b64_tr_b16 a[216:217], v32 offset:16392
 ds_read_b64_tr_b16 a[218:219], v32 offset:20488
 v_mfma_f32_16x16x32_bf16 v[172:175], a[204:207], a[28:31], v[172:175]
 v_mfma_f32_16x16x32_bf16 v[168:171], a[204:207], a[20:23], v[168:171]
 ds_read_b64_tr_b16 a[220:221], v32 offset:24584
 ds_read_b64_tr_b16 a[222:223], v32 offset:28680
 v_mfma_f32_16x16x32_bf16 v[168:171], a[200:203], a[16:19], v[168:171]
 v_xor_b32 v32, 0x8000, v32
 v_mfma_f32_16x16x32_bf16 v[164:167], a[200:203], a[8:11], v[164:167]
 v_mfma_f32_16x16x32_bf16 v[164:167], a[204:207], a[12:15], v[164:167]
 v_mfma_f32_16x16x32_bf16 v[160:163], a[204:207], a[4:7], v[160:163]
 buffer_load_dwordx4 v23, s[24:27], s52 offen offset:0 lds
 v_mfma_f32_16x16x32_bf16 v[160:163], a[200:203], a[0:3], v[160:163]
 s_waitcnt lgkmcnt(4)
 v_mfma_f32_16x16x32_bf16 v[240:243], a[208:211], a[0:3], v[240:243]
 ds_read_b64_tr_b16 a[192:193], v33 offset:0
 ds_read_b64_tr_b16 a[194:195], v33 offset:2048
 v_mfma_f32_16x16x32_bf16 v[240:243], a[212:215], a[4:7], v[240:243]
 v_mfma_f32_16x16x32_bf16 v[244:247], a[212:215], a[12:15], v[244:247]
 ds_read_b64_tr_b16 a[196:197], v33 offset:4096
 ds_read_b64_tr_b16 a[198:199], v33 offset:6144
 v_mfma_f32_16x16x32_bf16 v[244:247], a[208:211], a[8:11], v[244:247]
 v_mfma_f32_16x16x32_bf16 v[248:251], a[208:211], a[16:19], v[248:251]
 v_mfma_f32_16x16x32_bf16 v[248:251], a[212:215], a[20:23], v[248:251]
 buffer_load_dwordx4 v24, s[24:27], s52 offen offset:1024 lds
 v_mfma_f32_16x16x32_bf16 v[252:255], a[212:215], a[28:31], v[252:255]
 s_add_u32 s52, s52, 229376
 s_add_u32 s54, s54, 16384
 s_and_b32 s54, s54, 0xffff
 s_sub_u32 s58, s54, s48
 s_add_u32 s55, s58, 81920
 v_mfma_f32_16x16x32_bf16 v[252:255], a[208:211], a[24:27], v[252:255]
 s_waitcnt lgkmcnt(4)
 v_mfma_f32_16x16x32_bf16 v[188:191], a[216:219], a[24:27], v[188:191]
 ds_read_b64_tr_b16 a[200:201], v33 offset:8192
 ds_read_b64_tr_b16 a[202:203], v33 offset:10240
 v_mfma_f32_16x16x32_bf16 v[188:191], a[220:223], a[28:31], v[188:191]
 v_mfma_f32_16x16x32_bf16 v[184:187], a[220:223], a[20:23], v[184:187]
 ds_read_b64_tr_b16 a[204:205], v33 offset:12288
 ds_read_b64_tr_b16 a[206:207], v33 offset:14336
 v_mfma_f32_16x16x32_bf16 v[184:187], a[216:219], a[16:19], v[184:187]
 v_mfma_f32_16x16x32_bf16 v[180:183], a[216:219], a[8:11], v[180:183]
 v_mfma_f32_16x16x32_bf16 v[180:183], a[220:223], a[12:15], v[180:183]
 v_mfma_f32_16x16x32_bf16 v[176:179], a[220:223], a[4:7], v[176:179]
 s_waitcnt vmcnt(16)
 v_mfma_f32_16x16x32_bf16 v[176:179], a[216:219], a[0:3], v[176:179]
 s_waitcnt lgkmcnt(4)
 v_mfma_f32_16x16x32_bf16 a[64:67], a[192:195], a[32:35], a[64:67]
 ds_read_b64_tr_b16 a[208:209], v34 offset:0
 ds_read_b64_tr_b16 a[210:211], v34 offset:2048
 v_mfma_f32_16x16x32_bf16 a[64:67], a[196:199], a[36:39], a[64:67]
 buffer_load_dwordx4 a[0:3], v25, s[28:31], s53 offen offset:0 sc1
 v_mfma_f32_16x16x32_bf16 a[68:71], a[196:199], a[44:47], a[68:71]
 ds_read_b64_tr_b16 a[212:213], v34 offset:4096
 ds_read_b64_tr_b16 a[214:215], v34 offset:6144
 v_mfma_f32_16x16x32_bf16 a[68:71], a[192:195], a[40:43], a[68:71]
 v_mfma_f32_16x16x32_bf16 a[72:75], a[192:195], a[48:51], a[72:75]
 v_mfma_f32_16x16x32_bf16 a[72:75], a[196:199], a[52:55], a[72:75]
 v_mfma_f32_16x16x32_bf16 a[76:79], a[196:199], a[60:63], a[76:79]
 buffer_load_dwordx4 a[4:7], v25, s[28:31], s53 offen offset:1024 sc1
 v_mfma_f32_16x16x32_bf16 a[76:79], a[192:195], a[56:59], a[76:79]
 s_waitcnt lgkmcnt(4)
 v_mfma_f32_16x16x32_bf16 v[76:79], a[200:203], a[56:59], v[76:79]
 ds_read_b64_tr_b16 a[216:217], v34 offset:8192
 ds_read_b64_tr_b16 a[218:219], v34 offset:10240
 v_mfma_f32_16x16x32_bf16 v[76:79], a[204:207], a[60:63], v[76:79]
 v_mfma_f32_16x16x32_bf16 v[72:75], a[204:207], a[52:55], v[72:75]
 ds_read_b64_tr_b16 a[220:221], v34 offset:12288
 ds_read_b64_tr_b16 a[222:223], v34 offset:14336
 v_mfma_f32_16x16x32_bf16 v[72:75], a[200:203], a[48:51], v[72:75]
 v_mfma_f32_16x16x32_bf16 v[68:71], a[200:203], a[40:43], v[68:71]
 buffer_load_dwordx4 a[8:11], v26, s[28:31], s53 offen offset:0 sc1
 v_mfma_f32_16x16x32_bf16 v[68:71], a[204:207], a[44:47], v[68:71]
 v_mfma_f32_16x16x32_bf16 v[64:67], a[204:207], a[36:39], v[64:67]
 v_mfma_f32_16x16x32_bf16 v[64:67], a[200:203], a[32:35], v[64:67]
 s_waitcnt lgkmcnt(4)
 v_mfma_f32_16x16x32_bf16 a[80:83], a[208:211], a[32:35], a[80:83]
 ds_read_b64_tr_b16 a[192:193], v35 offset:0
 ds_read_b64_tr_b16 a[194:195], v35 offset:2048
 v_mfma_f32_16x16x32_bf16 a[80:83], a[212:215], a[36:39], a[80:83]
 buffer_load_dwordx4 a[12:15], v26, s[28:31], s53 offen offset:1024 sc1
 v_mfma_f32_16x16x32_bf16 a[84:87], a[212:215], a[44:47], a[84:87]
 ds_read_b64_tr_b16 a[196:197], v35 offset:4096
 ds_read_b64_tr_b16 a[198:199], v35 offset:6144
 v_mfma_f32_16x16x32_bf16 a[84:87], a[208:211], a[40:43], a[84:87]
 v_mfma_f32_16x16x32_bf16 a[88:91], a[208:211], a[48:51], a[88:91]
 v_mfma_f32_16x16x32_bf16 a[88:91], a[212:215], a[52:55], a[88:91]
 v_mfma_f32_16x16x32_bf16 a[92:95], a[212:215], a[60:63], a[92:95]
 buffer_load_dwordx4 a[16:19], v27, s[28:31], s53 offen offset:0 sc1
 v_mfma_f32_16x16x32_bf16 a[92:95], a[208:211], a[56:59], a[92:95]
 s_waitcnt lgkmcnt(4)
 v_mfma_f32_16x16x32_bf16 v[92:95], a[216:219], a[56:59], v[92:95]
 ds_read_b64_tr_b16 a[200:201], v35 offset:8192
 ds_read_b64_tr_b16 a[202:203], v35 offset:10240
 v_mfma_f32_16x16x32_bf16 v[92:95], a[220:223], a[60:63], v[92:95]
 v_mfma_f32_16x16x32_bf16 v[88:91], a[220:223], a[52:55], v[88:91]
 ds_read_b64_tr_b16 a[204:205], v35 offset:12288
 ds_read_b64_tr_b16 a[206:207], v35 offset:14336
 v_mfma_f32_16x16x32_bf16 v[88:91], a[216:219], a[48:51], v[88:91]
 v_mfma_f32_16x16x32_bf16 v[84:87], a[216:219], a[40:43], v[84:87]
 buffer_load_dwordx4 a[20:23], v27, s[28:31], s53 offen offset:1024 sc1
 v_mfma_f32_16x16x32_bf16 v[84:87], a[220:223], a[44:47], v[84:87]
 v_mfma_f32_16x16x32_bf16 v[80:83], a[220:223], a[36:39], v[80:83]
 v_mfma_f32_16x16x32_bf16 v[80:83], a[216:219], a[32:35], v[80:83]
 s_waitcnt lgkmcnt(4)
 v_mfma_f32_16x16x32_bf16 a[96:99], a[192:195], a[32:35], a[96:99]
 ds_read_b64_tr_b16 a[208:209], v36 offset:0
 ds_read_b64_tr_b16 a[210:211], v36 offset:2048
 v_mfma_f32_16x16x32_bf16 a[96:99], a[196:199], a[36:39], a[96:99]
 buffer_load_dwordx4 a[24:27], v28, s[28:31], s53 offen offset:0 sc1
 v_mfma_f32_16x16x32_bf16 a[100:103], a[196:199], a[44:47], a[100:103]
 ds_read_b64_tr_b16 a[212:213], v36 offset:4096
 ds_read_b64_tr_b16 a[214:215], v36 offset:6144
 v_mfma_f32_16x16x32_bf16 a[100:103], a[192:195], a[40:43], a[100:103]
 v_mfma_f32_16x16x32_bf16 a[104:107], a[192:195], a[48:51], a[104:107]
 v_mfma_f32_16x16x32_bf16 a[104:107], a[196:199], a[52:55], a[104:107]
 v_mfma_f32_16x16x32_bf16 a[108:111], a[196:199], a[60:63], a[108:111]
 buffer_load_dwordx4 a[28:31], v28, s[28:31], s53 offen offset:1024 sc1
 v_mfma_f32_16x16x32_bf16 a[108:111], a[192:195], a[56:59], a[108:111]
 s_waitcnt lgkmcnt(4)
 s_add_u32 s53, s53, 2048
 v_mfma_f32_16x16x32_bf16 v[108:111], a[200:203], a[56:59], v[108:111]
 ds_read_b64_tr_b16 a[216:217], v36 offset:8192
 ds_read_b64_tr_b16 a[218:219], v36 offset:10240
 v_mfma_f32_16x16x32_bf16 v[108:111], a[204:207], a[60:63], v[108:111]
 v_mfma_f32_16x16x32_bf16 v[104:107], a[204:207], a[52:55], v[104:107]
 ds_read_b64_tr_b16 a[220:221], v36 offset:12288
 ds_read_b64_tr_b16 a[222:223], v36 offset:14336
 v_mfma_f32_16x16x32_bf16 v[104:107], a[200:203], a[48:51], v[104:107]
 v_mfma_f32_16x16x32_bf16 v[100:103], a[200:203], a[40:43], v[100:103]
 v_mfma_f32_16x16x32_bf16 v[100:103], a[204:207], a[44:47], v[100:103]
 v_mfma_f32_16x16x32_bf16 v[96:99], a[204:207], a[36:39], v[96:99]
 v_mfma_f32_16x16x32_bf16 v[96:99], a[200:203], a[32:35], v[96:99]
 s_waitcnt lgkmcnt(4)
 v_mfma_f32_16x16x32_bf16 a[112:115], a[208:211], a[32:35], a[112:115]
 ds_read_b64_tr_b16 a[192:193], v29 offset:0
 ds_read_b64_tr_b16 a[194:195], v29 offset:4096
 v_mfma_f32_16x16x32_bf16 a[112:115], a[212:215], a[36:39], a[112:115]
 v_mfma_f32_16x16x32_bf16 a[116:119], a[212:215], a[44:47], a[116:119]
 ds_read_b64_tr_b16 a[196:197], v29 offset:8192
 ds_read_b64_tr_b16 a[198:199], v29 offset:12288
 v_mfma_f32_16x16x32_bf16 a[116:119], a[208:211], a[40:43], a[116:119]
 v_mfma_f32_16x16x32_bf16 a[120:123], a[208:211], a[48:51], a[120:123]
 v_mfma_f32_16x16x32_bf16 a[120:123], a[212:215], a[52:55], a[120:123]
 v_mfma_f32_16x16x32_bf16 a[124:127], a[212:215], a[60:63], a[124:127]
 v_mfma_f32_16x16x32_bf16 a[124:127], a[208:211], a[56:59], a[124:127]
 s_waitcnt lgkmcnt(4)
 v_mfma_f32_16x16x32_bf16 v[124:127], a[216:219], a[56:59], v[124:127]
 ds_read_b64_tr_b16 a[200:201], v29 offset:8
 ds_read_b64_tr_b16 a[202:203], v29 offset:4104
 v_mfma_f32_16x16x32_bf16 v[124:127], a[220:223], a[60:63], v[124:127]
 v_mfma_f32_16x16x32_bf16 v[120:123], a[220:223], a[52:55], v[120:123]
 ds_read_b64_tr_b16 a[204:205], v29 offset:8200
 ds_read_b64_tr_b16 a[206:207], v29 offset:12296
 v_mfma_f32_16x16x32_bf16 v[120:123], a[216:219], a[48:51], v[120:123]
 v_mfma_f32_16x16x32_bf16 v[116:119], a[216:219], a[40:43], v[116:119]
 v_mfma_f32_16x16x32_bf16 v[116:119], a[220:223], a[44:47], v[116:119]
 v_mfma_f32_16x16x32_bf16 v[112:115], a[220:223], a[36:39], v[112:115]
 v_mfma_f32_16x16x32_bf16 v[112:115], a[216:219], a[32:35], v[112:115]
 s_waitcnt lgkmcnt(4)
 v_mfma_f32_16x16x32_bf16 v[192:195], a[192:195], a[32:35], v[192:195]
 s_barrier
 ds_read_b64_tr_b16 a[208:209], v30 offset:0
 ds_read_b64_tr_b16 a[210:211], v30 offset:4096
 v_mfma_f32_16x16x32_bf16 v[192:195], a[196:199], a[36:39], v[192:195]
 v_mfma_f32_16x16x32_bf16 v[196:199], a[196:199], a[44:47], v[196:199]
 ds_read_b64_tr_b16 a[212:213], v30 offset:8192
 ds_read_b64_tr_b16 a[214:215], v30 offset:12288
 v_mfma_f32_16x16x32_bf16 v[196:199], a[192:195], a[40:43], v[196:199]
 s_add_u32 m0, s47, 16384
 v_mfma_f32_16x16x32_bf16 v[200:203], a[192:195], a[48:51], v[200:203]
 buffer_load_dwordx4 v1, s[8:11], s49 offen offset:0 lds
 v_mfma_f32_16x16x32_bf16 v[200:203], a[196:199], a[52:55], v[200:203]
 v_mfma_f32_16x16x32_bf16 v[204:207], a[196:199], a[60:63], v[204:207]
 v_mfma_f32_16x16x32_bf16 v[204:207], a[192:195], a[56:59], v[204:207]
 s_waitcnt lgkmcnt(4)
 v_mfma_f32_16x16x32_bf16 v[140:143], a[200:203], a[56:59], v[140:143]
 ds_read_b64_tr_b16 a[216:217], v30 offset:8
 ds_read_b64_tr_b16 a[218:219], v30 offset:4104
 v_mfma_f32_16x16x32_bf16 v[140:143], a[204:207], a[60:63], v[140:143]
 buffer_load_dwordx4 v2, s[8:11], s49 offen offset:1024 lds
 v_mfma_f32_16x16x32_bf16 v[136:139], a[204:207], a[52:55], v[136:139]
 ds_read_b64_tr_b16 a[220:221], v30 offset:8200
 ds_read_b64_tr_b16 a[222:223], v30 offset:12296
 v_mfma_f32_16x16x32_bf16 v[136:139], a[200:203], a[48:51], v[136:139]
 v_mfma_f32_16x16x32_bf16 v[132:135], a[200:203], a[40:43], v[132:135]
 v_mfma_f32_16x16x32_bf16 v[132:135], a[204:207], a[44:47], v[132:135]
 v_mfma_f32_16x16x32_bf16 v[128:131], a[204:207], a[36:39], v[128:131]
 buffer_load_dwordx4 v3, s[8:11], s49 offen offset:2048 lds
 v_mfma_f32_16x16x32_bf16 v[128:131], a[200:203], a[32:35], v[128:131]
 s_waitcnt lgkmcnt(4)
 v_mfma_f32_16x16x32_bf16 v[208:211], a[208:211], a[32:35], v[208:211]
 ds_read_b64_tr_b16 a[192:193], v31 offset:0
 ds_read_b64_tr_b16 a[194:195], v31 offset:4096
 v_mfma_f32_16x16x32_bf16 v[208:211], a[212:215], a[36:39], v[208:211]
 v_mfma_f32_16x16x32_bf16 v[212:215], a[212:215], a[44:47], v[212:215]
 ds_read_b64_tr_b16 a[196:197], v31 offset:8192
 ds_read_b64_tr_b16 a[198:199], v31 offset:12288
 v_mfma_f32_16x16x32_bf16 v[212:215], a[208:211], a[40:43], v[212:215]
 v_mfma_f32_16x16x32_bf16 v[216:219], a[208:211], a[48:51], v[216:219]
 buffer_load_dwordx4 v4, s[8:11], s49 offen offset:3072 lds
 v_mfma_f32_16x16x32_bf16 v[216:219], a[212:215], a[52:55], v[216:219]
 s_add_u32 s49, s49, 16384
 s_add_u32 m0, s47, 98304
 v_mfma_f32_16x16x32_bf16 v[220:223], a[212:215], a[60:63], v[220:223]
 v_mfma_f32_16x16x32_bf16 v[220:223], a[208:211], a[56:59], v[220:223]
 s_waitcnt lgkmcnt(4)
 v_mfma_f32_16x16x32_bf16 v[156:159], a[216:219], a[56:59], v[156:159]
 ds_read_b64_tr_b16 a[200:201], v31 offset:8
 ds_read_b64_tr_b16 a[202:203], v31 offset:4104
 v_mfma_f32_16x16x32_bf16 v[156:159], a[220:223], a[60:63], v[156:159]
 buffer_load_dwordx4 v1, s[12:15], s50 offen offset:0 lds
 v_mfma_f32_16x16x32_bf16 v[152:155], a[220:223], a[52:55], v[152:155]
 ds_read_b64_tr_b16 a[204:205], v31 offset:8200
 ds_read_b64_tr_b16 a[206:207], v31 offset:12296
 v_mfma_f32_16x16x32_bf16 v[152:155], a[216:219], a[48:51], v[152:155]
 v_mfma_f32_16x16x32_bf16 v[148:151], a[216:219], a[40:43], v[148:151]
 v_mfma_f32_16x16x32_bf16 v[148:151], a[220:223], a[44:47], v[148:151]
 v_mfma_f32_16x16x32_bf16 v[144:147], a[220:223], a[36:39], v[144:147]
 buffer_load_dwordx4 v2, s[12:15], s50 offen offset:1024 lds
 v_mfma_f32_16x16x32_bf16 v[144:147], a[216:219], a[32:35], v[144:147]
 s_waitcnt lgkmcnt(4)
 v_mfma_f32_16x16x32_bf16 v[224:227], a[192:195], a[32:35], v[224:227]
 ds_read_b64_tr_b16 a[208:209], v32 offset:0
 ds_read_b64_tr_b16 a[210:211], v32 offset:4096
 v_mfma_f32_16x16x32_bf16 v[224:227], a[196:199], a[36:39], v[224:227]
 v_mfma_f32_16x16x32_bf16 v[228:231], a[196:199], a[44:47], v[228:231]
 ds_read_b64_tr_b16 a[212:213], v32 offset:8192
 ds_read_b64_tr_b16 a[214:215], v32 offset:12288
 v_mfma_f32_16x16x32_bf16 v[228:231], a[192:195], a[40:43], v[228:231]
 v_mfma_f32_16x16x32_bf16 v[232:235], a[192:195], a[48:51], v[232:235]
 buffer_load_dwordx4 v3, s[12:15], s50 offen offset:2048 lds
 v_mfma_f32_16x16x32_bf16 v[232:235], a[196:199], a[52:55], v[232:235]
 v_mfma_f32_16x16x32_bf16 v[236:239], a[196:199], a[60:63], v[236:239]
 v_mfma_f32_16x16x32_bf16 v[236:239], a[192:195], a[56:59], v[236:239]
 s_waitcnt lgkmcnt(4)
 v_mfma_f32_16x16x32_bf16 v[172:175], a[200:203], a[56:59], v[172:175]
 ds_read_b64_tr_b16 a[216:217], v32 offset:8
 ds_read_b64_tr_b16 a[218:219], v32 offset:4104
 v_mfma_f32_16x16x32_bf16 v[172:175], a[204:207], a[60:63], v[172:175]
 buffer_load_dwordx4 v4, s[12:15], s50 offen offset:3072 lds
 v_mfma_f32_16x16x32_bf16 v[168:171], a[204:207], a[52:55], v[168:171]
 s_add_u32 s50, s50, 16384
 ds_read_b64_tr_b16 a[220:221], v32 offset:8200
 ds_read_b64_tr_b16 a[222:223], v32 offset:12296
 v_mfma_f32_16x16x32_bf16 v[168:171], a[200:203], a[48:51], v[168:171]
 v_mfma_f32_16x16x32_bf16 v[164:167], a[200:203], a[40:43], v[164:167]
 v_mfma_f32_16x16x32_bf16 v[164:167], a[204:207], a[44:47], v[164:167]
 v_mfma_f32_16x16x32_bf16 v[160:163], a[204:207], a[36:39], v[160:163]
 v_mfma_f32_16x16x32_bf16 v[160:163], a[200:203], a[32:35], v[160:163]
 s_waitcnt lgkmcnt(4)
 v_mfma_f32_16x16x32_bf16 v[240:243], a[208:211], a[32:35], v[240:243]
 ds_read_b64_tr_b16 a[192:193], v33 offset:16384
 ds_read_b64_tr_b16 a[194:195], v33 offset:18432
 v_mfma_f32_16x16x32_bf16 v[240:243], a[212:215], a[36:39], v[240:243]
 v_mfma_f32_16x16x32_bf16 v[244:247], a[212:215], a[44:47], v[244:247]
 ds_read_b64_tr_b16 a[196:197], v33 offset:20480
 ds_read_b64_tr_b16 a[198:199], v33 offset:22528
 v_mfma_f32_16x16x32_bf16 v[244:247], a[208:211], a[40:43], v[244:247]
 v_mfma_f32_16x16x32_bf16 v[248:251], a[208:211], a[48:51], v[248:251]
 v_mfma_f32_16x16x32_bf16 v[248:251], a[212:215], a[52:55], v[248:251]
 v_mfma_f32_16x16x32_bf16 v[252:255], a[212:215], a[60:63], v[252:255]
 v_mfma_f32_16x16x32_bf16 v[252:255], a[208:211], a[56:59], v[252:255]
 s_waitcnt lgkmcnt(4)
 v_mfma_f32_16x16x32_bf16 v[188:191], a[216:219], a[56:59], v[188:191]
 ds_read_b64_tr_b16 a[200:201], v33 offset:24576
 ds_read_b64_tr_b16 a[202:203], v33 offset:26624
 v_mfma_f32_16x16x32_bf16 v[188:191], a[220:223], a[60:63], v[188:191]
 v_mfma_f32_16x16x32_bf16 v[184:187], a[220:223], a[52:55], v[184:187]
 ds_read_b64_tr_b16 a[204:205], v33 offset:28672
 ds_read_b64_tr_b16 a[206:207], v33 offset:30720
 v_mfma_f32_16x16x32_bf16 v[184:187], a[216:219], a[48:51], v[184:187]
 v_mfma_f32_16x16x32_bf16 v[180:183], a[216:219], a[40:43], v[180:183]
 v_mfma_f32_16x16x32_bf16 v[180:183], a[220:223], a[44:47], v[180:183]
 v_mfma_f32_16x16x32_bf16 v[176:179], a[220:223], a[36:39], v[176:179]
 s_waitcnt vmcnt(8)
 v_mfma_f32_16x16x32_bf16 v[176:179], a[216:219], a[32:35], v[176:179]
 s_waitcnt lgkmcnt(4)
 v_mfma_f32_16x16x32_bf16 a[64:67], a[192:195], a[0:3], a[64:67]
 ds_read_b64_tr_b16 a[208:209], v34 offset:16384
 ds_read_b64_tr_b16 a[210:211], v34 offset:18432
 v_mfma_f32_16x16x32_bf16 a[64:67], a[196:199], a[4:7], a[64:67]
 buffer_load_dwordx4 a[32:35], v25, s[28:31], s53 offen offset:0 sc1
 v_mfma_f32_16x16x32_bf16 a[68:71], a[196:199], a[12:15], a[68:71]
 ds_read_b64_tr_b16 a[212:213], v34 offset:20480
 ds_read_b64_tr_b16 a[214:215], v34 offset:22528
 v_mfma_f32_16x16x32_bf16 a[68:71], a[192:195], a[8:11], a[68:71]
 v_xor_b32 v33, 0x8000, v33
 v_mfma_f32_16x16x32_bf16 a[72:75], a[192:195], a[16:19], a[72:75]
 v_mfma_f32_16x16x32_bf16 a[72:75], a[196:199], a[20:23], a[72:75]
 v_mfma_f32_16x16x32_bf16 a[76:79], a[196:199], a[28:31], a[76:79]
 buffer_load_dwordx4 a[36:39], v25, s[28:31], s53 offen offset:1024 sc1
 v_mfma_f32_16x16x32_bf16 a[76:79], a[192:195], a[24:27], a[76:79]
 s_waitcnt lgkmcnt(4)
 v_mfma_f32_16x16x32_bf16 v[76:79], a[200:203], a[24:27], v[76:79]
 ds_read_b64_tr_b16 a[216:217], v34 offset:24576
 ds_read_b64_tr_b16 a[218:219], v34 offset:26624
 v_mfma_f32_16x16x32_bf16 v[76:79], a[204:207], a[28:31], v[76:79]
 v_mfma_f32_16x16x32_bf16 v[72:75], a[204:207], a[20:23], v[72:75]
 ds_read_b64_tr_b16 a[220:221], v34 offset:28672
 ds_read_b64_tr_b16 a[222:223], v34 offset:30720
 v_mfma_f32_16x16x32_bf16 v[72:75], a[200:203], a[16:19], v[72:75]
 v_xor_b32 v34, 0x8000, v34
 v_mfma_f32_16x16x32_bf16 v[68:71], a[200:203], a[8:11], v[68:71]
 buffer_load_dwordx4 a[40:43], v26, s[28:31], s53 offen offset:0 sc1
 v_mfma_f32_16x16x32_bf16 v[68:71], a[204:207], a[12:15], v[68:71]
 v_mfma_f32_16x16x32_bf16 v[64:67], a[204:207], a[4:7], v[64:67]
 v_mfma_f32_16x16x32_bf16 v[64:67], a[200:203], a[0:3], v[64:67]
 s_waitcnt lgkmcnt(4)
 v_mfma_f32_16x16x32_bf16 a[80:83], a[208:211], a[0:3], a[80:83]
 ds_read_b64_tr_b16 a[192:193], v35 offset:16384
 ds_read_b64_tr_b16 a[194:195], v35 offset:18432
 v_mfma_f32_16x16x32_bf16 a[80:83], a[212:215], a[4:7], a[80:83]
 buffer_load_dwordx4 a[44:47], v26, s[28:31], s53 offen offset:1024 sc1
 v_mfma_f32_16x16x32_bf16 a[84:87], a[212:215], a[12:15], a[84:87]
 ds_read_b64_tr_b16 a[196:197], v35 offset:20480
 ds_read_b64_tr_b16 a[198:199], v35 offset:22528
 v_mfma_f32_16x16x32_bf16 a[84:87], a[208:211], a[8:11], a[84:87]
 v_mfma_f32_16x16x32_bf16 a[88:91], a[208:211], a[16:19], a[88:91]
 v_mfma_f32_16x16x32_bf16 a[88:91], a[212:215], a[20:23], a[88:91]
 v_mfma_f32_16x16x32_bf16 a[92:95], a[212:215], a[28:31], a[92:95]
 buffer_load_dwordx4 a[48:51], v27, s[28:31], s53 offen offset:0 sc1
 v_mfma_f32_16x16x32_bf16 a[92:95], a[208:211], a[24:27], a[92:95]
 s_waitcnt lgkmcnt(4)
 v_mfma_f32_16x16x32_bf16 v[92:95], a[216:219], a[24:27], v[92:95]
 ds_read_b64_tr_b16 a[200:201], v35 offset:24576
 ds_read_b64_tr_b16 a[202:203], v35 offset:26624
 v_mfma_f32_16x16x32_bf16 v[92:95], a[220:223], a[28:31], v[92:95]
 v_mfma_f32_16x16x32_bf16 v[88:91], a[220:223], a[20:23], v[88:91]
 ds_read_b64_tr_b16 a[204:205], v35 offset:28672
 ds_read_b64_tr_b16 a[206:207], v35 offset:30720
 v_mfma_f32_16x16x32_bf16 v[88:91], a[216:219], a[16:19], v[88:91]
 v_xor_b32 v35, 0x8000, v35
 v_mfma_f32_16x16x32_bf16 v[84:87], a[216:219], a[8:11], v[84:87]
 buffer_load_dwordx4 a[52:55], v27, s[28:31], s53 offen offset:1024 sc1
 v_mfma_f32_16x16x32_bf16 v[84:87], a[220:223], a[12:15], v[84:87]
 v_mfma_f32_16x16x32_bf16 v[80:83], a[220:223], a[4:7], v[80:83]
 v_mfma_f32_16x16x32_bf16 v[80:83], a[216:219], a[0:3], v[80:83]
 s_waitcnt lgkmcnt(4)
 v_mfma_f32_16x16x32_bf16 a[96:99], a[192:195], a[0:3], a[96:99]
 ds_read_b64_tr_b16 a[208:209], v36 offset:16384
 ds_read_b64_tr_b16 a[210:211], v36 offset:18432
 v_mfma_f32_16x16x32_bf16 a[96:99], a[196:199], a[4:7], a[96:99]
 buffer_load_dwordx4 a[56:59], v28, s[28:31], s53 offen offset:0 sc1
 v_mfma_f32_16x16x32_bf16 a[100:103], a[196:199], a[12:15], a[100:103]
 ds_read_b64_tr_b16 a[212:213], v36 offset:20480
 ds_read_b64_tr_b16 a[214:215], v36 offset:22528
 v_mfma_f32_16x16x32_bf16 a[100:103], a[192:195], a[8:11], a[100:103]
 v_mfma_f32_16x16x32_bf16 a[104:107], a[192:195], a[16:19], a[104:107]
 v_mfma_f32_16x16x32_bf16 a[104:107], a[196:199], a[20:23], a[104:107]
 v_mfma_f32_16x16x32_bf16 a[108:111], a[196:199], a[28:31], a[108:111]
 buffer_load_dwordx4 a[60:63], v28, s[28:31], s53 offen offset:1024 sc1
 v_mfma_f32_16x16x32_bf16 a[108:111], a[192:195], a[24:27], a[108:111]
 s_waitcnt lgkmcnt(4)
 s_add_u32 s53, s53, 2048
 v_mfma_f32_16x16x32_bf16 v[108:111], a[200:203], a[24:27], v[108:111]
 ds_read_b64_tr_b16 a[216:217], v36 offset:24576
 ds_read_b64_tr_b16 a[218:219], v36 offset:26624
 v_mfma_f32_16x16x32_bf16 v[108:111], a[204:207], a[28:31], v[108:111]
 v_mfma_f32_16x16x32_bf16 v[104:107], a[204:207], a[20:23], v[104:107]
 ds_read_b64_tr_b16 a[220:221], v36 offset:28672
 ds_read_b64_tr_b16 a[222:223], v36 offset:30720
 v_mfma_f32_16x16x32_bf16 v[104:107], a[200:203], a[16:19], v[104:107]
 v_xor_b32 v36, 0x8000, v36
 v_mfma_f32_16x16x32_bf16 v[100:103], a[200:203], a[8:11], v[100:103]
 v_mfma_f32_16x16x32_bf16 v[100:103], a[204:207], a[12:15], v[100:103]
 v_mfma_f32_16x16x32_bf16 v[96:99], a[204:207], a[4:7], v[96:99]
 v_mfma_f32_16x16x32_bf16 v[96:99], a[200:203], a[0:3], v[96:99]
 s_waitcnt lgkmcnt(4)
 v_mfma_f32_16x16x32_bf16 a[112:115], a[208:211], a[0:3], a[112:115]
 ds_read_b64_tr_b16 a[192:193], v29 offset:16384
 ds_read_b64_tr_b16 a[194:195], v29 offset:20480
 v_mfma_f32_16x16x32_bf16 a[112:115], a[212:215], a[4:7], a[112:115]
 v_mfma_f32_16x16x32_bf16 a[116:119], a[212:215], a[12:15], a[116:119]
 ds_read_b64_tr_b16 a[196:197], v29 offset:24576
 ds_read_b64_tr_b16 a[198:199], v29 offset:28672
 v_mfma_f32_16x16x32_bf16 a[116:119], a[208:211], a[8:11], a[116:119]
 v_mfma_f32_16x16x32_bf16 a[120:123], a[208:211], a[16:19], a[120:123]
 v_mfma_f32_16x16x32_bf16 a[120:123], a[212:215], a[20:23], a[120:123]
 v_mfma_f32_16x16x32_bf16 a[124:127], a[212:215], a[28:31], a[124:127]
 v_mfma_f32_16x16x32_bf16 a[124:127], a[208:211], a[24:27], a[124:127]
 s_waitcnt lgkmcnt(4)
 v_mfma_f32_16x16x32_bf16 v[124:127], a[216:219], a[24:27], v[124:127]
 ds_read_b64_tr_b16 a[200:201], v29 offset:16392
 ds_read_b64_tr_b16 a[202:203], v29 offset:20488
 v_mfma_f32_16x16x32_bf16 v[124:127], a[220:223], a[28:31], v[124:127]
 v_mfma_f32_16x16x32_bf16 v[120:123], a[220:223], a[20:23], v[120:123]
 ds_read_b64_tr_b16 a[204:205], v29 offset:24584
 ds_read_b64_tr_b16 a[206:207], v29 offset:28680
 v_mfma_f32_16x16x32_bf16 v[120:123], a[216:219], a[16:19], v[120:123]
 v_xor_b32 v29, 0x8000, v29
 v_mfma_f32_16x16x32_bf16 v[116:119], a[216:219], a[8:11], v[116:119]
 v_mfma_f32_16x16x32_bf16 v[116:119], a[220:223], a[12:15], v[116:119]
 v_mfma_f32_16x16x32_bf16 v[112:115], a[220:223], a[4:7], v[112:115]
 v_mfma_f32_16x16x32_bf16 v[112:115], a[216:219], a[0:3], v[112:115]
 s_waitcnt lgkmcnt(4)
 v_mfma_f32_16x16x32_bf16 v[192:195], a[192:195], a[0:3], v[192:195]
 s_barrier
 ds_read_b64_tr_b16 a[208:209], v30 offset:16384
 ds_read_b64_tr_b16 a[210:211], v30 offset:20480
 v_mfma_f32_16x16x32_bf16 v[192:195], a[196:199], a[4:7], v[192:195]
 v_mfma_f32_16x16x32_bf16 v[196:199], a[196:199], a[12:15], v[196:199]
 ds_read_b64_tr_b16 a[212:213], v30 offset:24576
 ds_read_b64_tr_b16 a[214:215], v30 offset:28672
 v_mfma_f32_16x16x32_bf16 v[196:199], a[192:195], a[8:11], v[196:199]
 s_add_u32 m0, s47, 32768
 v_mfma_f32_16x16x32_bf16 v[200:203], a[192:195], a[16:19], v[200:203]
 buffer_load_dwordx4 v1, s[8:11], s49 offen offset:0 lds
 v_mfma_f32_16x16x32_bf16 v[200:203], a[196:199], a[20:23], v[200:203]
 v_mfma_f32_16x16x32_bf16 v[204:207], a[196:199], a[28:31], v[204:207]
 v_mfma_f32_16x16x32_bf16 v[204:207], a[192:195], a[24:27], v[204:207]
 s_waitcnt lgkmcnt(4)
 v_mfma_f32_16x16x32_bf16 v[140:143], a[200:203], a[24:27], v[140:143]
 ds_read_b64_tr_b16 a[216:217], v30 offset:16392
 ds_read_b64_tr_b16 a[218:219], v30 offset:20488
 v_mfma_f32_16x16x32_bf16 v[140:143], a[204:207], a[28:31], v[140:143]
 buffer_load_dwordx4 v2, s[8:11], s49 offen offset:1024 lds
 v_mfma_f32_16x16x32_bf16 v[136:139], a[204:207], a[20:23], v[136:139]
 ds_read_b64_tr_b16 a[220:221], v30 offset:24584
 ds_read_b64_tr_b16 a[222:223], v30 offset:28680
 v_mfma_f32_16x16x32_bf16 v[136:139], a[200:203], a[16:19], v[136:139]
 v_xor_b32 v30, 0x8000, v30
 v_mfma_f32_16x16x32_bf16 v[132:135], a[200:203], a[8:11], v[132:135]
 v_mfma_f32_16x16x32_bf16 v[132:135], a[204:207], a[12:15], v[132:135]
 v_mfma_f32_16x16x32_bf16 v[128:131], a[204:207], a[4:7], v[128:131]
 buffer_load_dwordx4 v3, s[8:11], s49 offen offset:2048 lds
 v_mfma_f32_16x16x32_bf16 v[128:131], a[200:203], a[0:3], v[128:131]
 s_waitcnt lgkmcnt(4)
 v_mfma_f32_16x16x32_bf16 v[208:211], a[208:211], a[0:3], v[208:211]
 ds_read_b64_tr_b16 a[192:193], v31 offset:16384
 ds_read_b64_tr_b16 a[194:195], v31 offset:20480
 v_mfma_f32_16x16x32_bf16 v[208:211], a[212:215], a[4:7], v[208:211]
 v_mfma_f32_16x16x32_bf16 v[212:215], a[212:215], a[12:15], v[212:215]
 ds_read_b64_tr_b16 a[196:197], v31 offset:24576
 ds_read_b64_tr_b16 a[198:199], v31 offset:28672
 v_mfma_f32_16x16x32_bf16 v[212:215], a[208:211], a[8:11], v[212:215]
 v_mfma_f32_16x16x32_bf16 v[216:219], a[208:211], a[16:19], v[216:219]
 buffer_load_dwordx4 v4, s[8:11], s49 offen offset:3072 lds
 v_mfma_f32_16x16x32_bf16 v[216:219], a[212:215], a[20:23], v[216:219]
 s_add_u32 s49, s49, 16384
 s_add_u32 m0, s47, 114688
 v_mfma_f32_16x16x32_bf16 v[220:223], a[212:215], a[28:31], v[220:223]
 v_mfma_f32_16x16x32_bf16 v[220:223], a[208:211], a[24:27], v[220:223]
 s_waitcnt lgkmcnt(4)
 v_mfma_f32_16x16x32_bf16 v[156:159], a[216:219], a[24:27], v[156:159]
 ds_read_b64_tr_b16 a[200:201], v31 offset:16392
 ds_read_b64_tr_b16 a[202:203], v31 offset:20488
 v_mfma_f32_16x16x32_bf16 v[156:159], a[220:223], a[28:31], v[156:159]
 buffer_load_dwordx4 v1, s[12:15], s50 offen offset:0 lds
 v_mfma_f32_16x16x32_bf16 v[152:155], a[220:223], a[20:23], v[152:155]
 ds_read_b64_tr_b16 a[204:205], v31 offset:24584
 ds_read_b64_tr_b16 a[206:207], v31 offset:28680
 v_mfma_f32_16x16x32_bf16 v[152:155], a[216:219], a[16:19], v[152:155]
 v_xor_b32 v31, 0x8000, v31
 v_mfma_f32_16x16x32_bf16 v[148:151], a[216:219], a[8:11], v[148:151]
 v_mfma_f32_16x16x32_bf16 v[148:151], a[220:223], a[12:15], v[148:151]
 v_mfma_f32_16x16x32_bf16 v[144:147], a[220:223], a[4:7], v[144:147]
 buffer_load_dwordx4 v2, s[12:15], s50 offen offset:1024 lds
 v_mfma_f32_16x16x32_bf16 v[144:147], a[216:219], a[0:3], v[144:147]
 s_waitcnt lgkmcnt(4)
 v_mfma_f32_16x16x32_bf16 v[224:227], a[192:195], a[0:3], v[224:227]
 ds_read_b64_tr_b16 a[208:209], v32 offset:16384
 ds_read_b64_tr_b16 a[210:211], v32 offset:20480
 v_mfma_f32_16x16x32_bf16 v[224:227], a[196:199], a[4:7], v[224:227]
 v_mfma_f32_16x16x32_bf16 v[228:231], a[196:199], a[12:15], v[228:231]
 ds_read_b64_tr_b16 a[212:213], v32 offset:24576
 ds_read_b64_tr_b16 a[214:215], v32 offset:28672
 v_mfma_f32_16x16x32_bf16 v[228:231], a[192:195], a[8:11], v[228:231]
 v_mfma_f32_16x16x32_bf16 v[232:235], a[192:195], a[16:19], v[232:235]
 buffer_load_dwordx4 v3, s[12:15], s50 offen offset:2048 lds
 v_mfma_f32_16x16x32_bf16 v[232:235], a[196:199], a[20:23], v[232:235]
 v_mfma_f32_16x16x32_bf16 v[236:239], a[196:199], a[28:31], v[236:239]
 v_mfma_f32_16x16x32_bf16 v[236:239], a[192:195], a[24:27], v[236:239]
 s_waitcnt lgkmcnt(4)
 v_mfma_f32_16x16x32_bf16 v[172:175], a[200:203], a[24:27], v[172:175]
 ds_read_b64_tr_b16 a[216:217], v32 offset:16392
 ds_read_b64_tr_b16 a[218:219], v32 offset:20488
 v_mfma_f32_16x16x32_bf16 v[172:175], a[204:207], a[28:31], v[172:175]
 buffer_load_dwordx4 v4, s[12:15], s50 offen offset:3072 lds
 v_mfma_f32_16x16x32_bf16 v[168:171], a[204:207], a[20:23], v[168:171]
 s_add_u32 s50, s50, 16384
 ds_read_b64_tr_b16 a[220:221], v32 offset:24584
 ds_read_b64_tr_b16 a[222:223], v32 offset:28680
 v_mfma_f32_16x16x32_bf16 v[168:171], a[200:203], a[16:19], v[168:171]
 v_xor_b32 v32, 0x8000, v32
 v_mfma_f32_16x16x32_bf16 v[164:167], a[200:203], a[8:11], v[164:167]
 v_mfma_f32_16x16x32_bf16 v[164:167], a[204:207], a[12:15], v[164:167]
 v_mfma_f32_16x16x32_bf16 v[160:163], a[204:207], a[4:7], v[160:163]
 v_mfma_f32_16x16x32_bf16 v[160:163], a[200:203], a[0:3], v[160:163]
 s_waitcnt lgkmcnt(4)
 v_mfma_f32_16x16x32_bf16 v[240:243], a[208:211], a[0:3], v[240:243]
 ds_read_b64_tr_b16 a[192:193], v33 offset:0
 ds_read_b64_tr_b16 a[194:195], v33 offset:2048
 v_mfma_f32_16x16x32_bf16 v[240:243], a[212:215], a[4:7], v[240:243]
 v_mfma_f32_16x16x32_bf16 v[244:247], a[212:215], a[12:15], v[244:247]
 ds_read_b64_tr_b16 a[196:197], v33 offset:4096
 ds_read_b64_tr_b16 a[198:199], v33 offset:6144
 v_mfma_f32_16x16x32_bf16 v[244:247], a[208:211], a[8:11], v[244:247]
 v_mfma_f32_16x16x32_bf16 v[248:251], a[208:211], a[16:19], v[248:251]
 v_mfma_f32_16x16x32_bf16 v[248:251], a[212:215], a[20:23], v[248:251]
 v_mfma_f32_16x16x32_bf16 v[252:255], a[212:215], a[28:31], v[252:255]
 v_mfma_f32_16x16x32_bf16 v[252:255], a[208:211], a[24:27], v[252:255]
 s_waitcnt lgkmcnt(4)
 v_mfma_f32_16x16x32_bf16 v[188:191], a[216:219], a[24:27], v[188:191]
 ds_read_b64_tr_b16 a[200:201], v33 offset:8192
 ds_read_b64_tr_b16 a[202:203], v33 offset:10240
 v_mfma_f32_16x16x32_bf16 v[188:191], a[220:223], a[28:31], v[188:191]
 v_mfma_f32_16x16x32_bf16 v[184:187], a[220:223], a[20:23], v[184:187]
 ds_read_b64_tr_b16 a[204:205], v33 offset:12288
 ds_read_b64_tr_b16 a[206:207], v33 offset:14336
 v_mfma_f32_16x16x32_bf16 v[184:187], a[216:219], a[16:19], v[184:187]
 v_mfma_f32_16x16x32_bf16 v[180:183], a[216:219], a[8:11], v[180:183]
 v_mfma_f32_16x16x32_bf16 v[180:183], a[220:223], a[12:15], v[180:183]
 v_mfma_f32_16x16x32_bf16 v[176:179], a[220:223], a[4:7], v[176:179]
 s_waitcnt vmcnt(8)
 v_mfma_f32_16x16x32_bf16 v[176:179], a[216:219], a[0:3], v[176:179]
 s_waitcnt lgkmcnt(4)
 v_mfma_f32_16x16x32_bf16 a[64:67], a[192:195], a[32:35], a[64:67]
 ds_read_b64_tr_b16 a[208:209], v34 offset:0
 ds_read_b64_tr_b16 a[210:211], v34 offset:2048
 v_mfma_f32_16x16x32_bf16 a[64:67], a[196:199], a[36:39], a[64:67]
 s_lshl_b32 s58, s46, 2
 v_mfma_f32_16x16x32_bf16 a[68:71], a[196:199], a[44:47], a[68:71]
 s_add_u32 s58, s58, s44
 ds_read_b64_tr_b16 a[212:213], v34 offset:4096
 ds_read_b64_tr_b16 a[214:215], v34 offset:6144
 v_mfma_f32_16x16x32_bf16 a[68:71], a[192:195], a[40:43], a[68:71]
 s_mul_i32 s58, s58, 229376
 v_add_u32 v25, 0, v18
 v_add_u32 v26, 57344, v18
 v_mfma_f32_16x16x32_bf16 a[72:75], a[192:195], a[48:51], a[72:75]
 s_lshl_b32 s59, s63, 11
 v_add_u32 v27, 114688, v18
 v_add_u32 v28, 172032, v18
 v_mfma_f32_16x16x32_bf16 a[72:75], a[196:199], a[52:55], a[72:75]
 s_add_u32 s58, s58, s59
 v_mfma_f32_16x16x32_bf16 a[76:79], a[196:199], a[60:63], a[76:79]
 v_mfma_f32_16x16x32_bf16 a[76:79], a[192:195], a[56:59], a[76:79]
 s_waitcnt lgkmcnt(4)
 v_mfma_f32_16x16x32_bf16 v[76:79], a[200:203], a[56:59], v[76:79]
 ds_read_b64_tr_b16 a[216:217], v34 offset:8192
 ds_read_b64_tr_b16 a[218:219], v34 offset:10240
 v_mfma_f32_16x16x32_bf16 v[76:79], a[204:207], a[60:63], v[76:79]
 v_mfma_f32_16x16x32_bf16 v[72:75], a[204:207], a[52:55], v[72:75]
 ds_read_b64_tr_b16 a[220:221], v34 offset:12288
 ds_read_b64_tr_b16 a[222:223], v34 offset:14336
 v_mfma_f32_16x16x32_bf16 v[72:75], a[200:203], a[48:51], v[72:75]
 v_mfma_f32_16x16x32_bf16 v[68:71], a[200:203], a[40:43], v[68:71]
 v_mfma_f32_16x16x32_bf16 v[68:71], a[204:207], a[44:47], v[68:71]
 v_mfma_f32_16x16x32_bf16 v[64:67], a[204:207], a[36:39], v[64:67]
 v_mfma_f32_16x16x32_bf16 v[64:67], a[200:203], a[32:35], v[64:67]
 s_waitcnt lgkmcnt(4)
 v_mfma_f32_16x16x32_bf16 a[80:83], a[208:211], a[32:35], a[80:83]
 ds_read_b64_tr_b16 a[192:193], v35 offset:0
 ds_read_b64_tr_b16 a[194:195], v35 offset:2048
 v_mfma_f32_16x16x32_bf16 a[80:83], a[212:215], a[36:39], a[80:83]
 v_mfma_f32_16x16x32_bf16 a[84:87], a[212:215], a[44:47], a[84:87]
 ds_read_b64_tr_b16 a[196:197], v35 offset:4096
 ds_read_b64_tr_b16 a[198:199], v35 offset:6144
 v_mfma_f32_16x16x32_bf16 a[84:87], a[208:211], a[40:43], a[84:87]
 v_mfma_f32_16x16x32_bf16 a[88:91], a[208:211], a[48:51], a[88:91]
 v_accvgpr_read_b32 v40, a64
 v_accvgpr_read_b32 v41, a65
 v_mfma_f32_16x16x32_bf16 a[88:91], a[212:215], a[52:55], a[88:91]
 v_accvgpr_read_b32 v42, a66
 v_accvgpr_read_b32 v43, a67
 v_mfma_f32_16x16x32_bf16 a[92:95], a[212:215], a[60:63], a[92:95]
 v_mul_f32 v40, v40, v64
 v_mul_f32 v41, v41, v65
 v_mfma_f32_16x16x32_bf16 a[92:95], a[208:211], a[56:59], a[92:95]
 s_waitcnt lgkmcnt(4)
 v_mul_f32 v42, v42, v66
 v_mul_f32 v43, v43, v67
 v_mfma_f32_16x16x32_bf16 v[92:95], a[216:219], a[56:59], v[92:95]
 ds_read_b64_tr_b16 a[200:201], v35 offset:8192
 ds_read_b64_tr_b16 a[202:203], v35 offset:10240
 v_mfma_f32_16x16x32_bf16 v[92:95], a[220:223], a[60:63], v[92:95]
 v_cvt_pk_bf16_f32 v64, v40, v41
 v_cvt_pk_bf16_f32 v65, v42, v43
 v_mfma_f32_16x16x32_bf16 v[88:91], a[220:223], a[52:55], v[88:91]
 ds_read_b64_tr_b16 a[204:205], v35 offset:12288
 ds_read_b64_tr_b16 a[206:207], v35 offset:14336
 v_mfma_f32_16x16x32_bf16 v[88:91], a[216:219], a[48:51], v[88:91]
 v_accvgpr_read_b32 v44, a68
 v_accvgpr_read_b32 v45, a69
 v_mfma_f32_16x16x32_bf16 v[84:87], a[216:219], a[40:43], v[84:87]
 v_accvgpr_read_b32 v46, a70
 v_accvgpr_read_b32 v47, a71
 v_mfma_f32_16x16x32_bf16 v[84:87], a[220:223], a[44:47], v[84:87]
 v_mul_f32 v44, v44, v68
 v_mul_f32 v45, v45, v69
 v_mfma_f32_16x16x32_bf16 v[80:83], a[220:223], a[36:39], v[80:83]
 v_mul_f32 v46, v46, v70
 v_mul_f32 v47, v47, v71
 v_mfma_f32_16x16x32_bf16 v[80:83], a[216:219], a[32:35], v[80:83]
 s_waitcnt lgkmcnt(4)
 v_cvt_pk_bf16_f32 v68, v44, v45
 v_cvt_pk_bf16_f32 v69, v46, v47
 v_mfma_f32_16x16x32_bf16 a[96:99], a[192:195], a[32:35], a[96:99]
 ds_read_b64_tr_b16 a[208:209], v36 offset:0
 ds_read_b64_tr_b16 a[210:211], v36 offset:2048
 v_mfma_f32_16x16x32_bf16 a[96:99], a[196:199], a[36:39], a[96:99]
 v_accvgpr_read_b32 v40, a72
 v_accvgpr_read_b32 v41, a73
 v_mfma_f32_16x16x32_bf16 a[100:103], a[196:199], a[44:47], a[100:103]
 ds_read_b64_tr_b16 a[212:213], v36 offset:4096
 ds_read_b64_tr_b16 a[214:215], v36 offset:6144
 v_mfma_f32_16x16x32_bf16 a[100:103], a[192:195], a[40:43], a[100:103]
 v_accvgpr_read_b32 v42, a74
 v_accvgpr_read_b32 v43, a75
 v_mfma_f32_16x16x32_bf16 a[104:107], a[192:195], a[48:51], a[104:107]
 v_mul_f32 v40, v40, v72
 v_mul_f32 v41, v41, v73
 v_mfma_f32_16x16x32_bf16 a[104:107], a[196:199], a[52:55], a[104:107]
 v_mul_f32 v42, v42, v74
 v_mul_f32 v43, v43, v75
 v_mfma_f32_16x16x32_bf16 a[108:111], a[196:199], a[60:63], a[108:111]
 v_cvt_pk_bf16_f32 v72, v40, v41
 v_cvt_pk_bf16_f32 v73, v42, v43
 v_mfma_f32_16x16x32_bf16 a[108:111], a[192:195], a[56:59], a[108:111]
 s_waitcnt lgkmcnt(4)
 v_accvgpr_read_b32 v44, a76
 v_accvgpr_read_b32 v45, a77
 v_mfma_f32_16x16x32_bf16 v[108:111], a[200:203], a[56:59], v[108:111]
 ds_read_b64_tr_b16 a[216:217], v36 offset:8192
 ds_read_b64_tr_b16 a[218:219], v36 offset:10240
 v_mfma_f32_16x16x32_bf16 v[108:111], a[204:207], a[60:63], v[108:111]
 v_accvgpr_read_b32 v46, a78
 v_accvgpr_read_b32 v47, a79
 v_mfma_f32_16x16x32_bf16 v[104:107], a[204:207], a[52:55], v[104:107]
 ds_read_b64_tr_b16 a[220:221], v36 offset:12288
 ds_read_b64_tr_b16 a[222:223], v36 offset:14336
 v_mfma_f32_16x16x32_bf16 v[104:107], a[200:203], a[48:51], v[104:107]
 v_mul_f32 v44, v44, v76
 v_mul_f32 v45, v45, v77
 v_mfma_f32_16x16x32_bf16 v[100:103], a[200:203], a[40:43], v[100:103]
 v_mul_f32 v46, v46, v78
 v_mul_f32 v47, v47, v79
 v_mfma_f32_16x16x32_bf16 v[100:103], a[204:207], a[44:47], v[100:103]
 v_cvt_pk_bf16_f32 v76, v44, v45
 v_cvt_pk_bf16_f32 v77, v46, v47
 v_mfma_f32_16x16x32_bf16 v[96:99], a[204:207], a[36:39], v[96:99]
 v_accvgpr_read_b32 v40, a80
 v_accvgpr_read_b32 v41, a81
 v_mfma_f32_16x16x32_bf16 v[96:99], a[200:203], a[32:35], v[96:99]
 s_waitcnt lgkmcnt(4)
 v_accvgpr_read_b32 v42, a82
 v_accvgpr_read_b32 v43, a83
 v_mfma_f32_16x16x32_bf16 a[112:115], a[208:211], a[32:35], a[112:115]
 ds_read_b64_tr_b16 a[192:193], v29 offset:0
 ds_read_b64_tr_b16 a[194:195], v29 offset:4096
 v_mfma_f32_16x16x32_bf16 a[112:115], a[212:215], a[36:39], a[112:115]
 v_mul_f32 v40, v40, v80
 v_mul_f32 v41, v41, v81
 v_mfma_f32_16x16x32_bf16 a[116:119], a[212:215], a[44:47], a[116:119]
 ds_read_b64_tr_b16 a[196:197], v29 offset:8192
 ds_read_b64_tr_b16 a[198:199], v29 offset:12288
 v_mfma_f32_16x16x32_bf16 a[116:119], a[208:211], a[40:43], a[116:119]
 v_mul_f32 v42, v42, v82
 v_mul_f32 v43, v43, v83
 v_mfma_f32_16x16x32_bf16 a[120:123], a[208:211], a[48:51], a[120:123]
 v_cvt_pk_bf16_f32 v66, v40, v41
 v_cvt_pk_bf16_f32 v67, v42, v43
 v_mfma_f32_16x16x32_bf16 a[120:123], a[212:215], a[52:55], a[120:123]
 v_accvgpr_read_b32 v44, a84
 v_accvgpr_read_b32 v45, a85
 v_mfma_f32_16x16x32_bf16 a[124:127], a[212:215], a[60:63], a[124:127]
 v_accvgpr_read_b32 v46, a86
 v_accvgpr_read_b32 v47, a87
 v_mfma_f32_16x16x32_bf16 a[124:127], a[208:211], a[56:59], a[124:127]
 s_waitcnt lgkmcnt(4)
 v_mul_f32 v44, v44, v84
 v_mul_f32 v45, v45, v85
 v_mfma_f32_16x16x32_bf16 v[124:127], a[216:219], a[56:59], v[124:127]
 ds_read_b64_tr_b16 a[200:201], v29 offset:8
 ds_read_b64_tr_b16 a[202:203], v29 offset:4104
 v_mfma_f32_16x16x32_bf16 v[124:127], a[220:223], a[60:63], v[124:127]
 v_mul_f32 v46, v46, v86
 v_mul_f32 v47, v47, v87
 v_mfma_f32_16x16x32_bf16 v[120:123], a[220:223], a[52:55], v[120:123]
 ds_read_b64_tr_b16 a[204:205], v29 offset:8200
 ds_read_b64_tr_b16 a[206:207], v29 offset:12296
 v_mfma_f32_16x16x32_bf16 v[120:123], a[216:219], a[48:51], v[120:123]
 v_cvt_pk_bf16_f32 v70, v44, v45
 v_cvt_pk_bf16_f32 v71, v46, v47
 v_mfma_f32_16x16x32_bf16 v[116:119], a[216:219], a[40:43], v[116:119]
 v_accvgpr_read_b32 v40, a88
 v_accvgpr_read_b32 v41, a89
 v_mfma_f32_16x16x32_bf16 v[116:119], a[220:223], a[44:47], v[116:119]
 v_accvgpr_read_b32 v42, a90
 v_accvgpr_read_b32 v43, a91
 v_mfma_f32_16x16x32_bf16 v[112:115], a[220:223], a[36:39], v[112:115]
 v_mul_f32 v40, v40, v88
 v_mul_f32 v41, v41, v89
 v_mfma_f32_16x16x32_bf16 v[112:115], a[216:219], a[32:35], v[112:115]
 s_waitcnt lgkmcnt(4)
 v_mul_f32 v42, v42, v90
 v_mul_f32 v43, v43, v91
 v_mfma_f32_16x16x32_bf16 v[192:195], a[192:195], a[32:35], v[192:195]
 s_barrier
 ds_read_b64_tr_b16 a[208:209], v30 offset:0
 ds_read_b64_tr_b16 a[210:211], v30 offset:4096
 v_mfma_f32_16x16x32_bf16 v[192:195], a[196:199], a[36:39], v[192:195]
 v_cvt_pk_bf16_f32 v74, v40, v41
 v_cvt_pk_bf16_f32 v75, v42, v43
 v_mfma_f32_16x16x32_bf16 v[196:199], a[196:199], a[44:47], v[196:199]
 ds_read_b64_tr_b16 a[212:213], v30 offset:8192
 ds_read_b64_tr_b16 a[214:215], v30 offset:12288
 v_mfma_f32_16x16x32_bf16 v[196:199], a[192:195], a[40:43], v[196:199]
 s_add_u32 m0, s47, 49152
 buffer_store_dwordx4 v[64:67], v25, s[32:35], s58 offen offset:0 sc1
 v_mfma_f32_16x16x32_bf16 v[200:203], a[192:195], a[48:51], v[200:203]
 buffer_load_dwordx4 v1, s[8:11], s49 offen offset:0 lds
 v_mfma_f32_16x16x32_bf16 v[200:203], a[196:199], a[52:55], v[200:203]
 v_accvgpr_read_b32 v44, a92
 v_accvgpr_read_b32 v45, a93
 v_mfma_f32_16x16x32_bf16 v[204:207], a[196:199], a[60:63], v[204:207]
 v_accvgpr_read_b32 v46, a94
 v_accvgpr_read_b32 v47, a95
 v_mfma_f32_16x16x32_bf16 v[204:207], a[192:195], a[56:59], v[204:207]
 s_waitcnt lgkmcnt(4)
 v_mul_f32 v44, v44, v92
 v_mul_f32 v45, v45, v93
 v_mfma_f32_16x16x32_bf16 v[140:143], a[200:203], a[56:59], v[140:143]
 ds_read_b64_tr_b16 a[216:217], v30 offset:8
 ds_read_b64_tr_b16 a[218:219], v30 offset:4104
 v_mfma_f32_16x16x32_bf16 v[140:143], a[204:207], a[60:63], v[140:143]
 buffer_load_dwordx4 v2, s[8:11], s49 offen offset:1024 lds
 v_mfma_f32_16x16x32_bf16 v[136:139], a[204:207], a[52:55], v[136:139]
 ds_read_b64_tr_b16 a[220:221], v30 offset:8200
 ds_read_b64_tr_b16 a[222:223], v30 offset:12296
 v_mfma_f32_16x16x32_bf16 v[136:139], a[200:203], a[48:51], v[136:139]
 v_mul_f32 v46, v46, v94
 v_mul_f32 v47, v47, v95
 v_mfma_f32_16x16x32_bf16 v[132:135], a[200:203], a[40:43], v[132:135]
 v_cvt_pk_bf16_f32 v78, v44, v45
 v_cvt_pk_bf16_f32 v79, v46, v47
 v_mfma_f32_16x16x32_bf16 v[132:135], a[204:207], a[44:47], v[132:135]
 v_accvgpr_read_b32 v40, a96
 v_mfma_f32_16x16x32_bf16 v[128:131], a[204:207], a[36:39], v[128:131]
 buffer_load_dwordx4 v3, s[8:11], s49 offen offset:2048 lds
 v_mfma_f32_16x16x32_bf16 v[128:131], a[200:203], a[32:35], v[128:131]
 s_waitcnt lgkmcnt(4)
 v_accvgpr_read_b32 v41, a97
 v_accvgpr_read_b32 v42, a98
 v_mfma_f32_16x16x32_bf16 v[208:211], a[208:211], a[32:35], v[208:211]
 ds_read_b64_tr_b16 a[192:193], v31 offset:0
 ds_read_b64_tr_b16 a[194:195], v31 offset:4096
 v_mfma_f32_16x16x32_bf16 v[208:211], a[212:215], a[36:39], v[208:211]
 v_accvgpr_read_b32 v43, a99
 v_mul_f32 v40, v40, v96
 v_mfma_f32_16x16x32_bf16 v[212:215], a[212:215], a[44:47], v[212:215]
 ds_read_b64_tr_b16 a[196:197], v31 offset:8192
 ds_read_b64_tr_b16 a[198:199], v31 offset:12288
 v_mfma_f32_16x16x32_bf16 v[212:215], a[208:211], a[40:43], v[212:215]
 buffer_store_dwordx4 v[68:71], v26, s[32:35], s58 offen offset:0 sc1
 v_mfma_f32_16x16x32_bf16 v[216:219], a[208:211], a[48:51], v[216:219]
 buffer_load_dwordx4 v4, s[8:11], s49 offen offset:3072 lds
 v_mfma_f32_16x16x32_bf16 v[216:219], a[212:215], a[52:55], v[216:219]
 s_add_u32 s49, s49, 16384
 s_add_u32 m0, s47, 131072
 v_mul_f32 v41, v41, v97
 v_mul_f32 v42, v42, v98
 v_mfma_f32_16x16x32_bf16 v[220:223], a[212:215], a[60:63], v[220:223]
 v_mul_f32 v43, v43, v99
 v_cvt_pk_bf16_f32 v96, v40, v41
 v_mfma_f32_16x16x32_bf16 v[220:223], a[208:211], a[56:59], v[220:223]
 s_waitcnt lgkmcnt(4)
 v_cvt_pk_bf16_f32 v97, v42, v43
 v_accvgpr_read_b32 v44, a100
 v_mfma_f32_16x16x32_bf16 v[156:159], a[216:219], a[56:59], v[156:159]
 ds_read_b64_tr_b16 a[200:201], v31 offset:8
 ds_read_b64_tr_b16 a[202:203], v31 offset:4104
 v_mfma_f32_16x16x32_bf16 v[156:159], a[220:223], a[60:63], v[156:159]
 buffer_load_dwordx4 v1, s[12:15], s50 offen offset:0 lds
 v_mfma_f32_16x16x32_bf16 v[152:155], a[220:223], a[52:55], v[152:155]
 ds_read_b64_tr_b16 a[204:205], v31 offset:8200
 ds_read_b64_tr_b16 a[206:207], v31 offset:12296
 v_mfma_f32_16x16x32_bf16 v[152:155], a[216:219], a[48:51], v[152:155]
 v_accvgpr_read_b32 v45, a101
 v_accvgpr_read_b32 v46, a102
 v_mfma_f32_16x16x32_bf16 v[148:151], a[216:219], a[40:43], v[148:151]
 v_accvgpr_read_b32 v47, a103
 v_mul_f32 v44, v44, v100
 v_mfma_f32_16x16x32_bf16 v[148:151], a[220:223], a[44:47], v[148:151]
 v_mul_f32 v45, v45, v101
 v_mfma_f32_16x16x32_bf16 v[144:147], a[220:223], a[36:39], v[144:147]
 buffer_load_dwordx4 v2, s[12:15], s50 offen offset:1024 lds
 v_mfma_f32_16x16x32_bf16 v[144:147], a[216:219], a[32:35], v[144:147]
 s_waitcnt lgkmcnt(4)
 v_mul_f32 v46, v46, v102
 v_mul_f32 v47, v47, v103
 v_mfma_f32_16x16x32_bf16 v[224:227], a[192:195], a[32:35], v[224:227]
 ds_read_b64_tr_b16 a[208:209], v32 offset:0
 ds_read_b64_tr_b16 a[210:211], v32 offset:4096
 v_mfma_f32_16x16x32_bf16 v[224:227], a[196:199], a[36:39], v[224:227]
 v_cvt_pk_bf16_f32 v100, v44, v45
 v_cvt_pk_bf16_f32 v101, v46, v47
 v_mfma_f32_16x16x32_bf16 v[228:231], a[196:199], a[44:47], v[228:231]
 ds_read_b64_tr_b16 a[212:213], v32 offset:8192
 ds_read_b64_tr_b16 a[214:215], v32 offset:12288
 v_mfma_f32_16x16x32_bf16 v[228:231], a[192:195], a[40:43], v[228:231]
 buffer_store_dwordx4 v[72:75], v27, s[32:35], s58 offen offset:0 sc1
 v_mfma_f32_16x16x32_bf16 v[232:235], a[192:195], a[48:51], v[232:235]
 buffer_load_dwordx4 v3, s[12:15], s50 offen offset:2048 lds
 v_mfma_f32_16x16x32_bf16 v[232:235], a[196:199], a[52:55], v[232:235]
 v_accvgpr_read_b32 v40, a104
 v_accvgpr_read_b32 v41, a105
 v_mfma_f32_16x16x32_bf16 v[236:239], a[196:199], a[60:63], v[236:239]
 v_accvgpr_read_b32 v42, a106
 v_accvgpr_read_b32 v43, a107
 v_mfma_f32_16x16x32_bf16 v[236:239], a[192:195], a[56:59], v[236:239]
 s_waitcnt lgkmcnt(4)
 v_mul_f32 v40, v40, v104
 v_mul_f32 v41, v41, v105
 v_mfma_f32_16x16x32_bf16 v[172:175], a[200:203], a[56:59], v[172:175]
 ds_read_b64_tr_b16 a[216:217], v32 offset:8
 ds_read_b64_tr_b16 a[218:219], v32 offset:4104
 v_mfma_f32_16x16x32_bf16 v[172:175], a[204:207], a[60:63], v[172:175]
 buffer_load_dwordx4 v4, s[12:15], s50 offen offset:3072 lds
 v_mfma_f32_16x16x32_bf16 v[168:171], a[204:207], a[52:55], v[168:171]
 s_add_u32 s50, s50, 16384
 ds_read_b64_tr_b16 a[220:221], v32 offset:8200
 ds_read_b64_tr_b16 a[222:223], v32 offset:12296
 v_mfma_f32_16x16x32_bf16 v[168:171], a[200:203], a[48:51], v[168:171]
 v_mul_f32 v42, v42, v106
 v_mul_f32 v43, v43, v107
 v_mfma_f32_16x16x32_bf16 v[164:167], a[200:203], a[40:43], v[164:167]
 v_cvt_pk_bf16_f32 v104, v40, v41
 v_cvt_pk_bf16_f32 v105, v42, v43
 v_mfma_f32_16x16x32_bf16 v[164:167], a[204:207], a[44:47], v[164:167]
 v_accvgpr_read_b32 v44, a108
 v_accvgpr_read_b32 v45, a109
 v_mfma_f32_16x16x32_bf16 v[160:163], a[204:207], a[36:39], v[160:163]
 v_accvgpr_read_b32 v46, a110
 v_mfma_f32_16x16x32_bf16 v[160:163], a[200:203], a[32:35], v[160:163]
 s_waitcnt lgkmcnt(4)
 buffer_store_dwordx4 v[76:79], v28, s[32:35], s58 offen offset:0 sc1
 v_mfma_f32_16x16x32_bf16 v[240:243], a[208:211], a[32:35], v[240:243]
 ds_read_b128 a[128:131], v5 offset:49152
 ds_read_b128 a[132:135], v6 offset:49152
 v_mfma_f32_16x16x32_bf16 v[240:243], a[212:215], a[36:39], v[240:243]
 v_accvgpr_read_b32 v47, a111
 v_mul_f32 v44, v44, v108
 v_mfma_f32_16x16x32_bf16 v[244:247], a[212:215], a[44:47], v[244:247]
 ds_read_b128 a[136:139], v7 offset:49152
 ds_read_b128 a[140:143], v8 offset:49152
 v_mfma_f32_16x16x32_bf16 v[244:247], a[208:211], a[40:43], v[244:247]
 v_mul_f32 v45, v45, v109
 v_mul_f32 v46, v46, v110
 v_mfma_f32_16x16x32_bf16 v[248:251], a[208:211], a[48:51], v[248:251]
 v_mul_f32 v47, v47, v111
 v_cvt_pk_bf16_f32 v108, v44, v45
 v_mfma_f32_16x16x32_bf16 v[248:251], a[212:215], a[52:55], v[248:251]
 v_cvt_pk_bf16_f32 v109, v46, v47
 v_accvgpr_read_b32 v40, a112
 v_mfma_f32_16x16x32_bf16 v[252:255], a[212:215], a[60:63], v[252:255]
 v_accvgpr_read_b32 v41, a113
 v_accvgpr_read_b32 v42, a114
 v_mfma_f32_16x16x32_bf16 v[252:255], a[208:211], a[56:59], v[252:255]
 s_waitcnt lgkmcnt(4)
 v_accvgpr_read_b32 v43, a115
 v_mul_f32 v40, v40, v112
 v_mfma_f32_16x16x32_bf16 v[188:191], a[216:219], a[56:59], v[188:191]
 ds_read_b128 a[144:147], v5 offset:53248
 ds_read_b128 a[148:151], v6 offset:53248
 v_mfma_f32_16x16x32_bf16 v[188:191], a[220:223], a[60:63], v[188:191]
 v_mul_f32 v41, v41, v113
 v_mul_f32 v42, v42, v114
 v_mfma_f32_16x16x32_bf16 v[184:187], a[220:223], a[52:55], v[184:187]
 ds_read_b128 a[152:155], v7 offset:53248
 ds_read_b128 a[156:159], v8 offset:53248
 v_mfma_f32_16x16x32_bf16 v[184:187], a[216:219], a[48:51], v[184:187]
 v_mul_f32 v43, v43, v115
 v_cvt_pk_bf16_f32 v98, v40, v41
 v_mfma_f32_16x16x32_bf16 v[180:183], a[216:219], a[40:43], v[180:183]
 v_cvt_pk_bf16_f32 v99, v42, v43
 v_accvgpr_read_b32 v44, a116
 v_mfma_f32_16x16x32_bf16 v[180:183], a[220:223], a[44:47], v[180:183]
 v_accvgpr_read_b32 v45, a117
 v_accvgpr_read_b32 v46, a118
 v_mfma_f32_16x16x32_bf16 v[176:179], a[220:223], a[36:39], v[176:179]
 v_accvgpr_read_b32 v47, a119
 v_mul_f32 v44, v44, v116
 v_mfma_f32_16x16x32_bf16 v[176:179], a[216:219], a[32:35], v[176:179]
 v_mul_f32 v45, v45, v117
 v_mul_f32 v46, v46, v118
 v_mul_f32 v47, v47, v119
 v_cvt_pk_bf16_f32 v102, v44, v45
 v_cvt_pk_bf16_f32 v103, v46, v47
 v_accvgpr_read_b32 v40, a120
 v_accvgpr_read_b32 v41, a121
 v_accvgpr_read_b32 v42, a122
 v_accvgpr_read_b32 v43, a123
 v_mul_f32 v40, v40, v120
 v_mul_f32 v41, v41, v121
 v_mul_f32 v42, v42, v122
 v_mul_f32 v43, v43, v123
 v_cvt_pk_bf16_f32 v106, v40, v41
 v_cvt_pk_bf16_f32 v107, v42, v43
 v_accvgpr_read_b32 v44, a124
 v_accvgpr_read_b32 v45, a125
 v_accvgpr_read_b32 v46, a126
 v_accvgpr_read_b32 v47, a127
 v_mul_f32 v44, v44, v124
 v_mul_f32 v45, v45, v125
 v_mul_f32 v46, v46, v126
 v_mul_f32 v47, v47, v127
 v_cvt_pk_bf16_f32 v110, v44, v45
 v_cvt_pk_bf16_f32 v111, v46, v47
mg_done:
 s_waitcnt lgkmcnt(4)
 v_cvt_pk_bf16_f32 v192, v192, v193
 v_cvt_pk_bf16_f32 v193, v194, v195
 v_cvt_pk_bf16_f32 v194, v128, v129
 v_cvt_pk_bf16_f32 v195, v130, v131
 v_cvt_pk_bf16_f32 v196, v196, v197
 v_cvt_pk_bf16_f32 v197, v198, v199
 v_cvt_pk_bf16_f32 v198, v132, v133
 v_cvt_pk_bf16_f32 v199, v134, v135
 v_cvt_pk_bf16_f32 v200, v200, v201
 v_cvt_pk_bf16_f32 v201, v202, v203
 v_cvt_pk_bf16_f32 v202, v136, v137
 v_cvt_pk_bf16_f32 v203, v138, v139
 v_cvt_pk_bf16_f32 v204, v204, v205
 v_cvt_pk_bf16_f32 v205, v206, v207
 v_cvt_pk_bf16_f32 v206, v140, v141
 v_cvt_pk_bf16_f32 v207, v142, v143
 v_cvt_pk_bf16_f32 v208, v208, v209
 v_cvt_pk_bf16_f32 v209, v210, v211
 v_cvt_pk_bf16_f32 v210, v144, v145
 v_cvt_pk_bf16_f32 v211, v146, v147
 v_cvt_pk_bf16_f32 v212, v212, v213
 v_cvt_pk_bf16_f32 v213, v214, v215
 v_cvt_pk_bf16_f32 v214, v148, v149
 v_cvt_pk_bf16_f32 v215, v150, v151
 v_cvt_pk_bf16_f32 v216, v216, v217
 v_cvt_pk_bf16_f32 v217, v218, v219
 v_cvt_pk_bf16_f32 v218, v152, v153
 v_cvt_pk_bf16_f32 v219, v154, v155
 v_cvt_pk_bf16_f32 v220, v220, v221
 v_cvt_pk_bf16_f32 v221, v222, v223
 v_cvt_pk_bf16_f32 v222, v156, v157
 v_cvt_pk_bf16_f32 v223, v158, v159
 v_cvt_pk_bf16_f32 v224, v224, v225
 v_cvt_pk_bf16_f32 v225, v226, v227
 v_cvt_pk_bf16_f32 v226, v160, v161
 v_cvt_pk_bf16_f32 v227, v162, v163
 v_cvt_pk_bf16_f32 v228, v228, v229
 v_cvt_pk_bf16_f32 v229, v230, v231
 v_cvt_pk_bf16_f32 v230, v164, v165
 v_cvt_pk_bf16_f32 v231, v166, v167
 v_cvt_pk_bf16_f32 v232, v232, v233
 v_cvt_pk_bf16_f32 v233, v234, v235
 v_cvt_pk_bf16_f32 v234, v168, v169
 v_cvt_pk_bf16_f32 v235, v170, v171
 v_cvt_pk_bf16_f32 v236, v236, v237
 v_cvt_pk_bf16_f32 v237, v238, v239
 v_cvt_pk_bf16_f32 v238, v172, v173
 v_cvt_pk_bf16_f32 v239, v174, v175
 v_mfma_f32_16x16x32_bf16 v[128:131], a[128:131], v[192:195], v[48:51]
 s_mov_b32 s20, s72
 v_mfma_f32_16x16x32_bf16 v[128:131], a[132:135], v[208:211], v[128:131]
 s_mov_b32 s21, s73
 v_mfma_f32_16x16x32_bf16 v[128:131], a[136:139], v[224:227], v[128:131]
 s_mov_b32 s22, 4194304
 v_cvt_pk_bf16_f32 v240, v240, v241
 v_cvt_pk_bf16_f32 v241, v242, v243
 v_mfma_f32_16x16x32_bf16 v[132:135], a[136:139], v[228:231], v[52:55]
 s_mov_b32 s23, 0x00020000
 v_cvt_pk_bf16_f32 v242, v176, v177
 v_cvt_pk_bf16_f32 v243, v178, v179
 v_mfma_f32_16x16x32_bf16 v[132:135], a[132:135], v[212:215], v[132:135]
 s_mov_b32 s16, s80
 v_cvt_pk_bf16_f32 v244, v244, v245
 v_cvt_pk_bf16_f32 v245, v246, v247
 v_mfma_f32_16x16x32_bf16 v[132:135], a[128:131], v[196:199], v[132:135]
 s_mov_b32 s17, s81
 v_cvt_pk_bf16_f32 v246, v180, v181
 v_cvt_pk_bf16_f32 v247, v182, v183
 v_mfma_f32_16x16x32_bf16 v[136:139], a[128:131], v[200:203], v[56:59]
 s_mov_b32 s18, 1835008
 v_cvt_pk_bf16_f32 v248, v248, v249
 v_cvt_pk_bf16_f32 v249, v250, v251
 v_mfma_f32_16x16x32_bf16 v[136:139], a[132:135], v[216:219], v[136:139]
 s_mov_b32 s19, 0x00020000
 v_cvt_pk_bf16_f32 v250, v184, v185
 v_cvt_pk_bf16_f32 v251, v186, v187
 v_mfma_f32_16x16x32_bf16 v[136:139], a[136:139], v[232:235], v[136:139]
 s_add_u32 s24, s86, 33554432
 s_addc_u32 s25, s87, 0
 v_cvt_pk_bf16_f32 v252, v252, v253
 v_cvt_pk_bf16_f32 v253, v254, v255
 v_mfma_f32_16x16x32_bf16 v[140:143], a[136:139], v[236:239], v[60:63]
 s_mov_b32 s26, 6029312
 v_cvt_pk_bf16_f32 v254, v188, v189
 v_cvt_pk_bf16_f32 v255, v190, v191
 v_mfma_f32_16x16x32_bf16 v[140:143], a[132:135], v[220:223], v[140:143]
 s_mov_b32 s27, 0x00020000
 ds_read_b128 a[160:163], v5 offset:57344
 ds_read_b128 a[164:167], v6 offset:57344
 v_mfma_f32_16x16x32_bf16 v[140:143], a[128:131], v[204:207], v[140:143]
 s_lshl_b32 s3, s2, 2
 ds_read_b128 a[168:171], v7 offset:57344
 ds_read_b128 a[172:175], v8 offset:57344
 v_mfma_f32_16x16x32_bf16 v[128:131], a[140:143], v[240:243], v[128:131]
 s_add_u32 s3, s3, s44
 ds_read_b128 a[176:179], v5 offset:61440
 ds_read_b128 a[180:183], v6 offset:61440
 v_mfma_f32_16x16x32_bf16 v[132:135], a[140:143], v[244:247], v[132:135]
 s_and_b32 s4, s3, 7
 ds_read_b128 a[184:187], v7 offset:61440
 ds_read_b128 a[188:191], v8 offset:61440
 v_mfma_f32_16x16x32_bf16 v[136:139], a[140:143], v[248:251], v[136:139]
 s_lshr_b32 s3, s3, 3
 v_lshrrev_b32 v29, 7, v18
 v_bfe_u32 v30, v18, 4, 3
 v_mfma_f32_16x16x32_bf16 v[140:143], a[140:143], v[252:255], v[140:143]
 s_waitcnt lgkmcnt(8)
 s_lshl_b32 s5, s3, 15
 v_and_b32 v31, 6, v29
 v_xor_b32 v30, v30, v31
 v_mfma_f32_16x16x32_bf16 v[144:147], a[144:147], v[204:207], v[60:63]
 s_lshl_b32 s6, s4, 7
 v_lshlrev_b32 v30, 4, v30
 v_lshl_add_u32 v21, v29, 10, v30
 v_mfma_f32_16x16x32_bf16 v[144:147], a[148:151], v[220:223], v[144:147]
 s_add_u32 s51, s5, s6
 v_add_u32 v22, 7168, v21
 v_add_u32 v23, 14336, v21
 v_mfma_f32_16x16x32_bf16 v[144:147], a[152:155], v[236:239], v[144:147]
 s_mul_i32 s4, s4, 753664
 v_add_u32 v24, 21504, v21
 v_mfma_f32_16x16x32_bf16 v[144:147], a[156:159], v[252:255], v[144:147]
 s_lshl_b32 s5, s3, 12
 v_mfma_f32_16x16x32_bf16 v[148:151], a[156:159], v[248:251], v[56:59]
 s_add_u32 s52, s4, s5
 v_mfma_f32_16x16x32_bf16 v[148:151], a[152:155], v[232:235], v[148:151]
 s_add_u32 s53, s52, 229376
 buffer_store_dwordx4 v[96:99], v25, s[32:35], s58 offen offset:1024 sc1
 v_mfma_f32_16x16x32_bf16 v[148:151], a[148:151], v[216:219], v[148:151]
 s_cmp_lt_u32 s3, 56
 s_cselect_b32 s52, s52, 0x7ff00000
 v_mfma_f32_16x16x32_bf16 v[148:151], a[144:147], v[200:203], v[148:151]
 v_exp_f32 v128, v128
 v_mfma_f32_16x16x32_bf16 v[152:155], a[144:147], v[196:199], v[52:55]
 v_exp_f32 v129, v129
 v_mfma_f32_16x16x32_bf16 v[152:155], a[148:151], v[212:215], v[152:155]
 v_exp_f32 v130, v130
 v_mfma_f32_16x16x32_bf16 v[152:155], a[152:155], v[228:231], v[152:155]
 v_exp_f32 v131, v131
 v_mfma_f32_16x16x32_bf16 v[152:155], a[156:159], v[244:247], v[152:155]
 v_exp_f32 v132, v132
 v_mfma_f32_16x16x32_bf16 v[156:159], a[156:159], v[240:243], v[48:51]
 v_exp_f32 v133, v133
 v_mfma_f32_16x16x32_bf16 v[156:159], a[152:155], v[224:227], v[156:159]
 v_exp_f32 v134, v134
 v_mfma_f32_16x16x32_bf16 v[156:159], a[148:151], v[208:211], v[156:159]
 v_exp_f32 v135, v135
 v_mfma_f32_16x16x32_bf16 v[156:159], a[144:147], v[192:195], v[156:159]
 s_waitcnt lgkmcnt(4)
 v_exp_f32 v136, v136
 v_mfma_f32_16x16x32_bf16 v[160:163], a[160:163], v[192:195], v[48:51]
 v_exp_f32 v137, v137
 v_mfma_f32_16x16x32_bf16 v[160:163], a[164:167], v[208:211], v[160:163]
 v_exp_f32 v138, v138
 v_mfma_f32_16x16x32_bf16 v[160:163], a[168:171], v[224:227], v[160:163]
 v_exp_f32 v139, v139
 v_mfma_f32_16x16x32_bf16 v[160:163], a[172:175], v[240:243], v[160:163]
 v_exp_f32 v140, v140
 v_mfma_f32_16x16x32_bf16 v[164:167], a[172:175], v[244:247], v[52:55]
 v_exp_f32 v141, v141
 v_mfma_f32_16x16x32_bf16 v[164:167], a[168:171], v[228:231], v[164:167]
 v_exp_f32 v142, v142
 v_mfma_f32_16x16x32_bf16 v[164:167], a[164:167], v[212:215], v[164:167]
 v_exp_f32 v143, v143
 v_mfma_f32_16x16x32_bf16 v[164:167], a[160:163], v[196:199], v[164:167]
 v_exp_f32 v144, v144
 v_mfma_f32_16x16x32_bf16 v[168:171], a[160:163], v[200:203], v[56:59]
 v_exp_f32 v145, v145
 v_mfma_f32_16x16x32_bf16 v[168:171], a[164:167], v[216:219], v[168:171]
 v_exp_f32 v146, v146
 v_mfma_f32_16x16x32_bf16 v[168:171], a[168:171], v[232:235], v[168:171]
 v_mfma_f32_16x16x32_bf16 v[168:171], a[172:175], v[248:251], v[168:171]
 buffer_store_dwordx4 v[100:103], v26, s[32:35], s58 offen offset:1024 sc1
 v_mfma_f32_16x16x32_bf16 v[172:175], a[172:175], v[252:255], v[60:63]
 v_mfma_f32_16x16x32_bf16 v[172:175], a[168:171], v[236:239], v[172:175]
 v_exp_f32 v147, v147
 v_mfma_f32_16x16x32_bf16 v[172:175], a[164:167], v[220:223], v[172:175]
 v_exp_f32 v148, v148
 v_mfma_f32_16x16x32_bf16 v[172:175], a[160:163], v[204:207], v[172:175]
 s_waitcnt lgkmcnt(0)
 v_exp_f32 v149, v149
 v_mfma_f32_16x16x32_bf16 v[176:179], a[176:179], v[204:207], v[60:63]
 v_exp_f32 v150, v150
 v_mfma_f32_16x16x32_bf16 v[176:179], a[180:183], v[220:223], v[176:179]
 v_exp_f32 v151, v151
 v_mfma_f32_16x16x32_bf16 v[176:179], a[184:187], v[236:239], v[176:179]
 v_exp_f32 v152, v152
 v_mfma_f32_16x16x32_bf16 v[176:179], a[188:191], v[252:255], v[176:179]
 v_exp_f32 v153, v153
 v_mfma_f32_16x16x32_bf16 v[180:183], a[188:191], v[248:251], v[56:59]
 v_exp_f32 v154, v154
 v_mfma_f32_16x16x32_bf16 v[180:183], a[184:187], v[232:235], v[180:183]
 v_exp_f32 v155, v155
 v_mfma_f32_16x16x32_bf16 v[180:183], a[180:183], v[216:219], v[180:183]
 v_exp_f32 v156, v156
 v_mfma_f32_16x16x32_bf16 v[180:183], a[176:179], v[200:203], v[180:183]
 v_exp_f32 v157, v157
 v_mfma_f32_16x16x32_bf16 v[184:187], a[176:179], v[196:199], v[52:55]
 v_exp_f32 v158, v158
 v_mfma_f32_16x16x32_bf16 v[184:187], a[180:183], v[212:215], v[184:187]
 v_exp_f32 v159, v159
 v_mfma_f32_16x16x32_bf16 v[184:187], a[184:187], v[228:231], v[184:187]
 v_exp_f32 v160, v160
 v_mfma_f32_16x16x32_bf16 v[184:187], a[188:191], v[244:247], v[184:187]
 v_exp_f32 v161, v161
 v_mfma_f32_16x16x32_bf16 v[188:191], a[188:191], v[240:243], v[48:51]
 v_exp_f32 v162, v162
 v_mfma_f32_16x16x32_bf16 v[188:191], a[184:187], v[224:227], v[188:191]
 v_exp_f32 v163, v163
 v_mfma_f32_16x16x32_bf16 v[188:191], a[180:183], v[208:211], v[188:191]
 v_exp_f32 v164, v164
 v_mov_b32 v32, 0
 v_mov_b32 v33, 0
 v_mfma_f32_16x16x32_bf16 v[188:191], a[176:179], v[192:195], v[188:191]
 s_barrier
 v_exp_f32 v165, v165
 ds_read_b128 a[128:131], v5 offset:0
 ds_read_b128 a[132:135], v6 offset:0
 ds_read_b128 a[136:139], v7 offset:0
 ds_read_b128 a[140:143], v8 offset:0
 ds_read_b128 a[144:147], v5 offset:4096
 ds_read_b128 a[148:151], v6 offset:4096
 ds_read_b128 a[152:155], v7 offset:4096
 ds_read_b128 a[156:159], v8 offset:4096
 v_exp_f32 v166, v166
 v_cvt_pk_bf16_f32 v64, v128, v129
 v_cvt_pk_bf16_f32 v65, v130, v131
 v_cvt_pk_bf16_f32 v72, v132, v133
 v_cvt_pk_bf16_f32 v73, v134, v135
 v_cvt_pk_bf16_f32 v80, v136, v137
 v_cvt_pk_bf16_f32 v81, v138, v139
 v_cvt_pk_bf16_f32 v88, v140, v141
 v_cvt_pk_bf16_f32 v89, v142, v143
 v_cvt_pk_bf16_f32 v90, v144, v145
 v_cvt_pk_bf16_f32 v91, v146, v147
 v_cvt_pk_bf16_f32 v82, v148, v149
 v_cvt_pk_bf16_f32 v83, v150, v151
 v_cvt_pk_bf16_f32 v74, v152, v153
 v_cvt_pk_bf16_f32 v75, v154, v155
 v_cvt_pk_bf16_f32 v66, v156, v157
 v_cvt_pk_bf16_f32 v67, v158, v159
 v_cvt_pk_bf16_f32 v68, v160, v161
 v_cvt_pk_bf16_f32 v69, v162, v163
 v_cvt_pk_bf16_f32 v76, v164, v165
 v_exp_f32 v167, v167
 v_exp_f32 v168, v168
 v_cvt_pk_bf16_f32 v77, v166, v167
 v_exp_f32 v169, v169
 v_exp_f32 v170, v170
 v_cvt_pk_bf16_f32 v84, v168, v169
 v_exp_f32 v171, v171
 v_exp_f32 v172, v172
 v_cvt_pk_bf16_f32 v85, v170, v171
 v_exp_f32 v173, v173
 v_exp_f32 v174, v174
 v_cvt_pk_bf16_f32 v92, v172, v173
 v_exp_f32 v175, v175
 v_exp_f32 v176, v176
 v_cvt_pk_bf16_f32 v93, v174, v175
 v_exp_f32 v177, v177
 v_exp_f32 v178, v178
 v_cvt_pk_bf16_f32 v94, v176, v177
 v_exp_f32 v179, v179
 v_exp_f32 v180, v180
 v_cvt_pk_bf16_f32 v95, v178, v179
 v_exp_f32 v181, v181
 v_exp_f32 v182, v182
 v_cvt_pk_bf16_f32 v86, v180, v181
 v_exp_f32 v183, v183
 v_exp_f32 v184, v184
 v_cvt_pk_bf16_f32 v87, v182, v183
 v_exp_f32 v185, v185
 v_exp_f32 v186, v186
 v_cvt_pk_bf16_f32 v78, v184, v185
 v_exp_f32 v187, v187
 v_exp_f32 v188, v188
 v_cvt_pk_bf16_f32 v79, v186, v187
 v_exp_f32 v189, v189
 v_exp_f32 v190, v190
 v_cvt_pk_bf16_f32 v70, v188, v189
 v_exp_f32 v191, v191
 s_nop 0
 v_cvt_pk_bf16_f32 v71, v190, v191
 v_pk_mov_b32 v[32:33], v[32:33], v[32:33]
 v_pk_mov_b32 v[34:35], v[32:33], v[32:33]
 v_pk_mov_b32 v[36:37], v[32:33], v[32:33]
 v_pk_mov_b32 v[38:39], v[32:33], v[32:33]
 v_pk_mov_b32 v[40:41], v[32:33], v[32:33]
 v_pk_mov_b32 v[42:43], v[32:33], v[32:33]
 v_pk_mov_b32 v[44:45], v[32:33], v[32:33]
 v_pk_mov_b32 v[46:47], v[32:33], v[32:33]
 s_waitcnt lgkmcnt(4)
att_it0:
 v_mfma_f32_16x16x32_bf16 v[128:131], a[128:131], v[192:195], v[48:51]
 ds_read_b128 a[160:163], v5 offset:8192
 v_mfma_f32_16x16x32_bf16 v[128:131], a[132:135], v[208:211], v[128:131]
 s_add_u32 m0, s47, 65536
 ds_read_b128 a[164:167], v6 offset:8192
 v_mfma_f32_16x16x32_bf16 v[128:131], a[136:139], v[224:227], v[128:131]
 ds_read_b128 a[168:171], v7 offset:8192
 buffer_load_dwordx4 v1, s[8:11], s49 offen offset:0 lds
 v_mfma_f32_16x16x32_bf16 v[128:131], a[140:143], v[240:243], v[128:131]
 ds_read_b128 a[172:175], v8 offset:8192
 v_mfma_f32_16x16x32_bf16 v[132:135], a[140:143], v[244:247], v[52:55]
 ds_read_b128 a[176:179], v5 offset:12288
 v_mfma_f32_16x16x32_bf16 v[132:135], a[136:139], v[228:231], v[132:135]
 ds_read_b128 a[180:183], v6 offset:12288
 buffer_store_dwordx4 v[104:107], v27, s[32:35], s58 offen offset:1024 sc1
 v_mfma_f32_16x16x32_bf16 v[132:135], a[132:135], v[212:215], v[132:135]
 ds_read_b128 a[184:187], v7 offset:12288
 v_mfma_f32_16x16x32_bf16 v[132:135], a[128:131], v[196:199], v[132:135]
 ds_read_b128 a[188:191], v8 offset:12288
 v_mfma_f32_16x16x32_bf16 v[136:139], a[128:131], v[200:203], v[56:59]
 v_exp_f32 v128, v128
 v_mfma_f32_16x16x32_bf16 v[136:139], a[132:135], v[216:219], v[136:139]
 v_exp_f32 v129, v129
 v_mfma_f32_16x16x32_bf16 v[136:139], a[136:139], v[232:235], v[136:139]
 v_exp_f32 v130, v130
 v_mfma_f32_16x16x32_bf16 v[136:139], a[140:143], v[248:251], v[136:139]
 v_exp_f32 v131, v131
 v_mfma_f32_16x16x32_bf16 v[140:143], a[140:143], v[252:255], v[60:63]
 v_exp_f32 v132, v132
 v_mfma_f32_16x16x32_bf16 v[140:143], a[136:139], v[236:239], v[140:143]
 v_exp_f32 v133, v133
 v_mfma_f32_16x16x32_bf16 v[140:143], a[132:135], v[220:223], v[140:143]
 v_exp_f32 v134, v134
 v_mfma_f32_16x16x32_bf16 v[140:143], a[128:131], v[204:207], v[140:143]
 s_waitcnt lgkmcnt(8)
 v_exp_f32 v135, v135
 v_mfma_f32_16x16x32_bf16 v[144:147], a[144:147], v[204:207], v[60:63]
 v_exp_f32 v136, v136
 buffer_load_dwordx4 v2, s[8:11], s49 offen offset:1024 lds
 v_mfma_f32_16x16x32_bf16 v[144:147], a[148:151], v[220:223], v[144:147]
 v_exp_f32 v137, v137
 v_mfma_f32_16x16x32_bf16 v[144:147], a[152:155], v[236:239], v[144:147]
 v_exp_f32 v138, v138
 v_mfma_f32_16x16x32_bf16 v[144:147], a[156:159], v[252:255], v[144:147]
 v_exp_f32 v139, v139
 v_mfma_f32_16x16x32_bf16 v[148:151], a[156:159], v[248:251], v[56:59]
 v_exp_f32 v140, v140
 v_mfma_f32_16x16x32_bf16 v[148:151], a[152:155], v[232:235], v[148:151]
 v_exp_f32 v141, v141
 v_mfma_f32_16x16x32_bf16 v[148:151], a[148:151], v[216:219], v[148:151]
 v_exp_f32 v142, v142
 v_mfma_f32_16x16x32_bf16 v[148:151], a[144:147], v[200:203], v[148:151]
 v_exp_f32 v143, v143
 v_mfma_f32_16x16x32_bf16 v[152:155], a[144:147], v[196:199], v[52:55]
 v_exp_f32 v144, v144
 v_mfma_f32_16x16x32_bf16 v[152:155], a[148:151], v[212:215], v[152:155]
 v_exp_f32 v145, v145
 v_mfma_f32_16x16x32_bf16 v[152:155], a[152:155], v[228:231], v[152:155]
 v_exp_f32 v146, v146
 v_mfma_f32_16x16x32_bf16 v[152:155], a[156:159], v[244:247], v[152:155]
 v_exp_f32 v147, v147
 v_mfma_f32_16x16x32_bf16 v[156:159], a[156:159], v[240:243], v[48:51]
 v_exp_f32 v148, v148
 v_mfma_f32_16x16x32_bf16 v[156:159], a[152:155], v[224:227], v[156:159]
 v_exp_f32 v149, v149
 v_mfma_f32_16x16x32_bf16 v[156:159], a[148:151], v[208:211], v[156:159]
 v_exp_f32 v150, v150
 buffer_load_dwordx4 v3, s[8:11], s49 offen offset:2048 lds
 v_mfma_f32_16x16x32_bf16 v[156:159], a[144:147], v[192:195], v[156:159]
 s_waitcnt lgkmcnt(4)
 v_exp_f32 v151, v151
 v_mfma_f32_16x16x32_bf16 v[160:163], a[160:163], v[192:195], v[48:51]
 v_exp_f32 v152, v152
 v_mfma_f32_16x16x32_bf16 v[160:163], a[164:167], v[208:211], v[160:163]
 v_exp_f32 v153, v153
 v_mfma_f32_16x16x32_bf16 v[160:163], a[168:171], v[224:227], v[160:163]
 v_exp_f32 v154, v154
 v_mfma_f32_16x16x32_bf16 v[160:163], a[172:175], v[240:243], v[160:163]
 v_exp_f32 v155, v155
 v_mfma_f32_16x16x32_bf16 v[164:167], a[172:175], v[244:247], v[52:55]
 v_exp_f32 v156, v156
 v_mfma_f32_16x16x32_bf16 v[164:167], a[168:171], v[228:231], v[164:167]
 v_exp_f32 v157, v157
 v_mfma_f32_16x16x32_bf16 v[164:167], a[164:167], v[212:215], v[164:167]
 v_exp_f32 v158, v158
 v_mfma_f32_16x16x32_bf16 v[164:167], a[160:163], v[196:199], v[164:167]
 v_exp_f32 v159, v159
 v_mfma_f32_16x16x32_bf16 v[168:171], a[160:163], v[200:203], v[56:59]
 v_exp_f32 v160, v160
 v_mfma_f32_16x16x32_bf16 v[168:171], a[164:167], v[216:219], v[168:171]
 v_exp_f32 v161, v161
 buffer_store_dwordx4 v[108:111], v28, s[32:35], s58 offen offset:1024 sc1
 v_mfma_f32_16x16x32_bf16 v[168:171], a[168:171], v[232:235], v[168:171]
 v_exp_f32 v162, v162
 v_mfma_f32_16x16x32_bf16 v[168:171], a[172:175], v[248:251], v[168:171]
 v_exp_f32 v163, v163
 v_mfma_f32_16x16x32_bf16 v[172:175], a[172:175], v[252:255], v[60:63]
 ds_read_b64_tr_b16 a[192:193], v9 offset:49152
 v_cvt_pk_bf16_f32 v96, v128, v129
 v_mfma_f32_16x16x32_bf16 v[172:175], a[168:171], v[236:239], v[172:175]
 v_exp_f32 v164, v164
 buffer_load_dwordx4 v4, s[8:11], s49 offen offset:3072 lds
 v_mfma_f32_16x16x32_bf16 v[172:175], a[164:167], v[220:223], v[172:175]
 s_add_u32 s49, s49, 16384
 ds_read_b64_tr_b16 a[194:195], v9 offset:53248
 v_cvt_pk_bf16_f32 v97, v130, v131
 v_mfma_f32_16x16x32_bf16 v[172:175], a[160:163], v[204:207], v[172:175]
 s_waitcnt lgkmcnt(2)
 v_exp_f32 v165, v165
 v_mfma_f32_16x16x32_bf16 v[176:179], a[176:179], v[204:207], v[60:63]
 ds_read_b64_tr_b16 a[196:197], v9 offset:57344
 v_cvt_pk_bf16_f32 v104, v132, v133
 v_mfma_f32_16x16x32_bf16 v[176:179], a[180:183], v[220:223], v[176:179]
 v_exp_f32 v166, v166
 v_mfma_f32_16x16x32_bf16 v[176:179], a[184:187], v[236:239], v[176:179]
 ds_read_b64_tr_b16 a[198:199], v9 offset:61440
 v_cvt_pk_bf16_f32 v105, v134, v135
 v_mfma_f32_16x16x32_bf16 v[176:179], a[188:191], v[252:255], v[176:179]
 v_exp_f32 v167, v167
 v_mfma_f32_16x16x32_bf16 v[180:183], a[188:191], v[248:251], v[56:59]
 ds_read_b64_tr_b16 a[200:201], v10 offset:49152
 v_cvt_pk_bf16_f32 v112, v136, v137
 v_mfma_f32_16x16x32_bf16 v[180:183], a[184:187], v[232:235], v[180:183]
 v_exp_f32 v168, v168
 v_mfma_f32_16x16x32_bf16 v[180:183], a[180:183], v[216:219], v[180:183]
 ds_read_b64_tr_b16 a[202:203], v10 offset:53248
 v_cvt_pk_bf16_f32 v113, v138, v139
 v_mfma_f32_16x16x32_bf16 v[180:183], a[176:179], v[200:203], v[180:183]
 v_exp_f32 v169, v169
 v_mfma_f32_16x16x32_bf16 v[184:187], a[176:179], v[196:199], v[52:55]
 ds_read_b64_tr_b16 a[204:205], v10 offset:57344
 v_cvt_pk_bf16_f32 v120, v140, v141
 v_mfma_f32_16x16x32_bf16 v[184:187], a[180:183], v[212:215], v[184:187]
 v_exp_f32 v170, v170
 v_mfma_f32_16x16x32_bf16 v[184:187], a[184:187], v[228:231], v[184:187]
 ds_read_b64_tr_b16 a[206:207], v10 offset:61440
 v_cvt_pk_bf16_f32 v121, v142, v143
 v_mfma_f32_16x16x32_bf16 v[184:187], a[188:191], v[244:247], v[184:187]
 v_exp_f32 v171, v171
 v_mfma_f32_16x16x32_bf16 v[188:191], a[188:191], v[240:243], v[48:51]
 v_exp_f32 v172, v172
 v_mfma_f32_16x16x32_bf16 v[188:191], a[184:187], v[224:227], v[188:191]
 v_exp_f32 v173, v173
 v_mfma_f32_16x16x32_bf16 v[188:191], a[180:183], v[208:211], v[188:191]
 s_waitcnt vmcnt(18)
 v_exp_f32 v174, v174
 v_mfma_f32_16x16x32_bf16 v[188:191], a[176:179], v[192:195], v[188:191]
 s_barrier
 v_exp_f32 v175, v175
 v_smfmac_f32_16x16x64_bf16 v[32:35], a[224:227], v[64:71], v17
 v_exp_f32 v176, v176
 v_smfmac_f32_16x16x64_bf16 v[36:39], a[224:227], v[72:79], v17
 s_or_b32 s3, s44, s57
 v_exp_f32 v177, v177
 v_smfmac_f32_16x16x64_bf16 v[40:43], a[224:227], v[80:87], v17
 s_lshl_b32 s3, s3, 17
 v_exp_f32 v178, v178
 v_smfmac_f32_16x16x64_bf16 v[44:47], a[224:227], v[88:95], v17
 s_waitcnt lgkmcnt(4)
 v_exp_f32 v179, v179
 v_mfma_f32_16x16x32_bf16 a[0:3], a[192:195], v[64:67], 0
 s_lshl_b32 s4, s46, 2
 ds_read_b64_tr_b16 a[208:209], v11 offset:49152
 ds_read_b64_tr_b16 a[210:211], v11 offset:53248
 v_mfma_f32_16x16x32_bf16 a[0:3], a[196:199], v[68:71], a[0:3]
 s_add_u32 s3, s3, s4
 v_mfma_f32_16x16x32_bf16 a[4:7], a[196:199], v[76:79], 0
 s_add_u32 s6, s3, 32
 ds_read_b64_tr_b16 a[212:213], v11 offset:57344
 ds_read_b64_tr_b16 a[214:215], v11 offset:61440
 v_mfma_f32_16x16x32_bf16 a[4:7], a[192:195], v[72:75], a[4:7]
 s_lshl_b32 s5, s44, 24
 v_exp_f32 v180, v180
 v_mfma_f32_16x16x32_bf16 a[8:11], a[192:195], v[80:83], 0
 s_add_u32 s5, s5, 524320
 v_exp_f32 v181, v181
 v_mfma_f32_16x16x32_bf16 a[8:11], a[196:199], v[84:87], a[8:11]
 s_lshr_b32 s3, s2, 3
 v_exp_f32 v182, v182
 v_mfma_f32_16x16x32_bf16 a[12:15], a[196:199], v[92:95], 0
 s_lshl_b32 s3, s3, 2
 v_exp_f32 v183, v183
 v_mfma_f32_16x16x32_bf16 a[12:15], a[192:195], v[88:91], a[12:15]
 s_waitcnt lgkmcnt(4)
 v_exp_f32 v184, v184
 v_mfma_f32_16x16x32_bf16 a[28:31], a[200:203], v[88:91], 0
 s_add_u32 s3, s3, s44
 ds_read_b64_tr_b16 a[216:217], v12 offset:49152
 ds_read_b64_tr_b16 a[218:219], v12 offset:53248
 v_mfma_f32_16x16x32_bf16 a[28:31], a[204:207], v[92:95], a[28:31]
 s_bfe_u32 s4, s2, 0x10002
 v_mfma_f32_16x16x32_bf16 a[24:27], a[204:207], v[84:87], 0
 s_lshl_b32 s4, s4, 6
 ds_read_b64_tr_b16 a[220:221], v12 offset:57344
 ds_read_b64_tr_b16 a[222:223], v12 offset:61440
 v_mfma_f32_16x16x32_bf16 a[24:27], a[200:203], v[80:83], a[24:27]
 s_lshr_b32 s7, s3, 1
 v_exp_f32 v185, v185
 v_mfma_f32_16x16x32_bf16 a[20:23], a[200:203], v[72:75], 0
 s_add_u32 s4, s4, s7
 v_exp_f32 v186, v186
 v_mfma_f32_16x16x32_bf16 a[20:23], a[204:207], v[76:79], a[20:23]
 s_mul_i32 s4, s4, 57344
 v_exp_f32 v187, v187
 v_mfma_f32_16x16x32_bf16 a[16:19], a[204:207], v[68:71], 0
 s_bfe_u32 s7, s2, 0x10001
 v_exp_f32 v188, v188
 v_mfma_f32_16x16x32_bf16 a[16:19], a[200:203], v[64:67], a[16:19]
 s_waitcnt lgkmcnt(4)
 v_exp_f32 v189, v189
 v_mfma_f32_16x16x32_bf16 a[32:35], a[208:211], v[64:67], 0
 s_mul_i32 s7, s7, 28672
 ds_read_b64_tr_b16 a[192:193], v13 offset:49152
 ds_read_b64_tr_b16 a[194:195], v13 offset:53248
 v_mfma_f32_16x16x32_bf16 a[32:35], a[212:215], v[68:71], a[32:35]
 s_add_u32 s4, s4, s7
 v_mfma_f32_16x16x32_bf16 a[36:39], a[212:215], v[76:79], 0
 s_and_b32 s7, s2, 1
 ds_read_b64_tr_b16 a[196:197], v13 offset:57344
 ds_read_b64_tr_b16 a[198:199], v13 offset:61440
 v_mfma_f32_16x16x32_bf16 a[36:39], a[208:211], v[72:75], a[36:39]
 s_mul_i32 s7, s7, 20480
 v_exp_f32 v190, v190
 v_mfma_f32_16x16x32_bf16 a[40:43], a[208:211], v[80:83], 0
 s_add_u32 s4, s4, s7
 v_exp_f32 v191, v191
 v_mfma_f32_16x16x32_bf16 a[40:43], a[212:215], v[84:87], a[40:43]
 s_and_b32 s7, s3, 1
 v_cvt_pk_bf16_f32 v122, v144, v145
 v_cvt_pk_bf16_f32 v123, v146, v147
 v_mfma_f32_16x16x32_bf16 a[44:47], a[212:215], v[92:95], 0
 s_lshl_b32 s7, s7, 13
 v_cvt_pk_bf16_f32 v114, v148, v149
 v_cvt_pk_bf16_f32 v115, v150, v151
 v_mfma_f32_16x16x32_bf16 a[44:47], a[208:211], v[88:91], a[44:47]
 s_waitcnt lgkmcnt(4)
 v_cvt_pk_bf16_f32 v106, v152, v153
 v_cvt_pk_bf16_f32 v107, v154, v155
 v_mfma_f32_16x16x32_bf16 a[60:63], a[216:219], v[88:91], 0
 s_add_u32 s4, s4, s7
 ds_read_b64_tr_b16 a[200:201], v14 offset:49152
 ds_read_b64_tr_b16 a[202:203], v14 offset:53248
 v_mfma_f32_16x16x32_bf16 a[60:63], a[220:223], v[92:95], a[60:63]
 s_add_u32 s88, s4, 8192
 v_mfma_f32_16x16x32_bf16 a[56:59], a[220:223], v[84:87], 0
 s_lshr_b32 s4, s3, 4
 ds_read_b64_tr_b16 a[204:205], v14 offset:57344
 ds_read_b64_tr_b16 a[206:207], v14 offset:61440
 v_mfma_f32_16x16x32_bf16 a[56:59], a[216:219], v[80:83], a[56:59]
 s_mul_i32 s4, s4, 753664
 v_cvt_pk_bf16_f32 v98, v156, v157
 v_cvt_pk_bf16_f32 v99, v158, v159
 v_mfma_f32_16x16x32_bf16 a[52:55], a[216:219], v[72:75], 0
 s_and_b32 s3, s3, 15
 v_cvt_pk_bf16_f32 v100, v160, v161
 v_cvt_pk_bf16_f32 v101, v162, v163
 v_mfma_f32_16x16x32_bf16 a[52:55], a[220:223], v[76:79], a[52:55]
 s_and_b32 s7, s2, 3
 v_cvt_pk_bf16_f32 v108, v164, v165
 v_cvt_pk_bf16_f32 v109, v166, v167
 v_mfma_f32_16x16x32_bf16 a[48:51], a[220:223], v[68:71], 0
 s_mul_i32 s7, s7, 131072
 v_cvt_pk_bf16_f32 v116, v168, v169
 v_cvt_pk_bf16_f32 v117, v170, v171
 v_mfma_f32_16x16x32_bf16 a[48:51], a[216:219], v[64:67], a[48:51]
 s_waitcnt lgkmcnt(4)
 v_cvt_pk_bf16_f32 v124, v172, v173
 v_cvt_pk_bf16_f32 v125, v174, v175
 v_mfma_f32_16x16x32_bf16 a[64:67], a[192:195], v[64:67], 0
 s_add_u32 m0, s47, 16384
 ds_read_b64_tr_b16 a[208:209], v15 offset:49152
 ds_read_b64_tr_b16 a[210:211], v15 offset:53248
 v_mfma_f32_16x16x32_bf16 a[64:67], a[196:199], v[68:71], a[64:67]
 s_add_u32 s4, s4, s7
 buffer_load_dwordx4 v1, s[8:11], s49 offen offset:0 lds
 v_mfma_f32_16x16x32_bf16 a[68:71], a[196:199], v[76:79], 0
 s_lshl_b32 s7, s3, 13
 ds_read_b64_tr_b16 a[212:213], v15 offset:57344
 ds_read_b64_tr_b16 a[214:215], v15 offset:61440
 v_mfma_f32_16x16x32_bf16 a[68:71], a[192:195], v[72:75], a[68:71]
 s_add_u32 s4, s4, s7
 v_cvt_pk_bf16_f32 v126, v176, v177
 v_cvt_pk_bf16_f32 v127, v178, v179
 v_mfma_f32_16x16x32_bf16 a[72:75], a[192:195], v[80:83], 0
 s_add_u32 s90, s4, 229376
 v_cvt_pk_bf16_f32 v118, v180, v181
 v_cvt_pk_bf16_f32 v119, v182, v183
 v_mfma_f32_16x16x32_bf16 a[72:75], a[196:199], v[84:87], a[72:75]
 s_mov_b32 s56, 0
 v_cvt_pk_bf16_f32 v110, v184, v185
 v_cvt_pk_bf16_f32 v111, v186, v187
 v_mfma_f32_16x16x32_bf16 a[76:79], a[196:199], v[92:95], 0
 s_mov_b32 s62, 0
 v_cvt_pk_bf16_f32 v102, v188, v189
 v_cvt_pk_bf16_f32 v103, v190, v191
 v_mfma_f32_16x16x32_bf16 a[76:79], a[192:195], v[88:91], a[76:79]
 s_waitcnt lgkmcnt(4)
 v_mfma_f32_16x16x32_bf16 a[92:95], a[200:203], v[88:91], 0
 s_mov_b32 s91, 0x7ff00000
 ds_read_b64_tr_b16 a[216:217], v16 offset:49152
 ds_read_b64_tr_b16 a[218:219], v16 offset:53248
 v_mfma_f32_16x16x32_bf16 a[92:95], a[204:207], v[92:95], a[92:95]
 buffer_load_dwordx4 v2, s[8:11], s49 offen offset:1024 lds
 v_mfma_f32_16x16x32_bf16 a[88:91], a[204:207], v[84:87], 0
 ds_read_b64_tr_b16 a[220:221], v16 offset:57344
 ds_read_b64_tr_b16 a[222:223], v16 offset:61440
 v_mfma_f32_16x16x32_bf16 a[88:91], a[200:203], v[80:83], a[88:91]
 v_mfma_f32_16x16x32_bf16 a[84:87], a[200:203], v[72:75], 0
 v_mfma_f32_16x16x32_bf16 a[84:87], a[204:207], v[76:79], a[84:87]
 v_mfma_f32_16x16x32_bf16 a[80:83], a[204:207], v[68:71], 0
 v_mfma_f32_16x16x32_bf16 a[80:83], a[200:203], v[64:67], a[80:83]
 s_waitcnt lgkmcnt(4)
 v_mfma_f32_16x16x32_bf16 a[96:99], a[208:211], v[64:67], 0
 ds_read_b128 a[128:131], v5 offset:16384
 ds_read_b128 a[132:135], v6 offset:16384
 v_mfma_f32_16x16x32_bf16 a[96:99], a[212:215], v[68:71], a[96:99]
 buffer_load_dwordx4 v3, s[8:11], s49 offen offset:2048 lds
 v_mfma_f32_16x16x32_bf16 a[100:103], a[212:215], v[76:79], 0
 ds_read_b128 a[136:139], v7 offset:16384
 ds_read_b128 a[140:143], v8 offset:16384
 v_mfma_f32_16x16x32_bf16 a[100:103], a[208:211], v[72:75], a[100:103]
 v_mfma_f32_16x16x32_bf16 a[104:107], a[208:211], v[80:83], 0
 v_mfma_f32_16x16x32_bf16 a[104:107], a[212:215], v[84:87], a[104:107]
 v_mfma_f32_16x16x32_bf16 a[108:111], a[212:215], v[92:95], 0
 v_mfma_f32_16x16x32_bf16 a[108:111], a[208:211], v[88:91], a[108:111]
 s_waitcnt lgkmcnt(4)
 v_mfma_f32_16x16x32_bf16 a[124:127], a[216:219], v[88:91], 0
 ds_read_b128 a[144:147], v5 offset:20480
 ds_read_b128 a[148:151], v6 offset:20480
 v_mfma_f32_16x16x32_bf16 a[124:127], a[220:223], v[92:95], a[124:127]
 buffer_load_dwordx4 v4, s[8:11], s49 offen offset:3072 lds
 v_mfma_f32_16x16x32_bf16 a[120:123], a[220:223], v[84:87], 0
 s_add_u32 s49, s49, 16384
 ds_read_b128 a[152:155], v7 offset:20480
 ds_read_b128 a[156:159], v8 offset:20480
 v_mfma_f32_16x16x32_bf16 a[120:123], a[216:219], v[80:83], a[120:123]
 v_mfma_f32_16x16x32_bf16 a[116:119], a[216:219], v[72:75], 0
 v_mfma_f32_16x16x32_bf16 a[116:119], a[220:223], v[76:79], a[116:119]
 v_mfma_f32_16x16x32_bf16 a[112:115], a[220:223], v[68:71], 0
 v_mfma_f32_16x16x32_bf16 a[112:115], a[216:219], v[64:67], a[112:115]
 s_waitcnt lgkmcnt(4)
 v_mfma_f32_16x16x32_bf16 v[128:131], a[128:131], v[192:195], v[48:51]
 ds_read_b128 a[160:163], v5 offset:24576
 v_mfma_f32_16x16x32_bf16 v[128:131], a[132:135], v[208:211], v[128:131]
 s_add_u32 m0, s47, 0
 ds_read_b128 a[164:167], v6 offset:24576
 v_mfma_f32_16x16x32_bf16 v[128:131], a[136:139], v[224:227], v[128:131]
 ds_read_b128 a[168:171], v7 offset:24576
 buffer_load_dwordx4 v21, s[20:23], s51 offen offset:0 lds
 v_mfma_f32_16x16x32_bf16 v[128:131], a[140:143], v[240:243], v[128:131]
 ds_read_b128 a[172:175], v8 offset:24576
 v_mfma_f32_16x16x32_bf16 v[132:135], a[140:143], v[244:247], v[52:55]
 ds_read_b128 a[176:179], v5 offset:28672
 v_mfma_f32_16x16x32_bf16 v[132:135], a[136:139], v[228:231], v[132:135]
 ds_read_b128 a[180:183], v6 offset:28672
 v_mfma_f32_16x16x32_bf16 v[132:135], a[132:135], v[212:215], v[132:135]
 ds_read_b128 a[184:187], v7 offset:28672
 buffer_load_dwordx4 v22, s[20:23], s51 offen offset:1024 lds
 v_mfma_f32_16x16x32_bf16 v[132:135], a[128:131], v[196:199], v[132:135]
 ds_read_b128 a[188:191], v8 offset:28672
 v_mfma_f32_16x16x32_bf16 v[136:139], a[128:131], v[200:203], v[56:59]
 v_exp_f32 v128, v128
 v_mfma_f32_16x16x32_bf16 v[136:139], a[132:135], v[216:219], v[136:139]
 v_exp_f32 v129, v129
 v_mfma_f32_16x16x32_bf16 v[136:139], a[136:139], v[232:235], v[136:139]
 v_exp_f32 v130, v130
 v_mfma_f32_16x16x32_bf16 v[136:139], a[140:143], v[248:251], v[136:139]
 v_exp_f32 v131, v131
 v_mfma_f32_16x16x32_bf16 v[140:143], a[140:143], v[252:255], v[60:63]
 v_exp_f32 v132, v132
 v_mfma_f32_16x16x32_bf16 v[140:143], a[136:139], v[236:239], v[140:143]
 v_exp_f32 v133, v133
 buffer_load_dwordx4 v23, s[20:23], s51 offen offset:2048 lds
 v_mfma_f32_16x16x32_bf16 v[140:143], a[132:135], v[220:223], v[140:143]
 v_exp_f32 v134, v134
 v_mfma_f32_16x16x32_bf16 v[140:143], a[128:131], v[204:207], v[140:143]
 s_waitcnt lgkmcnt(8)
 v_exp_f32 v135, v135
 v_mfma_f32_16x16x32_bf16 v[144:147], a[144:147], v[204:207], v[60:63]
 v_exp_f32 v136, v136
 v_mfma_f32_16x16x32_bf16 v[144:147], a[148:151], v[220:223], v[144:147]
 v_exp_f32 v137, v137
 v_mfma_f32_16x16x32_bf16 v[144:147], a[152:155], v[236:239], v[144:147]
 v_exp_f32 v138, v138
 v_mfma_f32_16x16x32_bf16 v[144:147], a[156:159], v[252:255], v[144:147]
 v_exp_f32 v139, v139
 v_mfma_f32_16x16x32_bf16 v[148:151], a[156:159], v[248:251], v[56:59]
 v_exp_f32 v140, v140
 buffer_load_dwordx4 v24, s[20:23], s51 offen offset:3072 lds
 v_mfma_f32_16x16x32_bf16 v[148:151], a[152:155], v[232:235], v[148:151]
 s_add_u32 m0, s47, 81920
 v_exp_f32 v141, v141
 v_mfma_f32_16x16x32_bf16 v[148:151], a[148:151], v[216:219], v[148:151]
 v_exp_f32 v142, v142
 v_mfma_f32_16x16x32_bf16 v[148:151], a[144:147], v[200:203], v[148:151]
 v_exp_f32 v143, v143
 v_mfma_f32_16x16x32_bf16 v[152:155], a[144:147], v[196:199], v[52:55]
 v_exp_f32 v144, v144
 v_mfma_f32_16x16x32_bf16 v[152:155], a[148:151], v[212:215], v[152:155]
 v_exp_f32 v145, v145
 v_mfma_f32_16x16x32_bf16 v[152:155], a[152:155], v[228:231], v[152:155]
 v_exp_f32 v146, v146
 v_mfma_f32_16x16x32_bf16 v[152:155], a[156:159], v[244:247], v[152:155]
 v_exp_f32 v147, v147
 buffer_load_dwordx4 v21, s[16:19], s51 offen offset:0 lds
 v_mfma_f32_16x16x32_bf16 v[156:159], a[156:159], v[240:243], v[48:51]
 v_exp_f32 v148, v148
 v_mfma_f32_16x16x32_bf16 v[156:159], a[152:155], v[224:227], v[156:159]
 v_exp_f32 v149, v149
 v_mfma_f32_16x16x32_bf16 v[156:159], a[148:151], v[208:211], v[156:159]
 v_exp_f32 v150, v150
 v_mfma_f32_16x16x32_bf16 v[156:159], a[144:147], v[192:195], v[156:159]
 s_waitcnt lgkmcnt(4)
 v_exp_f32 v151, v151
 v_mfma_f32_16x16x32_bf16 v[160:163], a[160:163], v[192:195], v[48:51]
 v_exp_f32 v152, v152
 v_mfma_f32_16x16x32_bf16 v[160:163], a[164:167], v[208:211], v[160:163]
 v_exp_f32 v153, v153
 v_mfma_f32_16x16x32_bf16 v[160:163], a[168:171], v[224:227], v[160:163]
 v_exp_f32 v154, v154
 buffer_load_dwordx4 v22, s[16:19], s51 offen offset:1024 lds
 v_mfma_f32_16x16x32_bf16 v[160:163], a[172:175], v[240:243], v[160:163]
 v_exp_f32 v155, v155
 v_mfma_f32_16x16x32_bf16 v[164:167], a[172:175], v[244:247], v[52:55]
 v_exp_f32 v156, v156
 v_mfma_f32_16x16x32_bf16 v[164:167], a[168:171], v[228:231], v[164:167]
 v_exp_f32 v157, v157
 v_mfma_f32_16x16x32_bf16 v[164:167], a[164:167], v[212:215], v[164:167]
 v_exp_f32 v158, v158
 v_mfma_f32_16x16x32_bf16 v[164:167], a[160:163], v[196:199], v[164:167]
 v_exp_f32 v159, v159
 v_mfma_f32_16x16x32_bf16 v[168:171], a[160:163], v[200:203], v[56:59]
 v_exp_f32 v160, v160
 v_mfma_f32_16x16x32_bf16 v[168:171], a[164:167], v[216:219], v[168:171]
 v_exp_f32 v161, v161
 buffer_load_dwordx4 v23, s[16:19], s51 offen offset:2048 lds
 v_mfma_f32_16x16x32_bf16 v[168:171], a[168:171], v[232:235], v[168:171]
 v_exp_f32 v162, v162
 v_mfma_f32_16x16x32_bf16 v[168:171], a[172:175], v[248:251], v[168:171]
 v_exp_f32 v163, v163
 v_mfma_f32_16x16x32_bf16 v[172:175], a[172:175], v[252:255], v[60:63]
 ds_read_b64_tr_b16 a[192:193], v9 offset:0
 v_cvt_pk_bf16_f32 v64, v128, v129
 v_mfma_f32_16x16x32_bf16 v[172:175], a[168:171], v[236:239], v[172:175]
 v_exp_f32 v164, v164
 v_mfma_f32_16x16x32_bf16 v[172:175], a[164:167], v[220:223], v[172:175]
 ds_read_b64_tr_b16 a[194:195], v9 offset:4096
 v_cvt_pk_bf16_f32 v65, v130, v131
 v_mfma_f32_16x16x32_bf16 v[172:175], a[160:163], v[204:207], v[172:175]
 s_waitcnt lgkmcnt(2)
 v_exp_f32 v165, v165
 buffer_load_dwordx4 v24, s[16:19], s51 offen offset:3072 lds
 v_mfma_f32_16x16x32_bf16 v[176:179], a[176:179], v[204:207], v[60:63]
 ds_read_b64_tr_b16 a[196:197], v9 offset:8192
 v_cvt_pk_bf16_f32 v72, v132, v133
 v_mfma_f32_16x16x32_bf16 v[176:179], a[180:183], v[220:223], v[176:179]
 v_exp_f32 v166, v166
 v_mfma_f32_16x16x32_bf16 v[176:179], a[184:187], v[236:239], v[176:179]
 ds_read_b64_tr_b16 a[198:199], v9 offset:12288
 v_cvt_pk_bf16_f32 v73, v134, v135
 v_mfma_f32_16x16x32_bf16 v[176:179], a[188:191], v[252:255], v[176:179]
 v_exp_f32 v167, v167
 v_mfma_f32_16x16x32_bf16 v[180:183], a[188:191], v[248:251], v[56:59]
 ds_read_b64_tr_b16 a[200:201], v10 offset:0
 v_cvt_pk_bf16_f32 v80, v136, v137
 v_mfma_f32_16x16x32_bf16 v[180:183], a[184:187], v[232:235], v[180:183]
 v_exp_f32 v168, v168
 v_mfma_f32_16x16x32_bf16 v[180:183], a[180:183], v[216:219], v[180:183]
 ds_read_b64_tr_b16 a[202:203], v10 offset:4096
 v_cvt_pk_bf16_f32 v81, v138, v139
 v_mfma_f32_16x16x32_bf16 v[180:183], a[176:179], v[200:203], v[180:183]
 v_exp_f32 v169, v169
 v_mfma_f32_16x16x32_bf16 v[184:187], a[176:179], v[196:199], v[52:55]
 ds_read_b64_tr_b16 a[204:205], v10 offset:8192
 v_cvt_pk_bf16_f32 v88, v140, v141
 v_mfma_f32_16x16x32_bf16 v[184:187], a[180:183], v[212:215], v[184:187]
 v_exp_f32 v170, v170
 v_mfma_f32_16x16x32_bf16 v[184:187], a[184:187], v[228:231], v[184:187]
 ds_read_b64_tr_b16 a[206:207], v10 offset:12288
 v_cvt_pk_bf16_f32 v89, v142, v143
 v_mfma_f32_16x16x32_bf16 v[184:187], a[188:191], v[244:247], v[184:187]
 v_exp_f32 v171, v171
 v_mfma_f32_16x16x32_bf16 v[188:191], a[188:191], v[240:243], v[48:51]
 v_exp_f32 v172, v172
 v_mfma_f32_16x16x32_bf16 v[188:191], a[184:187], v[224:227], v[188:191]
 v_exp_f32 v173, v173
 v_mfma_f32_16x16x32_bf16 v[188:191], a[180:183], v[208:211], v[188:191]
 s_waitcnt vmcnt(22)
 v_exp_f32 v174, v174
 v_mfma_f32_16x16x32_bf16 v[188:191], a[176:179], v[192:195], v[188:191]
 s_barrier
 v_exp_f32 v175, v175
 v_smfmac_f32_16x16x64_bf16 v[32:35], a[224:227], v[96:103], v17
 v_exp_f32 v176, v176
 v_smfmac_f32_16x16x64_bf16 v[36:39], a[224:227], v[104:111], v17
 v_exp_f32 v177, v177
 v_smfmac_f32_16x16x64_bf16 v[40:43], a[224:227], v[112:119], v17
 v_exp_f32 v178, v178
 v_smfmac_f32_16x16x64_bf16 v[44:47], a[224:227], v[120:127], v17
 s_waitcnt lgkmcnt(4)
 v_exp_f32 v179, v179
 v_mfma_f32_16x16x32_bf16 a[0:3], a[192:195], v[96:99], a[0:3]
 s_add_u32 m0, s47, 147456
 ds_read_b64_tr_b16 a[208:209], v11 offset:0
 ds_read_b64_tr_b16 a[210:211], v11 offset:4096
 v_mfma_f32_16x16x32_bf16 a[0:3], a[196:199], v[100:103], a[0:3]
 buffer_load_dwordx4 v1, s[12:15], s50 offen offset:0 lds
 v_mfma_f32_16x16x32_bf16 a[4:7], a[196:199], v[108:111], a[4:7]
 ds_read_b64_tr_b16 a[212:213], v11 offset:8192
 ds_read_b64_tr_b16 a[214:215], v11 offset:12288
 v_mfma_f32_16x16x32_bf16 a[4:7], a[192:195], v[104:107], a[4:7]
 v_exp_f32 v180, v180
 v_mfma_f32_16x16x32_bf16 a[8:11], a[192:195], v[112:115], a[8:11]
 v_exp_f32 v181, v181
 v_mfma_f32_16x16x32_bf16 a[8:11], a[196:199], v[116:119], a[8:11]
 v_exp_f32 v182, v182
 v_mfma_f32_16x16x32_bf16 a[12:15], a[196:199], v[124:127], a[12:15]
 v_exp_f32 v183, v183
 v_mfma_f32_16x16x32_bf16 a[12:15], a[192:195], v[120:123], a[12:15]
 s_waitcnt lgkmcnt(4)
 v_exp_f32 v184, v184
 v_mfma_f32_16x16x32_bf16 a[28:31], a[200:203], v[120:123], a[28:31]
 ds_read_b64_tr_b16 a[216:217], v12 offset:0
 ds_read_b64_tr_b16 a[218:219], v12 offset:4096
 v_mfma_f32_16x16x32_bf16 a[28:31], a[204:207], v[124:127], a[28:31]
 buffer_load_dwordx4 v2, s[12:15], s50 offen offset:1024 lds
 v_mfma_f32_16x16x32_bf16 a[24:27], a[204:207], v[116:119], a[24:27]
 ds_read_b64_tr_b16 a[220:221], v12 offset:8192
 ds_read_b64_tr_b16 a[222:223], v12 offset:12288
 v_mfma_f32_16x16x32_bf16 a[24:27], a[200:203], v[112:115], a[24:27]
 v_exp_f32 v185, v185
 v_mfma_f32_16x16x32_bf16 a[20:23], a[200:203], v[104:107], a[20:23]
 v_exp_f32 v186, v186
 v_mfma_f32_16x16x32_bf16 a[20:23], a[204:207], v[108:111], a[20:23]
 v_exp_f32 v187, v187
 v_mfma_f32_16x16x32_bf16 a[16:19], a[204:207], v[100:103], a[16:19]
 v_exp_f32 v188, v188
 v_mfma_f32_16x16x32_bf16 a[16:19], a[200:203], v[96:99], a[16:19]
 s_waitcnt lgkmcnt(4)
 v_exp_f32 v189, v189
 v_mfma_f32_16x16x32_bf16 a[32:35], a[208:211], v[96:99], a[32:35]
 ds_read_b64_tr_b16 a[192:193], v13 offset:0
 ds_read_b64_tr_b16 a[194:195], v13 offset:4096
 v_mfma_f32_16x16x32_bf16 a[32:35], a[212:215], v[100:103], a[32:35]
 buffer_load_dwordx4 v3, s[12:15], s50 offen offset:2048 lds
 v_mfma_f32_16x16x32_bf16 a[36:39], a[212:215], v[108:111], a[36:39]
 ds_read_b64_tr_b16 a[196:197], v13 offset:8192
 ds_read_b64_tr_b16 a[198:199], v13 offset:12288
 v_mfma_f32_16x16x32_bf16 a[36:39], a[208:211], v[104:107], a[36:39]
 v_exp_f32 v190, v190
 v_mfma_f32_16x16x32_bf16 a[40:43], a[208:211], v[112:115], a[40:43]
 v_exp_f32 v191, v191
 v_mfma_f32_16x16x32_bf16 a[40:43], a[212:215], v[116:119], a[40:43]
 v_cvt_pk_bf16_f32 v90, v144, v145
 v_cvt_pk_bf16_f32 v91, v146, v147
 v_mfma_f32_16x16x32_bf16 a[44:47], a[212:215], v[124:127], a[44:47]
 v_cvt_pk_bf16_f32 v82, v148, v149
 v_cvt_pk_bf16_f32 v83, v150, v151
 v_mfma_f32_16x16x32_bf16 a[44:47], a[208:211], v[120:123], a[44:47]
 s_waitcnt lgkmcnt(4)
 v_cvt_pk_bf16_f32 v74, v152, v153
 v_cvt_pk_bf16_f32 v75, v154, v155
 v_mfma_f32_16x16x32_bf16 a[60:63], a[216:219], v[120:123], a[60:63]
 ds_read_b64_tr_b16 a[200:201], v14 offset:0
 ds_read_b64_tr_b16 a[202:203], v14 offset:4096
 v_mfma_f32_16x16x32_bf16 a[60:63], a[220:223], v[124:127], a[60:63]
 buffer_load_dwordx4 v4, s[12:15], s50 offen offset:3072 lds
 v_mfma_f32_16x16x32_bf16 a[56:59], a[220:223], v[116:119], a[56:59]
 s_add_u32 s50, s50, 16384
 ds_read_b64_tr_b16 a[204:205], v14 offset:8192
 ds_read_b64_tr_b16 a[206:207], v14 offset:12288
 v_mfma_f32_16x16x32_bf16 a[56:59], a[216:219], v[112:115], a[56:59]
 v_cvt_pk_bf16_f32 v66, v156, v157
 v_cvt_pk_bf16_f32 v67, v158, v159
 v_mfma_f32_16x16x32_bf16 a[52:55], a[216:219], v[104:107], a[52:55]
 v_cvt_pk_bf16_f32 v68, v160, v161
 v_cvt_pk_bf16_f32 v69, v162, v163
 v_mfma_f32_16x16x32_bf16 a[52:55], a[220:223], v[108:111], a[52:55]
 v_cvt_pk_bf16_f32 v76, v164, v165
 v_cvt_pk_bf16_f32 v77, v166, v167
 v_mfma_f32_16x16x32_bf16 a[48:51], a[220:223], v[100:103], a[48:51]
 v_cvt_pk_bf16_f32 v84, v168, v169
 v_cvt_pk_bf16_f32 v85, v170, v171
 v_mfma_f32_16x16x32_bf16 a[48:51], a[216:219], v[96:99], a[48:51]
 s_waitcnt lgkmcnt(4)
 v_cvt_pk_bf16_f32 v92, v172, v173
 v_cvt_pk_bf16_f32 v93, v174, v175
 v_mfma_f32_16x16x32_bf16 a[64:67], a[192:195], v[96:99], a[64:67]
 s_add_u32 m0, s47, 32768
 ds_read_b64_tr_b16 a[208:209], v15 offset:0
 ds_read_b64_tr_b16 a[210:211], v15 offset:4096
 v_mfma_f32_16x16x32_bf16 a[64:67], a[196:199], v[100:103], a[64:67]
 buffer_load_dwordx4 v1, s[8:11], s49 offen offset:0 lds
 v_mfma_f32_16x16x32_bf16 a[68:71], a[196:199], v[108:111], a[68:71]
 ds_read_b64_tr_b16 a[212:213], v15 offset:8192
 ds_read_b64_tr_b16 a[214:215], v15 offset:12288
 v_mfma_f32_16x16x32_bf16 a[68:71], a[192:195], v[104:107], a[68:71]
 v_cvt_pk_bf16_f32 v94, v176, v177
 v_cvt_pk_bf16_f32 v95, v178, v179
 v_mfma_f32_16x16x32_bf16 a[72:75], a[192:195], v[112:115], a[72:75]
 v_cvt_pk_bf16_f32 v86, v180, v181
 v_cvt_pk_bf16_f32 v87, v182, v183
 v_mfma_f32_16x16x32_bf16 a[72:75], a[196:199], v[116:119], a[72:75]
 v_cvt_pk_bf16_f32 v78, v184, v185
 v_cvt_pk_bf16_f32 v79, v186, v187
 v_mfma_f32_16x16x32_bf16 a[76:79], a[196:199], v[124:127], a[76:79]
 v_cvt_pk_bf16_f32 v70, v188, v189
 v_cvt_pk_bf16_f32 v71, v190, v191
 v_mfma_f32_16x16x32_bf16 a[76:79], a[192:195], v[120:123], a[76:79]
 s_waitcnt lgkmcnt(4)
 v_mfma_f32_16x16x32_bf16 a[92:95], a[200:203], v[120:123], a[92:95]
 ds_read_b64_tr_b16 a[216:217], v16 offset:0
 ds_read_b64_tr_b16 a[218:219], v16 offset:4096
 v_mfma_f32_16x16x32_bf16 a[92:95], a[204:207], v[124:127], a[92:95]
 buffer_load_dwordx4 v2, s[8:11], s49 offen offset:1024 lds
 v_mfma_f32_16x16x32_bf16 a[88:91], a[204:207], v[116:119], a[88:91]
 ds_read_b64_tr_b16 a[220:221], v16 offset:8192
 ds_read_b64_tr_b16 a[222:223], v16 offset:12288
 v_mfma_f32_16x16x32_bf16 a[88:91], a[200:203], v[112:115], a[88:91]
 v_lshrrev_b32 v29, 6, v18
 v_and_b32 v30, 6, v29
 v_mfma_f32_16x16x32_bf16 a[84:87], a[200:203], v[104:107], a[84:87]
 v_bfe_u32 v31, v18, 5, 1
 v_xor_b32 v30, v30, v31
 v_mfma_f32_16x16x32_bf16 a[84:87], a[204:207], v[108:111], a[84:87]
 v_lshlrev_b32 v29, 7, v29
 v_bfe_u32 v31, v18, 4, 1
 v_mfma_f32_16x16x32_bf16 a[80:83], a[204:207], v[100:103], a[80:83]
 v_lshl_add_u32 v29, v31, 3, v29
 v_add_u32 v29, s47, v29
 v_mfma_f32_16x16x32_bf16 a[80:83], a[200:203], v[96:99], a[80:83]
 s_waitcnt lgkmcnt(4)
 v_xor_b32 v31, 0, v30
 v_lshl_add_u32 v25, v31, 4, v29
 v_mfma_f32_16x16x32_bf16 a[96:99], a[208:211], v[96:99], a[96:99]
 ds_read_b128 a[128:131], v5 offset:32768
 ds_read_b128 a[132:135], v6 offset:32768
 v_mfma_f32_16x16x32_bf16 a[96:99], a[212:215], v[100:103], a[96:99]
 buffer_load_dwordx4 v3, s[8:11], s49 offen offset:2048 lds
 v_mfma_f32_16x16x32_bf16 a[100:103], a[212:215], v[108:111], a[100:103]
 ds_read_b128 a[136:139], v7 offset:32768
 ds_read_b128 a[140:143], v8 offset:32768
 v_mfma_f32_16x16x32_bf16 a[100:103], a[208:211], v[104:107], a[100:103]
 v_xor_b32 v31, 2, v30
 v_lshl_add_u32 v26, v31, 4, v29
 v_mfma_f32_16x16x32_bf16 a[104:107], a[208:211], v[112:115], a[104:107]
 v_xor_b32 v31, 4, v30
 v_lshl_add_u32 v27, v31, 4, v29
 v_mfma_f32_16x16x32_bf16 a[104:107], a[212:215], v[116:119], a[104:107]
 v_xor_b32 v31, 6, v30
 v_lshl_add_u32 v28, v31, 4, v29
 v_mfma_f32_16x16x32_bf16 a[108:111], a[212:215], v[124:127], a[108:111]
 v_bfe_u32 v20, v18, 4, 3
 v_lshlrev_b32 v20, 2, v20
 v_mfma_f32_16x16x32_bf16 a[108:111], a[208:211], v[120:123], a[108:111]
 s_waitcnt lgkmcnt(4)
 v_add_u32 v20, s5, v20
 v_lshlrev_b32 v29, 13, v18
 v_mfma_f32_16x16x32_bf16 a[124:127], a[216:219], v[120:123], a[124:127]
 ds_read_b128 a[144:147], v5 offset:36864
 ds_read_b128 a[148:151], v6 offset:36864
 v_mfma_f32_16x16x32_bf16 a[124:127], a[220:223], v[124:127], a[124:127]
 buffer_load_dwordx4 v4, s[8:11], s49 offen offset:3072 lds
 v_mfma_f32_16x16x32_bf16 a[120:123], a[220:223], v[116:119], a[120:123]
 s_add_u32 s49, s49, 16384
 ds_read_b128 a[152:155], v7 offset:36864
 ds_read_b128 a[156:159], v8 offset:36864
 v_mfma_f32_16x16x32_bf16 a[120:123], a[216:219], v[112:115], a[120:123]
 v_add_u32 v29, s6, v29
 v_mov_b32 v30, 1
 v_mfma_f32_16x16x32_bf16 a[116:119], a[216:219], v[104:107], a[116:119]
 v_mfma_f32_16x16x32_bf16 a[116:119], a[220:223], v[108:111], a[116:119]
 v_mfma_f32_16x16x32_bf16 a[112:115], a[220:223], v[100:103], a[112:115]
 v_mfma_f32_16x16x32_bf16 a[112:115], a[216:219], v[96:99], a[112:115]
 s_waitcnt lgkmcnt(4)
 v_mfma_f32_16x16x32_bf16 v[128:131], a[128:131], v[192:195], v[48:51]
 ds_read_b128 a[160:163], v5 offset:40960
 v_mfma_f32_16x16x32_bf16 v[128:131], a[132:135], v[208:211], v[128:131]
 ds_read_b128 a[164:167], v6 offset:40960
 v_mfma_f32_16x16x32_bf16 v[128:131], a[136:139], v[224:227], v[128:131]
 ds_read_b128 a[168:171], v7 offset:40960
 v_mfma_f32_16x16x32_bf16 v[128:131], a[140:143], v[240:243], v[128:131]
 ds_read_b128 a[172:175], v8 offset:40960
 v_mfma_f32_16x16x32_bf16 v[132:135], a[140:143], v[244:247], v[52:55]
 ds_read_b128 a[176:179], v5 offset:45056
 v_mfma_f32_16x16x32_bf16 v[132:135], a[136:139], v[228:231], v[132:135]
 ds_read_b128 a[180:183], v6 offset:45056
 v_mfma_f32_16x16x32_bf16 v[132:135], a[132:135], v[212:215], v[132:135]
 ds_read_b128 a[184:187], v7 offset:45056
 v_mfma_f32_16x16x32_bf16 v[132:135], a[128:131], v[196:199], v[132:135]
 ds_read_b128 a[188:191], v8 offset:45056
 v_mfma_f32_16x16x32_bf16 v[136:139], a[128:131], v[200:203], v[56:59]
 v_exp_f32 v128, v128
 v_mfma_f32_16x16x32_bf16 v[136:139], a[132:135], v[216:219], v[136:139]
 v_exp_f32 v129, v129
 v_mfma_f32_16x16x32_bf16 v[136:139], a[136:139], v[232:235], v[136:139]
 v_exp_f32 v130, v130
 v_mfma_f32_16x16x32_bf16 v[136:139], a[140:143], v[248:251], v[136:139]
 v_exp_f32 v131, v131
 v_mfma_f32_16x16x32_bf16 v[140:143], a[140:143], v[252:255], v[60:63]
 v_exp_f32 v132, v132
 v_mfma_f32_16x16x32_bf16 v[140:143], a[136:139], v[236:239], v[140:143]
 v_exp_f32 v133, v133
 v_mfma_f32_16x16x32_bf16 v[140:143], a[132:135], v[220:223], v[140:143]
 v_exp_f32 v134, v134
 v_mfma_f32_16x16x32_bf16 v[140:143], a[128:131], v[204:207], v[140:143]
 s_waitcnt lgkmcnt(8)
 v_exp_f32 v135, v135
 v_mfma_f32_16x16x32_bf16 v[144:147], a[144:147], v[204:207], v[60:63]
 v_exp_f32 v136, v136
 v_mfma_f32_16x16x32_bf16 v[144:147], a[148:151], v[220:223], v[144:147]
 v_exp_f32 v137, v137
 v_mfma_f32_16x16x32_bf16 v[144:147], a[152:155], v[236:239], v[144:147]
 v_exp_f32 v138, v138
 v_mfma_f32_16x16x32_bf16 v[144:147], a[156:159], v[252:255], v[144:147]
 v_exp_f32 v139, v139
 v_mfma_f32_16x16x32_bf16 v[148:151], a[156:159], v[248:251], v[56:59]
 v_exp_f32 v140, v140
 v_mfma_f32_16x16x32_bf16 v[148:151], a[152:155], v[232:235], v[148:151]
 v_exp_f32 v141, v141
 v_mfma_f32_16x16x32_bf16 v[148:151], a[148:151], v[216:219], v[148:151]
 v_exp_f32 v142, v142
 v_mfma_f32_16x16x32_bf16 v[148:151], a[144:147], v[200:203], v[148:151]
 v_exp_f32 v143, v143
 v_mfma_f32_16x16x32_bf16 v[152:155], a[144:147], v[196:199], v[52:55]
 v_exp_f32 v144, v144
 v_mfma_f32_16x16x32_bf16 v[152:155], a[148:151], v[212:215], v[152:155]
 v_exp_f32 v145, v145
 v_mfma_f32_16x16x32_bf16 v[152:155], a[152:155], v[228:231], v[152:155]
 v_exp_f32 v146, v146
 v_mfma_f32_16x16x32_bf16 v[152:155], a[156:159], v[244:247], v[152:155]
 v_exp_f32 v147, v147
 v_mfma_f32_16x16x32_bf16 v[156:159], a[156:159], v[240:243], v[48:51]
 v_exp_f32 v148, v148
 v_mfma_f32_16x16x32_bf16 v[156:159], a[152:155], v[224:227], v[156:159]
 v_exp_f32 v149, v149
 v_mfma_f32_16x16x32_bf16 v[156:159], a[148:151], v[208:211], v[156:159]
 v_exp_f32 v150, v150
 v_mfma_f32_16x16x32_bf16 v[156:159], a[144:147], v[192:195], v[156:159]
 s_waitcnt lgkmcnt(4)
 v_exp_f32 v151, v151
 v_mfma_f32_16x16x32_bf16 v[160:163], a[160:163], v[192:195], v[48:51]
 v_exp_f32 v152, v152
 v_mfma_f32_16x16x32_bf16 v[160:163], a[164:167], v[208:211], v[160:163]
 v_exp_f32 v153, v153
 v_mfma_f32_16x16x32_bf16 v[160:163], a[168:171], v[224:227], v[160:163]
 v_exp_f32 v154, v154
 v_mfma_f32_16x16x32_bf16 v[160:163], a[172:175], v[240:243], v[160:163]
 v_exp_f32 v155, v155
 v_mfma_f32_16x16x32_bf16 v[164:167], a[172:175], v[244:247], v[52:55]
 v_exp_f32 v156, v156
 v_mfma_f32_16x16x32_bf16 v[164:167], a[168:171], v[228:231], v[164:167]
 v_exp_f32 v157, v157
 v_mfma_f32_16x16x32_bf16 v[164:167], a[164:167], v[212:215], v[164:167]
 v_exp_f32 v158, v158
 v_mfma_f32_16x16x32_bf16 v[164:167], a[160:163], v[196:199], v[164:167]
 v_exp_f32 v159, v159
 v_mfma_f32_16x16x32_bf16 v[168:171], a[160:163], v[200:203], v[56:59]
 v_exp_f32 v160, v160
 v_mfma_f32_16x16x32_bf16 v[168:171], a[164:167], v[216:219], v[168:171]
 v_exp_f32 v161, v161
 v_mfma_f32_16x16x32_bf16 v[168:171], a[168:171], v[232:235], v[168:171]
 v_exp_f32 v162, v162
 v_mfma_f32_16x16x32_bf16 v[168:171], a[172:175], v[248:251], v[168:171]
 v_exp_f32 v163, v163
 v_mfma_f32_16x16x32_bf16 v[172:175], a[172:175], v[252:255], v[60:63]
 ds_read_b64_tr_b16 a[192:193], v9 offset:16384
 v_cvt_pk_bf16_f32 v96, v128, v129
 v_mfma_f32_16x16x32_bf16 v[172:175], a[168:171], v[236:239], v[172:175]
 v_exp_f32 v164, v164
 v_mfma_f32_16x16x32_bf16 v[172:175], a[164:167], v[220:223], v[172:175]
 ds_read_b64_tr_b16 a[194:195], v9 offset:20480
 v_cvt_pk_bf16_f32 v97, v130, v131
 v_mfma_f32_16x16x32_bf16 v[172:175], a[160:163], v[204:207], v[172:175]
 s_waitcnt lgkmcnt(2)
 v_exp_f32 v165, v165
 v_mfma_f32_16x16x32_bf16 v[176:179], a[176:179], v[204:207], v[60:63]
 ds_read_b64_tr_b16 a[196:197], v9 offset:24576
 v_cvt_pk_bf16_f32 v104, v132, v133
 v_mfma_f32_16x16x32_bf16 v[176:179], a[180:183], v[220:223], v[176:179]
 v_exp_f32 v166, v166
 v_mfma_f32_16x16x32_bf16 v[176:179], a[184:187], v[236:239], v[176:179]
 ds_read_b64_tr_b16 a[198:199], v9 offset:28672
 v_cvt_pk_bf16_f32 v105, v134, v135
 v_mfma_f32_16x16x32_bf16 v[176:179], a[188:191], v[252:255], v[176:179]
 v_exp_f32 v167, v167
 v_mfma_f32_16x16x32_bf16 v[180:183], a[188:191], v[248:251], v[56:59]
 ds_read_b64_tr_b16 a[200:201], v10 offset:16384
 v_cvt_pk_bf16_f32 v112, v136, v137
 v_mfma_f32_16x16x32_bf16 v[180:183], a[184:187], v[232:235], v[180:183]
 v_exp_f32 v168, v168
 v_mfma_f32_16x16x32_bf16 v[180:183], a[180:183], v[216:219], v[180:183]
 ds_read_b64_tr_b16 a[202:203], v10 offset:20480
 v_cvt_pk_bf16_f32 v113, v138, v139
 v_mfma_f32_16x16x32_bf16 v[180:183], a[176:179], v[200:203], v[180:183]
 v_exp_f32 v169, v169
 v_mfma_f32_16x16x32_bf16 v[184:187], a[176:179], v[196:199], v[52:55]
 ds_read_b64_tr_b16 a[204:205], v10 offset:24576
 v_cvt_pk_bf16_f32 v120, v140, v141
 v_mfma_f32_16x16x32_bf16 v[184:187], a[180:183], v[212:215], v[184:187]
 v_exp_f32 v170, v170
 v_mfma_f32_16x16x32_bf16 v[184:187], a[184:187], v[228:231], v[184:187]
 ds_read_b64_tr_b16 a[206:207], v10 offset:28672
 v_cvt_pk_bf16_f32 v121, v142, v143
 v_mfma_f32_16x16x32_bf16 v[184:187], a[188:191], v[244:247], v[184:187]
 v_exp_f32 v171, v171
 v_mfma_f32_16x16x32_bf16 v[188:191], a[188:191], v[240:243], v[48:51]
 v_exp_f32 v172, v172
 v_mfma_f32_16x16x32_bf16 v[188:191], a[184:187], v[224:227], v[188:191]
 v_exp_f32 v173, v173
 v_mfma_f32_16x16x32_bf16 v[188:191], a[180:183], v[208:211], v[188:191]
 s_waitcnt vmcnt(20)
 v_exp_f32 v174, v174
 v_mfma_f32_16x16x32_bf16 v[188:191], a[176:179], v[192:195], v[188:191]
 s_barrier
 v_exp_f32 v175, v175
 v_smfmac_f32_16x16x64_bf16 v[32:35], a[224:227], v[64:71], v17
 v_exp_f32 v176, v176
 v_smfmac_f32_16x16x64_bf16 v[36:39], a[224:227], v[72:79], v17
 v_exp_f32 v177, v177
 v_smfmac_f32_16x16x64_bf16 v[40:43], a[224:227], v[80:87], v17
 v_exp_f32 v178, v178
 v_smfmac_f32_16x16x64_bf16 v[44:47], a[224:227], v[88:95], v17
 s_waitcnt lgkmcnt(4)
 v_exp_f32 v179, v179
 v_mfma_f32_16x16x32_bf16 a[0:3], a[192:195], v[64:67], a[0:3]
 s_add_u32 m0, s47, 98304
 ds_read_b64_tr_b16 a[208:209], v11 offset:16384
 ds_read_b64_tr_b16 a[210:211], v11 offset:20480
 v_mfma_f32_16x16x32_bf16 a[0:3], a[196:199], v[68:71], a[0:3]
 buffer_load_dwordx4 v1, s[12:15], s50 offen offset:0 lds
 v_mfma_f32_16x16x32_bf16 a[4:7], a[196:199], v[76:79], a[4:7]
 ds_read_b64_tr_b16 a[212:213], v11 offset:24576
 ds_read_b64_tr_b16 a[214:215], v11 offset:28672
 v_mfma_f32_16x16x32_bf16 a[4:7], a[192:195], v[72:75], a[4:7]
 v_exp_f32 v180, v180
 v_mfma_f32_16x16x32_bf16 a[8:11], a[192:195], v[80:83], a[8:11]
 v_exp_f32 v181, v181
 v_mfma_f32_16x16x32_bf16 a[8:11], a[196:199], v[84:87], a[8:11]
 v_exp_f32 v182, v182
 v_mfma_f32_16x16x32_bf16 a[12:15], a[196:199], v[92:95], a[12:15]
 v_exp_f32 v183, v183
 v_mfma_f32_16x16x32_bf16 a[12:15], a[192:195], v[88:91], a[12:15]
 s_waitcnt lgkmcnt(4)
 v_exp_f32 v184, v184
 v_mfma_f32_16x16x32_bf16 a[28:31], a[200:203], v[88:91], a[28:31]
 ds_read_b64_tr_b16 a[216:217], v12 offset:16384
 ds_read_b64_tr_b16 a[218:219], v12 offset:20480
 v_mfma_f32_16x16x32_bf16 a[28:31], a[204:207], v[92:95], a[28:31]
 buffer_load_dwordx4 v2, s[12:15], s50 offen offset:1024 lds
 v_mfma_f32_16x16x32_bf16 a[24:27], a[204:207], v[84:87], a[24:27]
 ds_read_b64_tr_b16 a[220:221], v12 offset:24576
 ds_read_b64_tr_b16 a[222:223], v12 offset:28672
 v_mfma_f32_16x16x32_bf16 a[24:27], a[200:203], v[80:83], a[24:27]
 v_exp_f32 v185, v185
 v_mfma_f32_16x16x32_bf16 a[20:23], a[200:203], v[72:75], a[20:23]
 v_exp_f32 v186, v186
 v_mfma_f32_16x16x32_bf16 a[20:23], a[204:207], v[76:79], a[20:23]
 v_exp_f32 v187, v187
 v_mfma_f32_16x16x32_bf16 a[16:19], a[204:207], v[68:71], a[16:19]
 v_exp_f32 v188, v188
 v_mfma_f32_16x16x32_bf16 a[16:19], a[200:203], v[64:67], a[16:19]
 s_waitcnt lgkmcnt(4)
 v_exp_f32 v189, v189
 v_mfma_f32_16x16x32_bf16 a[32:35], a[208:211], v[64:67], a[32:35]
 ds_read_b64_tr_b16 a[192:193], v13 offset:16384
 ds_read_b64_tr_b16 a[194:195], v13 offset:20480
 v_mfma_f32_16x16x32_bf16 a[32:35], a[212:215], v[68:71], a[32:35]
 buffer_load_dwordx4 v3, s[12:15], s50 offen offset:2048 lds
 v_mfma_f32_16x16x32_bf16 a[36:39], a[212:215], v[76:79], a[36:39]
 ds_read_b64_tr_b16 a[196:197], v13 offset:24576
 ds_read_b64_tr_b16 a[198:199], v13 offset:28672
 v_mfma_f32_16x16x32_bf16 a[36:39], a[208:211], v[72:75], a[36:39]
 v_exp_f32 v190, v190
 v_mfma_f32_16x16x32_bf16 a[40:43], a[208:211], v[80:83], a[40:43]
 v_exp_f32 v191, v191
 v_mfma_f32_16x16x32_bf16 a[40:43], a[212:215], v[84:87], a[40:43]
 v_cvt_pk_bf16_f32 v122, v144, v145
 v_cvt_pk_bf16_f32 v123, v146, v147
 v_mfma_f32_16x16x32_bf16 a[44:47], a[212:215], v[92:95], a[44:47]
 v_cvt_pk_bf16_f32 v114, v148, v149
 v_cvt_pk_bf16_f32 v115, v150, v151
 v_mfma_f32_16x16x32_bf16 a[44:47], a[208:211], v[88:91], a[44:47]
 s_waitcnt lgkmcnt(4)
 v_cvt_pk_bf16_f32 v106, v152, v153
 v_cvt_pk_bf16_f32 v107, v154, v155
 v_mfma_f32_16x16x32_bf16 a[60:63], a[216:219], v[88:91], a[60:63]
 ds_read_b64_tr_b16 a[200:201], v14 offset:16384
 ds_read_b64_tr_b16 a[202:203], v14 offset:20480
 v_mfma_f32_16x16x32_bf16 a[60:63], a[220:223], v[92:95], a[60:63]
 buffer_load_dwordx4 v4, s[12:15], s50 offen offset:3072 lds
 v_mfma_f32_16x16x32_bf16 a[56:59], a[220:223], v[84:87], a[56:59]
 s_add_u32 s50, s50, 16384
 ds_read_b64_tr_b16 a[204:205], v14 offset:24576
 ds_read_b64_tr_b16 a[206:207], v14 offset:28672
 v_mfma_f32_16x16x32_bf16 a[56:59], a[216:219], v[80:83], a[56:59]
 v_cvt_pk_bf16_f32 v98, v156, v157
 v_cvt_pk_bf16_f32 v99, v158, v159
 v_mfma_f32_16x16x32_bf16 a[52:55], a[216:219], v[72:75], a[52:55]
 v_cvt_pk_bf16_f32 v100, v160, v161
 v_cvt_pk_bf16_f32 v101, v162, v163
 v_mfma_f32_16x16x32_bf16 a[52:55], a[220:223], v[76:79], a[52:55]
 v_cvt_pk_bf16_f32 v108, v164, v165
 v_cvt_pk_bf16_f32 v109, v166, v167
 v_mfma_f32_16x16x32_bf16 a[48:51], a[220:223], v[68:71], a[48:51]
 v_cvt_pk_bf16_f32 v116, v168, v169
 v_cvt_pk_bf16_f32 v117, v170, v171
 v_mfma_f32_16x16x32_bf16 a[48:51], a[216:219], v[64:67], a[48:51]
 s_waitcnt lgkmcnt(4)
 v_cvt_pk_bf16_f32 v124, v172, v173
 v_cvt_pk_bf16_f32 v125, v174, v175
 v_mfma_f32_16x16x32_bf16 a[64:67], a[192:195], v[64:67], a[64:67]
 s_add_u32 m0, s47, 49152
 ds_read_b64_tr_b16 a[208:209], v15 offset:16384
 ds_read_b64_tr_b16 a[210:211], v15 offset:20480
 v_mfma_f32_16x16x32_bf16 a[64:67], a[196:199], v[68:71], a[64:67]
 s_or_b32 s3, s44, s57
 buffer_load_dwordx4 v1, s[8:11], s49 offen offset:0 lds
 v_mfma_f32_16x16x32_bf16 a[68:71], a[196:199], v[76:79], a[68:71]
 s_lshl_b32 s3, s3, 17
 ds_read_b64_tr_b16 a[212:213], v15 offset:24576
 ds_read_b64_tr_b16 a[214:215], v15 offset:28672
 v_mfma_f32_16x16x32_bf16 a[68:71], a[192:195], v[72:75], a[68:71]
 s_lshl_b32 s4, s2, 8
 v_cvt_pk_bf16_f32 v126, v176, v177
 v_cvt_pk_bf16_f32 v127, v178, v179
 v_mfma_f32_16x16x32_bf16 a[72:75], a[192:195], v[80:83], a[72:75]
 s_add_u32 s3, s3, s4
 v_cvt_pk_bf16_f32 v118, v180, v181
 v_cvt_pk_bf16_f32 v119, v182, v183
 v_mfma_f32_16x16x32_bf16 a[72:75], a[196:199], v[84:87], a[72:75]
 s_add_u32 s5, s3, 18432
 v_cvt_pk_bf16_f32 v110, v184, v185
 v_cvt_pk_bf16_f32 v111, v186, v187
 v_mfma_f32_16x16x32_bf16 a[76:79], a[196:199], v[92:95], a[76:79]
 s_add_u32 s3, s3, 2048
 v_cvt_pk_bf16_f32 v102, v188, v189
 v_cvt_pk_bf16_f32 v103, v190, v191
 v_mfma_f32_16x16x32_bf16 a[76:79], a[192:195], v[88:91], a[76:79]
 s_waitcnt lgkmcnt(4)
 v_mfma_f32_16x16x32_bf16 a[92:95], a[200:203], v[88:91], a[92:95]
 s_cmp_lt_u32 s2, 64
 s_cselect_b32 s3, s3, 131072
 ds_read_b64_tr_b16 a[216:217], v16 offset:16384
 ds_read_b64_tr_b16 a[218:219], v16 offset:20480
 v_mfma_f32_16x16x32_bf16 a[92:95], a[204:207], v[92:95], a[92:95]
 buffer_load_dwordx4 v2, s[8:11], s49 offen offset:1024 lds
 v_mfma_f32_16x16x32_bf16 a[88:91], a[204:207], v[84:87], a[88:91]
 ds_read_b64_tr_b16 a[220:221], v16 offset:24576
 ds_read_b64_tr_b16 a[222:223], v16 offset:28672
 v_mfma_f32_16x16x32_bf16 a[88:91], a[200:203], v[80:83], a[88:91]
 v_mfma_f32_16x16x32_bf16 a[84:87], a[200:203], v[72:75], a[84:87]
 v_lshrrev_b32 v21, 7, v18
 v_lshl_add_u32 v21, v21, 17, v18
 v_mfma_f32_16x16x32_bf16 a[84:87], a[204:207], v[76:79], a[84:87]
 v_mfma_f32_16x16x32_bf16 a[80:83], a[204:207], v[68:71], a[80:83]
 v_mfma_f32_16x16x32_bf16 a[80:83], a[200:203], v[64:67], a[80:83]
 s_waitcnt lgkmcnt(4)
 v_mfma_f32_16x16x32_bf16 a[96:99], a[208:211], v[64:67], a[96:99]
 ds_read_b128 a[128:131], v5 offset:49152
 ds_read_b128 a[132:135], v6 offset:49152
 v_mfma_f32_16x16x32_bf16 a[96:99], a[212:215], v[68:71], a[96:99]
 buffer_load_dwordx4 v3, s[8:11], s49 offen offset:2048 lds
 v_mfma_f32_16x16x32_bf16 a[100:103], a[212:215], v[76:79], a[100:103]
 ds_read_b128 a[136:139], v7 offset:49152
 ds_read_b128 a[140:143], v8 offset:49152
 v_mfma_f32_16x16x32_bf16 a[100:103], a[208:211], v[72:75], a[100:103]
 v_mfma_f32_16x16x32_bf16 a[104:107], a[208:211], v[80:83], a[104:107]
 v_mfma_f32_16x16x32_bf16 a[104:107], a[212:215], v[84:87], a[104:107]
 buffer_store_dwordx4 v[48:51], v21, s[40:43], s5 offen sc1
 v_mfma_f32_16x16x32_bf16 a[108:111], a[212:215], v[92:95], a[108:111]
 v_mfma_f32_16x16x32_bf16 a[108:111], a[208:211], v[88:91], a[108:111]
 s_waitcnt lgkmcnt(4)
 v_mfma_f32_16x16x32_bf16 a[124:127], a[216:219], v[88:91], a[124:127]
 ds_read_b128 a[144:147], v5 offset:53248
 ds_read_b128 a[148:151], v6 offset:53248
 v_mfma_f32_16x16x32_bf16 a[124:127], a[220:223], v[92:95], a[124:127]
 buffer_load_dwordx4 v4, s[8:11], s49 offen offset:3072 lds
 v_mfma_f32_16x16x32_bf16 a[120:123], a[220:223], v[84:87], a[120:123]
 s_add_u32 s49, s49, 16384
 ds_read_b128 a[152:155], v7 offset:53248
 ds_read_b128 a[156:159], v8 offset:53248
 v_mfma_f32_16x16x32_bf16 a[120:123], a[216:219], v[80:83], a[120:123]
 v_mfma_f32_16x16x32_bf16 a[116:119], a[216:219], v[72:75], a[116:119]
 v_mfma_f32_16x16x32_bf16 a[116:119], a[220:223], v[76:79], a[116:119]
 buffer_store_dwordx4 v[48:51], v21, s[40:43], s3 offen sc1
 v_mfma_f32_16x16x32_bf16 a[112:115], a[220:223], v[68:71], a[112:115]
 v_mfma_f32_16x16x32_bf16 a[112:115], a[216:219], v[64:67], a[112:115]
 s_waitcnt lgkmcnt(4)
 v_mfma_f32_16x16x32_bf16 v[128:131], a[128:131], v[192:195], v[48:51]
 ds_read_b128 a[160:163], v5 offset:57344
 v_mfma_f32_16x16x32_bf16 v[128:131], a[132:135], v[208:211], v[128:131]
 ds_read_b128 a[164:167], v6 offset:57344
 v_mfma_f32_16x16x32_bf16 v[128:131], a[136:139], v[224:227], v[128:131]
 ds_read_b128 a[168:171], v7 offset:57344
 v_mfma_f32_16x16x32_bf16 v[128:131], a[140:143], v[240:243], v[128:131]
 ds_read_b128 a[172:175], v8 offset:57344
 v_mfma_f32_16x16x32_bf16 v[132:135], a[140:143], v[244:247], v[52:55]
 ds_read_b128 a[176:179], v5 offset:61440
 v_mfma_f32_16x16x32_bf16 v[132:135], a[136:139], v[228:231], v[132:135]
 ds_read_b128 a[180:183], v6 offset:61440
 v_mfma_f32_16x16x32_bf16 v[132:135], a[132:135], v[212:215], v[132:135]
 ds_read_b128 a[184:187], v7 offset:61440
 v_mfma_f32_16x16x32_bf16 v[132:135], a[128:131], v[196:199], v[132:135]
 ds_read_b128 a[188:191], v8 offset:61440
 v_mfma_f32_16x16x32_bf16 v[136:139], a[128:131], v[200:203], v[56:59]
 v_exp_f32 v128, v128
 v_mfma_f32_16x16x32_bf16 v[136:139], a[132:135], v[216:219], v[136:139]
 v_exp_f32 v129, v129
 v_mfma_f32_16x16x32_bf16 v[136:139], a[136:139], v[232:235], v[136:139]
 v_exp_f32 v130, v130
 v_mfma_f32_16x16x32_bf16 v[136:139], a[140:143], v[248:251], v[136:139]
 v_exp_f32 v131, v131
 v_mfma_f32_16x16x32_bf16 v[140:143], a[140:143], v[252:255], v[60:63]
 v_exp_f32 v132, v132
 v_mfma_f32_16x16x32_bf16 v[140:143], a[136:139], v[236:239], v[140:143]
 v_exp_f32 v133, v133
 v_mfma_f32_16x16x32_bf16 v[140:143], a[132:135], v[220:223], v[140:143]
 v_exp_f32 v134, v134
 v_mfma_f32_16x16x32_bf16 v[140:143], a[128:131], v[204:207], v[140:143]
 s_waitcnt lgkmcnt(8)
 v_exp_f32 v135, v135
 v_mfma_f32_16x16x32_bf16 v[144:147], a[144:147], v[204:207], v[60:63]
 v_exp_f32 v136, v136
 v_mfma_f32_16x16x32_bf16 v[144:147], a[148:151], v[220:223], v[144:147]
 v_exp_f32 v137, v137
 v_mfma_f32_16x16x32_bf16 v[144:147], a[152:155], v[236:239], v[144:147]
 v_exp_f32 v138, v138
 v_mfma_f32_16x16x32_bf16 v[144:147], a[156:159], v[252:255], v[144:147]
 v_exp_f32 v139, v139
 v_mfma_f32_16x16x32_bf16 v[148:151], a[156:159], v[248:251], v[56:59]
 v_exp_f32 v140, v140
 v_mfma_f32_16x16x32_bf16 v[148:151], a[152:155], v[232:235], v[148:151]
 v_exp_f32 v141, v141
 v_mfma_f32_16x16x32_bf16 v[148:151], a[148:151], v[216:219], v[148:151]
 v_exp_f32 v142, v142
 v_mfma_f32_16x16x32_bf16 v[148:151], a[144:147], v[200:203], v[148:151]
 v_exp_f32 v143, v143
 v_mfma_f32_16x16x32_bf16 v[152:155], a[144:147], v[196:199], v[52:55]
 v_exp_f32 v144, v144
 v_mfma_f32_16x16x32_bf16 v[152:155], a[148:151], v[212:215], v[152:155]
 v_exp_f32 v145, v145
 v_mfma_f32_16x16x32_bf16 v[152:155], a[152:155], v[228:231], v[152:155]
 v_exp_f32 v146, v146
 v_mfma_f32_16x16x32_bf16 v[152:155], a[156:159], v[244:247], v[152:155]
 v_exp_f32 v147, v147
 v_mfma_f32_16x16x32_bf16 v[156:159], a[156:159], v[240:243], v[48:51]
 v_exp_f32 v148, v148
 v_mfma_f32_16x16x32_bf16 v[156:159], a[152:155], v[224:227], v[156:159]
 v_exp_f32 v149, v149
 v_mfma_f32_16x16x32_bf16 v[156:159], a[148:151], v[208:211], v[156:159]
 v_exp_f32 v150, v150
 v_mfma_f32_16x16x32_bf16 v[156:159], a[144:147], v[192:195], v[156:159]
 s_waitcnt lgkmcnt(4)
 v_exp_f32 v151, v151
 v_mfma_f32_16x16x32_bf16 v[160:163], a[160:163], v[192:195], v[48:51]
 v_exp_f32 v152, v152
 v_mfma_f32_16x16x32_bf16 v[160:163], a[164:167], v[208:211], v[160:163]
 v_exp_f32 v153, v153
 v_mfma_f32_16x16x32_bf16 v[160:163], a[168:171], v[224:227], v[160:163]
 v_exp_f32 v154, v154
 v_mfma_f32_16x16x32_bf16 v[160:163], a[172:175], v[240:243], v[160:163]
 v_exp_f32 v155, v155
 v_mfma_f32_16x16x32_bf16 v[164:167], a[172:175], v[244:247], v[52:55]
 v_exp_f32 v156, v156
 v_mfma_f32_16x16x32_bf16 v[164:167], a[168:171], v[228:231], v[164:167]
 v_exp_f32 v157, v157
 v_mfma_f32_16x16x32_bf16 v[164:167], a[164:167], v[212:215], v[164:167]
 v_exp_f32 v158, v158
 v_mfma_f32_16x16x32_bf16 v[164:167], a[160:163], v[196:199], v[164:167]
 v_exp_f32 v159, v159
 v_mfma_f32_16x16x32_bf16 v[168:171], a[160:163], v[200:203], v[56:59]
 v_exp_f32 v160, v160
 v_mfma_f32_16x16x32_bf16 v[168:171], a[164:167], v[216:219], v[168:171]
 v_exp_f32 v161, v161
 v_mfma_f32_16x16x32_bf16 v[168:171], a[168:171], v[232:235], v[168:171]
 v_exp_f32 v162, v162
 v_mfma_f32_16x16x32_bf16 v[168:171], a[172:175], v[248:251], v[168:171]
 v_exp_f32 v163, v163
 v_mfma_f32_16x16x32_bf16 v[172:175], a[172:175], v[252:255], v[60:63]
 ds_read_b64_tr_b16 a[192:193], v9 offset:32768
 v_cvt_pk_bf16_f32 v64, v128, v129
 v_mfma_f32_16x16x32_bf16 v[172:175], a[168:171], v[236:239], v[172:175]
 v_exp_f32 v164, v164
 v_mfma_f32_16x16x32_bf16 v[172:175], a[164:167], v[220:223], v[172:175]
 ds_read_b64_tr_b16 a[194:195], v9 offset:36864
 v_cvt_pk_bf16_f32 v65, v130, v131
 v_mfma_f32_16x16x32_bf16 v[172:175], a[160:163], v[204:207], v[172:175]
 s_waitcnt lgkmcnt(2)
 v_exp_f32 v165, v165
 v_mfma_f32_16x16x32_bf16 v[176:179], a[176:179], v[204:207], v[60:63]
 ds_read_b64_tr_b16 a[196:197], v9 offset:40960
 v_cvt_pk_bf16_f32 v72, v132, v133
 v_mfma_f32_16x16x32_bf16 v[176:179], a[180:183], v[220:223], v[176:179]
 v_exp_f32 v166, v166
 v_mfma_f32_16x16x32_bf16 v[176:179], a[184:187], v[236:239], v[176:179]
 ds_read_b64_tr_b16 a[198:199], v9 offset:45056
 v_cvt_pk_bf16_f32 v73, v134, v135
 v_mfma_f32_16x16x32_bf16 v[176:179], a[188:191], v[252:255], v[176:179]
 v_exp_f32 v167, v167
 v_mfma_f32_16x16x32_bf16 v[180:183], a[188:191], v[248:251], v[56:59]
 ds_read_b64_tr_b16 a[200:201], v10 offset:32768
 v_cvt_pk_bf16_f32 v80, v136, v137
 v_mfma_f32_16x16x32_bf16 v[180:183], a[184:187], v[232:235], v[180:183]
 v_exp_f32 v168, v168
 v_mfma_f32_16x16x32_bf16 v[180:183], a[180:183], v[216:219], v[180:183]
 ds_read_b64_tr_b16 a[202:203], v10 offset:36864
 v_cvt_pk_bf16_f32 v81, v138, v139
 v_mfma_f32_16x16x32_bf16 v[180:183], a[176:179], v[200:203], v[180:183]
 v_exp_f32 v169, v169
 v_mfma_f32_16x16x32_bf16 v[184:187], a[176:179], v[196:199], v[52:55]
 ds_read_b64_tr_b16 a[204:205], v10 offset:40960
 v_cvt_pk_bf16_f32 v88, v140, v141
 v_mfma_f32_16x16x32_bf16 v[184:187], a[180:183], v[212:215], v[184:187]
 v_exp_f32 v170, v170
 v_mfma_f32_16x16x32_bf16 v[184:187], a[184:187], v[228:231], v[184:187]
 ds_read_b64_tr_b16 a[206:207], v10 offset:45056
 v_cvt_pk_bf16_f32 v89, v142, v143
 v_mfma_f32_16x16x32_bf16 v[184:187], a[188:191], v[244:247], v[184:187]
 v_exp_f32 v171, v171
 v_mfma_f32_16x16x32_bf16 v[188:191], a[188:191], v[240:243], v[48:51]
 v_exp_f32 v172, v172
 v_mfma_f32_16x16x32_bf16 v[188:191], a[184:187], v[224:227], v[188:191]
 v_exp_f32 v173, v173
 v_mfma_f32_16x16x32_bf16 v[188:191], a[180:183], v[208:211], v[188:191]
 s_waitcnt vmcnt(14)
 v_exp_f32 v174, v174
 v_mfma_f32_16x16x32_bf16 v[188:191], a[176:179], v[192:195], v[188:191]
 s_barrier
 v_exp_f32 v175, v175
 v_smfmac_f32_16x16x64_bf16 v[32:35], a[224:227], v[96:103], v17
 ds_read_b64_tr_b16 a[228:229], v25 offset:0
 ds_read_b64_tr_b16 a[230:231], v25 offset:2048
 v_exp_f32 v176, v176
 v_smfmac_f32_16x16x64_bf16 v[36:39], a[224:227], v[104:111], v17
 ds_read_b64_tr_b16 a[232:233], v26 offset:0
 ds_read_b64_tr_b16 a[234:235], v26 offset:2048
 v_exp_f32 v177, v177
 v_smfmac_f32_16x16x64_bf16 v[40:43], a[224:227], v[112:119], v17
 ds_read_b64_tr_b16 a[236:237], v27 offset:0
 ds_read_b64_tr_b16 a[238:239], v27 offset:2048
 v_exp_f32 v178, v178
 v_smfmac_f32_16x16x64_bf16 v[44:47], a[224:227], v[120:127], v17
 s_waitcnt lgkmcnt(10)
 ds_read_b64_tr_b16 a[240:241], v28 offset:0
 ds_read_b64_tr_b16 a[242:243], v28 offset:2048
 v_exp_f32 v179, v179
 v_mfma_f32_16x16x32_bf16 a[0:3], a[192:195], v[96:99], a[0:3]
 s_add_u32 m0, s47, 114688
 ds_read_b64_tr_b16 a[208:209], v11 offset:32768
 ds_read_b64_tr_b16 a[210:211], v11 offset:36864
 v_mfma_f32_16x16x32_bf16 a[0:3], a[196:199], v[100:103], a[0:3]
 buffer_load_dwordx4 v1, s[12:15], s50 offen offset:0 lds
 v_mfma_f32_16x16x32_bf16 a[4:7], a[196:199], v[108:111], a[4:7]
 ds_read_b64_tr_b16 a[212:213], v11 offset:40960
 ds_read_b64_tr_b16 a[214:215], v11 offset:45056
 v_mfma_f32_16x16x32_bf16 a[4:7], a[192:195], v[104:107], a[4:7]
 v_exp_f32 v180, v180
 v_mfma_f32_16x16x32_bf16 a[8:11], a[192:195], v[112:115], a[8:11]
 v_exp_f32 v181, v181
 v_mfma_f32_16x16x32_bf16 a[8:11], a[196:199], v[116:119], a[8:11]
 v_exp_f32 v182, v182
 v_mfma_f32_16x16x32_bf16 a[12:15], a[196:199], v[124:127], a[12:15]
 v_exp_f32 v183, v183
 v_mfma_f32_16x16x32_bf16 a[12:15], a[192:195], v[120:123], a[12:15]
 s_waitcnt lgkmcnt(12)
 v_exp_f32 v184, v184
 v_mfma_f32_16x16x32_bf16 a[28:31], a[200:203], v[120:123], a[28:31]
 ds_read_b64_tr_b16 a[216:217], v12 offset:32768
 ds_read_b64_tr_b16 a[218:219], v12 offset:36864
 v_mfma_f32_16x16x32_bf16 a[28:31], a[204:207], v[124:127], a[28:31]
 buffer_load_dwordx4 v2, s[12:15], s50 offen offset:1024 lds
 v_mfma_f32_16x16x32_bf16 a[24:27], a[204:207], v[116:119], a[24:27]
 ds_read_b64_tr_b16 a[220:221], v12 offset:40960
 ds_read_b64_tr_b16 a[222:223], v12 offset:45056
 v_mfma_f32_16x16x32_bf16 a[24:27], a[200:203], v[112:115], a[24:27]
 v_exp_f32 v185, v185
 v_mfma_f32_16x16x32_bf16 a[20:23], a[200:203], v[104:107], a[20:23]
 v_exp_f32 v186, v186
 v_mfma_f32_16x16x32_bf16 a[20:23], a[204:207], v[108:111], a[20:23]
 v_exp_f32 v187, v187
 v_mfma_f32_16x16x32_bf16 a[16:19], a[204:207], v[100:103], a[16:19]
 v_exp_f32 v188, v188
 v_mfma_f32_16x16x32_bf16 a[16:19], a[200:203], v[96:99], a[16:19]
 s_waitcnt lgkmcnt(4)
 v_exp_f32 v189, v189
 v_mfma_f32_16x16x32_bf16 a[32:35], a[208:211], v[96:99], a[32:35]
 ds_read_b64_tr_b16 a[192:193], v13 offset:32768
 ds_read_b64_tr_b16 a[194:195], v13 offset:36864
 v_mfma_f32_16x16x32_bf16 a[32:35], a[212:215], v[100:103], a[32:35]
 buffer_load_dwordx4 v3, s[12:15], s50 offen offset:2048 lds
 v_mfma_f32_16x16x32_bf16 a[36:39], a[212:215], v[108:111], a[36:39]
 ds_read_b64_tr_b16 a[196:197], v13 offset:40960
 ds_read_b64_tr_b16 a[198:199], v13 offset:45056
 v_mfma_f32_16x16x32_bf16 a[36:39], a[208:211], v[104:107], a[36:39]
 v_exp_f32 v190, v190
 v_mfma_f32_16x16x32_bf16 a[40:43], a[208:211], v[112:115], a[40:43]
 v_exp_f32 v191, v191
 v_mfma_f32_16x16x32_bf16 a[40:43], a[212:215], v[116:119], a[40:43]
 v_cvt_pk_bf16_f32 v90, v144, v145
 v_cvt_pk_bf16_f32 v91, v146, v147
 buffer_store_dwordx4 a[228:231], v18, s[24:27], s53 offen offset:0 sc1
 v_mfma_f32_16x16x32_bf16 a[44:47], a[212:215], v[124:127], a[44:47]
 v_cvt_pk_bf16_f32 v82, v148, v149
 v_cvt_pk_bf16_f32 v83, v150, v151
 v_mfma_f32_16x16x32_bf16 a[44:47], a[208:211], v[120:123], a[44:47]
 s_waitcnt lgkmcnt(4)
 v_cvt_pk_bf16_f32 v74, v152, v153
 v_cvt_pk_bf16_f32 v75, v154, v155
 v_mfma_f32_16x16x32_bf16 a[60:63], a[216:219], v[120:123], a[60:63]
 ds_read_b64_tr_b16 a[200:201], v14 offset:32768
 ds_read_b64_tr_b16 a[202:203], v14 offset:36864
 v_mfma_f32_16x16x32_bf16 a[60:63], a[220:223], v[124:127], a[60:63]
 buffer_load_dwordx4 v4, s[12:15], s50 offen offset:3072 lds
 v_mfma_f32_16x16x32_bf16 a[56:59], a[220:223], v[116:119], a[56:59]
 s_add_u32 s50, s50, 16384
 ds_read_b64_tr_b16 a[204:205], v14 offset:40960
 ds_read_b64_tr_b16 a[206:207], v14 offset:45056
 v_mfma_f32_16x16x32_bf16 a[56:59], a[216:219], v[112:115], a[56:59]
 v_cvt_pk_bf16_f32 v66, v156, v157
 v_cvt_pk_bf16_f32 v67, v158, v159
 v_mfma_f32_16x16x32_bf16 a[52:55], a[216:219], v[104:107], a[52:55]
 v_cvt_pk_bf16_f32 v68, v160, v161
 v_cvt_pk_bf16_f32 v69, v162, v163
 v_mfma_f32_16x16x32_bf16 a[52:55], a[220:223], v[108:111], a[52:55]
 v_cvt_pk_bf16_f32 v76, v164, v165
 v_cvt_pk_bf16_f32 v77, v166, v167
 v_mfma_f32_16x16x32_bf16 a[48:51], a[220:223], v[100:103], a[48:51]
 v_cvt_pk_bf16_f32 v84, v168, v169
 v_cvt_pk_bf16_f32 v85, v170, v171
 v_mfma_f32_16x16x32_bf16 a[48:51], a[216:219], v[96:99], a[48:51]
 s_waitcnt lgkmcnt(4)
 v_cvt_pk_bf16_f32 v92, v172, v173
 v_cvt_pk_bf16_f32 v93, v174, v175
 v_mfma_f32_16x16x32_bf16 a[64:67], a[192:195], v[96:99], a[64:67]
 s_add_u32 m0, s47, 65536
 ds_read_b64_tr_b16 a[208:209], v15 offset:32768
 ds_read_b64_tr_b16 a[210:211], v15 offset:36864
 v_mfma_f32_16x16x32_bf16 a[64:67], a[196:199], v[100:103], a[64:67]
 buffer_load_dwordx4 v1, s[8:11], s49 offen offset:0 lds
 v_mfma_f32_16x16x32_bf16 a[68:71], a[196:199], v[108:111], a[68:71]
 ds_read_b64_tr_b16 a[212:213], v15 offset:40960
 ds_read_b64_tr_b16 a[214:215], v15 offset:45056
 v_mfma_f32_16x16x32_bf16 a[68:71], a[192:195], v[104:107], a[68:71]
 v_cvt_pk_bf16_f32 v94, v176, v177
 v_cvt_pk_bf16_f32 v95, v178, v179
 v_mfma_f32_16x16x32_bf16 a[72:75], a[192:195], v[112:115], a[72:75]
 v_cvt_pk_bf16_f32 v86, v180, v181
 v_cvt_pk_bf16_f32 v87, v182, v183
 v_mfma_f32_16x16x32_bf16 a[72:75], a[196:199], v[116:119], a[72:75]
 v_cvt_pk_bf16_f32 v78, v184, v185
 v_cvt_pk_bf16_f32 v79, v186, v187
 buffer_store_dwordx4 a[232:235], v18, s[24:27], s53 offen offset:1024 sc1
 v_mfma_f32_16x16x32_bf16 a[76:79], a[196:199], v[124:127], a[76:79]
 v_cvt_pk_bf16_f32 v70, v188, v189
 v_cvt_pk_bf16_f32 v71, v190, v191
 v_mfma_f32_16x16x32_bf16 a[76:79], a[192:195], v[120:123], a[76:79]
 s_waitcnt lgkmcnt(4)
 v_mfma_f32_16x16x32_bf16 a[92:95], a[200:203], v[120:123], a[92:95]
 ds_read_b64_tr_b16 a[216:217], v16 offset:32768
 ds_read_b64_tr_b16 a[218:219], v16 offset:36864
 v_mfma_f32_16x16x32_bf16 a[92:95], a[204:207], v[124:127], a[92:95]
 buffer_load_dwordx4 v2, s[8:11], s49 offen offset:1024 lds
 v_mfma_f32_16x16x32_bf16 a[88:91], a[204:207], v[116:119], a[88:91]
 ds_read_b64_tr_b16 a[220:221], v16 offset:40960
 ds_read_b64_tr_b16 a[222:223], v16 offset:45056
 v_mfma_f32_16x16x32_bf16 a[88:91], a[200:203], v[112:115], a[88:91]
 v_add_u32 v25, 81920, v25
 v_add_u32 v26, 81920, v26
 v_add_u32 v27, 81920, v27
 v_add_u32 v28, 81920, v28
 v_mfma_f32_16x16x32_bf16 a[84:87], a[200:203], v[104:107], a[84:87]
 ds_read_b64_tr_b16 a[244:245], v25 offset:0
 ds_read_b64_tr_b16 a[246:247], v25 offset:2048
 v_mfma_f32_16x16x32_bf16 a[84:87], a[204:207], v[108:111], a[84:87]
 ds_read_b64_tr_b16 a[248:249], v26 offset:0
 ds_read_b64_tr_b16 a[250:251], v26 offset:2048
 v_mfma_f32_16x16x32_bf16 a[80:83], a[204:207], v[100:103], a[80:83]
 ds_read_b64_tr_b16 a[252:253], v27 offset:0
 ds_read_b64_tr_b16 a[254:255], v27 offset:2048
 v_mfma_f32_16x16x32_bf16 a[80:83], a[200:203], v[96:99], a[80:83]
 s_waitcnt lgkmcnt(10)
 v_mfma_f32_16x16x32_bf16 a[96:99], a[208:211], v[96:99], a[96:99]
 ds_read_b128 a[128:131], v5 offset:0
 ds_read_b128 a[132:135], v6 offset:0
 v_mfma_f32_16x16x32_bf16 a[96:99], a[212:215], v[100:103], a[96:99]
 buffer_load_dwordx4 v3, s[8:11], s49 offen offset:2048 lds
 v_mfma_f32_16x16x32_bf16 a[100:103], a[212:215], v[108:111], a[100:103]
 ds_read_b128 a[136:139], v7 offset:0
 ds_read_b128 a[140:143], v8 offset:0
 v_mfma_f32_16x16x32_bf16 a[100:103], a[208:211], v[104:107], a[100:103]
 ds_read_b64_tr_b16 a[228:229], v28 offset:0
 ds_read_b64_tr_b16 a[230:231], v28 offset:2048
 v_mfma_f32_16x16x32_bf16 a[104:107], a[208:211], v[112:115], a[104:107]
 v_mfma_f32_16x16x32_bf16 a[104:107], a[212:215], v[116:119], a[104:107]
 buffer_store_dwordx4 a[236:239], v18, s[24:27], s53 offen offset:2048 sc1
 v_mfma_f32_16x16x32_bf16 a[108:111], a[212:215], v[124:127], a[108:111]
 v_mfma_f32_16x16x32_bf16 a[108:111], a[208:211], v[120:123], a[108:111]
 s_waitcnt lgkmcnt(12)
 v_mfma_f32_16x16x32_bf16 a[124:127], a[216:219], v[120:123], a[124:127]
 ds_read_b128 a[144:147], v5 offset:4096
 ds_read_b128 a[148:151], v6 offset:4096
 v_mfma_f32_16x16x32_bf16 a[124:127], a[220:223], v[124:127], a[124:127]
 buffer_load_dwordx4 v4, s[8:11], s49 offen offset:3072 lds
 v_mfma_f32_16x16x32_bf16 a[120:123], a[220:223], v[116:119], a[120:123]
 s_add_u32 s49, s49, 16384
 ds_read_b128 a[152:155], v7 offset:4096
 ds_read_b128 a[156:159], v8 offset:4096
 v_mfma_f32_16x16x32_bf16 a[120:123], a[216:219], v[112:115], a[120:123]
 v_mfma_f32_16x16x32_bf16 a[116:119], a[216:219], v[104:107], a[116:119]
 v_mfma_f32_16x16x32_bf16 a[116:119], a[220:223], v[108:111], a[116:119]
 buffer_store_dwordx4 a[240:243], v18, s[24:27], s53 offen offset:3072 sc1
 v_mfma_f32_16x16x32_bf16 a[112:115], a[220:223], v[100:103], a[112:115]
 v_mfma_f32_16x16x32_bf16 a[112:115], a[216:219], v[96:99], a[112:115]
 s_waitcnt lgkmcnt(6)
 v_mfma_f32_16x16x32_bf16 v[128:131], a[128:131], v[192:195], v[48:51]
 ds_read_b128 a[160:163], v5 offset:8192
 v_mfma_f32_16x16x32_bf16 v[128:131], a[132:135], v[208:211], v[128:131]
 ds_read_b128 a[164:167], v6 offset:8192
 v_mfma_f32_16x16x32_bf16 v[128:131], a[136:139], v[224:227], v[128:131]
 ds_read_b128 a[168:171], v7 offset:8192
 v_mfma_f32_16x16x32_bf16 v[128:131], a[140:143], v[240:243], v[128:131]
 ds_read_b128 a[172:175], v8 offset:8192
 v_mfma_f32_16x16x32_bf16 v[132:135], a[140:143], v[244:247], v[52:55]
 ds_read_b128 a[176:179], v5 offset:12288
 v_mfma_f32_16x16x32_bf16 v[132:135], a[136:139], v[228:231], v[132:135]
 ds_read_b128 a[180:183], v6 offset:12288
 v_mfma_f32_16x16x32_bf16 v[132:135], a[132:135], v[212:215], v[132:135]
 ds_read_b128 a[184:187], v7 offset:12288
 v_mfma_f32_16x16x32_bf16 v[132:135], a[128:131], v[196:199], v[132:135]
 ds_read_b128 a[188:191], v8 offset:12288
 v_mfma_f32_16x16x32_bf16 v[136:139], a[128:131], v[200:203], v[56:59]
 v_exp_f32 v128, v128
 v_mfma_f32_16x16x32_bf16 v[136:139], a[132:135], v[216:219], v[136:139]
 v_exp_f32 v129, v129
 v_mfma_f32_16x16x32_bf16 v[136:139], a[136:139], v[232:235], v[136:139]
 v_exp_f32 v130, v130
 v_mfma_f32_16x16x32_bf16 v[136:139], a[140:143], v[248:251], v[136:139]
 v_exp_f32 v131, v131
 v_mfma_f32_16x16x32_bf16 v[140:143], a[140:143], v[252:255], v[60:63]
 v_exp_f32 v132, v132
 v_mfma_f32_16x16x32_bf16 v[140:143], a[136:139], v[236:239], v[140:143]
 v_exp_f32 v133, v133
 buffer_store_dwordx4 a[244:247], v18, s[24:27], s52 offen offset:0 sc1
 v_mfma_f32_16x16x32_bf16 v[140:143], a[132:135], v[220:223], v[140:143]
 v_exp_f32 v134, v134
 v_mfma_f32_16x16x32_bf16 v[140:143], a[128:131], v[204:207], v[140:143]
 s_waitcnt lgkmcnt(8)
 v_exp_f32 v135, v135
 v_mfma_f32_16x16x32_bf16 v[144:147], a[144:147], v[204:207], v[60:63]
 v_exp_f32 v136, v136
 v_mfma_f32_16x16x32_bf16 v[144:147], a[148:151], v[220:223], v[144:147]
 v_exp_f32 v137, v137
 v_mfma_f32_16x16x32_bf16 v[144:147], a[152:155], v[236:239], v[144:147]
 v_exp_f32 v138, v138
 v_mfma_f32_16x16x32_bf16 v[144:147], a[156:159], v[252:255], v[144:147]
 v_exp_f32 v139, v139
 v_mfma_f32_16x16x32_bf16 v[148:151], a[156:159], v[248:251], v[56:59]
 v_exp_f32 v140, v140
 v_mfma_f32_16x16x32_bf16 v[148:151], a[152:155], v[232:235], v[148:151]
 v_exp_f32 v141, v141
 v_mfma_f32_16x16x32_bf16 v[148:151], a[148:151], v[216:219], v[148:151]
 v_exp_f32 v142, v142
 v_mfma_f32_16x16x32_bf16 v[148:151], a[144:147], v[200:203], v[148:151]
 v_exp_f32 v143, v143
 v_mfma_f32_16x16x32_bf16 v[152:155], a[144:147], v[196:199], v[52:55]
 v_exp_f32 v144, v144
 v_mfma_f32_16x16x32_bf16 v[152:155], a[148:151], v[212:215], v[152:155]
 v_exp_f32 v145, v145
 v_mfma_f32_16x16x32_bf16 v[152:155], a[152:155], v[228:231], v[152:155]
 v_exp_f32 v146, v146
 v_mfma_f32_16x16x32_bf16 v[152:155], a[156:159], v[244:247], v[152:155]
 v_exp_f32 v147, v147
 v_mfma_f32_16x16x32_bf16 v[156:159], a[156:159], v[240:243], v[48:51]
 v_exp_f32 v148, v148
 v_mfma_f32_16x16x32_bf16 v[156:159], a[152:155], v[224:227], v[156:159]
 v_exp_f32 v149, v149
 v_mfma_f32_16x16x32_bf16 v[156:159], a[148:151], v[208:211], v[156:159]
 v_exp_f32 v150, v150
 v_mfma_f32_16x16x32_bf16 v[156:159], a[144:147], v[192:195], v[156:159]
 s_waitcnt lgkmcnt(4)
 v_exp_f32 v151, v151
 v_mfma_f32_16x16x32_bf16 v[160:163], a[160:163], v[192:195], v[48:51]
 v_exp_f32 v152, v152
 v_mfma_f32_16x16x32_bf16 v[160:163], a[164:167], v[208:211], v[160:163]
 v_exp_f32 v153, v153
 v_mfma_f32_16x16x32_bf16 v[160:163], a[168:171], v[224:227], v[160:163]
 v_exp_f32 v154, v154
 v_mfma_f32_16x16x32_bf16 v[160:163], a[172:175], v[240:243], v[160:163]
 v_exp_f32 v155, v155
 v_mfma_f32_16x16x32_bf16 v[164:167], a[172:175], v[244:247], v[52:55]
 v_exp_f32 v156, v156
 v_mfma_f32_16x16x32_bf16 v[164:167], a[168:171], v[228:231], v[164:167]
 v_exp_f32 v157, v157
 v_mfma_f32_16x16x32_bf16 v[164:167], a[164:167], v[212:215], v[164:167]
 v_exp_f32 v158, v158
 v_mfma_f32_16x16x32_bf16 v[164:167], a[160:163], v[196:199], v[164:167]
 v_exp_f32 v159, v159
 v_mfma_f32_16x16x32_bf16 v[168:171], a[160:163], v[200:203], v[56:59]
 v_exp_f32 v160, v160
 v_mfma_f32_16x16x32_bf16 v[168:171], a[164:167], v[216:219], v[168:171]
 v_exp_f32 v161, v161
 v_mfma_f32_16x16x32_bf16 v[168:171], a[168:171], v[232:235], v[168:171]
 v_exp_f32 v162, v162
 v_mfma_f32_16x16x32_bf16 v[168:171], a[172:175], v[248:251], v[168:171]
 v_exp_f32 v163, v163
 v_mfma_f32_16x16x32_bf16 v[172:175], a[172:175], v[252:255], v[60:63]
 ds_read_b64_tr_b16 a[192:193], v9 offset:49152
 v_cvt_pk_bf16_f32 v96, v128, v129
 v_mfma_f32_16x16x32_bf16 v[172:175], a[168:171], v[236:239], v[172:175]
 v_exp_f32 v164, v164
 buffer_store_dwordx4 a[248:251], v18, s[24:27], s52 offen offset:1024 sc1
 v_mfma_f32_16x16x32_bf16 v[172:175], a[164:167], v[220:223], v[172:175]
 ds_read_b64_tr_b16 a[194:195], v9 offset:53248
 v_cvt_pk_bf16_f32 v97, v130, v131
 v_mfma_f32_16x16x32_bf16 v[172:175], a[160:163], v[204:207], v[172:175]
 s_waitcnt lgkmcnt(2)
 v_exp_f32 v165, v165
 v_mfma_f32_16x16x32_bf16 v[176:179], a[176:179], v[204:207], v[60:63]
 ds_read_b64_tr_b16 a[196:197], v9 offset:57344
 v_cvt_pk_bf16_f32 v104, v132, v133
 v_mfma_f32_16x16x32_bf16 v[176:179], a[180:183], v[220:223], v[176:179]
 v_exp_f32 v166, v166
 v_mfma_f32_16x16x32_bf16 v[176:179], a[184:187], v[236:239], v[176:179]
 ds_read_b64_tr_b16 a[198:199], v9 offset:61440
 v_cvt_pk_bf16_f32 v105, v134, v135
 v_mfma_f32_16x16x32_bf16 v[176:179], a[188:191], v[252:255], v[176:179]
 v_exp_f32 v167, v167
 v_mfma_f32_16x16x32_bf16 v[180:183], a[188:191], v[248:251], v[56:59]
 ds_read_b64_tr_b16 a[200:201], v10 offset:49152
 v_cvt_pk_bf16_f32 v112, v136, v137
 v_mfma_f32_16x16x32_bf16 v[180:183], a[184:187], v[232:235], v[180:183]
 v_exp_f32 v168, v168
 v_mfma_f32_16x16x32_bf16 v[180:183], a[180:183], v[216:219], v[180:183]
 ds_read_b64_tr_b16 a[202:203], v10 offset:53248
 v_cvt_pk_bf16_f32 v113, v138, v139
 v_mfma_f32_16x16x32_bf16 v[180:183], a[176:179], v[200:203], v[180:183]
 v_exp_f32 v169, v169
 v_mfma_f32_16x16x32_bf16 v[184:187], a[176:179], v[196:199], v[52:55]
 ds_read_b64_tr_b16 a[204:205], v10 offset:57344
 v_cvt_pk_bf16_f32 v120, v140, v141
 v_mfma_f32_16x16x32_bf16 v[184:187], a[180:183], v[212:215], v[184:187]
 v_exp_f32 v170, v170
 v_mfma_f32_16x16x32_bf16 v[184:187], a[184:187], v[228:231], v[184:187]
 ds_read_b64_tr_b16 a[206:207], v10 offset:61440
 v_cvt_pk_bf16_f32 v121, v142, v143
 v_mfma_f32_16x16x32_bf16 v[184:187], a[188:191], v[244:247], v[184:187]
 v_exp_f32 v171, v171
 v_mfma_f32_16x16x32_bf16 v[188:191], a[188:191], v[240:243], v[48:51]
 v_exp_f32 v172, v172
 v_mfma_f32_16x16x32_bf16 v[188:191], a[184:187], v[224:227], v[188:191]
 v_exp_f32 v173, v173
 v_mfma_f32_16x16x32_bf16 v[188:191], a[180:183], v[208:211], v[188:191]
 s_waitcnt vmcnt(20)
 v_exp_f32 v174, v174
 v_mfma_f32_16x16x32_bf16 v[188:191], a[176:179], v[192:195], v[188:191]
 s_barrier
 v_exp_f32 v175, v175
 v_smfmac_f32_16x16x64_bf16 v[32:35], a[224:227], v[64:71], v17
 v_exp_f32 v176, v176
 v_smfmac_f32_16x16x64_bf16 v[36:39], a[224:227], v[72:79], v17
 v_exp_f32 v177, v177
 buffer_store_dwordx4 a[252:255], v18, s[24:27], s52 offen offset:2048 sc1
 v_smfmac_f32_16x16x64_bf16 v[40:43], a[224:227], v[80:87], v17
 v_exp_f32 v178, v178
 v_smfmac_f32_16x16x64_bf16 v[44:47], a[224:227], v[88:95], v17
 s_waitcnt lgkmcnt(4)
 v_exp_f32 v179, v179
 v_mfma_f32_16x16x32_bf16 a[0:3], a[192:195], v[64:67], a[0:3]
 s_add_u32 m0, s47, 131072
 ds_read_b64_tr_b16 a[208:209], v11 offset:49152
 ds_read_b64_tr_b16 a[210:211], v11 offset:53248
 v_mfma_f32_16x16x32_bf16 a[0:3], a[196:199], v[68:71], a[0:3]
 buffer_load_dwordx4 v1, s[12:15], s50 offen offset:0 lds
 v_mfma_f32_16x16x32_bf16 a[4:7], a[196:199], v[76:79], a[4:7]
 ds_read_b64_tr_b16 a[212:213], v11 offset:57344
 ds_read_b64_tr_b16 a[214:215], v11 offset:61440
 v_mfma_f32_16x16x32_bf16 a[4:7], a[192:195], v[72:75], a[4:7]
 v_exp_f32 v180, v180
 v_mfma_f32_16x16x32_bf16 a[8:11], a[192:195], v[80:83], a[8:11]
 v_exp_f32 v181, v181
 v_mfma_f32_16x16x32_bf16 a[8:11], a[196:199], v[84:87], a[8:11]
 v_exp_f32 v182, v182
 v_mfma_f32_16x16x32_bf16 a[12:15], a[196:199], v[92:95], a[12:15]
 v_exp_f32 v183, v183
 v_mfma_f32_16x16x32_bf16 a[12:15], a[192:195], v[88:91], a[12:15]
 s_waitcnt lgkmcnt(4)
 v_exp_f32 v184, v184
 v_mfma_f32_16x16x32_bf16 a[28:31], a[200:203], v[88:91], a[28:31]
 ds_read_b64_tr_b16 a[216:217], v12 offset:49152
 ds_read_b64_tr_b16 a[218:219], v12 offset:53248
 v_mfma_f32_16x16x32_bf16 a[28:31], a[204:207], v[92:95], a[28:31]
 buffer_load_dwordx4 v2, s[12:15], s50 offen offset:1024 lds
 v_mfma_f32_16x16x32_bf16 a[24:27], a[204:207], v[84:87], a[24:27]
 ds_read_b64_tr_b16 a[220:221], v12 offset:57344
 ds_read_b64_tr_b16 a[222:223], v12 offset:61440
 v_mfma_f32_16x16x32_bf16 a[24:27], a[200:203], v[80:83], a[24:27]
 v_exp_f32 v185, v185
 v_mfma_f32_16x16x32_bf16 a[20:23], a[200:203], v[72:75], a[20:23]
 v_exp_f32 v186, v186
 v_mfma_f32_16x16x32_bf16 a[20:23], a[204:207], v[76:79], a[20:23]
 v_exp_f32 v187, v187
 v_mfma_f32_16x16x32_bf16 a[16:19], a[204:207], v[68:71], a[16:19]
 v_exp_f32 v188, v188
 v_mfma_f32_16x16x32_bf16 a[16:19], a[200:203], v[64:67], a[16:19]
 s_waitcnt lgkmcnt(4)
 v_exp_f32 v189, v189
 v_mfma_f32_16x16x32_bf16 a[32:35], a[208:211], v[64:67], a[32:35]
 ds_read_b64_tr_b16 a[192:193], v13 offset:49152
 ds_read_b64_tr_b16 a[194:195], v13 offset:53248
 v_mfma_f32_16x16x32_bf16 a[32:35], a[212:215], v[68:71], a[32:35]
 buffer_load_dwordx4 v3, s[12:15], s50 offen offset:2048 lds
 v_mfma_f32_16x16x32_bf16 a[36:39], a[212:215], v[76:79], a[36:39]
 ds_read_b64_tr_b16 a[196:197], v13 offset:57344
 ds_read_b64_tr_b16 a[198:199], v13 offset:61440
 v_mfma_f32_16x16x32_bf16 a[36:39], a[208:211], v[72:75], a[36:39]
 v_exp_f32 v190, v190
 v_mfma_f32_16x16x32_bf16 a[40:43], a[208:211], v[80:83], a[40:43]
 v_exp_f32 v191, v191
 v_mfma_f32_16x16x32_bf16 a[40:43], a[212:215], v[84:87], a[40:43]
 v_cvt_pk_bf16_f32 v122, v144, v145
 v_cvt_pk_bf16_f32 v123, v146, v147
 v_mfma_f32_16x16x32_bf16 a[44:47], a[212:215], v[92:95], a[44:47]
 v_cvt_pk_bf16_f32 v114, v148, v149
 v_cvt_pk_bf16_f32 v115, v150, v151
 v_mfma_f32_16x16x32_bf16 a[44:47], a[208:211], v[88:91], a[44:47]
 s_waitcnt lgkmcnt(4)
 v_cvt_pk_bf16_f32 v106, v152, v153
 v_cvt_pk_bf16_f32 v107, v154, v155
 v_mfma_f32_16x16x32_bf16 a[60:63], a[216:219], v[88:91], a[60:63]
 ds_read_b64_tr_b16 a[200:201], v14 offset:49152
 ds_read_b64_tr_b16 a[202:203], v14 offset:53248
 v_mfma_f32_16x16x32_bf16 a[60:63], a[220:223], v[92:95], a[60:63]
 buffer_load_dwordx4 v4, s[12:15], s50 offen offset:3072 lds
 v_mfma_f32_16x16x32_bf16 a[56:59], a[220:223], v[84:87], a[56:59]
 s_add_u32 s50, s50, 16384
 ds_read_b64_tr_b16 a[204:205], v14 offset:57344
 ds_read_b64_tr_b16 a[206:207], v14 offset:61440
 v_mfma_f32_16x16x32_bf16 a[56:59], a[216:219], v[80:83], a[56:59]
 v_cvt_pk_bf16_f32 v98, v156, v157
 v_cvt_pk_bf16_f32 v99, v158, v159
 v_mfma_f32_16x16x32_bf16 a[52:55], a[216:219], v[72:75], a[52:55]
 v_cvt_pk_bf16_f32 v100, v160, v161
 v_cvt_pk_bf16_f32 v101, v162, v163
 v_mfma_f32_16x16x32_bf16 a[52:55], a[220:223], v[76:79], a[52:55]
 v_cvt_pk_bf16_f32 v108, v164, v165
 v_cvt_pk_bf16_f32 v109, v166, v167
 v_mfma_f32_16x16x32_bf16 a[48:51], a[220:223], v[68:71], a[48:51]
 v_cvt_pk_bf16_f32 v116, v168, v169
 v_cvt_pk_bf16_f32 v117, v170, v171
 v_mfma_f32_16x16x32_bf16 a[48:51], a[216:219], v[64:67], a[48:51]
 s_waitcnt lgkmcnt(4)
 v_cvt_pk_bf16_f32 v124, v172, v173
 v_cvt_pk_bf16_f32 v125, v174, v175
 v_mfma_f32_16x16x32_bf16 a[64:67], a[192:195], v[64:67], a[64:67]
 s_add_u32 m0, s47, 16384
 ds_read_b64_tr_b16 a[208:209], v15 offset:49152
 ds_read_b64_tr_b16 a[210:211], v15 offset:53248
 v_mfma_f32_16x16x32_bf16 a[64:67], a[196:199], v[68:71], a[64:67]
 buffer_load_dwordx4 v1, s[8:11], s49 offen offset:0 lds
 v_mfma_f32_16x16x32_bf16 a[68:71], a[196:199], v[76:79], a[68:71]
 ds_read_b64_tr_b16 a[212:213], v15 offset:57344
 ds_read_b64_tr_b16 a[214:215], v15 offset:61440
 v_mfma_f32_16x16x32_bf16 a[68:71], a[192:195], v[72:75], a[68:71]
 v_cvt_pk_bf16_f32 v126, v176, v177
 v_cvt_pk_bf16_f32 v127, v178, v179
 v_mfma_f32_16x16x32_bf16 a[72:75], a[192:195], v[80:83], a[72:75]
 v_cvt_pk_bf16_f32 v118, v180, v181
 v_cvt_pk_bf16_f32 v119, v182, v183
 v_mfma_f32_16x16x32_bf16 a[72:75], a[196:199], v[84:87], a[72:75]
 v_cvt_pk_bf16_f32 v110, v184, v185
 v_cvt_pk_bf16_f32 v111, v186, v187
 v_mfma_f32_16x16x32_bf16 a[76:79], a[196:199], v[92:95], a[76:79]
 v_cvt_pk_bf16_f32 v102, v188, v189
 v_cvt_pk_bf16_f32 v103, v190, v191
 v_mfma_f32_16x16x32_bf16 a[76:79], a[192:195], v[88:91], a[76:79]
 s_waitcnt lgkmcnt(4)
 v_mfma_f32_16x16x32_bf16 a[92:95], a[200:203], v[88:91], a[92:95]
 ds_read_b64_tr_b16 a[216:217], v16 offset:49152
 ds_read_b64_tr_b16 a[218:219], v16 offset:53248
 v_mfma_f32_16x16x32_bf16 a[92:95], a[204:207], v[92:95], a[92:95]
 buffer_load_dwordx4 v2, s[8:11], s49 offen offset:1024 lds
 v_mfma_f32_16x16x32_bf16 a[88:91], a[204:207], v[84:87], a[88:91]
 ds_read_b64_tr_b16 a[220:221], v16 offset:57344
 ds_read_b64_tr_b16 a[222:223], v16 offset:61440
 v_mfma_f32_16x16x32_bf16 a[88:91], a[200:203], v[80:83], a[88:91]
 v_lshlrev_b32 v21, 3, v18
 v_mfma_f32_16x16x32_bf16 a[84:87], a[200:203], v[72:75], a[84:87]
 s_getpc_b64 s[28:29]
t_pc:
 s_add_u32 s28, s28, att_tail-t_pc
 s_addc_u32 s29, s29, 0
 s_mov_b32 s30, outo_z-att_tail
 s_mov_b32 s31, 0x00020000
 s_lshr_b32 s3, s2, 3
 s_lshl_b32 s3, s3, 2
 s_add_u32 s3, s3, s44
 s_mul_i32 s3, s3, 384
 s_add_u32 s91, s3, 524288
 v_mfma_f32_16x16x32_bf16 a[84:87], a[204:207], v[76:79], a[84:87]
 v_mfma_f32_16x16x32_bf16 a[80:83], a[204:207], v[68:71], a[80:83]
 v_lshrrev_b32 v26, 4, v18
 v_min_u32 v26, 2, v26
 v_mfma_f32_16x16x32_bf16 a[80:83], a[200:203], v[64:67], a[80:83]
 s_waitcnt lgkmcnt(4)
 v_lshlrev_b32 v26, 7, v26
 v_mfma_f32_16x16x32_bf16 a[96:99], a[208:211], v[64:67], a[96:99]
 ds_read_b128 a[128:131], v5 offset:16384
 ds_read_b128 a[132:135], v6 offset:16384
 v_mfma_f32_16x16x32_bf16 a[96:99], a[212:215], v[68:71], a[96:99]
 buffer_load_dwordx4 v3, s[8:11], s49 offen offset:2048 lds
 v_mfma_f32_16x16x32_bf16 a[100:103], a[212:215], v[76:79], a[100:103]
 ds_read_b128 a[136:139], v7 offset:16384
 ds_read_b128 a[140:143], v8 offset:16384
 v_mfma_f32_16x16x32_bf16 a[100:103], a[208:211], v[72:75], a[100:103]
 v_lshlrev_b32 v22, 2, v18
 v_mfma_f32_16x16x32_bf16 a[104:107], a[208:211], v[80:83], a[104:107]
 v_mfma_f32_16x16x32_bf16 a[104:107], a[212:215], v[84:87], a[104:107]
 buffer_store_dwordx4 a[228:231], v18, s[24:27], s52 offen offset:3072 sc1
 v_mfma_f32_16x16x32_bf16 a[108:111], a[212:215], v[92:95], a[108:111]
 v_mfma_f32_16x16x32_bf16 a[108:111], a[208:211], v[88:91], a[108:111]
 s_waitcnt lgkmcnt(4)
 v_mfma_f32_16x16x32_bf16 a[124:127], a[216:219], v[88:91], a[124:127]
 ds_read_b128 a[144:147], v5 offset:20480
 ds_read_b128 a[148:151], v6 offset:20480
 v_mfma_f32_16x16x32_bf16 a[124:127], a[220:223], v[92:95], a[124:127]
 buffer_load_dwordx4 v4, s[8:11], s49 offen offset:3072 lds
 v_mfma_f32_16x16x32_bf16 a[120:123], a[220:223], v[84:87], a[120:123]
 s_add_u32 s49, s49, 16384
 ds_read_b128 a[152:155], v7 offset:20480
 ds_read_b128 a[156:159], v8 offset:20480
 v_mfma_f32_16x16x32_bf16 a[120:123], a[216:219], v[80:83], a[120:123]
 v_mfma_f32_16x16x32_bf16 a[116:119], a[216:219], v[72:75], a[116:119]
 v_mfma_f32_16x16x32_bf16 a[116:119], a[220:223], v[76:79], a[116:119]
 v_mfma_f32_16x16x32_bf16 a[112:115], a[220:223], v[68:71], a[112:115]
 v_mfma_f32_16x16x32_bf16 a[112:115], a[216:219], v[64:67], a[112:115]
 s_waitcnt lgkmcnt(4)
 s_branch att_l1
att_j:
.p2align 3
att_loop:
att_l_:
 v_mfma_f32_16x16x32_bf16 v[128:131], a[128:131], v[192:195], v[48:51]
 ds_read_b128 a[160:163], v5 offset:57344
 v_mfma_f32_16x16x32_bf16 v[128:131], a[132:135], v[208:211], v[128:131]
 ds_read_b128 a[164:167], v6 offset:57344
 v_mfma_f32_16x16x32_bf16 v[128:131], a[136:139], v[224:227], v[128:131]
 ds_read_b128 a[168:171], v7 offset:57344
 v_mfma_f32_16x16x32_bf16 v[128:131], a[140:143], v[240:243], v[128:131]
 ds_read_b128 a[172:175], v8 offset:57344
 v_mfma_f32_16x16x32_bf16 v[132:135], a[140:143], v[244:247], v[52:55]
 ds_read_b128 a[176:179], v5 offset:61440
 v_mfma_f32_16x16x32_bf16 v[132:135], a[136:139], v[228:231], v[132:135]
 ds_read_b128 a[180:183], v6 offset:61440
 v_mfma_f32_16x16x32_bf16 v[132:135], a[132:135], v[212:215], v[132:135]
 ds_read_b128 a[184:187], v7 offset:61440
 v_mfma_f32_16x16x32_bf16 v[132:135], a[128:131], v[196:199], v[132:135]
 ds_read_b128 a[188:191], v8 offset:61440
 v_mfma_f32_16x16x32_bf16 v[136:139], a[128:131], v[200:203], v[56:59]
 v_exp_f32 v128, v128
 v_mfma_f32_16x16x32_bf16 v[136:139], a[132:135], v[216:219], v[136:139]
 v_exp_f32 v129, v129
 v_mfma_f32_16x16x32_bf16 v[136:139], a[136:139], v[232:235], v[136:139]
 v_exp_f32 v130, v130
 v_mfma_f32_16x16x32_bf16 v[136:139], a[140:143], v[248:251], v[136:139]
 v_exp_f32 v131, v131
 v_mfma_f32_16x16x32_bf16 v[140:143], a[140:143], v[252:255], v[60:63]
 v_exp_f32 v132, v132
 v_mfma_f32_16x16x32_bf16 v[140:143], a[136:139], v[236:239], v[140:143]
 v_exp_f32 v133, v133
 v_mfma_f32_16x16x32_bf16 v[140:143], a[132:135], v[220:223], v[140:143]
 v_exp_f32 v134, v134
 v_mfma_f32_16x16x32_bf16 v[140:143], a[128:131], v[204:207], v[140:143]
 s_waitcnt lgkmcnt(8)
 v_exp_f32 v135, v135
 v_mfma_f32_16x16x32_bf16 v[144:147], a[144:147], v[204:207], v[60:63]
 v_exp_f32 v136, v136
 v_mfma_f32_16x16x32_bf16 v[144:147], a[148:151], v[220:223], v[144:147]
 v_exp_f32 v137, v137
 v_mfma_f32_16x16x32_bf16 v[144:147], a[152:155], v[236:239], v[144:147]
 v_exp_f32 v138, v138
 v_mfma_f32_16x16x32_bf16 v[144:147], a[156:159], v[252:255], v[144:147]
 v_exp_f32 v139, v139
 v_mfma_f32_16x16x32_bf16 v[148:151], a[156:159], v[248:251], v[56:59]
 v_exp_f32 v140, v140
 v_mfma_f32_16x16x32_bf16 v[148:151], a[152:155], v[232:235], v[148:151]
 v_exp_f32 v141, v141
 v_mfma_f32_16x16x32_bf16 v[148:151], a[148:151], v[216:219], v[148:151]
 v_exp_f32 v142, v142
 v_mfma_f32_16x16x32_bf16 v[148:151], a[144:147], v[200:203], v[148:151]
 v_exp_f32 v143, v143
 v_mfma_f32_16x16x32_bf16 v[152:155], a[144:147], v[196:199], v[52:55]
 v_exp_f32 v144, v144
 v_mfma_f32_16x16x32_bf16 v[152:155], a[148:151], v[212:215], v[152:155]
 v_exp_f32 v145, v145
 v_mfma_f32_16x16x32_bf16 v[152:155], a[152:155], v[228:231], v[152:155]
 v_exp_f32 v146, v146
 v_mfma_f32_16x16x32_bf16 v[152:155], a[156:159], v[244:247], v[152:155]
 v_exp_f32 v147, v147
 v_mfma_f32_16x16x32_bf16 v[156:159], a[156:159], v[240:243], v[48:51]
 v_exp_f32 v148, v148
 v_mfma_f32_16x16x32_bf16 v[156:159], a[152:155], v[224:227], v[156:159]
 v_exp_f32 v149, v149
 v_mfma_f32_16x16x32_bf16 v[156:159], a[148:151], v[208:211], v[156:159]
 v_exp_f32 v150, v150
 v_mfma_f32_16x16x32_bf16 v[156:159], a[144:147], v[192:195], v[156:159]
 s_waitcnt lgkmcnt(4)
 v_exp_f32 v151, v151
 v_mfma_f32_16x16x32_bf16 v[160:163], a[160:163], v[192:195], v[48:51]
 v_exp_f32 v152, v152
 v_mfma_f32_16x16x32_bf16 v[160:163], a[164:167], v[208:211], v[160:163]
 v_exp_f32 v153, v153
 v_mfma_f32_16x16x32_bf16 v[160:163], a[168:171], v[224:227], v[160:163]
 v_exp_f32 v154, v154
 v_mfma_f32_16x16x32_bf16 v[160:163], a[172:175], v[240:243], v[160:163]
 v_exp_f32 v155, v155
 v_mfma_f32_16x16x32_bf16 v[164:167], a[172:175], v[244:247], v[52:55]
 v_exp_f32 v156, v156
 v_mfma_f32_16x16x32_bf16 v[164:167], a[168:171], v[228:231], v[164:167]
 v_exp_f32 v157, v157
 v_mfma_f32_16x16x32_bf16 v[164:167], a[164:167], v[212:215], v[164:167]
 v_exp_f32 v158, v158
 v_mfma_f32_16x16x32_bf16 v[164:167], a[160:163], v[196:199], v[164:167]
 v_exp_f32 v159, v159
 v_mfma_f32_16x16x32_bf16 v[168:171], a[160:163], v[200:203], v[56:59]
 v_exp_f32 v160, v160
 v_mfma_f32_16x16x32_bf16 v[168:171], a[164:167], v[216:219], v[168:171]
 v_exp_f32 v161, v161
 v_mfma_f32_16x16x32_bf16 v[168:171], a[168:171], v[232:235], v[168:171]
 v_exp_f32 v162, v162
 v_mfma_f32_16x16x32_bf16 v[168:171], a[172:175], v[248:251], v[168:171]
 v_exp_f32 v163, v163
 v_mfma_f32_16x16x32_bf16 v[172:175], a[172:175], v[252:255], v[60:63]
 ds_read_b64_tr_b16 a[192:193], v9 offset:32768
 v_cvt_pk_bf16_f32 v64, v128, v129
 v_mfma_f32_16x16x32_bf16 v[172:175], a[168:171], v[236:239], v[172:175]
 v_exp_f32 v164, v164
 v_mfma_f32_16x16x32_bf16 v[172:175], a[164:167], v[220:223], v[172:175]
 ds_read_b64_tr_b16 a[194:195], v9 offset:36864
 v_cvt_pk_bf16_f32 v65, v130, v131
 v_mfma_f32_16x16x32_bf16 v[172:175], a[160:163], v[204:207], v[172:175]
 s_waitcnt lgkmcnt(2)
 v_exp_f32 v165, v165
 v_mfma_f32_16x16x32_bf16 v[176:179], a[176:179], v[204:207], v[60:63]
 ds_read_b64_tr_b16 a[196:197], v9 offset:40960
 v_cvt_pk_bf16_f32 v72, v132, v133
 v_mfma_f32_16x16x32_bf16 v[176:179], a[180:183], v[220:223], v[176:179]
 v_exp_f32 v166, v166
 v_mfma_f32_16x16x32_bf16 v[176:179], a[184:187], v[236:239], v[176:179]
 ds_read_b64_tr_b16 a[198:199], v9 offset:45056
 v_cvt_pk_bf16_f32 v73, v134, v135
 v_mfma_f32_16x16x32_bf16 v[176:179], a[188:191], v[252:255], v[176:179]
 v_exp_f32 v167, v167
 v_mfma_f32_16x16x32_bf16 v[180:183], a[188:191], v[248:251], v[56:59]
 ds_read_b64_tr_b16 a[200:201], v10 offset:32768
 v_cvt_pk_bf16_f32 v80, v136, v137
 v_mfma_f32_16x16x32_bf16 v[180:183], a[184:187], v[232:235], v[180:183]
 v_exp_f32 v168, v168
 v_mfma_f32_16x16x32_bf16 v[180:183], a[180:183], v[216:219], v[180:183]
 ds_read_b64_tr_b16 a[202:203], v10 offset:36864
 v_cvt_pk_bf16_f32 v81, v138, v139
 v_mfma_f32_16x16x32_bf16 v[180:183], a[176:179], v[200:203], v[180:183]
 v_exp_f32 v169, v169
 v_mfma_f32_16x16x32_bf16 v[184:187], a[176:179], v[196:199], v[52:55]
 ds_read_b64_tr_b16 a[204:205], v10 offset:40960
 v_cvt_pk_bf16_f32 v88, v140, v141
 v_mfma_f32_16x16x32_bf16 v[184:187], a[180:183], v[212:215], v[184:187]
 v_exp_f32 v170, v170
 v_mfma_f32_16x16x32_bf16 v[184:187], a[184:187], v[228:231], v[184:187]
 ds_read_b64_tr_b16 a[206:207], v10 offset:45056
 v_cvt_pk_bf16_f32 v89, v142, v143
 v_mfma_f32_16x16x32_bf16 v[184:187], a[188:191], v[244:247], v[184:187]
 v_exp_f32 v171, v171
 v_mfma_f32_16x16x32_bf16 v[188:191], a[188:191], v[240:243], v[48:51]
 v_exp_f32 v172, v172
 v_mfma_f32_16x16x32_bf16 v[188:191], a[184:187], v[224:227], v[188:191]
 v_exp_f32 v173, v173
 v_mfma_f32_16x16x32_bf16 v[188:191], a[180:183], v[208:211], v[188:191]
 s_waitcnt vmcnt(13)
 v_exp_f32 v174, v174
 v_mfma_f32_16x16x32_bf16 v[188:191], a[176:179], v[192:195], v[188:191]
 s_barrier
 v_exp_f32 v175, v175
 v_smfmac_f32_16x16x64_bf16 v[32:35], a[224:227], v[96:103], v17
 v_exp_f32 v176, v176
 v_smfmac_f32_16x16x64_bf16 v[36:39], a[224:227], v[104:111], v17
 v_exp_f32 v177, v177
 v_smfmac_f32_16x16x64_bf16 v[40:43], a[224:227], v[112:119], v17
 v_exp_f32 v178, v178
 v_smfmac_f32_16x16x64_bf16 v[44:47], a[224:227], v[120:127], v17
 s_waitcnt lgkmcnt(4)
 v_exp_f32 v179, v179
 v_mfma_f32_16x16x32_bf16 a[0:3], a[192:195], v[96:99], a[0:3]
 s_add_u32 m0, s47, 114688
 ds_read_b64_tr_b16 a[208:209], v11 offset:32768
 ds_read_b64_tr_b16 a[210:211], v11 offset:36864
 v_mfma_f32_16x16x32_bf16 a[0:3], a[196:199], v[100:103], a[0:3]
 buffer_load_dwordx4 v1, s[12:15], s50 offen offset:0 lds
 v_mfma_f32_16x16x32_bf16 a[4:7], a[196:199], v[108:111], a[4:7]
 ds_read_b64_tr_b16 a[212:213], v11 offset:40960
 ds_read_b64_tr_b16 a[214:215], v11 offset:45056
 v_mfma_f32_16x16x32_bf16 a[4:7], a[192:195], v[104:107], a[4:7]
 v_exp_f32 v180, v180
 v_mfma_f32_16x16x32_bf16 a[8:11], a[192:195], v[112:115], a[8:11]
 v_exp_f32 v181, v181
 v_mfma_f32_16x16x32_bf16 a[8:11], a[196:199], v[116:119], a[8:11]
 v_exp_f32 v182, v182
 v_mfma_f32_16x16x32_bf16 a[12:15], a[196:199], v[124:127], a[12:15]
 v_exp_f32 v183, v183
 v_mfma_f32_16x16x32_bf16 a[12:15], a[192:195], v[120:123], a[12:15]
 s_waitcnt lgkmcnt(4)
 v_exp_f32 v184, v184
 v_mfma_f32_16x16x32_bf16 a[28:31], a[200:203], v[120:123], a[28:31]
 ds_read_b64_tr_b16 a[216:217], v12 offset:32768
 ds_read_b64_tr_b16 a[218:219], v12 offset:36864
 v_mfma_f32_16x16x32_bf16 a[28:31], a[204:207], v[124:127], a[28:31]
 buffer_load_dwordx4 v2, s[12:15], s50 offen offset:1024 lds
 v_mfma_f32_16x16x32_bf16 a[24:27], a[204:207], v[116:119], a[24:27]
 ds_read_b64_tr_b16 a[220:221], v12 offset:40960
 ds_read_b64_tr_b16 a[222:223], v12 offset:45056
 v_mfma_f32_16x16x32_bf16 a[24:27], a[200:203], v[112:115], a[24:27]
 v_exp_f32 v185, v185
 v_mfma_f32_16x16x32_bf16 a[20:23], a[200:203], v[104:107], a[20:23]
 v_exp_f32 v186, v186
 v_mfma_f32_16x16x32_bf16 a[20:23], a[204:207], v[108:111], a[20:23]
 v_exp_f32 v187, v187
 v_mfma_f32_16x16x32_bf16 a[16:19], a[204:207], v[100:103], a[16:19]
 v_exp_f32 v188, v188
 v_mfma_f32_16x16x32_bf16 a[16:19], a[200:203], v[96:99], a[16:19]
 s_waitcnt lgkmcnt(4)
 v_exp_f32 v189, v189
 v_mfma_f32_16x16x32_bf16 a[32:35], a[208:211], v[96:99], a[32:35]
 ds_read_b64_tr_b16 a[192:193], v13 offset:32768
 ds_read_b64_tr_b16 a[194:195], v13 offset:36864
 v_mfma_f32_16x16x32_bf16 a[32:35], a[212:215], v[100:103], a[32:35]
 buffer_load_dwordx4 v3, s[12:15], s50 offen offset:2048 lds
 v_mfma_f32_16x16x32_bf16 a[36:39], a[212:215], v[108:111], a[36:39]
 ds_read_b64_tr_b16 a[196:197], v13 offset:40960
 ds_read_b64_tr_b16 a[198:199], v13 offset:45056
 v_mfma_f32_16x16x32_bf16 a[36:39], a[208:211], v[104:107], a[36:39]
 v_exp_f32 v190, v190
 v_mfma_f32_16x16x32_bf16 a[40:43], a[208:211], v[112:115], a[40:43]
 v_exp_f32 v191, v191
 v_mfma_f32_16x16x32_bf16 a[40:43], a[212:215], v[116:119], a[40:43]
 v_cvt_pk_bf16_f32 v90, v144, v145
 v_cvt_pk_bf16_f32 v91, v146, v147
 v_mfma_f32_16x16x32_bf16 a[44:47], a[212:215], v[124:127], a[44:47]
 v_cvt_pk_bf16_f32 v82, v148, v149
 v_cvt_pk_bf16_f32 v83, v150, v151
 v_mfma_f32_16x16x32_bf16 a[44:47], a[208:211], v[120:123], a[44:47]
 s_waitcnt lgkmcnt(4)
 v_cvt_pk_bf16_f32 v74, v152, v153
 v_cvt_pk_bf16_f32 v75, v154, v155
 v_mfma_f32_16x16x32_bf16 a[60:63], a[216:219], v[120:123], a[60:63]
 ds_read_b64_tr_b16 a[200:201], v14 offset:32768
 ds_read_b64_tr_b16 a[202:203], v14 offset:36864
 v_mfma_f32_16x16x32_bf16 a[60:63], a[220:223], v[124:127], a[60:63]
 buffer_load_dwordx4 v4, s[12:15], s50 offen offset:3072 lds
 v_mfma_f32_16x16x32_bf16 a[56:59], a[220:223], v[116:119], a[56:59]
 s_add_u32 s50, s50, 16384
 ds_read_b64_tr_b16 a[204:205], v14 offset:40960
 ds_read_b64_tr_b16 a[206:207], v14 offset:45056
 v_mfma_f32_16x16x32_bf16 a[56:59], a[216:219], v[112:115], a[56:59]
 v_cvt_pk_bf16_f32 v66, v156, v157
 v_cvt_pk_bf16_f32 v67, v158, v159
 v_mfma_f32_16x16x32_bf16 a[52:55], a[216:219], v[104:107], a[52:55]
 v_cvt_pk_bf16_f32 v68, v160, v161
 v_cvt_pk_bf16_f32 v69, v162, v163
 v_mfma_f32_16x16x32_bf16 a[52:55], a[220:223], v[108:111], a[52:55]
 v_cvt_pk_bf16_f32 v76, v164, v165
 v_cvt_pk_bf16_f32 v77, v166, v167
 v_mfma_f32_16x16x32_bf16 a[48:51], a[220:223], v[100:103], a[48:51]
 v_cvt_pk_bf16_f32 v84, v168, v169
 v_cvt_pk_bf16_f32 v85, v170, v171
 v_mfma_f32_16x16x32_bf16 a[48:51], a[216:219], v[96:99], a[48:51]
 s_waitcnt lgkmcnt(4)
 v_cvt_pk_bf16_f32 v92, v172, v173
 v_cvt_pk_bf16_f32 v93, v174, v175
 v_mfma_f32_16x16x32_bf16 a[64:67], a[192:195], v[96:99], a[64:67]
 s_add_u32 m0, s47, 65536
 ds_read_b64_tr_b16 a[208:209], v15 offset:32768
 ds_read_b64_tr_b16 a[210:211], v15 offset:36864
 v_mfma_f32_16x16x32_bf16 a[64:67], a[196:199], v[100:103], a[64:67]
 buffer_load_dwordx4 v1, s[8:11], s49 offen offset:0 lds
 v_mfma_f32_16x16x32_bf16 a[68:71], a[196:199], v[108:111], a[68:71]
 ds_read_b64_tr_b16 a[212:213], v15 offset:40960
 ds_read_b64_tr_b16 a[214:215], v15 offset:45056
 v_mfma_f32_16x16x32_bf16 a[68:71], a[192:195], v[104:107], a[68:71]
 v_cvt_pk_bf16_f32 v94, v176, v177
 v_cvt_pk_bf16_f32 v95, v178, v179
 v_mfma_f32_16x16x32_bf16 a[72:75], a[192:195], v[112:115], a[72:75]
 v_cvt_pk_bf16_f32 v86, v180, v181
 v_cvt_pk_bf16_f32 v87, v182, v183
 v_mfma_f32_16x16x32_bf16 a[72:75], a[196:199], v[116:119], a[72:75]
 v_cvt_pk_bf16_f32 v78, v184, v185
 v_cvt_pk_bf16_f32 v79, v186, v187
 v_mfma_f32_16x16x32_bf16 a[76:79], a[196:199], v[124:127], a[76:79]
 v_cvt_pk_bf16_f32 v70, v188, v189
 v_cvt_pk_bf16_f32 v71, v190, v191
 v_mfma_f32_16x16x32_bf16 a[76:79], a[192:195], v[120:123], a[76:79]
 s_waitcnt lgkmcnt(4)
 v_mfma_f32_16x16x32_bf16 a[92:95], a[200:203], v[120:123], a[92:95]
 ds_read_b64_tr_b16 a[216:217], v16 offset:32768
 ds_read_b64_tr_b16 a[218:219], v16 offset:36864
 v_mfma_f32_16x16x32_bf16 a[92:95], a[204:207], v[124:127], a[92:95]
 buffer_load_dwordx4 v2, s[8:11], s49 offen offset:1024 lds
 v_mfma_f32_16x16x32_bf16 a[88:91], a[204:207], v[116:119], a[88:91]
 ds_read_b64_tr_b16 a[220:221], v16 offset:40960
 ds_read_b64_tr_b16 a[222:223], v16 offset:45056
 v_mfma_f32_16x16x32_bf16 a[88:91], a[200:203], v[112:115], a[88:91]
 v_mfma_f32_16x16x32_bf16 a[84:87], a[200:203], v[104:107], a[84:87]
 v_mfma_f32_16x16x32_bf16 a[84:87], a[204:207], v[108:111], a[84:87]
 v_mfma_f32_16x16x32_bf16 a[80:83], a[204:207], v[100:103], a[80:83]
 v_mfma_f32_16x16x32_bf16 a[80:83], a[200:203], v[96:99], a[80:83]
 s_waitcnt lgkmcnt(4)
 v_mfma_f32_16x16x32_bf16 a[96:99], a[208:211], v[96:99], a[96:99]
 ds_read_b128 a[128:131], v5 offset:0
 ds_read_b128 a[132:135], v6 offset:0
 v_mfma_f32_16x16x32_bf16 a[96:99], a[212:215], v[100:103], a[96:99]
 buffer_load_dwordx4 v3, s[8:11], s49 offen offset:2048 lds
 v_mfma_f32_16x16x32_bf16 a[100:103], a[212:215], v[108:111], a[100:103]
 ds_read_b128 a[136:139], v7 offset:0
 ds_read_b128 a[140:143], v8 offset:0
 v_mfma_f32_16x16x32_bf16 a[100:103], a[208:211], v[104:107], a[100:103]
 v_mfma_f32_16x16x32_bf16 a[104:107], a[208:211], v[112:115], a[104:107]
 v_mfma_f32_16x16x32_bf16 a[104:107], a[212:215], v[116:119], a[104:107]
 v_mfma_f32_16x16x32_bf16 a[108:111], a[212:215], v[124:127], a[108:111]
 v_mfma_f32_16x16x32_bf16 a[108:111], a[208:211], v[120:123], a[108:111]
 s_waitcnt lgkmcnt(4)
 v_mfma_f32_16x16x32_bf16 a[124:127], a[216:219], v[120:123], a[124:127]
 ds_read_b128 a[144:147], v5 offset:4096
 ds_read_b128 a[148:151], v6 offset:4096
 v_mfma_f32_16x16x32_bf16 a[124:127], a[220:223], v[124:127], a[124:127]
 buffer_load_dwordx4 v4, s[8:11], s49 offen offset:3072 lds
 v_mfma_f32_16x16x32_bf16 a[120:123], a[220:223], v[116:119], a[120:123]
 s_add_u32 s49, s49, 16384
 ds_read_b128 a[152:155], v7 offset:4096
 ds_read_b128 a[156:159], v8 offset:4096
 v_mfma_f32_16x16x32_bf16 a[120:123], a[216:219], v[112:115], a[120:123]
 v_mfma_f32_16x16x32_bf16 a[116:119], a[216:219], v[104:107], a[116:119]
 v_mfma_f32_16x16x32_bf16 a[116:119], a[220:223], v[108:111], a[116:119]
 buffer_atomic_add v30, v29, s[92:95], 0 offen sc1
 v_or_b32 v29, 131072, v29
 v_mfma_f32_16x16x32_bf16 a[112:115], a[220:223], v[100:103], a[112:115]
 v_mfma_f32_16x16x32_bf16 a[112:115], a[216:219], v[96:99], a[112:115]
 s_waitcnt lgkmcnt(4)
 v_mfma_f32_16x16x32_bf16 v[128:131], a[128:131], v[192:195], v[48:51]
 ds_read_b128 a[160:163], v5 offset:8192
 v_mfma_f32_16x16x32_bf16 v[128:131], a[132:135], v[208:211], v[128:131]
 ds_read_b128 a[164:167], v6 offset:8192
 v_mfma_f32_16x16x32_bf16 v[128:131], a[136:139], v[224:227], v[128:131]
 ds_read_b128 a[168:171], v7 offset:8192
 v_mfma_f32_16x16x32_bf16 v[128:131], a[140:143], v[240:243], v[128:131]
 ds_read_b128 a[172:175], v8 offset:8192
 v_mfma_f32_16x16x32_bf16 v[132:135], a[140:143], v[244:247], v[52:55]
 ds_read_b128 a[176:179], v5 offset:12288
 v_mfma_f32_16x16x32_bf16 v[132:135], a[136:139], v[228:231], v[132:135]
 ds_read_b128 a[180:183], v6 offset:12288
 v_mfma_f32_16x16x32_bf16 v[132:135], a[132:135], v[212:215], v[132:135]
 ds_read_b128 a[184:187], v7 offset:12288
 v_mfma_f32_16x16x32_bf16 v[132:135], a[128:131], v[196:199], v[132:135]
 ds_read_b128 a[188:191], v8 offset:12288
 v_mfma_f32_16x16x32_bf16 v[136:139], a[128:131], v[200:203], v[56:59]
 v_exp_f32 v128, v128
 v_mfma_f32_16x16x32_bf16 v[136:139], a[132:135], v[216:219], v[136:139]
 v_exp_f32 v129, v129
 v_mfma_f32_16x16x32_bf16 v[136:139], a[136:139], v[232:235], v[136:139]
 v_exp_f32 v130, v130
 v_mfma_f32_16x16x32_bf16 v[136:139], a[140:143], v[248:251], v[136:139]
 v_exp_f32 v131, v131
 v_mfma_f32_16x16x32_bf16 v[140:143], a[140:143], v[252:255], v[60:63]
 v_exp_f32 v132, v132
 v_mfma_f32_16x16x32_bf16 v[140:143], a[136:139], v[236:239], v[140:143]
 v_exp_f32 v133, v133
 v_mfma_f32_16x16x32_bf16 v[140:143], a[132:135], v[220:223], v[140:143]
 v_exp_f32 v134, v134
 v_mfma_f32_16x16x32_bf16 v[140:143], a[128:131], v[204:207], v[140:143]
 s_waitcnt lgkmcnt(8)
 v_exp_f32 v135, v135
 v_mfma_f32_16x16x32_bf16 v[144:147], a[144:147], v[204:207], v[60:63]
 v_exp_f32 v136, v136
 v_mfma_f32_16x16x32_bf16 v[144:147], a[148:151], v[220:223], v[144:147]
 v_exp_f32 v137, v137
 v_mfma_f32_16x16x32_bf16 v[144:147], a[152:155], v[236:239], v[144:147]
 v_exp_f32 v138, v138
 v_mfma_f32_16x16x32_bf16 v[144:147], a[156:159], v[252:255], v[144:147]
 v_exp_f32 v139, v139
 v_mfma_f32_16x16x32_bf16 v[148:151], a[156:159], v[248:251], v[56:59]
 v_exp_f32 v140, v140
 v_mfma_f32_16x16x32_bf16 v[148:151], a[152:155], v[232:235], v[148:151]
 v_exp_f32 v141, v141
 v_mfma_f32_16x16x32_bf16 v[148:151], a[148:151], v[216:219], v[148:151]
 v_exp_f32 v142, v142
 v_mfma_f32_16x16x32_bf16 v[148:151], a[144:147], v[200:203], v[148:151]
 v_exp_f32 v143, v143
 v_mfma_f32_16x16x32_bf16 v[152:155], a[144:147], v[196:199], v[52:55]
 v_exp_f32 v144, v144
 v_mfma_f32_16x16x32_bf16 v[152:155], a[148:151], v[212:215], v[152:155]
 v_exp_f32 v145, v145
 v_mfma_f32_16x16x32_bf16 v[152:155], a[152:155], v[228:231], v[152:155]
 v_exp_f32 v146, v146
 v_mfma_f32_16x16x32_bf16 v[152:155], a[156:159], v[244:247], v[152:155]
 v_exp_f32 v147, v147
 v_mfma_f32_16x16x32_bf16 v[156:159], a[156:159], v[240:243], v[48:51]
 v_exp_f32 v148, v148
 v_mfma_f32_16x16x32_bf16 v[156:159], a[152:155], v[224:227], v[156:159]
 v_exp_f32 v149, v149
 v_mfma_f32_16x16x32_bf16 v[156:159], a[148:151], v[208:211], v[156:159]
 v_exp_f32 v150, v150
 v_mfma_f32_16x16x32_bf16 v[156:159], a[144:147], v[192:195], v[156:159]
 s_waitcnt lgkmcnt(4)
 v_exp_f32 v151, v151
 v_mfma_f32_16x16x32_bf16 v[160:163], a[160:163], v[192:195], v[48:51]
 v_exp_f32 v152, v152
 v_mfma_f32_16x16x32_bf16 v[160:163], a[164:167], v[208:211], v[160:163]
 v_exp_f32 v153, v153
 v_mfma_f32_16x16x32_bf16 v[160:163], a[168:171], v[224:227], v[160:163]
 v_exp_f32 v154, v154
 v_mfma_f32_16x16x32_bf16 v[160:163], a[172:175], v[240:243], v[160:163]
 v_exp_f32 v155, v155
 v_mfma_f32_16x16x32_bf16 v[164:167], a[172:175], v[244:247], v[52:55]
 v_exp_f32 v156, v156
 v_mfma_f32_16x16x32_bf16 v[164:167], a[168:171], v[228:231], v[164:167]
 v_exp_f32 v157, v157
 v_mfma_f32_16x16x32_bf16 v[164:167], a[164:167], v[212:215], v[164:167]
 v_exp_f32 v158, v158
 v_mfma_f32_16x16x32_bf16 v[164:167], a[160:163], v[196:199], v[164:167]
 v_exp_f32 v159, v159
 v_mfma_f32_16x16x32_bf16 v[168:171], a[160:163], v[200:203], v[56:59]
 v_exp_f32 v160, v160
 v_mfma_f32_16x16x32_bf16 v[168:171], a[164:167], v[216:219], v[168:171]
 v_exp_f32 v161, v161
 v_mfma_f32_16x16x32_bf16 v[168:171], a[168:171], v[232:235], v[168:171]
 v_exp_f32 v162, v162
 v_mfma_f32_16x16x32_bf16 v[168:171], a[172:175], v[248:251], v[168:171]
 v_exp_f32 v163, v163
 v_mfma_f32_16x16x32_bf16 v[172:175], a[172:175], v[252:255], v[60:63]
 ds_read_b64_tr_b16 a[192:193], v9 offset:49152
 v_cvt_pk_bf16_f32 v96, v128, v129
 v_mfma_f32_16x16x32_bf16 v[172:175], a[168:171], v[236:239], v[172:175]
 v_exp_f32 v164, v164
 v_mfma_f32_16x16x32_bf16 v[172:175], a[164:167], v[220:223], v[172:175]
 ds_read_b64_tr_b16 a[194:195], v9 offset:53248
 v_cvt_pk_bf16_f32 v97, v130, v131
 v_mfma_f32_16x16x32_bf16 v[172:175], a[160:163], v[204:207], v[172:175]
 s_waitcnt lgkmcnt(2)
 v_exp_f32 v165, v165
 v_mfma_f32_16x16x32_bf16 v[176:179], a[176:179], v[204:207], v[60:63]
 ds_read_b64_tr_b16 a[196:197], v9 offset:57344
 v_cvt_pk_bf16_f32 v104, v132, v133
 v_mfma_f32_16x16x32_bf16 v[176:179], a[180:183], v[220:223], v[176:179]
 v_exp_f32 v166, v166
 v_mfma_f32_16x16x32_bf16 v[176:179], a[184:187], v[236:239], v[176:179]
 ds_read_b64_tr_b16 a[198:199], v9 offset:61440
 v_cvt_pk_bf16_f32 v105, v134, v135
 v_mfma_f32_16x16x32_bf16 v[176:179], a[188:191], v[252:255], v[176:179]
 v_exp_f32 v167, v167
 v_mfma_f32_16x16x32_bf16 v[180:183], a[188:191], v[248:251], v[56:59]
 ds_read_b64_tr_b16 a[200:201], v10 offset:49152
 v_cvt_pk_bf16_f32 v112, v136, v137
 v_mfma_f32_16x16x32_bf16 v[180:183], a[184:187], v[232:235], v[180:183]
 v_exp_f32 v168, v168
 v_mfma_f32_16x16x32_bf16 v[180:183], a[180:183], v[216:219], v[180:183]
 ds_read_b64_tr_b16 a[202:203], v10 offset:53248
 v_cvt_pk_bf16_f32 v113, v138, v139
 v_mfma_f32_16x16x32_bf16 v[180:183], a[176:179], v[200:203], v[180:183]
 v_exp_f32 v169, v169
 v_mfma_f32_16x16x32_bf16 v[184:187], a[176:179], v[196:199], v[52:55]
 ds_read_b64_tr_b16 a[204:205], v10 offset:57344
 v_cvt_pk_bf16_f32 v120, v140, v141
 v_mfma_f32_16x16x32_bf16 v[184:187], a[180:183], v[212:215], v[184:187]
 v_exp_f32 v170, v170
 v_mfma_f32_16x16x32_bf16 v[184:187], a[184:187], v[228:231], v[184:187]
 ds_read_b64_tr_b16 a[206:207], v10 offset:61440
 v_cvt_pk_bf16_f32 v121, v142, v143
 v_mfma_f32_16x16x32_bf16 v[184:187], a[188:191], v[244:247], v[184:187]
 v_exp_f32 v171, v171
 v_mfma_f32_16x16x32_bf16 v[188:191], a[188:191], v[240:243], v[48:51]
 v_exp_f32 v172, v172
 v_mfma_f32_16x16x32_bf16 v[188:191], a[184:187], v[224:227], v[188:191]
 v_exp_f32 v173, v173
 v_mfma_f32_16x16x32_bf16 v[188:191], a[180:183], v[208:211], v[188:191]
 s_waitcnt vmcnt(13)
 v_exp_f32 v174, v174
 v_mfma_f32_16x16x32_bf16 v[188:191], a[176:179], v[192:195], v[188:191]
 s_barrier
 v_exp_f32 v175, v175
 v_smfmac_f32_16x16x64_bf16 v[32:35], a[224:227], v[64:71], v17
 v_exp_f32 v176, v176
 v_smfmac_f32_16x16x64_bf16 v[36:39], a[224:227], v[72:79], v17
 v_exp_f32 v177, v177
 v_smfmac_f32_16x16x64_bf16 v[40:43], a[224:227], v[80:87], v17
 v_exp_f32 v178, v178
 v_smfmac_f32_16x16x64_bf16 v[44:47], a[224:227], v[88:95], v17
 s_waitcnt lgkmcnt(4)
 v_exp_f32 v179, v179
 v_mfma_f32_16x16x32_bf16 a[0:3], a[192:195], v[64:67], a[0:3]
 s_add_u32 m0, s47, 131072
 ds_read_b64_tr_b16 a[208:209], v11 offset:49152
 ds_read_b64_tr_b16 a[210:211], v11 offset:53248
 v_mfma_f32_16x16x32_bf16 a[0:3], a[196:199], v[68:71], a[0:3]
 buffer_load_dwordx4 v1, s[12:15], s50 offen offset:0 lds
 v_mfma_f32_16x16x32_bf16 a[4:7], a[196:199], v[76:79], a[4:7]
 ds_read_b64_tr_b16 a[212:213], v11 offset:57344
 ds_read_b64_tr_b16 a[214:215], v11 offset:61440
 v_mfma_f32_16x16x32_bf16 a[4:7], a[192:195], v[72:75], a[4:7]
 v_exp_f32 v180, v180
 v_mfma_f32_16x16x32_bf16 a[8:11], a[192:195], v[80:83], a[8:11]
 v_exp_f32 v181, v181
 v_mfma_f32_16x16x32_bf16 a[8:11], a[196:199], v[84:87], a[8:11]
 v_exp_f32 v182, v182
 v_mfma_f32_16x16x32_bf16 a[12:15], a[196:199], v[92:95], a[12:15]
 v_exp_f32 v183, v183
 v_mfma_f32_16x16x32_bf16 a[12:15], a[192:195], v[88:91], a[12:15]
 s_waitcnt lgkmcnt(4)
 v_exp_f32 v184, v184
 v_mfma_f32_16x16x32_bf16 a[28:31], a[200:203], v[88:91], a[28:31]
 ds_read_b64_tr_b16 a[216:217], v12 offset:49152
 ds_read_b64_tr_b16 a[218:219], v12 offset:53248
 v_mfma_f32_16x16x32_bf16 a[28:31], a[204:207], v[92:95], a[28:31]
 buffer_load_dwordx4 v2, s[12:15], s50 offen offset:1024 lds
 v_mfma_f32_16x16x32_bf16 a[24:27], a[204:207], v[84:87], a[24:27]
 ds_read_b64_tr_b16 a[220:221], v12 offset:57344
 ds_read_b64_tr_b16 a[222:223], v12 offset:61440
 v_mfma_f32_16x16x32_bf16 a[24:27], a[200:203], v[80:83], a[24:27]
 v_exp_f32 v185, v185
 v_mfma_f32_16x16x32_bf16 a[20:23], a[200:203], v[72:75], a[20:23]
 v_exp_f32 v186, v186
 v_mfma_f32_16x16x32_bf16 a[20:23], a[204:207], v[76:79], a[20:23]
 v_exp_f32 v187, v187
 v_mfma_f32_16x16x32_bf16 a[16:19], a[204:207], v[68:71], a[16:19]
 v_exp_f32 v188, v188
 v_mfma_f32_16x16x32_bf16 a[16:19], a[200:203], v[64:67], a[16:19]
 s_waitcnt lgkmcnt(4)
 v_exp_f32 v189, v189
 v_mfma_f32_16x16x32_bf16 a[32:35], a[208:211], v[64:67], a[32:35]
 ds_read_b64_tr_b16 a[192:193], v13 offset:49152
 ds_read_b64_tr_b16 a[194:195], v13 offset:53248
 v_mfma_f32_16x16x32_bf16 a[32:35], a[212:215], v[68:71], a[32:35]
 buffer_load_dwordx4 v3, s[12:15], s50 offen offset:2048 lds
 v_mfma_f32_16x16x32_bf16 a[36:39], a[212:215], v[76:79], a[36:39]
 ds_read_b64_tr_b16 a[196:197], v13 offset:57344
 ds_read_b64_tr_b16 a[198:199], v13 offset:61440
 v_mfma_f32_16x16x32_bf16 a[36:39], a[208:211], v[72:75], a[36:39]
 v_exp_f32 v190, v190
 v_mfma_f32_16x16x32_bf16 a[40:43], a[208:211], v[80:83], a[40:43]
 v_exp_f32 v191, v191
 v_mfma_f32_16x16x32_bf16 a[40:43], a[212:215], v[84:87], a[40:43]
 v_cvt_pk_bf16_f32 v122, v144, v145
 v_cvt_pk_bf16_f32 v123, v146, v147
 v_mfma_f32_16x16x32_bf16 a[44:47], a[212:215], v[92:95], a[44:47]
 v_cvt_pk_bf16_f32 v114, v148, v149
 v_cvt_pk_bf16_f32 v115, v150, v151
 v_mfma_f32_16x16x32_bf16 a[44:47], a[208:211], v[88:91], a[44:47]
 s_waitcnt lgkmcnt(4)
 v_cvt_pk_bf16_f32 v106, v152, v153
 v_cvt_pk_bf16_f32 v107, v154, v155
 v_mfma_f32_16x16x32_bf16 a[60:63], a[216:219], v[88:91], a[60:63]
 ds_read_b64_tr_b16 a[200:201], v14 offset:49152
 ds_read_b64_tr_b16 a[202:203], v14 offset:53248
 v_mfma_f32_16x16x32_bf16 a[60:63], a[220:223], v[92:95], a[60:63]
 buffer_load_dwordx4 v4, s[12:15], s50 offen offset:3072 lds
 v_mfma_f32_16x16x32_bf16 a[56:59], a[220:223], v[84:87], a[56:59]
 s_add_u32 s50, s50, 16384
 ds_read_b64_tr_b16 a[204:205], v14 offset:57344
 ds_read_b64_tr_b16 a[206:207], v14 offset:61440
 v_mfma_f32_16x16x32_bf16 a[56:59], a[216:219], v[80:83], a[56:59]
 v_cvt_pk_bf16_f32 v98, v156, v157
 v_cvt_pk_bf16_f32 v99, v158, v159
 v_mfma_f32_16x16x32_bf16 a[52:55], a[216:219], v[72:75], a[52:55]
 v_cvt_pk_bf16_f32 v100, v160, v161
 v_cvt_pk_bf16_f32 v101, v162, v163
 v_mfma_f32_16x16x32_bf16 a[52:55], a[220:223], v[76:79], a[52:55]
 v_cvt_pk_bf16_f32 v108, v164, v165
 v_cvt_pk_bf16_f32 v109, v166, v167
 v_mfma_f32_16x16x32_bf16 a[48:51], a[220:223], v[68:71], a[48:51]
 v_cvt_pk_bf16_f32 v116, v168, v169
 v_cvt_pk_bf16_f32 v117, v170, v171
 v_mfma_f32_16x16x32_bf16 a[48:51], a[216:219], v[64:67], a[48:51]
 s_waitcnt lgkmcnt(4)
 v_cvt_pk_bf16_f32 v124, v172, v173
 v_cvt_pk_bf16_f32 v125, v174, v175
 v_mfma_f32_16x16x32_bf16 a[64:67], a[192:195], v[64:67], a[64:67]
 s_add_u32 m0, s47, 16384
 ds_read_b64_tr_b16 a[208:209], v15 offset:49152
 ds_read_b64_tr_b16 a[210:211], v15 offset:53248
 v_mfma_f32_16x16x32_bf16 a[64:67], a[196:199], v[68:71], a[64:67]
 buffer_load_dwordx4 v1, s[8:11], s49 offen offset:0 lds
 v_mfma_f32_16x16x32_bf16 a[68:71], a[196:199], v[76:79], a[68:71]
 ds_read_b64_tr_b16 a[212:213], v15 offset:57344
 ds_read_b64_tr_b16 a[214:215], v15 offset:61440
 v_mfma_f32_16x16x32_bf16 a[68:71], a[192:195], v[72:75], a[68:71]
 v_cvt_pk_bf16_f32 v126, v176, v177
 v_cvt_pk_bf16_f32 v127, v178, v179
 v_mfma_f32_16x16x32_bf16 a[72:75], a[192:195], v[80:83], a[72:75]
 v_cvt_pk_bf16_f32 v118, v180, v181
 v_cvt_pk_bf16_f32 v119, v182, v183
 v_mfma_f32_16x16x32_bf16 a[72:75], a[196:199], v[84:87], a[72:75]
 v_cvt_pk_bf16_f32 v110, v184, v185
 v_cvt_pk_bf16_f32 v111, v186, v187
 v_mfma_f32_16x16x32_bf16 a[76:79], a[196:199], v[92:95], a[76:79]
 v_cvt_pk_bf16_f32 v102, v188, v189
 v_cvt_pk_bf16_f32 v103, v190, v191
 v_mfma_f32_16x16x32_bf16 a[76:79], a[192:195], v[88:91], a[76:79]
 s_waitcnt lgkmcnt(4)
 v_mfma_f32_16x16x32_bf16 a[92:95], a[200:203], v[88:91], a[92:95]
 ds_read_b64_tr_b16 a[216:217], v16 offset:49152
 ds_read_b64_tr_b16 a[218:219], v16 offset:53248
 v_mfma_f32_16x16x32_bf16 a[92:95], a[204:207], v[92:95], a[92:95]
 buffer_load_dwordx4 v2, s[8:11], s49 offen offset:1024 lds
 v_mfma_f32_16x16x32_bf16 a[88:91], a[204:207], v[84:87], a[88:91]
 ds_read_b64_tr_b16 a[220:221], v16 offset:57344
 ds_read_b64_tr_b16 a[222:223], v16 offset:61440
 v_mfma_f32_16x16x32_bf16 a[88:91], a[200:203], v[80:83], a[88:91]
 v_mfma_f32_16x16x32_bf16 a[84:87], a[200:203], v[72:75], a[84:87]
 v_mfma_f32_16x16x32_bf16 a[84:87], a[204:207], v[76:79], a[84:87]
 v_mfma_f32_16x16x32_bf16 a[80:83], a[204:207], v[68:71], a[80:83]
 v_mfma_f32_16x16x32_bf16 a[80:83], a[200:203], v[64:67], a[80:83]
 s_waitcnt lgkmcnt(4)
 v_mfma_f32_16x16x32_bf16 a[96:99], a[208:211], v[64:67], a[96:99]
 ds_read_b128 a[128:131], v5 offset:16384
 ds_read_b128 a[132:135], v6 offset:16384
 v_mfma_f32_16x16x32_bf16 a[96:99], a[212:215], v[68:71], a[96:99]
 buffer_load_dwordx4 v3, s[8:11], s49 offen offset:2048 lds
 v_mfma_f32_16x16x32_bf16 a[100:103], a[212:215], v[76:79], a[100:103]
 ds_read_b128 a[136:139], v7 offset:16384
 ds_read_b128 a[140:143], v8 offset:16384
 v_mfma_f32_16x16x32_bf16 a[100:103], a[208:211], v[72:75], a[100:103]
 v_mfma_f32_16x16x32_bf16 a[104:107], a[208:211], v[80:83], a[104:107]
 v_mfma_f32_16x16x32_bf16 a[104:107], a[212:215], v[84:87], a[104:107]
 v_mfma_f32_16x16x32_bf16 a[108:111], a[212:215], v[92:95], a[108:111]
 v_mfma_f32_16x16x32_bf16 a[108:111], a[208:211], v[88:91], a[108:111]
 s_waitcnt lgkmcnt(4)
 v_mfma_f32_16x16x32_bf16 a[124:127], a[216:219], v[88:91], a[124:127]
 ds_read_b128 a[144:147], v5 offset:20480
 ds_read_b128 a[148:151], v6 offset:20480
 v_mfma_f32_16x16x32_bf16 a[124:127], a[220:223], v[92:95], a[124:127]
 buffer_load_dwordx4 v4, s[8:11], s49 offen offset:3072 lds
 v_mfma_f32_16x16x32_bf16 a[120:123], a[220:223], v[84:87], a[120:123]
 s_add_u32 s49, s49, 16384
 ds_read_b128 a[152:155], v7 offset:20480
 ds_read_b128 a[156:159], v8 offset:20480
 v_mfma_f32_16x16x32_bf16 a[120:123], a[216:219], v[80:83], a[120:123]
 v_mfma_f32_16x16x32_bf16 a[116:119], a[216:219], v[72:75], a[116:119]
 v_mfma_f32_16x16x32_bf16 a[116:119], a[220:223], v[76:79], a[116:119]
 buffer_load_dword v19, v20, s[92:95], 0 offen sc1
 v_subrev_u32 v20, 131072, v20
 v_mfma_f32_16x16x32_bf16 a[112:115], a[220:223], v[68:71], a[112:115]
 v_mfma_f32_16x16x32_bf16 a[112:115], a[216:219], v[64:67], a[112:115]
 s_waitcnt lgkmcnt(4)
att_l1:
 v_mfma_f32_16x16x32_bf16 v[128:131], a[128:131], v[192:195], v[48:51]
 ds_read_b128 a[160:163], v5 offset:24576
 v_mfma_f32_16x16x32_bf16 v[128:131], a[132:135], v[208:211], v[128:131]
 ds_read_b128 a[164:167], v6 offset:24576
 v_mfma_f32_16x16x32_bf16 v[128:131], a[136:139], v[224:227], v[128:131]
 ds_read_b128 a[168:171], v7 offset:24576
 v_mfma_f32_16x16x32_bf16 v[128:131], a[140:143], v[240:243], v[128:131]
 ds_read_b128 a[172:175], v8 offset:24576
 v_mfma_f32_16x16x32_bf16 v[132:135], a[140:143], v[244:247], v[52:55]
 ds_read_b128 a[176:179], v5 offset:28672
 v_mfma_f32_16x16x32_bf16 v[132:135], a[136:139], v[228:231], v[132:135]
 ds_read_b128 a[180:183], v6 offset:28672
 v_mfma_f32_16x16x32_bf16 v[132:135], a[132:135], v[212:215], v[132:135]
 ds_read_b128 a[184:187], v7 offset:28672
 v_mfma_f32_16x16x32_bf16 v[132:135], a[128:131], v[196:199], v[132:135]
 ds_read_b128 a[188:191], v8 offset:28672
 v_mfma_f32_16x16x32_bf16 v[136:139], a[128:131], v[200:203], v[56:59]
 v_exp_f32 v128, v128
 v_mfma_f32_16x16x32_bf16 v[136:139], a[132:135], v[216:219], v[136:139]
 v_exp_f32 v129, v129
 v_mfma_f32_16x16x32_bf16 v[136:139], a[136:139], v[232:235], v[136:139]
 v_exp_f32 v130, v130
 v_mfma_f32_16x16x32_bf16 v[136:139], a[140:143], v[248:251], v[136:139]
 v_exp_f32 v131, v131
 v_mfma_f32_16x16x32_bf16 v[140:143], a[140:143], v[252:255], v[60:63]
 v_exp_f32 v132, v132
 v_mfma_f32_16x16x32_bf16 v[140:143], a[136:139], v[236:239], v[140:143]
 v_exp_f32 v133, v133
 v_mfma_f32_16x16x32_bf16 v[140:143], a[132:135], v[220:223], v[140:143]
 v_exp_f32 v134, v134
 v_mfma_f32_16x16x32_bf16 v[140:143], a[128:131], v[204:207], v[140:143]
 s_waitcnt lgkmcnt(8)
 v_exp_f32 v135, v135
 v_mfma_f32_16x16x32_bf16 v[144:147], a[144:147], v[204:207], v[60:63]
 v_exp_f32 v136, v136
 v_mfma_f32_16x16x32_bf16 v[144:147], a[148:151], v[220:223], v[144:147]
 v_exp_f32 v137, v137
 v_mfma_f32_16x16x32_bf16 v[144:147], a[152:155], v[236:239], v[144:147]
 v_exp_f32 v138, v138
 v_mfma_f32_16x16x32_bf16 v[144:147], a[156:159], v[252:255], v[144:147]
 v_exp_f32 v139, v139
 v_mfma_f32_16x16x32_bf16 v[148:151], a[156:159], v[248:251], v[56:59]
 v_exp_f32 v140, v140
 v_mfma_f32_16x16x32_bf16 v[148:151], a[152:155], v[232:235], v[148:151]
 v_exp_f32 v141, v141
 v_mfma_f32_16x16x32_bf16 v[148:151], a[148:151], v[216:219], v[148:151]
 v_exp_f32 v142, v142
 v_mfma_f32_16x16x32_bf16 v[148:151], a[144:147], v[200:203], v[148:151]
 v_exp_f32 v143, v143
 v_mfma_f32_16x16x32_bf16 v[152:155], a[144:147], v[196:199], v[52:55]
 v_exp_f32 v144, v144
 v_mfma_f32_16x16x32_bf16 v[152:155], a[148:151], v[212:215], v[152:155]
 v_exp_f32 v145, v145
 v_mfma_f32_16x16x32_bf16 v[152:155], a[152:155], v[228:231], v[152:155]
 v_exp_f32 v146, v146
 v_mfma_f32_16x16x32_bf16 v[152:155], a[156:159], v[244:247], v[152:155]
 v_exp_f32 v147, v147
 v_mfma_f32_16x16x32_bf16 v[156:159], a[156:159], v[240:243], v[48:51]
 v_exp_f32 v148, v148
 v_mfma_f32_16x16x32_bf16 v[156:159], a[152:155], v[224:227], v[156:159]
 v_exp_f32 v149, v149
 v_mfma_f32_16x16x32_bf16 v[156:159], a[148:151], v[208:211], v[156:159]
 v_exp_f32 v150, v150
 v_mfma_f32_16x16x32_bf16 v[156:159], a[144:147], v[192:195], v[156:159]
 s_waitcnt lgkmcnt(4)
 v_exp_f32 v151, v151
 v_mfma_f32_16x16x32_bf16 v[160:163], a[160:163], v[192:195], v[48:51]
 v_exp_f32 v152, v152
 v_mfma_f32_16x16x32_bf16 v[160:163], a[164:167], v[208:211], v[160:163]
 v_exp_f32 v153, v153
 v_mfma_f32_16x16x32_bf16 v[160:163], a[168:171], v[224:227], v[160:163]
 v_exp_f32 v154, v154
 v_mfma_f32_16x16x32_bf16 v[160:163], a[172:175], v[240:243], v[160:163]
 v_exp_f32 v155, v155
 v_mfma_f32_16x16x32_bf16 v[164:167], a[172:175], v[244:247], v[52:55]
 v_exp_f32 v156, v156
 v_mfma_f32_16x16x32_bf16 v[164:167], a[168:171], v[228:231], v[164:167]
 v_exp_f32 v157, v157
 v_mfma_f32_16x16x32_bf16 v[164:167], a[164:167], v[212:215], v[164:167]
 v_exp_f32 v158, v158
 v_mfma_f32_16x16x32_bf16 v[164:167], a[160:163], v[196:199], v[164:167]
 v_exp_f32 v159, v159
 v_mfma_f32_16x16x32_bf16 v[168:171], a[160:163], v[200:203], v[56:59]
 v_exp_f32 v160, v160
 v_mfma_f32_16x16x32_bf16 v[168:171], a[164:167], v[216:219], v[168:171]
 v_exp_f32 v161, v161
 v_mfma_f32_16x16x32_bf16 v[168:171], a[168:171], v[232:235], v[168:171]
 v_exp_f32 v162, v162
 v_mfma_f32_16x16x32_bf16 v[168:171], a[172:175], v[248:251], v[168:171]
 v_exp_f32 v163, v163
 v_mfma_f32_16x16x32_bf16 v[172:175], a[172:175], v[252:255], v[60:63]
 ds_read_b64_tr_b16 a[192:193], v9 offset:0
 v_cvt_pk_bf16_f32 v64, v128, v129
 v_mfma_f32_16x16x32_bf16 v[172:175], a[168:171], v[236:239], v[172:175]
 v_exp_f32 v164, v164
 v_mfma_f32_16x16x32_bf16 v[172:175], a[164:167], v[220:223], v[172:175]
 ds_read_b64_tr_b16 a[194:195], v9 offset:4096
 v_cvt_pk_bf16_f32 v65, v130, v131
 v_mfma_f32_16x16x32_bf16 v[172:175], a[160:163], v[204:207], v[172:175]
 s_waitcnt lgkmcnt(2)
 v_exp_f32 v165, v165
 v_mfma_f32_16x16x32_bf16 v[176:179], a[176:179], v[204:207], v[60:63]
 ds_read_b64_tr_b16 a[196:197], v9 offset:8192
 v_cvt_pk_bf16_f32 v72, v132, v133
 v_mfma_f32_16x16x32_bf16 v[176:179], a[180:183], v[220:223], v[176:179]
 v_exp_f32 v166, v166
 v_mfma_f32_16x16x32_bf16 v[176:179], a[184:187], v[236:239], v[176:179]
 ds_read_b64_tr_b16 a[198:199], v9 offset:12288
 v_cvt_pk_bf16_f32 v73, v134, v135
 v_mfma_f32_16x16x32_bf16 v[176:179], a[188:191], v[252:255], v[176:179]
 v_exp_f32 v167, v167
 v_mfma_f32_16x16x32_bf16 v[180:183], a[188:191], v[248:251], v[56:59]
 ds_read_b64_tr_b16 a[200:201], v10 offset:0
 v_cvt_pk_bf16_f32 v80, v136, v137
 v_mfma_f32_16x16x32_bf16 v[180:183], a[184:187], v[232:235], v[180:183]
 v_exp_f32 v168, v168
 v_mfma_f32_16x16x32_bf16 v[180:183], a[180:183], v[216:219], v[180:183]
 ds_read_b64_tr_b16 a[202:203], v10 offset:4096
 v_cvt_pk_bf16_f32 v81, v138, v139
 v_mfma_f32_16x16x32_bf16 v[180:183], a[176:179], v[200:203], v[180:183]
 v_exp_f32 v169, v169
 v_mfma_f32_16x16x32_bf16 v[184:187], a[176:179], v[196:199], v[52:55]
 ds_read_b64_tr_b16 a[204:205], v10 offset:8192
 v_cvt_pk_bf16_f32 v88, v140, v141
 v_mfma_f32_16x16x32_bf16 v[184:187], a[180:183], v[212:215], v[184:187]
 v_exp_f32 v170, v170
 v_mfma_f32_16x16x32_bf16 v[184:187], a[184:187], v[228:231], v[184:187]
 ds_read_b64_tr_b16 a[206:207], v10 offset:12288
 v_cvt_pk_bf16_f32 v89, v142, v143
 v_mfma_f32_16x16x32_bf16 v[184:187], a[188:191], v[244:247], v[184:187]
 v_exp_f32 v171, v171
 v_mfma_f32_16x16x32_bf16 v[188:191], a[188:191], v[240:243], v[48:51]
 v_exp_f32 v172, v172
 v_mfma_f32_16x16x32_bf16 v[188:191], a[184:187], v[224:227], v[188:191]
 v_exp_f32 v173, v173
 v_mfma_f32_16x16x32_bf16 v[188:191], a[180:183], v[208:211], v[188:191]
 s_waitcnt vmcnt(14)
 v_exp_f32 v174, v174
 v_mfma_f32_16x16x32_bf16 v[188:191], a[176:179], v[192:195], v[188:191]
 s_barrier
 v_exp_f32 v175, v175
 v_smfmac_f32_16x16x64_bf16 v[32:35], a[224:227], v[96:103], v17
 v_exp_f32 v176, v176
 v_smfmac_f32_16x16x64_bf16 v[36:39], a[224:227], v[104:111], v17
 v_exp_f32 v177, v177
 v_smfmac_f32_16x16x64_bf16 v[40:43], a[224:227], v[112:119], v17
 v_exp_f32 v178, v178
 v_smfmac_f32_16x16x64_bf16 v[44:47], a[224:227], v[120:127], v17
 s_waitcnt lgkmcnt(4)
 v_exp_f32 v179, v179
 v_mfma_f32_16x16x32_bf16 a[0:3], a[192:195], v[96:99], a[0:3]
 s_add_u32 m0, s47, 147456
 ds_read_b64_tr_b16 a[208:209], v11 offset:0
 ds_read_b64_tr_b16 a[210:211], v11 offset:4096
 v_mfma_f32_16x16x32_bf16 a[0:3], a[196:199], v[100:103], a[0:3]
 buffer_load_dwordx4 v1, s[12:15], s50 offen offset:0 lds
 v_mfma_f32_16x16x32_bf16 a[4:7], a[196:199], v[108:111], a[4:7]
 ds_read_b64_tr_b16 a[212:213], v11 offset:8192
 ds_read_b64_tr_b16 a[214:215], v11 offset:12288
 v_mfma_f32_16x16x32_bf16 a[4:7], a[192:195], v[104:107], a[4:7]
 v_exp_f32 v180, v180
 v_mfma_f32_16x16x32_bf16 a[8:11], a[192:195], v[112:115], a[8:11]
 v_exp_f32 v181, v181
 v_mfma_f32_16x16x32_bf16 a[8:11], a[196:199], v[116:119], a[8:11]
 v_exp_f32 v182, v182
 v_mfma_f32_16x16x32_bf16 a[12:15], a[196:199], v[124:127], a[12:15]
 v_exp_f32 v183, v183
 v_mfma_f32_16x16x32_bf16 a[12:15], a[192:195], v[120:123], a[12:15]
 s_waitcnt lgkmcnt(4)
 v_exp_f32 v184, v184
 v_mfma_f32_16x16x32_bf16 a[28:31], a[200:203], v[120:123], a[28:31]
 ds_read_b64_tr_b16 a[216:217], v12 offset:0
 ds_read_b64_tr_b16 a[218:219], v12 offset:4096
 v_mfma_f32_16x16x32_bf16 a[28:31], a[204:207], v[124:127], a[28:31]
 buffer_load_dwordx4 v2, s[12:15], s50 offen offset:1024 lds
 v_mfma_f32_16x16x32_bf16 a[24:27], a[204:207], v[116:119], a[24:27]
 ds_read_b64_tr_b16 a[220:221], v12 offset:8192
 ds_read_b64_tr_b16 a[222:223], v12 offset:12288
 v_mfma_f32_16x16x32_bf16 a[24:27], a[200:203], v[112:115], a[24:27]
 v_exp_f32 v185, v185
 v_mfma_f32_16x16x32_bf16 a[20:23], a[200:203], v[104:107], a[20:23]
 v_exp_f32 v186, v186
 v_mfma_f32_16x16x32_bf16 a[20:23], a[204:207], v[108:111], a[20:23]
 v_exp_f32 v187, v187
 v_mfma_f32_16x16x32_bf16 a[16:19], a[204:207], v[100:103], a[16:19]
 v_exp_f32 v188, v188
 v_mfma_f32_16x16x32_bf16 a[16:19], a[200:203], v[96:99], a[16:19]
 s_waitcnt lgkmcnt(4)
 v_exp_f32 v189, v189
 v_mfma_f32_16x16x32_bf16 a[32:35], a[208:211], v[96:99], a[32:35]
 ds_read_b64_tr_b16 a[192:193], v13 offset:0
 ds_read_b64_tr_b16 a[194:195], v13 offset:4096
 v_mfma_f32_16x16x32_bf16 a[32:35], a[212:215], v[100:103], a[32:35]
 buffer_load_dwordx4 v3, s[12:15], s50 offen offset:2048 lds
 v_mfma_f32_16x16x32_bf16 a[36:39], a[212:215], v[108:111], a[36:39]
 ds_read_b64_tr_b16 a[196:197], v13 offset:8192
 ds_read_b64_tr_b16 a[198:199], v13 offset:12288
 v_mfma_f32_16x16x32_bf16 a[36:39], a[208:211], v[104:107], a[36:39]
 v_exp_f32 v190, v190
 v_mfma_f32_16x16x32_bf16 a[40:43], a[208:211], v[112:115], a[40:43]
 v_exp_f32 v191, v191
 v_mfma_f32_16x16x32_bf16 a[40:43], a[212:215], v[116:119], a[40:43]
 v_cvt_pk_bf16_f32 v90, v144, v145
 v_cvt_pk_bf16_f32 v91, v146, v147
 v_mfma_f32_16x16x32_bf16 a[44:47], a[212:215], v[124:127], a[44:47]
 v_cvt_pk_bf16_f32 v82, v148, v149
 v_cvt_pk_bf16_f32 v83, v150, v151
 v_mfma_f32_16x16x32_bf16 a[44:47], a[208:211], v[120:123], a[44:47]
 s_waitcnt lgkmcnt(4)
 v_cvt_pk_bf16_f32 v74, v152, v153
 v_cvt_pk_bf16_f32 v75, v154, v155
 v_mfma_f32_16x16x32_bf16 a[60:63], a[216:219], v[120:123], a[60:63]
 ds_read_b64_tr_b16 a[200:201], v14 offset:0
 ds_read_b64_tr_b16 a[202:203], v14 offset:4096
 v_mfma_f32_16x16x32_bf16 a[60:63], a[220:223], v[124:127], a[60:63]
 buffer_load_dwordx4 v4, s[12:15], s50 offen offset:3072 lds
 v_mfma_f32_16x16x32_bf16 a[56:59], a[220:223], v[116:119], a[56:59]
 s_add_u32 s50, s50, 16384
 ds_read_b64_tr_b16 a[204:205], v14 offset:8192
 ds_read_b64_tr_b16 a[206:207], v14 offset:12288
 v_mfma_f32_16x16x32_bf16 a[56:59], a[216:219], v[112:115], a[56:59]
 v_cvt_pk_bf16_f32 v66, v156, v157
 v_cvt_pk_bf16_f32 v67, v158, v159
 v_mfma_f32_16x16x32_bf16 a[52:55], a[216:219], v[104:107], a[52:55]
 v_cvt_pk_bf16_f32 v68, v160, v161
 v_cvt_pk_bf16_f32 v69, v162, v163
 v_mfma_f32_16x16x32_bf16 a[52:55], a[220:223], v[108:111], a[52:55]
 v_cvt_pk_bf16_f32 v76, v164, v165
 v_cvt_pk_bf16_f32 v77, v166, v167
 v_mfma_f32_16x16x32_bf16 a[48:51], a[220:223], v[100:103], a[48:51]
 v_cvt_pk_bf16_f32 v84, v168, v169
 v_cvt_pk_bf16_f32 v85, v170, v171
 v_mfma_f32_16x16x32_bf16 a[48:51], a[216:219], v[96:99], a[48:51]
 s_waitcnt lgkmcnt(4)
 v_cvt_pk_bf16_f32 v92, v172, v173
 v_cvt_pk_bf16_f32 v93, v174, v175
 v_mfma_f32_16x16x32_bf16 a[64:67], a[192:195], v[96:99], a[64:67]
 s_add_u32 m0, s47, 32768
 ds_read_b64_tr_b16 a[208:209], v15 offset:0
 ds_read_b64_tr_b16 a[210:211], v15 offset:4096
 v_mfma_f32_16x16x32_bf16 a[64:67], a[196:199], v[100:103], a[64:67]
 buffer_load_dwordx4 v1, s[8:11], s49 offen offset:0 lds
 v_mfma_f32_16x16x32_bf16 a[68:71], a[196:199], v[108:111], a[68:71]
 ds_read_b64_tr_b16 a[212:213], v15 offset:8192
 ds_read_b64_tr_b16 a[214:215], v15 offset:12288
 v_mfma_f32_16x16x32_bf16 a[68:71], a[192:195], v[104:107], a[68:71]
 v_cvt_pk_bf16_f32 v94, v176, v177
 v_cvt_pk_bf16_f32 v95, v178, v179
 v_mfma_f32_16x16x32_bf16 a[72:75], a[192:195], v[112:115], a[72:75]
 v_cvt_pk_bf16_f32 v86, v180, v181
 v_cvt_pk_bf16_f32 v87, v182, v183
 v_mfma_f32_16x16x32_bf16 a[72:75], a[196:199], v[116:119], a[72:75]
 v_cvt_pk_bf16_f32 v78, v184, v185
 v_cvt_pk_bf16_f32 v79, v186, v187
 v_mfma_f32_16x16x32_bf16 a[76:79], a[196:199], v[124:127], a[76:79]
 v_cvt_pk_bf16_f32 v70, v188, v189
 v_cvt_pk_bf16_f32 v71, v190, v191
 v_mfma_f32_16x16x32_bf16 a[76:79], a[192:195], v[120:123], a[76:79]
 s_waitcnt lgkmcnt(4)
 v_mfma_f32_16x16x32_bf16 a[92:95], a[200:203], v[120:123], a[92:95]
 ds_read_b64_tr_b16 a[216:217], v16 offset:0
 ds_read_b64_tr_b16 a[218:219], v16 offset:4096
 v_mfma_f32_16x16x32_bf16 a[92:95], a[204:207], v[124:127], a[92:95]
 buffer_load_dwordx4 v2, s[8:11], s49 offen offset:1024 lds
 v_mfma_f32_16x16x32_bf16 a[88:91], a[204:207], v[116:119], a[88:91]
 ds_read_b64_tr_b16 a[220:221], v16 offset:8192
 ds_read_b64_tr_b16 a[222:223], v16 offset:12288
 v_mfma_f32_16x16x32_bf16 a[88:91], a[200:203], v[112:115], a[88:91]
 v_mfma_f32_16x16x32_bf16 a[84:87], a[200:203], v[104:107], a[84:87]
 v_mfma_f32_16x16x32_bf16 a[84:87], a[204:207], v[108:111], a[84:87]
 v_mfma_f32_16x16x32_bf16 a[80:83], a[204:207], v[100:103], a[80:83]
 v_mfma_f32_16x16x32_bf16 a[80:83], a[200:203], v[96:99], a[80:83]
 s_waitcnt lgkmcnt(4)
 v_mfma_f32_16x16x32_bf16 a[96:99], a[208:211], v[96:99], a[96:99]
 ds_read_b128 a[128:131], v5 offset:32768
 ds_read_b128 a[132:135], v6 offset:32768
 v_mfma_f32_16x16x32_bf16 a[96:99], a[212:215], v[100:103], a[96:99]
 buffer_load_dwordx4 v3, s[8:11], s49 offen offset:2048 lds
 v_mfma_f32_16x16x32_bf16 a[100:103], a[212:215], v[108:111], a[100:103]
 ds_read_b128 a[136:139], v7 offset:32768
 ds_read_b128 a[140:143], v8 offset:32768
 v_mfma_f32_16x16x32_bf16 a[100:103], a[208:211], v[104:107], a[100:103]
 v_mfma_f32_16x16x32_bf16 a[104:107], a[208:211], v[112:115], a[104:107]
 v_mfma_f32_16x16x32_bf16 a[104:107], a[212:215], v[116:119], a[104:107]
 buffer_load_dword v27, v26, s[28:31], s91 offen
 s_sub_u32 s91, s91, 131072
 v_mfma_f32_16x16x32_bf16 a[108:111], a[212:215], v[124:127], a[108:111]
 v_mfma_f32_16x16x32_bf16 a[108:111], a[208:211], v[120:123], a[108:111]
 s_waitcnt lgkmcnt(4)
 v_mfma_f32_16x16x32_bf16 a[124:127], a[216:219], v[120:123], a[124:127]
 ds_read_b128 a[144:147], v5 offset:36864
 ds_read_b128 a[148:151], v6 offset:36864
 v_mfma_f32_16x16x32_bf16 a[124:127], a[220:223], v[124:127], a[124:127]
 buffer_load_dwordx4 v4, s[8:11], s49 offen offset:3072 lds
 v_mfma_f32_16x16x32_bf16 a[120:123], a[220:223], v[116:119], a[120:123]
 s_add_u32 s49, s49, 16384
 ds_read_b128 a[152:155], v7 offset:36864
 ds_read_b128 a[156:159], v8 offset:36864
 v_mfma_f32_16x16x32_bf16 a[120:123], a[216:219], v[112:115], a[120:123]
 v_mfma_f32_16x16x32_bf16 a[116:119], a[216:219], v[104:107], a[116:119]
 v_mfma_f32_16x16x32_bf16 a[116:119], a[220:223], v[108:111], a[116:119]
 v_mfma_f32_16x16x32_bf16 a[112:115], a[220:223], v[100:103], a[112:115]
 v_mfma_f32_16x16x32_bf16 a[112:115], a[216:219], v[96:99], a[112:115]
 s_waitcnt lgkmcnt(4)
 v_mfma_f32_16x16x32_bf16 v[128:131], a[128:131], v[192:195], v[48:51]
 ds_read_b128 a[160:163], v5 offset:40960
 v_mfma_f32_16x16x32_bf16 v[128:131], a[132:135], v[208:211], v[128:131]
 ds_read_b128 a[164:167], v6 offset:40960
 v_mfma_f32_16x16x32_bf16 v[128:131], a[136:139], v[224:227], v[128:131]
 ds_read_b128 a[168:171], v7 offset:40960
 v_mfma_f32_16x16x32_bf16 v[128:131], a[140:143], v[240:243], v[128:131]
 ds_read_b128 a[172:175], v8 offset:40960
 v_mfma_f32_16x16x32_bf16 v[132:135], a[140:143], v[244:247], v[52:55]
 ds_read_b128 a[176:179], v5 offset:45056
 v_mfma_f32_16x16x32_bf16 v[132:135], a[136:139], v[228:231], v[132:135]
 ds_read_b128 a[180:183], v6 offset:45056
 v_mfma_f32_16x16x32_bf16 v[132:135], a[132:135], v[212:215], v[132:135]
 ds_read_b128 a[184:187], v7 offset:45056
 v_mfma_f32_16x16x32_bf16 v[132:135], a[128:131], v[196:199], v[132:135]
 ds_read_b128 a[188:191], v8 offset:45056
 v_mfma_f32_16x16x32_bf16 v[136:139], a[128:131], v[200:203], v[56:59]
 v_exp_f32 v128, v128
 v_mfma_f32_16x16x32_bf16 v[136:139], a[132:135], v[216:219], v[136:139]
 v_exp_f32 v129, v129
 v_mfma_f32_16x16x32_bf16 v[136:139], a[136:139], v[232:235], v[136:139]
 v_exp_f32 v130, v130
 v_mfma_f32_16x16x32_bf16 v[136:139], a[140:143], v[248:251], v[136:139]
 v_exp_f32 v131, v131
 v_mfma_f32_16x16x32_bf16 v[140:143], a[140:143], v[252:255], v[60:63]
 v_exp_f32 v132, v132
 v_mfma_f32_16x16x32_bf16 v[140:143], a[136:139], v[236:239], v[140:143]
 v_exp_f32 v133, v133
 v_mfma_f32_16x16x32_bf16 v[140:143], a[132:135], v[220:223], v[140:143]
 v_exp_f32 v134, v134
 v_mfma_f32_16x16x32_bf16 v[140:143], a[128:131], v[204:207], v[140:143]
 s_waitcnt lgkmcnt(8)
 v_exp_f32 v135, v135
 v_mfma_f32_16x16x32_bf16 v[144:147], a[144:147], v[204:207], v[60:63]
 v_exp_f32 v136, v136
 v_mfma_f32_16x16x32_bf16 v[144:147], a[148:151], v[220:223], v[144:147]
 v_exp_f32 v137, v137
 v_mfma_f32_16x16x32_bf16 v[144:147], a[152:155], v[236:239], v[144:147]
 v_exp_f32 v138, v138
 v_mfma_f32_16x16x32_bf16 v[144:147], a[156:159], v[252:255], v[144:147]
 v_exp_f32 v139, v139
 v_mfma_f32_16x16x32_bf16 v[148:151], a[156:159], v[248:251], v[56:59]
 v_exp_f32 v140, v140
 v_mfma_f32_16x16x32_bf16 v[148:151], a[152:155], v[232:235], v[148:151]
 v_exp_f32 v141, v141
 v_mfma_f32_16x16x32_bf16 v[148:151], a[148:151], v[216:219], v[148:151]
 v_exp_f32 v142, v142
 v_mfma_f32_16x16x32_bf16 v[148:151], a[144:147], v[200:203], v[148:151]
 v_exp_f32 v143, v143
 v_mfma_f32_16x16x32_bf16 v[152:155], a[144:147], v[196:199], v[52:55]
 v_exp_f32 v144, v144
 v_mfma_f32_16x16x32_bf16 v[152:155], a[148:151], v[212:215], v[152:155]
 v_exp_f32 v145, v145
 v_mfma_f32_16x16x32_bf16 v[152:155], a[152:155], v[228:231], v[152:155]
 v_exp_f32 v146, v146
 v_mfma_f32_16x16x32_bf16 v[152:155], a[156:159], v[244:247], v[152:155]
 v_exp_f32 v147, v147
 v_mfma_f32_16x16x32_bf16 v[156:159], a[156:159], v[240:243], v[48:51]
 v_exp_f32 v148, v148
 v_mfma_f32_16x16x32_bf16 v[156:159], a[152:155], v[224:227], v[156:159]
 v_exp_f32 v149, v149
 v_mfma_f32_16x16x32_bf16 v[156:159], a[148:151], v[208:211], v[156:159]
 v_exp_f32 v150, v150
 v_mfma_f32_16x16x32_bf16 v[156:159], a[144:147], v[192:195], v[156:159]
 s_waitcnt lgkmcnt(4)
 v_exp_f32 v151, v151
 v_mfma_f32_16x16x32_bf16 v[160:163], a[160:163], v[192:195], v[48:51]
 v_exp_f32 v152, v152
 v_mfma_f32_16x16x32_bf16 v[160:163], a[164:167], v[208:211], v[160:163]
 v_exp_f32 v153, v153
 v_mfma_f32_16x16x32_bf16 v[160:163], a[168:171], v[224:227], v[160:163]
 v_exp_f32 v154, v154
 v_mfma_f32_16x16x32_bf16 v[160:163], a[172:175], v[240:243], v[160:163]
 v_exp_f32 v155, v155
 v_mfma_f32_16x16x32_bf16 v[164:167], a[172:175], v[244:247], v[52:55]
 v_exp_f32 v156, v156
 v_mfma_f32_16x16x32_bf16 v[164:167], a[168:171], v[228:231], v[164:167]
 v_exp_f32 v157, v157
 v_mfma_f32_16x16x32_bf16 v[164:167], a[164:167], v[212:215], v[164:167]
 v_exp_f32 v158, v158
 v_mfma_f32_16x16x32_bf16 v[164:167], a[160:163], v[196:199], v[164:167]
 v_exp_f32 v159, v159
 v_mfma_f32_16x16x32_bf16 v[168:171], a[160:163], v[200:203], v[56:59]
 v_exp_f32 v160, v160
 v_mfma_f32_16x16x32_bf16 v[168:171], a[164:167], v[216:219], v[168:171]
 v_exp_f32 v161, v161
 v_mfma_f32_16x16x32_bf16 v[168:171], a[168:171], v[232:235], v[168:171]
 v_exp_f32 v162, v162
 v_mfma_f32_16x16x32_bf16 v[168:171], a[172:175], v[248:251], v[168:171]
 v_exp_f32 v163, v163
 v_mfma_f32_16x16x32_bf16 v[172:175], a[172:175], v[252:255], v[60:63]
 ds_read_b64_tr_b16 a[192:193], v9 offset:16384
 v_cvt_pk_bf16_f32 v96, v128, v129
 v_mfma_f32_16x16x32_bf16 v[172:175], a[168:171], v[236:239], v[172:175]
 v_exp_f32 v164, v164
 v_mfma_f32_16x16x32_bf16 v[172:175], a[164:167], v[220:223], v[172:175]
 ds_read_b64_tr_b16 a[194:195], v9 offset:20480
 v_cvt_pk_bf16_f32 v97, v130, v131
 v_mfma_f32_16x16x32_bf16 v[172:175], a[160:163], v[204:207], v[172:175]
 s_waitcnt lgkmcnt(2)
 v_exp_f32 v165, v165
 v_mfma_f32_16x16x32_bf16 v[176:179], a[176:179], v[204:207], v[60:63]
 ds_read_b64_tr_b16 a[196:197], v9 offset:24576
 v_cvt_pk_bf16_f32 v104, v132, v133
 v_mfma_f32_16x16x32_bf16 v[176:179], a[180:183], v[220:223], v[176:179]
 v_exp_f32 v166, v166
 v_mfma_f32_16x16x32_bf16 v[176:179], a[184:187], v[236:239], v[176:179]
 ds_read_b64_tr_b16 a[198:199], v9 offset:28672
 v_cvt_pk_bf16_f32 v105, v134, v135
 v_mfma_f32_16x16x32_bf16 v[176:179], a[188:191], v[252:255], v[176:179]
 v_exp_f32 v167, v167
 v_mfma_f32_16x16x32_bf16 v[180:183], a[188:191], v[248:251], v[56:59]
 ds_read_b64_tr_b16 a[200:201], v10 offset:16384
 v_cvt_pk_bf16_f32 v112, v136, v137
 v_mfma_f32_16x16x32_bf16 v[180:183], a[184:187], v[232:235], v[180:183]
 v_exp_f32 v168, v168
 v_mfma_f32_16x16x32_bf16 v[180:183], a[180:183], v[216:219], v[180:183]
 ds_read_b64_tr_b16 a[202:203], v10 offset:20480
 v_cvt_pk_bf16_f32 v113, v138, v139
 v_mfma_f32_16x16x32_bf16 v[180:183], a[176:179], v[200:203], v[180:183]
 v_exp_f32 v169, v169
 v_mfma_f32_16x16x32_bf16 v[184:187], a[176:179], v[196:199], v[52:55]
 ds_read_b64_tr_b16 a[204:205], v10 offset:24576
 v_cvt_pk_bf16_f32 v120, v140, v141
 v_mfma_f32_16x16x32_bf16 v[184:187], a[180:183], v[212:215], v[184:187]
 v_exp_f32 v170, v170
 v_mfma_f32_16x16x32_bf16 v[184:187], a[184:187], v[228:231], v[184:187]
 ds_read_b64_tr_b16 a[206:207], v10 offset:28672
 v_cvt_pk_bf16_f32 v121, v142, v143
 v_mfma_f32_16x16x32_bf16 v[184:187], a[188:191], v[244:247], v[184:187]
 v_exp_f32 v171, v171
 v_mfma_f32_16x16x32_bf16 v[188:191], a[188:191], v[240:243], v[48:51]
 v_exp_f32 v172, v172
 v_mfma_f32_16x16x32_bf16 v[188:191], a[184:187], v[224:227], v[188:191]
 v_exp_f32 v173, v173
 v_mfma_f32_16x16x32_bf16 v[188:191], a[180:183], v[208:211], v[188:191]
 s_waitcnt vmcnt(14)
 v_exp_f32 v174, v174
 v_mfma_f32_16x16x32_bf16 v[188:191], a[176:179], v[192:195], v[188:191]
 s_barrier
 v_exp_f32 v175, v175
 v_smfmac_f32_16x16x64_bf16 v[32:35], a[224:227], v[64:71], v17
 v_exp_f32 v176, v176
 v_smfmac_f32_16x16x64_bf16 v[36:39], a[224:227], v[72:79], v17
 v_exp_f32 v177, v177
 v_smfmac_f32_16x16x64_bf16 v[40:43], a[224:227], v[80:87], v17
 v_exp_f32 v178, v178
 v_smfmac_f32_16x16x64_bf16 v[44:47], a[224:227], v[88:95], v17
 s_waitcnt lgkmcnt(4)
 v_exp_f32 v179, v179
 v_mfma_f32_16x16x32_bf16 a[0:3], a[192:195], v[64:67], a[0:3]
 s_add_u32 m0, s47, 98304
 ds_read_b64_tr_b16 a[208:209], v11 offset:16384
 ds_read_b64_tr_b16 a[210:211], v11 offset:20480
 v_mfma_f32_16x16x32_bf16 a[0:3], a[196:199], v[68:71], a[0:3]
 buffer_load_dwordx4 v1, s[12:15], s50 offen offset:0 lds
 v_mfma_f32_16x16x32_bf16 a[4:7], a[196:199], v[76:79], a[4:7]
 ds_read_b64_tr_b16 a[212:213], v11 offset:24576
 ds_read_b64_tr_b16 a[214:215], v11 offset:28672
 v_mfma_f32_16x16x32_bf16 a[4:7], a[192:195], v[72:75], a[4:7]
 v_exp_f32 v180, v180
 v_mfma_f32_16x16x32_bf16 a[8:11], a[192:195], v[80:83], a[8:11]
 v_exp_f32 v181, v181
 v_mfma_f32_16x16x32_bf16 a[8:11], a[196:199], v[84:87], a[8:11]
 v_exp_f32 v182, v182
 v_mfma_f32_16x16x32_bf16 a[12:15], a[196:199], v[92:95], a[12:15]
 v_exp_f32 v183, v183
 v_mfma_f32_16x16x32_bf16 a[12:15], a[192:195], v[88:91], a[12:15]
 s_waitcnt lgkmcnt(4)
 v_exp_f32 v184, v184
 v_mfma_f32_16x16x32_bf16 a[28:31], a[200:203], v[88:91], a[28:31]
 ds_read_b64_tr_b16 a[216:217], v12 offset:16384
 ds_read_b64_tr_b16 a[218:219], v12 offset:20480
 v_mfma_f32_16x16x32_bf16 a[28:31], a[204:207], v[92:95], a[28:31]
 buffer_load_dwordx4 v2, s[12:15], s50 offen offset:1024 lds
 v_mfma_f32_16x16x32_bf16 a[24:27], a[204:207], v[84:87], a[24:27]
 ds_read_b64_tr_b16 a[220:221], v12 offset:24576
 ds_read_b64_tr_b16 a[222:223], v12 offset:28672
 v_mfma_f32_16x16x32_bf16 a[24:27], a[200:203], v[80:83], a[24:27]
 v_exp_f32 v185, v185
 v_mfma_f32_16x16x32_bf16 a[20:23], a[200:203], v[72:75], a[20:23]
 v_exp_f32 v186, v186
 v_mfma_f32_16x16x32_bf16 a[20:23], a[204:207], v[76:79], a[20:23]
 v_exp_f32 v187, v187
 v_mfma_f32_16x16x32_bf16 a[16:19], a[204:207], v[68:71], a[16:19]
 v_exp_f32 v188, v188
 v_mfma_f32_16x16x32_bf16 a[16:19], a[200:203], v[64:67], a[16:19]
 s_waitcnt lgkmcnt(4)
 v_exp_f32 v189, v189
 v_mfma_f32_16x16x32_bf16 a[32:35], a[208:211], v[64:67], a[32:35]
 ds_read_b64_tr_b16 a[192:193], v13 offset:16384
 ds_read_b64_tr_b16 a[194:195], v13 offset:20480
 v_mfma_f32_16x16x32_bf16 a[32:35], a[212:215], v[68:71], a[32:35]
 buffer_load_dwordx4 v3, s[12:15], s50 offen offset:2048 lds
 v_mfma_f32_16x16x32_bf16 a[36:39], a[212:215], v[76:79], a[36:39]
 ds_read_b64_tr_b16 a[196:197], v13 offset:24576
 ds_read_b64_tr_b16 a[198:199], v13 offset:28672
 v_mfma_f32_16x16x32_bf16 a[36:39], a[208:211], v[72:75], a[36:39]
 v_exp_f32 v190, v190
 v_mfma_f32_16x16x32_bf16 a[40:43], a[208:211], v[80:83], a[40:43]
 v_exp_f32 v191, v191
 v_mfma_f32_16x16x32_bf16 a[40:43], a[212:215], v[84:87], a[40:43]
 v_cvt_pk_bf16_f32 v122, v144, v145
 v_cvt_pk_bf16_f32 v123, v146, v147
 v_mfma_f32_16x16x32_bf16 a[44:47], a[212:215], v[92:95], a[44:47]
 v_cvt_pk_bf16_f32 v114, v148, v149
 v_cvt_pk_bf16_f32 v115, v150, v151
 v_mfma_f32_16x16x32_bf16 a[44:47], a[208:211], v[88:91], a[44:47]
 s_waitcnt lgkmcnt(4)
 v_cvt_pk_bf16_f32 v106, v152, v153
 v_cvt_pk_bf16_f32 v107, v154, v155
 v_mfma_f32_16x16x32_bf16 a[60:63], a[216:219], v[88:91], a[60:63]
 ds_read_b64_tr_b16 a[200:201], v14 offset:16384
 ds_read_b64_tr_b16 a[202:203], v14 offset:20480
 v_mfma_f32_16x16x32_bf16 a[60:63], a[220:223], v[92:95], a[60:63]
 buffer_load_dwordx4 v4, s[12:15], s50 offen offset:3072 lds
 v_mfma_f32_16x16x32_bf16 a[56:59], a[220:223], v[84:87], a[56:59]
 s_add_u32 s50, s50, 16384
 s_add_u32 s56, s56, 1
 ds_read_b64_tr_b16 a[204:205], v14 offset:24576
 ds_read_b64_tr_b16 a[206:207], v14 offset:28672
 v_mfma_f32_16x16x32_bf16 a[56:59], a[216:219], v[80:83], a[56:59]
 v_cvt_pk_bf16_f32 v98, v156, v157
 v_cvt_pk_bf16_f32 v99, v158, v159
 v_mfma_f32_16x16x32_bf16 a[52:55], a[216:219], v[72:75], a[52:55]
 v_cvt_pk_bf16_f32 v100, v160, v161
 v_cvt_pk_bf16_f32 v101, v162, v163
 v_mfma_f32_16x16x32_bf16 a[52:55], a[220:223], v[76:79], a[52:55]
 v_cvt_pk_bf16_f32 v108, v164, v165
 v_cvt_pk_bf16_f32 v109, v166, v167
 v_mfma_f32_16x16x32_bf16 a[48:51], a[220:223], v[68:71], a[48:51]
 v_cvt_pk_bf16_f32 v116, v168, v169
 v_cvt_pk_bf16_f32 v117, v170, v171
 v_mfma_f32_16x16x32_bf16 a[48:51], a[216:219], v[64:67], a[48:51]
 s_waitcnt lgkmcnt(4)
 v_cvt_pk_bf16_f32 v124, v172, v173
 v_cvt_pk_bf16_f32 v125, v174, v175
 v_mfma_f32_16x16x32_bf16 a[64:67], a[192:195], v[64:67], a[64:67]
 s_add_u32 m0, s47, 49152
 ds_read_b64_tr_b16 a[208:209], v15 offset:16384
 ds_read_b64_tr_b16 a[210:211], v15 offset:20480
 v_mfma_f32_16x16x32_bf16 a[64:67], a[196:199], v[68:71], a[64:67]
 buffer_load_dwordx4 v1, s[8:11], s49 offen offset:0 lds
 v_mfma_f32_16x16x32_bf16 a[68:71], a[196:199], v[76:79], a[68:71]
 ds_read_b64_tr_b16 a[212:213], v15 offset:24576
 ds_read_b64_tr_b16 a[214:215], v15 offset:28672
 v_mfma_f32_16x16x32_bf16 a[68:71], a[192:195], v[72:75], a[68:71]
 v_cvt_pk_bf16_f32 v126, v176, v177
 v_cvt_pk_bf16_f32 v127, v178, v179
 v_mfma_f32_16x16x32_bf16 a[72:75], a[192:195], v[80:83], a[72:75]
 v_cvt_pk_bf16_f32 v118, v180, v181
 v_cvt_pk_bf16_f32 v119, v182, v183
 v_mfma_f32_16x16x32_bf16 a[72:75], a[196:199], v[84:87], a[72:75]
 v_cvt_pk_bf16_f32 v110, v184, v185
 v_cvt_pk_bf16_f32 v111, v186, v187
 v_mfma_f32_16x16x32_bf16 a[76:79], a[196:199], v[92:95], a[76:79]
 v_cvt_pk_bf16_f32 v102, v188, v189
 v_cvt_pk_bf16_f32 v103, v190, v191
 v_mfma_f32_16x16x32_bf16 a[76:79], a[192:195], v[88:91], a[76:79]
 s_waitcnt lgkmcnt(4)
 v_mfma_f32_16x16x32_bf16 a[92:95], a[200:203], v[88:91], a[92:95]
 ds_read_b64_tr_b16 a[216:217], v16 offset:16384
 ds_read_b64_tr_b16 a[218:219], v16 offset:20480
 v_mfma_f32_16x16x32_bf16 a[92:95], a[204:207], v[92:95], a[92:95]
 buffer_load_dwordx4 v2, s[8:11], s49 offen offset:1024 lds
 v_mfma_f32_16x16x32_bf16 a[88:91], a[204:207], v[84:87], a[88:91]
 ds_read_b64_tr_b16 a[220:221], v16 offset:24576
 ds_read_b64_tr_b16 a[222:223], v16 offset:28672
 v_mfma_f32_16x16x32_bf16 a[88:91], a[200:203], v[80:83], a[88:91]
 v_mfma_f32_16x16x32_bf16 a[84:87], a[200:203], v[72:75], a[84:87]
 v_mfma_f32_16x16x32_bf16 a[84:87], a[204:207], v[76:79], a[84:87]
 v_mfma_f32_16x16x32_bf16 a[80:83], a[204:207], v[68:71], a[80:83]
 v_mfma_f32_16x16x32_bf16 a[80:83], a[200:203], v[64:67], a[80:83]
 s_waitcnt lgkmcnt(4)
 v_mfma_f32_16x16x32_bf16 a[96:99], a[208:211], v[64:67], a[96:99]
 ds_read_b128 a[128:131], v5 offset:49152
 ds_read_b128 a[132:135], v6 offset:49152
 v_mfma_f32_16x16x32_bf16 a[96:99], a[212:215], v[68:71], a[96:99]
 buffer_load_dwordx4 v3, s[8:11], s49 offen offset:2048 lds
 v_mfma_f32_16x16x32_bf16 a[100:103], a[212:215], v[76:79], a[100:103]
 ds_read_b128 a[136:139], v7 offset:49152
 ds_read_b128 a[140:143], v8 offset:49152
 v_mfma_f32_16x16x32_bf16 a[100:103], a[208:211], v[72:75], a[100:103]
 v_mfma_f32_16x16x32_bf16 a[104:107], a[208:211], v[80:83], a[104:107]
 v_mfma_f32_16x16x32_bf16 a[104:107], a[212:215], v[84:87], a[104:107]
 v_mfma_f32_16x16x32_bf16 a[108:111], a[212:215], v[92:95], a[108:111]
 v_mfma_f32_16x16x32_bf16 a[108:111], a[208:211], v[88:91], a[108:111]
 s_waitcnt lgkmcnt(4)
 v_mfma_f32_16x16x32_bf16 a[124:127], a[216:219], v[88:91], a[124:127]
 ds_read_b128 a[144:147], v5 offset:53248
 ds_read_b128 a[148:151], v6 offset:53248
 v_mfma_f32_16x16x32_bf16 a[124:127], a[220:223], v[92:95], a[124:127]
 buffer_load_dwordx4 v4, s[8:11], s49 offen offset:3072 lds
 v_mfma_f32_16x16x32_bf16 a[120:123], a[220:223], v[84:87], a[120:123]
 s_add_u32 s49, s49, 16384
 ds_read_b128 a[152:155], v7 offset:53248
 ds_read_b128 a[156:159], v8 offset:53248
 v_mfma_f32_16x16x32_bf16 a[120:123], a[216:219], v[80:83], a[120:123]
 v_mfma_f32_16x16x32_bf16 a[116:119], a[216:219], v[72:75], a[116:119]
 v_mfma_f32_16x16x32_bf16 a[116:119], a[220:223], v[76:79], a[116:119]
 v_mfma_f32_16x16x32_bf16 a[112:115], a[220:223], v[68:71], a[112:115]
 v_mfma_f32_16x16x32_bf16 a[112:115], a[216:219], v[64:67], a[112:115]
 s_waitcnt lgkmcnt(4)
 s_cmp_lt_u32 s56, 6
 s_cbranch_scc1 att_loop
att_tail:
 v_mfma_f32_16x16x32_bf16 v[128:131], a[128:131], v[192:195], v[48:51]
 s_and_b32 s55, s2, 3
 ds_read_b128 a[160:163], v5 offset:57344
 v_mfma_f32_16x16x32_bf16 v[128:131], a[132:135], v[208:211], v[128:131]
 s_bfe_u32 s3, s2, 0x10002
 ds_read_b128 a[164:167], v6 offset:57344
 v_mfma_f32_16x16x32_bf16 v[128:131], a[136:139], v[224:227], v[128:131]
 s_lshl_b32 s3, s3, 3
 ds_read_b128 a[168:171], v7 offset:57344
 v_mfma_f32_16x16x32_bf16 v[128:131], a[140:143], v[240:243], v[128:131]
 s_lshr_b32 s4, s2, 5
 ds_read_b128 a[172:175], v8 offset:57344
 v_mfma_f32_16x16x32_bf16 v[132:135], a[140:143], v[244:247], v[52:55]
 s_add_u32 s53, s3, s4
 ds_read_b128 a[176:179], v5 offset:61440
 v_mfma_f32_16x16x32_bf16 v[132:135], a[136:139], v[228:231], v[132:135]
 s_and_b32 s7, s2, 24
 ds_read_b128 a[180:183], v6 offset:61440
 v_mfma_f32_16x16x32_bf16 v[132:135], a[132:135], v[212:215], v[132:135]
 s_lshr_b32 s7, s7, 2
 ds_read_b128 a[184:187], v7 offset:61440
 v_mfma_f32_16x16x32_bf16 v[132:135], a[128:131], v[196:199], v[132:135]
 s_lshr_b32 s3, s44, 1
 ds_read_b128 a[188:191], v8 offset:61440
 v_mfma_f32_16x16x32_bf16 v[136:139], a[128:131], v[200:203], v[56:59]
 s_add_u32 s7, s7, s3
 v_exp_f32 v128, v128
 v_mfma_f32_16x16x32_bf16 v[136:139], a[132:135], v[216:219], v[136:139]
 s_mul_i32 s7, s7, 753664
 v_exp_f32 v129, v129
 v_mfma_f32_16x16x32_bf16 v[136:139], a[136:139], v[232:235], v[136:139]
 s_and_b32 s3, s47, 4096
 v_exp_f32 v130, v130
 v_mfma_f32_16x16x32_bf16 v[136:139], a[140:143], v[248:251], v[136:139]
 s_add_u32 s7, s7, s3
 v_exp_f32 v131, v131
 v_mfma_f32_16x16x32_bf16 v[140:143], a[140:143], v[252:255], v[60:63]
 s_lshl_b32 s3, s55, 17
 v_exp_f32 v132, v132
 v_mfma_f32_16x16x32_bf16 v[140:143], a[136:139], v[236:239], v[140:143]
 s_add_u32 s3, s3, s7
 v_exp_f32 v133, v133
 v_mfma_f32_16x16x32_bf16 v[140:143], a[132:135], v[220:223], v[140:143]
 s_add_u32 s89, s3, 229376
 v_exp_f32 v134, v134
 v_mfma_f32_16x16x32_bf16 v[140:143], a[128:131], v[204:207], v[140:143]
 s_waitcnt lgkmcnt(8)
 v_exp_f32 v135, v135
 v_mfma_f32_16x16x32_bf16 v[144:147], a[144:147], v[204:207], v[60:63]
 s_lshr_b32 s3, s55, 1
 v_exp_f32 v136, v136
 v_mfma_f32_16x16x32_bf16 v[144:147], a[148:151], v[220:223], v[144:147]
 s_mul_i32 s3, s3, 14
 v_exp_f32 v137, v137
 v_mfma_f32_16x16x32_bf16 v[144:147], a[152:155], v[236:239], v[144:147]
 s_and_b32 s4, s55, 1
 v_exp_f32 v138, v138
 v_mfma_f32_16x16x32_bf16 v[144:147], a[156:159], v[252:255], v[144:147]
 s_mul_i32 s4, s4, 10
 v_exp_f32 v139, v139
 v_mfma_f32_16x16x32_bf16 v[148:151], a[156:159], v[248:251], v[56:59]
 s_add_u32 s3, s3, s4
 v_exp_f32 v140, v140
 v_mfma_f32_16x16x32_bf16 v[148:151], a[152:155], v[232:235], v[148:151]
 s_lshl_b32 s4, s3, 13
 v_exp_f32 v141, v141
 v_mfma_f32_16x16x32_bf16 v[148:151], a[148:151], v[216:219], v[148:151]
 s_add_u32 s51, s7, s4
 v_exp_f32 v142, v142
 v_mfma_f32_16x16x32_bf16 v[148:151], a[144:147], v[200:203], v[148:151]
 s_lshl_b32 s3, s3, 11
 v_exp_f32 v143, v143
 v_mfma_f32_16x16x32_bf16 v[152:155], a[144:147], v[196:199], v[52:55]
 s_lshl_b32 s7, s53, 2
 v_exp_f32 v144, v144
 v_mfma_f32_16x16x32_bf16 v[152:155], a[148:151], v[212:215], v[152:155]
 s_add_u32 s7, s7, s44
 v_exp_f32 v145, v145
 v_mfma_f32_16x16x32_bf16 v[152:155], a[152:155], v[228:231], v[152:155]
 s_mul_i32 s7, s7, 114688
 v_exp_f32 v146, v146
 v_mfma_f32_16x16x32_bf16 v[152:155], a[156:159], v[244:247], v[152:155]
 s_add_u32 s52, s7, s3
 v_exp_f32 v147, v147
 v_mfma_f32_16x16x32_bf16 v[156:159], a[156:159], v[240:243], v[48:51]
 s_sub_u32 s3, s89, 32768
 v_exp_f32 v148, v148
 v_mfma_f32_16x16x32_bf16 v[156:159], a[152:155], v[224:227], v[156:159]
 s_bitcmp1_b32 s2, 0
 s_cselect_b32 s56, s3, s51
 v_exp_f32 v149, v149
 v_mfma_f32_16x16x32_bf16 v[156:159], a[148:151], v[208:211], v[156:159]
 s_cmp_eq_u32 s44, 0
 s_cselect_b32 s62, 32, 0
 v_exp_f32 v150, v150
 v_mfma_f32_16x16x32_bf16 v[156:159], a[144:147], v[192:195], v[156:159]
 s_waitcnt lgkmcnt(4)
 v_exp_f32 v151, v151
 v_mfma_f32_16x16x32_bf16 v[160:163], a[160:163], v[192:195], v[48:51]
 v_exp_f32 v152, v152
 v_mfma_f32_16x16x32_bf16 v[160:163], a[164:167], v[208:211], v[160:163]
 v_exp_f32 v153, v153
 v_mfma_f32_16x16x32_bf16 v[160:163], a[168:171], v[224:227], v[160:163]
 v_exp_f32 v154, v154
 v_mfma_f32_16x16x32_bf16 v[160:163], a[172:175], v[240:243], v[160:163]
 v_exp_f32 v155, v155
 v_mfma_f32_16x16x32_bf16 v[164:167], a[172:175], v[244:247], v[52:55]
 v_exp_f32 v156, v156
 v_mfma_f32_16x16x32_bf16 v[164:167], a[168:171], v[228:231], v[164:167]
 v_exp_f32 v157, v157
 v_mfma_f32_16x16x32_bf16 v[164:167], a[164:167], v[212:215], v[164:167]
 v_exp_f32 v158, v158
 v_mfma_f32_16x16x32_bf16 v[164:167], a[160:163], v[196:199], v[164:167]
 v_exp_f32 v159, v159
 v_mfma_f32_16x16x32_bf16 v[168:171], a[160:163], v[200:203], v[56:59]
 v_exp_f32 v160, v160
 v_mfma_f32_16x16x32_bf16 v[168:171], a[164:167], v[216:219], v[168:171]
 v_exp_f32 v161, v161
 v_mfma_f32_16x16x32_bf16 v[168:171], a[168:171], v[232:235], v[168:171]
 v_exp_f32 v162, v162
 v_mfma_f32_16x16x32_bf16 v[168:171], a[172:175], v[248:251], v[168:171]
 v_exp_f32 v163, v163
 v_mfma_f32_16x16x32_bf16 v[172:175], a[172:175], v[252:255], v[60:63]
 ds_read_b64_tr_b16 a[192:193], v9 offset:32768
 v_cvt_pk_bf16_f32 v64, v128, v129
 v_mfma_f32_16x16x32_bf16 v[172:175], a[168:171], v[236:239], v[172:175]
 v_exp_f32 v164, v164
 v_mfma_f32_16x16x32_bf16 v[172:175], a[164:167], v[220:223], v[172:175]
 ds_read_b64_tr_b16 a[194:195], v9 offset:36864
 v_cvt_pk_bf16_f32 v65, v130, v131
 v_mfma_f32_16x16x32_bf16 v[172:175], a[160:163], v[204:207], v[172:175]
 s_waitcnt lgkmcnt(2)
 v_exp_f32 v165, v165
 v_mfma_f32_16x16x32_bf16 v[176:179], a[176:179], v[204:207], v[60:63]
 ds_read_b64_tr_b16 a[196:197], v9 offset:40960
 v_cvt_pk_bf16_f32 v72, v132, v133
 v_mfma_f32_16x16x32_bf16 v[176:179], a[180:183], v[220:223], v[176:179]
 v_exp_f32 v166, v166
 v_mfma_f32_16x16x32_bf16 v[176:179], a[184:187], v[236:239], v[176:179]
 ds_read_b64_tr_b16 a[198:199], v9 offset:45056
 v_cvt_pk_bf16_f32 v73, v134, v135
 v_mfma_f32_16x16x32_bf16 v[176:179], a[188:191], v[252:255], v[176:179]
 v_exp_f32 v167, v167
 v_mfma_f32_16x16x32_bf16 v[180:183], a[188:191], v[248:251], v[56:59]
 ds_read_b64_tr_b16 a[200:201], v10 offset:32768
 v_cvt_pk_bf16_f32 v80, v136, v137
 v_mfma_f32_16x16x32_bf16 v[180:183], a[184:187], v[232:235], v[180:183]
 v_exp_f32 v168, v168
 v_mfma_f32_16x16x32_bf16 v[180:183], a[180:183], v[216:219], v[180:183]
 ds_read_b64_tr_b16 a[202:203], v10 offset:36864
 v_cvt_pk_bf16_f32 v81, v138, v139
 v_mfma_f32_16x16x32_bf16 v[180:183], a[176:179], v[200:203], v[180:183]
 v_exp_f32 v169, v169
 v_mfma_f32_16x16x32_bf16 v[184:187], a[176:179], v[196:199], v[52:55]
 ds_read_b64_tr_b16 a[204:205], v10 offset:40960
 v_cvt_pk_bf16_f32 v88, v140, v141
 v_mfma_f32_16x16x32_bf16 v[184:187], a[180:183], v[212:215], v[184:187]
 v_exp_f32 v170, v170
 v_mfma_f32_16x16x32_bf16 v[184:187], a[184:187], v[228:231], v[184:187]
 ds_read_b64_tr_b16 a[206:207], v10 offset:45056
 v_cvt_pk_bf16_f32 v89, v142, v143
 v_mfma_f32_16x16x32_bf16 v[184:187], a[188:191], v[244:247], v[184:187]
 v_exp_f32 v171, v171
 v_mfma_f32_16x16x32_bf16 v[188:191], a[188:191], v[240:243], v[48:51]
 v_exp_f32 v172, v172
 v_mfma_f32_16x16x32_bf16 v[188:191], a[184:187], v[224:227], v[188:191]
 v_exp_f32 v173, v173
 v_mfma_f32_16x16x32_bf16 v[188:191], a[180:183], v[208:211], v[188:191]
 s_waitcnt vmcnt(13)
 v_exp_f32 v174, v174
 v_cmp_gt_u32 vcc, s62, v19
 v_mfma_f32_16x16x32_bf16 v[188:191], a[176:179], v[192:195], v[188:191]
 s_cbranch_vccnz h_spin
h_ok:
 s_barrier
 v_exp_f32 v175, v175
 v_smfmac_f32_16x16x64_bf16 v[32:35], a[224:227], v[96:103], v17
 v_exp_f32 v176, v176
 v_smfmac_f32_16x16x64_bf16 v[36:39], a[224:227], v[104:111], v17
 v_exp_f32 v177, v177
 v_smfmac_f32_16x16x64_bf16 v[40:43], a[224:227], v[112:119], v17
 v_exp_f32 v178, v178
 v_smfmac_f32_16x16x64_bf16 v[44:47], a[224:227], v[120:127], v17
 s_waitcnt lgkmcnt(4)
 v_exp_f32 v179, v179
 v_mfma_f32_16x16x32_bf16 a[0:3], a[192:195], v[96:99], a[0:3]
 s_add_u32 m0, s47, 114688
 ds_read_b64_tr_b16 a[208:209], v11 offset:32768
 ds_read_b64_tr_b16 a[210:211], v11 offset:36864
 v_mfma_f32_16x16x32_bf16 a[0:3], a[196:199], v[100:103], a[0:3]
 buffer_load_dwordx4 v1, s[12:15], s50 offen offset:0 lds
 v_mfma_f32_16x16x32_bf16 a[4:7], a[196:199], v[108:111], a[4:7]
 ds_read_b64_tr_b16 a[212:213], v11 offset:40960
 ds_read_b64_tr_b16 a[214:215], v11 offset:45056
 v_mfma_f32_16x16x32_bf16 a[4:7], a[192:195], v[104:107], a[4:7]
 v_exp_f32 v180, v180
 v_mfma_f32_16x16x32_bf16 a[8:11], a[192:195], v[112:115], a[8:11]
 v_exp_f32 v181, v181
 v_mfma_f32_16x16x32_bf16 a[8:11], a[196:199], v[116:119], a[8:11]
 v_exp_f32 v182, v182
 v_mfma_f32_16x16x32_bf16 a[12:15], a[196:199], v[124:127], a[12:15]
 v_exp_f32 v183, v183
 v_mfma_f32_16x16x32_bf16 a[12:15], a[192:195], v[120:123], a[12:15]
 s_waitcnt lgkmcnt(4)
 v_exp_f32 v184, v184
 v_mfma_f32_16x16x32_bf16 a[28:31], a[200:203], v[120:123], a[28:31]
 ds_read_b64_tr_b16 a[216:217], v12 offset:32768
 ds_read_b64_tr_b16 a[218:219], v12 offset:36864
 v_mfma_f32_16x16x32_bf16 a[28:31], a[204:207], v[124:127], a[28:31]
 buffer_load_dwordx4 v2, s[12:15], s50 offen offset:1024 lds
 v_mfma_f32_16x16x32_bf16 a[24:27], a[204:207], v[116:119], a[24:27]
 ds_read_b64_tr_b16 a[220:221], v12 offset:40960
 ds_read_b64_tr_b16 a[222:223], v12 offset:45056
 v_mfma_f32_16x16x32_bf16 a[24:27], a[200:203], v[112:115], a[24:27]
 v_exp_f32 v185, v185
 v_mfma_f32_16x16x32_bf16 a[20:23], a[200:203], v[104:107], a[20:23]
 v_exp_f32 v186, v186
 v_mfma_f32_16x16x32_bf16 a[20:23], a[204:207], v[108:111], a[20:23]
 v_exp_f32 v187, v187
 v_mfma_f32_16x16x32_bf16 a[16:19], a[204:207], v[100:103], a[16:19]
 v_exp_f32 v188, v188
 v_mfma_f32_16x16x32_bf16 a[16:19], a[200:203], v[96:99], a[16:19]
 s_waitcnt lgkmcnt(4)
 v_exp_f32 v189, v189
 v_mfma_f32_16x16x32_bf16 a[32:35], a[208:211], v[96:99], a[32:35]
 ds_read_b64_tr_b16 a[192:193], v13 offset:32768
 ds_read_b64_tr_b16 a[194:195], v13 offset:36864
 v_mfma_f32_16x16x32_bf16 a[32:35], a[212:215], v[100:103], a[32:35]
 buffer_load_dwordx4 v3, s[12:15], s50 offen offset:2048 lds
 v_mfma_f32_16x16x32_bf16 a[36:39], a[212:215], v[108:111], a[36:39]
 ds_read_b64_tr_b16 a[196:197], v13 offset:40960
 ds_read_b64_tr_b16 a[198:199], v13 offset:45056
 v_mfma_f32_16x16x32_bf16 a[36:39], a[208:211], v[104:107], a[36:39]
 v_exp_f32 v190, v190
 v_mfma_f32_16x16x32_bf16 a[40:43], a[208:211], v[112:115], a[40:43]
 v_exp_f32 v191, v191
 v_mfma_f32_16x16x32_bf16 a[40:43], a[212:215], v[116:119], a[40:43]
 v_cvt_pk_bf16_f32 v90, v144, v145
 v_cvt_pk_bf16_f32 v91, v146, v147
 v_mfma_f32_16x16x32_bf16 a[44:47], a[212:215], v[124:127], a[44:47]
 v_cvt_pk_bf16_f32 v82, v148, v149
 v_cvt_pk_bf16_f32 v83, v150, v151
 v_mfma_f32_16x16x32_bf16 a[44:47], a[208:211], v[120:123], a[44:47]
 s_waitcnt lgkmcnt(4)
 v_cvt_pk_bf16_f32 v74, v152, v153
 v_cvt_pk_bf16_f32 v75, v154, v155
 v_mfma_f32_16x16x32_bf16 a[60:63], a[216:219], v[120:123], a[60:63]
 ds_read_b64_tr_b16 a[200:201], v14 offset:32768
 ds_read_b64_tr_b16 a[202:203], v14 offset:36864
 v_mfma_f32_16x16x32_bf16 a[60:63], a[220:223], v[124:127], a[60:63]
 buffer_load_dwordx4 v4, s[12:15], s50 offen offset:3072 lds
 v_mfma_f32_16x16x32_bf16 a[56:59], a[220:223], v[116:119], a[56:59]
 s_add_u32 s50, s50, 16384
 ds_read_b64_tr_b16 a[204:205], v14 offset:40960
 ds_read_b64_tr_b16 a[206:207], v14 offset:45056
 v_mfma_f32_16x16x32_bf16 a[56:59], a[216:219], v[112:115], a[56:59]
 v_cvt_pk_bf16_f32 v66, v156, v157
 v_cvt_pk_bf16_f32 v67, v158, v159
 v_mfma_f32_16x16x32_bf16 a[52:55], a[216:219], v[104:107], a[52:55]
 v_cvt_pk_bf16_f32 v68, v160, v161
 v_cvt_pk_bf16_f32 v69, v162, v163
 v_mfma_f32_16x16x32_bf16 a[52:55], a[220:223], v[108:111], a[52:55]
 v_cvt_pk_bf16_f32 v76, v164, v165
 v_cvt_pk_bf16_f32 v77, v166, v167
 v_mfma_f32_16x16x32_bf16 a[48:51], a[220:223], v[100:103], a[48:51]
 v_cvt_pk_bf16_f32 v84, v168, v169
 v_cvt_pk_bf16_f32 v85, v170, v171
 v_mfma_f32_16x16x32_bf16 a[48:51], a[216:219], v[96:99], a[48:51]
 s_waitcnt lgkmcnt(4)
 v_cvt_pk_bf16_f32 v92, v172, v173
 v_cvt_pk_bf16_f32 v93, v174, v175
 v_mfma_f32_16x16x32_bf16 a[64:67], a[192:195], v[96:99], a[64:67]
 s_add_u32 s91, s56, 32768
 s_add_u32 m0, s47, 65536
 ds_read_b64_tr_b16 a[208:209], v15 offset:32768
 ds_read_b64_tr_b16 a[210:211], v15 offset:36864
 v_mfma_f32_16x16x32_bf16 a[64:67], a[196:199], v[100:103], a[64:67]
 buffer_load_dwordx4 v18, s[24:27], s91 offen offset:0 sc1 lds
 v_mfma_f32_16x16x32_bf16 a[68:71], a[196:199], v[108:111], a[68:71]
 ds_read_b64_tr_b16 a[212:213], v15 offset:40960
 ds_read_b64_tr_b16 a[214:215], v15 offset:45056
 v_mfma_f32_16x16x32_bf16 a[68:71], a[192:195], v[104:107], a[68:71]
 v_cvt_pk_bf16_f32 v94, v176, v177
 v_cvt_pk_bf16_f32 v95, v178, v179
 v_mfma_f32_16x16x32_bf16 a[72:75], a[192:195], v[112:115], a[72:75]
 v_cvt_pk_bf16_f32 v86, v180, v181
 v_cvt_pk_bf16_f32 v87, v182, v183
 v_mfma_f32_16x16x32_bf16 a[72:75], a[196:199], v[116:119], a[72:75]
 v_cvt_pk_bf16_f32 v78, v184, v185
 v_cvt_pk_bf16_f32 v79, v186, v187
 v_mfma_f32_16x16x32_bf16 a[76:79], a[196:199], v[124:127], a[76:79]
 v_cvt_pk_bf16_f32 v70, v188, v189
 v_cvt_pk_bf16_f32 v71, v190, v191
 v_mfma_f32_16x16x32_bf16 a[76:79], a[192:195], v[120:123], a[76:79]
 s_waitcnt lgkmcnt(4)
 v_mfma_f32_16x16x32_bf16 a[92:95], a[200:203], v[120:123], a[92:95]
 ds_read_b64_tr_b16 a[216:217], v16 offset:32768
 ds_read_b64_tr_b16 a[218:219], v16 offset:36864
 v_mfma_f32_16x16x32_bf16 a[92:95], a[204:207], v[124:127], a[92:95]
 buffer_load_dwordx4 v18, s[24:27], s91 offen offset:1024 sc1 lds
 v_mfma_f32_16x16x32_bf16 a[88:91], a[204:207], v[116:119], a[88:91]
 ds_read_b64_tr_b16 a[220:221], v16 offset:40960
 ds_read_b64_tr_b16 a[222:223], v16 offset:45056
 v_mfma_f32_16x16x32_bf16 a[88:91], a[200:203], v[112:115], a[88:91]
 v_mfma_f32_16x16x32_bf16 a[84:87], a[200:203], v[104:107], a[84:87]
 v_mfma_f32_16x16x32_bf16 a[84:87], a[204:207], v[108:111], a[84:87]
 v_mfma_f32_16x16x32_bf16 a[80:83], a[204:207], v[100:103], a[80:83]
 v_mfma_f32_16x16x32_bf16 a[80:83], a[200:203], v[96:99], a[80:83]
 s_waitcnt lgkmcnt(4)
 v_mfma_f32_16x16x32_bf16 a[96:99], a[208:211], v[96:99], a[96:99]
 ds_read_b128 a[128:131], v5 offset:0
 ds_read_b128 a[132:135], v6 offset:0
 v_mfma_f32_16x16x32_bf16 a[96:99], a[212:215], v[100:103], a[96:99]
 buffer_load_dwordx4 v18, s[24:27], s91 offen offset:2048 sc1 lds
 v_mfma_f32_16x16x32_bf16 a[100:103], a[212:215], v[108:111], a[100:103]
 ds_read_b128 a[136:139], v7 offset:0
 ds_read_b128 a[140:143], v8 offset:0
 v_mfma_f32_16x16x32_bf16 a[100:103], a[208:211], v[104:107], a[100:103]
 v_mfma_f32_16x16x32_bf16 a[104:107], a[208:211], v[112:115], a[104:107]
 v_mfma_f32_16x16x32_bf16 a[104:107], a[212:215], v[116:119], a[104:107]
 v_mfma_f32_16x16x32_bf16 a[108:111], a[212:215], v[124:127], a[108:111]
 v_mfma_f32_16x16x32_bf16 a[108:111], a[208:211], v[120:123], a[108:111]
 s_waitcnt lgkmcnt(4)
 v_mfma_f32_16x16x32_bf16 a[124:127], a[216:219], v[120:123], a[124:127]
 ds_read_b128 a[144:147], v5 offset:4096
 ds_read_b128 a[148:151], v6 offset:4096
 v_mfma_f32_16x16x32_bf16 a[124:127], a[220:223], v[124:127], a[124:127]
 buffer_load_dwordx4 v18, s[24:27], s91 offen offset:3072 sc1 lds
 v_mfma_f32_16x16x32_bf16 a[120:123], a[220:223], v[116:119], a[120:123]
 ds_read_b128 a[152:155], v7 offset:4096
 ds_read_b128 a[156:159], v8 offset:4096
 v_mfma_f32_16x16x32_bf16 a[120:123], a[216:219], v[112:115], a[120:123]
 v_mfma_f32_16x16x32_bf16 a[116:119], a[216:219], v[104:107], a[116:119]
 v_mfma_f32_16x16x32_bf16 a[116:119], a[220:223], v[108:111], a[116:119]
 v_mfma_f32_16x16x32_bf16 a[112:115], a[220:223], v[100:103], a[112:115]
 v_mfma_f32_16x16x32_bf16 a[112:115], a[216:219], v[96:99], a[112:115]
 s_waitcnt lgkmcnt(4)
 v_mfma_f32_16x16x32_bf16 v[128:131], a[128:131], v[192:195], v[48:51]
 ds_read_b128 a[160:163], v5 offset:8192
 v_mfma_f32_16x16x32_bf16 v[128:131], a[132:135], v[208:211], v[128:131]
 ds_read_b128 a[164:167], v6 offset:8192
 v_mfma_f32_16x16x32_bf16 v[128:131], a[136:139], v[224:227], v[128:131]
 ds_read_b128 a[168:171], v7 offset:8192
 v_mfma_f32_16x16x32_bf16 v[128:131], a[140:143], v[240:243], v[128:131]
 ds_read_b128 a[172:175], v8 offset:8192
 v_mfma_f32_16x16x32_bf16 v[132:135], a[140:143], v[244:247], v[52:55]
 ds_read_b128 a[176:179], v5 offset:12288
 v_mfma_f32_16x16x32_bf16 v[132:135], a[136:139], v[228:231], v[132:135]
 ds_read_b128 a[180:183], v6 offset:12288
 v_mfma_f32_16x16x32_bf16 v[132:135], a[132:135], v[212:215], v[132:135]
 ds_read_b128 a[184:187], v7 offset:12288
 v_mfma_f32_16x16x32_bf16 v[132:135], a[128:131], v[196:199], v[132:135]
 ds_read_b128 a[188:191], v8 offset:12288
 v_mfma_f32_16x16x32_bf16 v[136:139], a[128:131], v[200:203], v[56:59]
 v_exp_f32 v128, v128
 v_mfma_f32_16x16x32_bf16 v[136:139], a[132:135], v[216:219], v[136:139]
 v_exp_f32 v129, v129
 v_mfma_f32_16x16x32_bf16 v[136:139], a[136:139], v[232:235], v[136:139]
 v_exp_f32 v130, v130
 v_mfma_f32_16x16x32_bf16 v[136:139], a[140:143], v[248:251], v[136:139]
 v_exp_f32 v131, v131
 v_mfma_f32_16x16x32_bf16 v[140:143], a[140:143], v[252:255], v[60:63]
 v_exp_f32 v132, v132
 v_mfma_f32_16x16x32_bf16 v[140:143], a[136:139], v[236:239], v[140:143]
 v_exp_f32 v133, v133
 v_mfma_f32_16x16x32_bf16 v[140:143], a[132:135], v[220:223], v[140:143]
 v_exp_f32 v134, v134
 v_mfma_f32_16x16x32_bf16 v[140:143], a[128:131], v[204:207], v[140:143]
 s_waitcnt lgkmcnt(8)
 v_exp_f32 v135, v135
 v_mfma_f32_16x16x32_bf16 v[144:147], a[144:147], v[204:207], v[60:63]
 v_exp_f32 v136, v136
 v_mfma_f32_16x16x32_bf16 v[144:147], a[148:151], v[220:223], v[144:147]
 v_exp_f32 v137, v137
 v_mfma_f32_16x16x32_bf16 v[144:147], a[152:155], v[236:239], v[144:147]
 v_exp_f32 v138, v138
 v_mfma_f32_16x16x32_bf16 v[144:147], a[156:159], v[252:255], v[144:147]
 v_exp_f32 v139, v139
 v_mfma_f32_16x16x32_bf16 v[148:151], a[156:159], v[248:251], v[56:59]
 v_exp_f32 v140, v140
 v_mfma_f32_16x16x32_bf16 v[148:151], a[152:155], v[232:235], v[148:151]
 v_exp_f32 v141, v141
 v_mfma_f32_16x16x32_bf16 v[148:151], a[148:151], v[216:219], v[148:151]
 v_exp_f32 v142, v142
 v_mfma_f32_16x16x32_bf16 v[148:151], a[144:147], v[200:203], v[148:151]
 v_exp_f32 v143, v143
 v_mfma_f32_16x16x32_bf16 v[152:155], a[144:147], v[196:199], v[52:55]
 v_exp_f32 v144, v144
 v_mfma_f32_16x16x32_bf16 v[152:155], a[148:151], v[212:215], v[152:155]
 v_exp_f32 v145, v145
 v_mfma_f32_16x16x32_bf16 v[152:155], a[152:155], v[228:231], v[152:155]
 v_exp_f32 v146, v146
 v_mfma_f32_16x16x32_bf16 v[152:155], a[156:159], v[244:247], v[152:155]
 v_exp_f32 v147, v147
 v_mfma_f32_16x16x32_bf16 v[156:159], a[156:159], v[240:243], v[48:51]
 v_exp_f32 v148, v148
 v_mfma_f32_16x16x32_bf16 v[156:159], a[152:155], v[224:227], v[156:159]
 v_exp_f32 v149, v149
 v_mfma_f32_16x16x32_bf16 v[156:159], a[148:151], v[208:211], v[156:159]
 v_exp_f32 v150, v150
 v_mfma_f32_16x16x32_bf16 v[156:159], a[144:147], v[192:195], v[156:159]
 s_waitcnt lgkmcnt(4)
 v_exp_f32 v151, v151
 v_mfma_f32_16x16x32_bf16 v[160:163], a[160:163], v[192:195], v[48:51]
 v_exp_f32 v152, v152
 v_mfma_f32_16x16x32_bf16 v[160:163], a[164:167], v[208:211], v[160:163]
 v_exp_f32 v153, v153
 v_mfma_f32_16x16x32_bf16 v[160:163], a[168:171], v[224:227], v[160:163]
 v_exp_f32 v154, v154
 v_mfma_f32_16x16x32_bf16 v[160:163], a[172:175], v[240:243], v[160:163]
 v_exp_f32 v155, v155
 v_mfma_f32_16x16x32_bf16 v[164:167], a[172:175], v[244:247], v[52:55]
 v_exp_f32 v156, v156
 v_mfma_f32_16x16x32_bf16 v[164:167], a[168:171], v[228:231], v[164:167]
 v_exp_f32 v157, v157
 v_mfma_f32_16x16x32_bf16 v[164:167], a[164:167], v[212:215], v[164:167]
 v_exp_f32 v158, v158
 v_mfma_f32_16x16x32_bf16 v[164:167], a[160:163], v[196:199], v[164:167]
 v_exp_f32 v159, v159
 v_mfma_f32_16x16x32_bf16 v[168:171], a[160:163], v[200:203], v[56:59]
 v_exp_f32 v160, v160
 v_mfma_f32_16x16x32_bf16 v[168:171], a[164:167], v[216:219], v[168:171]
 v_exp_f32 v161, v161
 v_mfma_f32_16x16x32_bf16 v[168:171], a[168:171], v[232:235], v[168:171]
 v_exp_f32 v162, v162
 v_mfma_f32_16x16x32_bf16 v[168:171], a[172:175], v[248:251], v[168:171]
 v_exp_f32 v163, v163
 v_mfma_f32_16x16x32_bf16 v[172:175], a[172:175], v[252:255], v[60:63]
 ds_read_b64_tr_b16 a[192:193], v9 offset:49152
 v_cvt_pk_bf16_f32 v96, v128, v129
 v_mfma_f32_16x16x32_bf16 v[172:175], a[168:171], v[236:239], v[172:175]
 v_exp_f32 v164, v164
 v_mfma_f32_16x16x32_bf16 v[172:175], a[164:167], v[220:223], v[172:175]
 ds_read_b64_tr_b16 a[194:195], v9 offset:53248
 v_cvt_pk_bf16_f32 v97, v130, v131
 v_mfma_f32_16x16x32_bf16 v[172:175], a[160:163], v[204:207], v[172:175]
 s_waitcnt lgkmcnt(2)
 v_exp_f32 v165, v165
 v_mfma_f32_16x16x32_bf16 v[176:179], a[176:179], v[204:207], v[60:63]
 ds_read_b64_tr_b16 a[196:197], v9 offset:57344
 v_cvt_pk_bf16_f32 v104, v132, v133
 v_mfma_f32_16x16x32_bf16 v[176:179], a[180:183], v[220:223], v[176:179]
 v_exp_f32 v166, v166
 v_mfma_f32_16x16x32_bf16 v[176:179], a[184:187], v[236:239], v[176:179]
 ds_read_b64_tr_b16 a[198:199], v9 offset:61440
 v_cvt_pk_bf16_f32 v105, v134, v135
 v_mfma_f32_16x16x32_bf16 v[176:179], a[188:191], v[252:255], v[176:179]
 v_exp_f32 v167, v167
 v_mfma_f32_16x16x32_bf16 v[180:183], a[188:191], v[248:251], v[56:59]
 ds_read_b64_tr_b16 a[200:201], v10 offset:49152
 v_cvt_pk_bf16_f32 v112, v136, v137
 v_mfma_f32_16x16x32_bf16 v[180:183], a[184:187], v[232:235], v[180:183]
 v_exp_f32 v168, v168
 v_mfma_f32_16x16x32_bf16 v[180:183], a[180:183], v[216:219], v[180:183]
 ds_read_b64_tr_b16 a[202:203], v10 offset:53248
 v_cvt_pk_bf16_f32 v113, v138, v139
 v_mfma_f32_16x16x32_bf16 v[180:183], a[176:179], v[200:203], v[180:183]
 v_exp_f32 v169, v169
 v_mfma_f32_16x16x32_bf16 v[184:187], a[176:179], v[196:199], v[52:55]
 ds_read_b64_tr_b16 a[204:205], v10 offset:57344
 v_cvt_pk_bf16_f32 v120, v140, v141
 v_mfma_f32_16x16x32_bf16 v[184:187], a[180:183], v[212:215], v[184:187]
 v_exp_f32 v170, v170
 v_mfma_f32_16x16x32_bf16 v[184:187], a[184:187], v[228:231], v[184:187]
 ds_read_b64_tr_b16 a[206:207], v10 offset:61440
 v_cvt_pk_bf16_f32 v121, v142, v143
 v_mfma_f32_16x16x32_bf16 v[184:187], a[188:191], v[244:247], v[184:187]
 v_exp_f32 v171, v171
 v_mfma_f32_16x16x32_bf16 v[188:191], a[188:191], v[240:243], v[48:51]
 v_exp_f32 v172, v172
 v_mfma_f32_16x16x32_bf16 v[188:191], a[184:187], v[224:227], v[188:191]
 v_exp_f32 v173, v173
 v_mfma_f32_16x16x32_bf16 v[188:191], a[180:183], v[208:211], v[188:191]
 s_waitcnt vmcnt(12)
 v_exp_f32 v174, v174
 v_mfma_f32_16x16x32_bf16 v[188:191], a[176:179], v[192:195], v[188:191]
 s_barrier
 v_exp_f32 v175, v175
 v_smfmac_f32_16x16x64_bf16 v[32:35], a[224:227], v[64:71], v17
 v_exp_f32 v176, v176
 v_smfmac_f32_16x16x64_bf16 v[36:39], a[224:227], v[72:79], v17
 v_exp_f32 v177, v177
 v_smfmac_f32_16x16x64_bf16 v[40:43], a[224:227], v[80:87], v17
 v_exp_f32 v178, v178
 v_smfmac_f32_16x16x64_bf16 v[44:47], a[224:227], v[88:95], v17
 s_waitcnt lgkmcnt(4)
 v_exp_f32 v179, v179
 v_mfma_f32_16x16x32_bf16 a[0:3], a[192:195], v[64:67], a[0:3]
 s_add_u32 m0, s47, 131072
 ds_read_b64_tr_b16 a[208:209], v11 offset:49152
 ds_read_b64_tr_b16 a[210:211], v11 offset:53248
 v_mfma_f32_16x16x32_bf16 a[0:3], a[196:199], v[68:71], a[0:3]
 buffer_load_dwordx4 v1, s[12:15], s50 offen offset:0 lds
 v_mfma_f32_16x16x32_bf16 a[4:7], a[196:199], v[76:79], a[4:7]
 ds_read_b64_tr_b16 a[212:213], v11 offset:57344
 ds_read_b64_tr_b16 a[214:215], v11 offset:61440
 v_mfma_f32_16x16x32_bf16 a[4:7], a[192:195], v[72:75], a[4:7]
 v_exp_f32 v180, v180
 v_mfma_f32_16x16x32_bf16 a[8:11], a[192:195], v[80:83], a[8:11]
 v_exp_f32 v181, v181
 v_mfma_f32_16x16x32_bf16 a[8:11], a[196:199], v[84:87], a[8:11]
 v_exp_f32 v182, v182
 v_mfma_f32_16x16x32_bf16 a[12:15], a[196:199], v[92:95], a[12:15]
 v_exp_f32 v183, v183
 v_mfma_f32_16x16x32_bf16 a[12:15], a[192:195], v[88:91], a[12:15]
 s_waitcnt lgkmcnt(4)
 v_exp_f32 v184, v184
 v_mfma_f32_16x16x32_bf16 a[28:31], a[200:203], v[88:91], a[28:31]
 ds_read_b64_tr_b16 a[216:217], v12 offset:49152
 ds_read_b64_tr_b16 a[218:219], v12 offset:53248
 v_mfma_f32_16x16x32_bf16 a[28:31], a[204:207], v[92:95], a[28:31]
 buffer_load_dwordx4 v2, s[12:15], s50 offen offset:1024 lds
 v_mfma_f32_16x16x32_bf16 a[24:27], a[204:207], v[84:87], a[24:27]
 ds_read_b64_tr_b16 a[220:221], v12 offset:57344
 ds_read_b64_tr_b16 a[222:223], v12 offset:61440
 v_mfma_f32_16x16x32_bf16 a[24:27], a[200:203], v[80:83], a[24:27]
 v_exp_f32 v185, v185
 v_mfma_f32_16x16x32_bf16 a[20:23], a[200:203], v[72:75], a[20:23]
 v_exp_f32 v186, v186
 v_mfma_f32_16x16x32_bf16 a[20:23], a[204:207], v[76:79], a[20:23]
 v_exp_f32 v187, v187
 v_mfma_f32_16x16x32_bf16 a[16:19], a[204:207], v[68:71], a[16:19]
 v_exp_f32 v188, v188
 v_mfma_f32_16x16x32_bf16 a[16:19], a[200:203], v[64:67], a[16:19]
 s_waitcnt lgkmcnt(4)
 v_exp_f32 v189, v189
 v_mfma_f32_16x16x32_bf16 a[32:35], a[208:211], v[64:67], a[32:35]
 ds_read_b64_tr_b16 a[192:193], v13 offset:49152
 ds_read_b64_tr_b16 a[194:195], v13 offset:53248
 v_mfma_f32_16x16x32_bf16 a[32:35], a[212:215], v[68:71], a[32:35]
 buffer_load_dwordx4 v3, s[12:15], s50 offen offset:2048 lds
 v_mfma_f32_16x16x32_bf16 a[36:39], a[212:215], v[76:79], a[36:39]
 ds_read_b64_tr_b16 a[196:197], v13 offset:57344
 ds_read_b64_tr_b16 a[198:199], v13 offset:61440
 v_mfma_f32_16x16x32_bf16 a[36:39], a[208:211], v[72:75], a[36:39]
 v_exp_f32 v190, v190
 v_mfma_f32_16x16x32_bf16 a[40:43], a[208:211], v[80:83], a[40:43]
 v_exp_f32 v191, v191
 v_mfma_f32_16x16x32_bf16 a[40:43], a[212:215], v[84:87], a[40:43]
 v_cvt_pk_bf16_f32 v122, v144, v145
 v_cvt_pk_bf16_f32 v123, v146, v147
 v_mfma_f32_16x16x32_bf16 a[44:47], a[212:215], v[92:95], a[44:47]
 v_cvt_pk_bf16_f32 v114, v148, v149
 v_cvt_pk_bf16_f32 v115, v150, v151
 v_mfma_f32_16x16x32_bf16 a[44:47], a[208:211], v[88:91], a[44:47]
 s_waitcnt lgkmcnt(4)
 v_cvt_pk_bf16_f32 v106, v152, v153
 v_cvt_pk_bf16_f32 v107, v154, v155
 v_mfma_f32_16x16x32_bf16 a[60:63], a[216:219], v[88:91], a[60:63]
 ds_read_b64_tr_b16 a[200:201], v14 offset:49152
 ds_read_b64_tr_b16 a[202:203], v14 offset:53248
 v_mfma_f32_16x16x32_bf16 a[60:63], a[220:223], v[92:95], a[60:63]
 buffer_load_dwordx4 v4, s[12:15], s50 offen offset:3072 lds
 v_mfma_f32_16x16x32_bf16 a[56:59], a[220:223], v[84:87], a[56:59]
 s_add_u32 s50, s50, 16384
 ds_read_b64_tr_b16 a[204:205], v14 offset:57344
 ds_read_b64_tr_b16 a[206:207], v14 offset:61440
 v_mfma_f32_16x16x32_bf16 a[56:59], a[216:219], v[80:83], a[56:59]
 v_cvt_pk_bf16_f32 v98, v156, v157
 v_cvt_pk_bf16_f32 v99, v158, v159
 v_mfma_f32_16x16x32_bf16 a[52:55], a[216:219], v[72:75], a[52:55]
 v_cvt_pk_bf16_f32 v100, v160, v161
 v_cvt_pk_bf16_f32 v101, v162, v163
 v_mfma_f32_16x16x32_bf16 a[52:55], a[220:223], v[76:79], a[52:55]
 v_cvt_pk_bf16_f32 v108, v164, v165
 v_cvt_pk_bf16_f32 v109, v166, v167
 v_mfma_f32_16x16x32_bf16 a[48:51], a[220:223], v[68:71], a[48:51]
 v_cvt_pk_bf16_f32 v116, v168, v169
 v_cvt_pk_bf16_f32 v117, v170, v171
 v_mfma_f32_16x16x32_bf16 a[48:51], a[216:219], v[64:67], a[48:51]
 s_waitcnt lgkmcnt(4)
 v_cvt_pk_bf16_f32 v124, v172, v173
 v_cvt_pk_bf16_f32 v125, v174, v175
 v_mfma_f32_16x16x32_bf16 a[64:67], a[192:195], v[64:67], a[64:67]
 s_add_u32 s91, s51, 8192
 s_add_u32 m0, s47, 16384
 ds_read_b64_tr_b16 a[208:209], v15 offset:49152
 ds_read_b64_tr_b16 a[210:211], v15 offset:53248
 v_mfma_f32_16x16x32_bf16 a[64:67], a[196:199], v[68:71], a[64:67]
 buffer_load_dwordx4 v18, s[24:27], s91 offen offset:0 sc1 lds
 v_mfma_f32_16x16x32_bf16 a[68:71], a[196:199], v[76:79], a[68:71]
 ds_read_b64_tr_b16 a[212:213], v15 offset:57344
 ds_read_b64_tr_b16 a[214:215], v15 offset:61440
 v_mfma_f32_16x16x32_bf16 a[68:71], a[192:195], v[72:75], a[68:71]
 v_cvt_pk_bf16_f32 v126, v176, v177
 v_cvt_pk_bf16_f32 v127, v178, v179
 v_mfma_f32_16x16x32_bf16 a[72:75], a[192:195], v[80:83], a[72:75]
 v_cvt_pk_bf16_f32 v118, v180, v181
 v_cvt_pk_bf16_f32 v119, v182, v183
 v_mfma_f32_16x16x32_bf16 a[72:75], a[196:199], v[84:87], a[72:75]
 v_cvt_pk_bf16_f32 v110, v184, v185
 v_cvt_pk_bf16_f32 v111, v186, v187
 v_mfma_f32_16x16x32_bf16 a[76:79], a[196:199], v[92:95], a[76:79]
 v_cvt_pk_bf16_f32 v102, v188, v189
 v_cvt_pk_bf16_f32 v103, v190, v191
 v_mfma_f32_16x16x32_bf16 a[76:79], a[192:195], v[88:91], a[76:79]
 s_waitcnt lgkmcnt(4)
 v_mfma_f32_16x16x32_bf16 a[92:95], a[200:203], v[88:91], a[92:95]
 ds_read_b64_tr_b16 a[216:217], v16 offset:49152
 ds_read_b64_tr_b16 a[218:219], v16 offset:53248
 v_mfma_f32_16x16x32_bf16 a[92:95], a[204:207], v[92:95], a[92:95]
 buffer_load_dwordx4 v18, s[24:27], s91 offen offset:1024 sc1 lds
 v_mfma_f32_16x16x32_bf16 a[88:91], a[204:207], v[84:87], a[88:91]
 ds_read_b64_tr_b16 a[220:221], v16 offset:57344
 ds_read_b64_tr_b16 a[222:223], v16 offset:61440
 v_mfma_f32_16x16x32_bf16 a[88:91], a[200:203], v[80:83], a[88:91]
 v_mfma_f32_16x16x32_bf16 a[84:87], a[200:203], v[72:75], a[84:87]
 v_mfma_f32_16x16x32_bf16 a[84:87], a[204:207], v[76:79], a[84:87]
 v_mfma_f32_16x16x32_bf16 a[80:83], a[204:207], v[68:71], a[80:83]
 v_mfma_f32_16x16x32_bf16 a[80:83], a[200:203], v[64:67], a[80:83]
 s_waitcnt lgkmcnt(4)
 v_mfma_f32_16x16x32_bf16 a[96:99], a[208:211], v[64:67], a[96:99]
 ds_read_b128 a[128:131], v5 offset:16384
 ds_read_b128 a[132:135], v6 offset:16384
 v_mfma_f32_16x16x32_bf16 a[96:99], a[212:215], v[68:71], a[96:99]
 buffer_load_dwordx4 v18, s[24:27], s91 offen offset:2048 sc1 lds
 v_mfma_f32_16x16x32_bf16 a[100:103], a[212:215], v[76:79], a[100:103]
 ds_read_b128 a[136:139], v7 offset:16384
 ds_read_b128 a[140:143], v8 offset:16384
 v_mfma_f32_16x16x32_bf16 a[100:103], a[208:211], v[72:75], a[100:103]
 v_mfma_f32_16x16x32_bf16 a[104:107], a[208:211], v[80:83], a[104:107]
 v_mfma_f32_16x16x32_bf16 a[104:107], a[212:215], v[84:87], a[104:107]
 v_mfma_f32_16x16x32_bf16 a[108:111], a[212:215], v[92:95], a[108:111]
 v_mfma_f32_16x16x32_bf16 a[108:111], a[208:211], v[88:91], a[108:111]
 s_waitcnt lgkmcnt(4)
 v_mfma_f32_16x16x32_bf16 a[124:127], a[216:219], v[88:91], a[124:127]
 ds_read_b128 a[144:147], v5 offset:20480
 ds_read_b128 a[148:151], v6 offset:20480
 v_mfma_f32_16x16x32_bf16 a[124:127], a[220:223], v[92:95], a[124:127]
 buffer_load_dwordx4 v18, s[24:27], s91 offen offset:3072 sc1 lds
 v_mfma_f32_16x16x32_bf16 a[120:123], a[220:223], v[84:87], a[120:123]
 ds_read_b128 a[152:155], v7 offset:20480
 ds_read_b128 a[156:159], v8 offset:20480
 v_mfma_f32_16x16x32_bf16 a[120:123], a[216:219], v[80:83], a[120:123]
 v_mfma_f32_16x16x32_bf16 a[116:119], a[216:219], v[72:75], a[116:119]
 v_mfma_f32_16x16x32_bf16 a[116:119], a[220:223], v[76:79], a[116:119]
 v_mfma_f32_16x16x32_bf16 a[112:115], a[220:223], v[68:71], a[112:115]
 v_mfma_f32_16x16x32_bf16 a[112:115], a[216:219], v[64:67], a[112:115]
 s_waitcnt lgkmcnt(4)
 v_mfma_f32_16x16x32_bf16 v[128:131], a[128:131], v[192:195], v[48:51]
 s_add_u32 s91, s51, 0
 s_add_u32 m0, s47, 0
 ds_read_b128 a[160:163], v5 offset:24576
 v_mfma_f32_16x16x32_bf16 v[128:131], a[132:135], v[208:211], v[128:131]
 ds_read_b128 a[164:167], v6 offset:24576
 buffer_load_dwordx4 v18, s[24:27], s91 offen offset:0 sc1 lds
 v_mfma_f32_16x16x32_bf16 v[128:131], a[136:139], v[224:227], v[128:131]
 ds_read_b128 a[168:171], v7 offset:24576
 v_mfma_f32_16x16x32_bf16 v[128:131], a[140:143], v[240:243], v[128:131]
 ds_read_b128 a[172:175], v8 offset:24576
 buffer_load_dwordx4 v18, s[24:27], s91 offen offset:1024 sc1 lds
 v_mfma_f32_16x16x32_bf16 v[132:135], a[140:143], v[244:247], v[52:55]
 ds_read_b128 a[176:179], v5 offset:28672
 v_mfma_f32_16x16x32_bf16 v[132:135], a[136:139], v[228:231], v[132:135]
 ds_read_b128 a[180:183], v6 offset:28672
 buffer_load_dwordx4 v18, s[24:27], s91 offen offset:2048 sc1 lds
 v_mfma_f32_16x16x32_bf16 v[132:135], a[132:135], v[212:215], v[132:135]
 ds_read_b128 a[184:187], v7 offset:28672
 v_mfma_f32_16x16x32_bf16 v[132:135], a[128:131], v[196:199], v[132:135]
 ds_read_b128 a[188:191], v8 offset:28672
 buffer_load_dwordx4 v18, s[24:27], s91 offen offset:3072 sc1 lds
 v_mfma_f32_16x16x32_bf16 v[136:139], a[128:131], v[200:203], v[56:59]
 v_exp_f32 v128, v128
 v_mfma_f32_16x16x32_bf16 v[136:139], a[132:135], v[216:219], v[136:139]
 v_exp_f32 v129, v129
 v_mfma_f32_16x16x32_bf16 v[136:139], a[136:139], v[232:235], v[136:139]
 v_exp_f32 v130, v130
 v_mfma_f32_16x16x32_bf16 v[136:139], a[140:143], v[248:251], v[136:139]
 v_exp_f32 v131, v131
 v_mfma_f32_16x16x32_bf16 v[140:143], a[140:143], v[252:255], v[60:63]
 v_exp_f32 v132, v132
 v_mfma_f32_16x16x32_bf16 v[140:143], a[136:139], v[236:239], v[140:143]
 v_exp_f32 v133, v133
 v_mfma_f32_16x16x32_bf16 v[140:143], a[132:135], v[220:223], v[140:143]
 v_exp_f32 v134, v134
 v_mfma_f32_16x16x32_bf16 v[140:143], a[128:131], v[204:207], v[140:143]
 s_waitcnt lgkmcnt(8)
 v_exp_f32 v135, v135
 v_mfma_f32_16x16x32_bf16 v[144:147], a[144:147], v[204:207], v[60:63]
 v_exp_f32 v136, v136
 v_mfma_f32_16x16x32_bf16 v[144:147], a[148:151], v[220:223], v[144:147]
 v_exp_f32 v137, v137
 v_mfma_f32_16x16x32_bf16 v[144:147], a[152:155], v[236:239], v[144:147]
 v_exp_f32 v138, v138
 v_mfma_f32_16x16x32_bf16 v[144:147], a[156:159], v[252:255], v[144:147]
 v_exp_f32 v139, v139
 v_mfma_f32_16x16x32_bf16 v[148:151], a[156:159], v[248:251], v[56:59]
 v_exp_f32 v140, v140
 v_mfma_f32_16x16x32_bf16 v[148:151], a[152:155], v[232:235], v[148:151]
 v_exp_f32 v141, v141
 v_mfma_f32_16x16x32_bf16 v[148:151], a[148:151], v[216:219], v[148:151]
 v_exp_f32 v142, v142
 v_mfma_f32_16x16x32_bf16 v[148:151], a[144:147], v[200:203], v[148:151]
 v_exp_f32 v143, v143
 v_mfma_f32_16x16x32_bf16 v[152:155], a[144:147], v[196:199], v[52:55]
 v_exp_f32 v144, v144
 v_mfma_f32_16x16x32_bf16 v[152:155], a[148:151], v[212:215], v[152:155]
 v_exp_f32 v145, v145
 v_mfma_f32_16x16x32_bf16 v[152:155], a[152:155], v[228:231], v[152:155]
 v_exp_f32 v146, v146
 v_mfma_f32_16x16x32_bf16 v[152:155], a[156:159], v[244:247], v[152:155]
 v_exp_f32 v147, v147
 v_mfma_f32_16x16x32_bf16 v[156:159], a[156:159], v[240:243], v[48:51]
 v_exp_f32 v148, v148
 v_mfma_f32_16x16x32_bf16 v[156:159], a[152:155], v[224:227], v[156:159]
 v_exp_f32 v149, v149
 v_mfma_f32_16x16x32_bf16 v[156:159], a[148:151], v[208:211], v[156:159]
 v_exp_f32 v150, v150
 v_mfma_f32_16x16x32_bf16 v[156:159], a[144:147], v[192:195], v[156:159]
 s_waitcnt lgkmcnt(4)
 v_exp_f32 v151, v151
 v_mfma_f32_16x16x32_bf16 v[160:163], a[160:163], v[192:195], v[48:51]
 v_exp_f32 v152, v152
 v_mfma_f32_16x16x32_bf16 v[160:163], a[164:167], v[208:211], v[160:163]
 v_exp_f32 v153, v153
 v_mfma_f32_16x16x32_bf16 v[160:163], a[168:171], v[224:227], v[160:163]
 v_exp_f32 v154, v154
 v_mfma_f32_16x16x32_bf16 v[160:163], a[172:175], v[240:243], v[160:163]
 v_exp_f32 v155, v155
 v_mfma_f32_16x16x32_bf16 v[164:167], a[172:175], v[244:247], v[52:55]
 v_exp_f32 v156, v156
 v_mfma_f32_16x16x32_bf16 v[164:167], a[168:171], v[228:231], v[164:167]
 v_exp_f32 v157, v157
 v_mfma_f32_16x16x32_bf16 v[164:167], a[164:167], v[212:215], v[164:167]
 v_exp_f32 v158, v158
 v_mfma_f32_16x16x32_bf16 v[164:167], a[160:163], v[196:199], v[164:167]
 v_exp_f32 v159, v159
 v_mfma_f32_16x16x32_bf16 v[168:171], a[160:163], v[200:203], v[56:59]
 v_exp_f32 v160, v160
 v_mfma_f32_16x16x32_bf16 v[168:171], a[164:167], v[216:219], v[168:171]
 v_exp_f32 v161, v161
 v_mfma_f32_16x16x32_bf16 v[168:171], a[168:171], v[232:235], v[168:171]
 v_exp_f32 v162, v162
 v_mfma_f32_16x16x32_bf16 v[168:171], a[172:175], v[248:251], v[168:171]
 v_exp_f32 v163, v163
 v_mfma_f32_16x16x32_bf16 v[172:175], a[172:175], v[252:255], v[60:63]
 ds_read_b64_tr_b16 a[192:193], v9 offset:0
 v_cvt_pk_bf16_f32 v64, v128, v129
 v_mfma_f32_16x16x32_bf16 v[172:175], a[168:171], v[236:239], v[172:175]
 v_exp_f32 v164, v164
 v_mfma_f32_16x16x32_bf16 v[172:175], a[164:167], v[220:223], v[172:175]
 ds_read_b64_tr_b16 a[194:195], v9 offset:4096
 v_cvt_pk_bf16_f32 v65, v130, v131
 v_mfma_f32_16x16x32_bf16 v[172:175], a[160:163], v[204:207], v[172:175]
 s_waitcnt lgkmcnt(2)
 v_exp_f32 v165, v165
 v_mfma_f32_16x16x32_bf16 v[176:179], a[176:179], v[204:207], v[60:63]
 ds_read_b64_tr_b16 a[196:197], v9 offset:8192
 v_cvt_pk_bf16_f32 v72, v132, v133
 v_mfma_f32_16x16x32_bf16 v[176:179], a[180:183], v[220:223], v[176:179]
 v_exp_f32 v166, v166
 v_mfma_f32_16x16x32_bf16 v[176:179], a[184:187], v[236:239], v[176:179]
 ds_read_b64_tr_b16 a[198:199], v9 offset:12288
 v_cvt_pk_bf16_f32 v73, v134, v135
 v_mfma_f32_16x16x32_bf16 v[176:179], a[188:191], v[252:255], v[176:179]
 v_exp_f32 v167, v167
 v_mfma_f32_16x16x32_bf16 v[180:183], a[188:191], v[248:251], v[56:59]
 ds_read_b64_tr_b16 a[200:201], v10 offset:0
 v_cvt_pk_bf16_f32 v80, v136, v137
 v_mfma_f32_16x16x32_bf16 v[180:183], a[184:187], v[232:235], v[180:183]
 v_exp_f32 v168, v168
 v_mfma_f32_16x16x32_bf16 v[180:183], a[180:183], v[216:219], v[180:183]
 ds_read_b64_tr_b16 a[202:203], v10 offset:4096
 v_cvt_pk_bf16_f32 v81, v138, v139
 v_mfma_f32_16x16x32_bf16 v[180:183], a[176:179], v[200:203], v[180:183]
 v_exp_f32 v169, v169
 v_mfma_f32_16x16x32_bf16 v[184:187], a[176:179], v[196:199], v[52:55]
 ds_read_b64_tr_b16 a[204:205], v10 offset:8192
 v_cvt_pk_bf16_f32 v88, v140, v141
 v_mfma_f32_16x16x32_bf16 v[184:187], a[180:183], v[212:215], v[184:187]
 v_exp_f32 v170, v170
 v_mfma_f32_16x16x32_bf16 v[184:187], a[184:187], v[228:231], v[184:187]
 ds_read_b64_tr_b16 a[206:207], v10 offset:12288
 v_cvt_pk_bf16_f32 v89, v142, v143
 v_mfma_f32_16x16x32_bf16 v[184:187], a[188:191], v[244:247], v[184:187]
 v_exp_f32 v171, v171
 v_mfma_f32_16x16x32_bf16 v[188:191], a[188:191], v[240:243], v[48:51]
 v_exp_f32 v172, v172
 v_mfma_f32_16x16x32_bf16 v[188:191], a[184:187], v[224:227], v[188:191]
 v_exp_f32 v173, v173
 v_mfma_f32_16x16x32_bf16 v[188:191], a[180:183], v[208:211], v[188:191]
 s_waitcnt vmcnt(16)
 v_exp_f32 v174, v174
 v_mfma_f32_16x16x32_bf16 v[188:191], a[176:179], v[192:195], v[188:191]
 s_barrier
 v_exp_f32 v175, v175
 v_smfmac_f32_16x16x64_bf16 v[32:35], a[224:227], v[96:103], v17
 v_exp_f32 v176, v176
 v_smfmac_f32_16x16x64_bf16 v[36:39], a[224:227], v[104:111], v17
 v_exp_f32 v177, v177
 v_smfmac_f32_16x16x64_bf16 v[40:43], a[224:227], v[112:119], v17
 v_exp_f32 v178, v178
 v_smfmac_f32_16x16x64_bf16 v[44:47], a[224:227], v[120:127], v17
 s_waitcnt lgkmcnt(4)
 v_exp_f32 v179, v179
 v_mfma_f32_16x16x32_bf16 a[0:3], a[192:195], v[96:99], a[0:3]
 s_add_u32 s91, s56, 40960
 s_add_u32 m0, s47, 81920
 ds_read_b64_tr_b16 a[208:209], v11 offset:0
 ds_read_b64_tr_b16 a[210:211], v11 offset:4096
 v_mfma_f32_16x16x32_bf16 a[0:3], a[196:199], v[100:103], a[0:3]
 buffer_load_dwordx4 v18, s[24:27], s91 offen offset:0 sc1 lds
 v_mfma_f32_16x16x32_bf16 a[4:7], a[196:199], v[108:111], a[4:7]
 ds_read_b64_tr_b16 a[212:213], v11 offset:8192
 ds_read_b64_tr_b16 a[214:215], v11 offset:12288
 v_mfma_f32_16x16x32_bf16 a[4:7], a[192:195], v[104:107], a[4:7]
 v_exp_f32 v180, v180
 v_mfma_f32_16x16x32_bf16 a[8:11], a[192:195], v[112:115], a[8:11]
 v_exp_f32 v181, v181
 v_mfma_f32_16x16x32_bf16 a[8:11], a[196:199], v[116:119], a[8:11]
 v_exp_f32 v182, v182
 v_mfma_f32_16x16x32_bf16 a[12:15], a[196:199], v[124:127], a[12:15]
 v_exp_f32 v183, v183
 v_mfma_f32_16x16x32_bf16 a[12:15], a[192:195], v[120:123], a[12:15]
 s_waitcnt lgkmcnt(4)
 v_exp_f32 v184, v184
 v_mfma_f32_16x16x32_bf16 a[28:31], a[200:203], v[120:123], a[28:31]
 ds_read_b64_tr_b16 a[216:217], v12 offset:0
 ds_read_b64_tr_b16 a[218:219], v12 offset:4096
 v_mfma_f32_16x16x32_bf16 a[28:31], a[204:207], v[124:127], a[28:31]
 buffer_load_dwordx4 v18, s[24:27], s91 offen offset:1024 sc1 lds
 v_mfma_f32_16x16x32_bf16 a[24:27], a[204:207], v[116:119], a[24:27]
 ds_read_b64_tr_b16 a[220:221], v12 offset:8192
 ds_read_b64_tr_b16 a[222:223], v12 offset:12288
 v_mfma_f32_16x16x32_bf16 a[24:27], a[200:203], v[112:115], a[24:27]
 v_exp_f32 v185, v185
 v_mfma_f32_16x16x32_bf16 a[20:23], a[200:203], v[104:107], a[20:23]
 v_exp_f32 v186, v186
 v_mfma_f32_16x16x32_bf16 a[20:23], a[204:207], v[108:111], a[20:23]
 v_exp_f32 v187, v187
 v_mfma_f32_16x16x32_bf16 a[16:19], a[204:207], v[100:103], a[16:19]
 v_exp_f32 v188, v188
 v_mfma_f32_16x16x32_bf16 a[16:19], a[200:203], v[96:99], a[16:19]
 s_waitcnt lgkmcnt(4)
 v_exp_f32 v189, v189
 v_mfma_f32_16x16x32_bf16 a[32:35], a[208:211], v[96:99], a[32:35]
 ds_read_b64_tr_b16 a[192:193], v13 offset:0
 ds_read_b64_tr_b16 a[194:195], v13 offset:4096
 v_mfma_f32_16x16x32_bf16 a[32:35], a[212:215], v[100:103], a[32:35]
 buffer_load_dwordx4 v18, s[24:27], s91 offen offset:2048 sc1 lds
 v_mfma_f32_16x16x32_bf16 a[36:39], a[212:215], v[108:111], a[36:39]
 ds_read_b64_tr_b16 a[196:197], v13 offset:8192
 ds_read_b64_tr_b16 a[198:199], v13 offset:12288
 v_mfma_f32_16x16x32_bf16 a[36:39], a[208:211], v[104:107], a[36:39]
 v_exp_f32 v190, v190
 v_mfma_f32_16x16x32_bf16 a[40:43], a[208:211], v[112:115], a[40:43]
 v_exp_f32 v191, v191
 v_mfma_f32_16x16x32_bf16 a[40:43], a[212:215], v[116:119], a[40:43]
 v_cvt_pk_bf16_f32 v90, v144, v145
 v_cvt_pk_bf16_f32 v91, v146, v147
 v_mfma_f32_16x16x32_bf16 a[44:47], a[212:215], v[124:127], a[44:47]
 v_cvt_pk_bf16_f32 v82, v148, v149
 v_cvt_pk_bf16_f32 v83, v150, v151
 v_mfma_f32_16x16x32_bf16 a[44:47], a[208:211], v[120:123], a[44:47]
 s_waitcnt lgkmcnt(4)
 v_cvt_pk_bf16_f32 v74, v152, v153
 v_cvt_pk_bf16_f32 v75, v154, v155
 v_mfma_f32_16x16x32_bf16 a[60:63], a[216:219], v[120:123], a[60:63]
 ds_read_b64_tr_b16 a[200:201], v14 offset:0
 ds_read_b64_tr_b16 a[202:203], v14 offset:4096
 v_mfma_f32_16x16x32_bf16 a[60:63], a[220:223], v[124:127], a[60:63]
 buffer_load_dwordx4 v18, s[24:27], s91 offen offset:3072 sc1 lds
 v_mfma_f32_16x16x32_bf16 a[56:59], a[220:223], v[116:119], a[56:59]
 ds_read_b64_tr_b16 a[204:205], v14 offset:8192
 ds_read_b64_tr_b16 a[206:207], v14 offset:12288
 v_mfma_f32_16x16x32_bf16 a[56:59], a[216:219], v[112:115], a[56:59]
 v_cvt_pk_bf16_f32 v66, v156, v157
 v_cvt_pk_bf16_f32 v67, v158, v159
 v_mfma_f32_16x16x32_bf16 a[52:55], a[216:219], v[104:107], a[52:55]
 v_cvt_pk_bf16_f32 v68, v160, v161
 v_cvt_pk_bf16_f32 v69, v162, v163
 v_mfma_f32_16x16x32_bf16 a[52:55], a[220:223], v[108:111], a[52:55]
 v_cvt_pk_bf16_f32 v76, v164, v165
 v_cvt_pk_bf16_f32 v77, v166, v167
 v_mfma_f32_16x16x32_bf16 a[48:51], a[220:223], v[100:103], a[48:51]
 v_cvt_pk_bf16_f32 v84, v168, v169
 v_cvt_pk_bf16_f32 v85, v170, v171
 v_mfma_f32_16x16x32_bf16 a[48:51], a[216:219], v[96:99], a[48:51]
 s_waitcnt lgkmcnt(4)
 v_cvt_pk_bf16_f32 v92, v172, v173
 v_cvt_pk_bf16_f32 v93, v174, v175
 v_mfma_f32_16x16x32_bf16 a[64:67], a[192:195], v[96:99], a[64:67]
 s_add_u32 s91, s51, 16384
 s_add_u32 m0, s47, 32768
 ds_read_b64_tr_b16 a[208:209], v15 offset:0
 ds_read_b64_tr_b16 a[210:211], v15 offset:4096
 v_mfma_f32_16x16x32_bf16 a[64:67], a[196:199], v[100:103], a[64:67]
 buffer_load_dwordx4 v18, s[24:27], s91 offen offset:0 sc1 lds
 v_mfma_f32_16x16x32_bf16 a[68:71], a[196:199], v[108:111], a[68:71]
 ds_read_b64_tr_b16 a[212:213], v15 offset:8192
 ds_read_b64_tr_b16 a[214:215], v15 offset:12288
 v_mfma_f32_16x16x32_bf16 a[68:71], a[192:195], v[104:107], a[68:71]
 v_cvt_pk_bf16_f32 v94, v176, v177
 v_cvt_pk_bf16_f32 v95, v178, v179
 v_mfma_f32_16x16x32_bf16 a[72:75], a[192:195], v[112:115], a[72:75]
 v_cvt_pk_bf16_f32 v86, v180, v181
 v_cvt_pk_bf16_f32 v87, v182, v183
 v_mfma_f32_16x16x32_bf16 a[72:75], a[196:199], v[116:119], a[72:75]
 v_cvt_pk_bf16_f32 v78, v184, v185
 v_cvt_pk_bf16_f32 v79, v186, v187
 v_mfma_f32_16x16x32_bf16 a[76:79], a[196:199], v[124:127], a[76:79]
 v_cvt_pk_bf16_f32 v70, v188, v189
 v_cvt_pk_bf16_f32 v71, v190, v191
 v_mfma_f32_16x16x32_bf16 a[76:79], a[192:195], v[120:123], a[76:79]
 s_waitcnt lgkmcnt(4)
 v_mfma_f32_16x16x32_bf16 a[92:95], a[200:203], v[120:123], a[92:95]
 ds_read_b64_tr_b16 a[216:217], v16 offset:0
 ds_read_b64_tr_b16 a[218:219], v16 offset:4096
 v_mfma_f32_16x16x32_bf16 a[92:95], a[204:207], v[124:127], a[92:95]
 buffer_load_dwordx4 v18, s[24:27], s91 offen offset:1024 sc1 lds
 v_mfma_f32_16x16x32_bf16 a[88:91], a[204:207], v[116:119], a[88:91]
 ds_read_b64_tr_b16 a[220:221], v16 offset:8192
 ds_read_b64_tr_b16 a[222:223], v16 offset:12288
 v_mfma_f32_16x16x32_bf16 a[88:91], a[200:203], v[112:115], a[88:91]
 v_mfma_f32_16x16x32_bf16 a[84:87], a[200:203], v[104:107], a[84:87]
 v_mfma_f32_16x16x32_bf16 a[84:87], a[204:207], v[108:111], a[84:87]
 v_mfma_f32_16x16x32_bf16 a[80:83], a[204:207], v[100:103], a[80:83]
 v_mfma_f32_16x16x32_bf16 a[80:83], a[200:203], v[96:99], a[80:83]
 s_waitcnt lgkmcnt(4)
 v_mfma_f32_16x16x32_bf16 a[96:99], a[208:211], v[96:99], a[96:99]
 ds_read_b128 a[128:131], v5 offset:32768
 ds_read_b128 a[132:135], v6 offset:32768
 v_mfma_f32_16x16x32_bf16 a[96:99], a[212:215], v[100:103], a[96:99]
 buffer_load_dwordx4 v18, s[24:27], s91 offen offset:2048 sc1 lds
 v_mfma_f32_16x16x32_bf16 a[100:103], a[212:215], v[108:111], a[100:103]
 ds_read_b128 a[136:139], v7 offset:32768
 ds_read_b128 a[140:143], v8 offset:32768
 v_mfma_f32_16x16x32_bf16 a[100:103], a[208:211], v[104:107], a[100:103]
 v_mfma_f32_16x16x32_bf16 a[104:107], a[208:211], v[112:115], a[104:107]
 v_mfma_f32_16x16x32_bf16 a[104:107], a[212:215], v[116:119], a[104:107]
 v_mfma_f32_16x16x32_bf16 a[108:111], a[212:215], v[124:127], a[108:111]
 v_mfma_f32_16x16x32_bf16 a[108:111], a[208:211], v[120:123], a[108:111]
 s_waitcnt lgkmcnt(4)
 v_mfma_f32_16x16x32_bf16 a[124:127], a[216:219], v[120:123], a[124:127]
 ds_read_b128 a[144:147], v5 offset:36864
 ds_read_b128 a[148:151], v6 offset:36864
 v_mfma_f32_16x16x32_bf16 a[124:127], a[220:223], v[124:127], a[124:127]
 buffer_load_dwordx4 v18, s[24:27], s91 offen offset:3072 sc1 lds
 v_mfma_f32_16x16x32_bf16 a[120:123], a[220:223], v[116:119], a[120:123]
 ds_read_b128 a[152:155], v7 offset:36864
 ds_read_b128 a[156:159], v8 offset:36864
 v_mfma_f32_16x16x32_bf16 a[120:123], a[216:219], v[112:115], a[120:123]
 v_mfma_f32_16x16x32_bf16 a[116:119], a[216:219], v[104:107], a[116:119]
 v_mfma_f32_16x16x32_bf16 a[116:119], a[220:223], v[108:111], a[116:119]
 v_mfma_f32_16x16x32_bf16 a[112:115], a[220:223], v[100:103], a[112:115]
 v_mfma_f32_16x16x32_bf16 a[112:115], a[216:219], v[96:99], a[112:115]
 s_waitcnt lgkmcnt(4)
 v_mfma_f32_16x16x32_bf16 v[128:131], a[128:131], v[192:195], v[48:51]
 ds_read_b128 a[160:163], v5 offset:40960
 v_mov_b32 v21, v18
 v_mfma_f32_16x16x32_bf16 v[128:131], a[132:135], v[208:211], v[128:131]
 ds_read_b128 a[164:167], v6 offset:40960
 v_add_u32 v22, 57344, v18
 v_mfma_f32_16x16x32_bf16 v[128:131], a[136:139], v[224:227], v[128:131]
 ds_read_b128 a[168:171], v7 offset:40960
 v_mfma_f32_16x16x32_bf16 v[128:131], a[140:143], v[240:243], v[128:131]
 ds_read_b128 a[172:175], v8 offset:40960
 v_mfma_f32_16x16x32_bf16 v[132:135], a[140:143], v[244:247], v[52:55]
 ds_read_b128 a[176:179], v5 offset:45056
 v_mfma_f32_16x16x32_bf16 v[132:135], a[136:139], v[228:231], v[132:135]
 ds_read_b128 a[180:183], v6 offset:45056
 v_mfma_f32_16x16x32_bf16 v[132:135], a[132:135], v[212:215], v[132:135]
 ds_read_b128 a[184:187], v7 offset:45056
 v_mfma_f32_16x16x32_bf16 v[132:135], a[128:131], v[196:199], v[132:135]
 ds_read_b128 a[188:191], v8 offset:45056
 v_mfma_f32_16x16x32_bf16 v[136:139], a[128:131], v[200:203], v[56:59]
 v_exp_f32 v128, v128
 v_mfma_f32_16x16x32_bf16 v[136:139], a[132:135], v[216:219], v[136:139]
 v_exp_f32 v129, v129
 v_mfma_f32_16x16x32_bf16 v[136:139], a[136:139], v[232:235], v[136:139]
 v_exp_f32 v130, v130
 v_mfma_f32_16x16x32_bf16 v[136:139], a[140:143], v[248:251], v[136:139]
 v_exp_f32 v131, v131
 v_mfma_f32_16x16x32_bf16 v[140:143], a[140:143], v[252:255], v[60:63]
 v_exp_f32 v132, v132
 v_mfma_f32_16x16x32_bf16 v[140:143], a[136:139], v[236:239], v[140:143]
 v_exp_f32 v133, v133
 v_mfma_f32_16x16x32_bf16 v[140:143], a[132:135], v[220:223], v[140:143]
 v_exp_f32 v134, v134
 v_mfma_f32_16x16x32_bf16 v[140:143], a[128:131], v[204:207], v[140:143]
 s_waitcnt lgkmcnt(8)
 v_exp_f32 v135, v135
 v_mfma_f32_16x16x32_bf16 v[144:147], a[144:147], v[204:207], v[60:63]
 v_exp_f32 v136, v136
 v_mfma_f32_16x16x32_bf16 v[144:147], a[148:151], v[220:223], v[144:147]
 v_exp_f32 v137, v137
 v_mfma_f32_16x16x32_bf16 v[144:147], a[152:155], v[236:239], v[144:147]
 v_exp_f32 v138, v138
 v_mfma_f32_16x16x32_bf16 v[144:147], a[156:159], v[252:255], v[144:147]
 v_exp_f32 v139, v139
 v_mfma_f32_16x16x32_bf16 v[148:151], a[156:159], v[248:251], v[56:59]
 v_exp_f32 v140, v140
 v_mfma_f32_16x16x32_bf16 v[148:151], a[152:155], v[232:235], v[148:151]
 v_exp_f32 v141, v141
 v_mfma_f32_16x16x32_bf16 v[148:151], a[148:151], v[216:219], v[148:151]
 v_exp_f32 v142, v142
 v_mfma_f32_16x16x32_bf16 v[148:151], a[144:147], v[200:203], v[148:151]
 v_exp_f32 v143, v143
 v_mfma_f32_16x16x32_bf16 v[152:155], a[144:147], v[196:199], v[52:55]
 v_exp_f32 v144, v144
 v_mfma_f32_16x16x32_bf16 v[152:155], a[148:151], v[212:215], v[152:155]
 v_exp_f32 v145, v145
 v_mfma_f32_16x16x32_bf16 v[152:155], a[152:155], v[228:231], v[152:155]
 v_exp_f32 v146, v146
 v_mfma_f32_16x16x32_bf16 v[152:155], a[156:159], v[244:247], v[152:155]
 v_exp_f32 v147, v147
 v_mfma_f32_16x16x32_bf16 v[156:159], a[156:159], v[240:243], v[48:51]
 v_exp_f32 v148, v148
 v_mfma_f32_16x16x32_bf16 v[156:159], a[152:155], v[224:227], v[156:159]
 v_exp_f32 v149, v149
 v_mfma_f32_16x16x32_bf16 v[156:159], a[148:151], v[208:211], v[156:159]
 v_exp_f32 v150, v150
 v_mfma_f32_16x16x32_bf16 v[156:159], a[144:147], v[192:195], v[156:159]
 s_waitcnt lgkmcnt(4)
 v_exp_f32 v151, v151
 v_mfma_f32_16x16x32_bf16 v[160:163], a[160:163], v[192:195], v[48:51]
 v_exp_f32 v152, v152
 v_mfma_f32_16x16x32_bf16 v[160:163], a[164:167], v[208:211], v[160:163]
 v_exp_f32 v153, v153
 v_mfma_f32_16x16x32_bf16 v[160:163], a[168:171], v[224:227], v[160:163]
 v_exp_f32 v154, v154
 v_mfma_f32_16x16x32_bf16 v[160:163], a[172:175], v[240:243], v[160:163]
 v_exp_f32 v155, v155
 v_mfma_f32_16x16x32_bf16 v[164:167], a[172:175], v[244:247], v[52:55]
 v_exp_f32 v156, v156
 v_mfma_f32_16x16x32_bf16 v[164:167], a[168:171], v[228:231], v[164:167]
 v_exp_f32 v157, v157
 v_mfma_f32_16x16x32_bf16 v[164:167], a[164:167], v[212:215], v[164:167]
 v_exp_f32 v158, v158
 v_mfma_f32_16x16x32_bf16 v[164:167], a[160:163], v[196:199], v[164:167]
 v_exp_f32 v159, v159
 v_mfma_f32_16x16x32_bf16 v[168:171], a[160:163], v[200:203], v[56:59]
 v_exp_f32 v160, v160
 v_mfma_f32_16x16x32_bf16 v[168:171], a[164:167], v[216:219], v[168:171]
 v_exp_f32 v161, v161
 v_mfma_f32_16x16x32_bf16 v[168:171], a[168:171], v[232:235], v[168:171]
 v_exp_f32 v162, v162
 v_mfma_f32_16x16x32_bf16 v[168:171], a[172:175], v[248:251], v[168:171]
 v_exp_f32 v163, v163
 v_mfma_f32_16x16x32_bf16 v[172:175], a[172:175], v[252:255], v[60:63]
 ds_read_b64_tr_b16 a[192:193], v9 offset:16384
 v_cvt_pk_bf16_f32 v96, v128, v129
 v_mfma_f32_16x16x32_bf16 v[172:175], a[168:171], v[236:239], v[172:175]
 v_exp_f32 v164, v164
 v_mfma_f32_16x16x32_bf16 v[172:175], a[164:167], v[220:223], v[172:175]
 ds_read_b64_tr_b16 a[194:195], v9 offset:20480
 v_cvt_pk_bf16_f32 v97, v130, v131
 v_mfma_f32_16x16x32_bf16 v[172:175], a[160:163], v[204:207], v[172:175]
 s_waitcnt lgkmcnt(2)
 v_exp_f32 v165, v165
 v_mfma_f32_16x16x32_bf16 v[176:179], a[176:179], v[204:207], v[60:63]
 ds_read_b64_tr_b16 a[196:197], v9 offset:24576
 v_cvt_pk_bf16_f32 v104, v132, v133
 v_mfma_f32_16x16x32_bf16 v[176:179], a[180:183], v[220:223], v[176:179]
 v_exp_f32 v166, v166
 v_mfma_f32_16x16x32_bf16 v[176:179], a[184:187], v[236:239], v[176:179]
 ds_read_b64_tr_b16 a[198:199], v9 offset:28672
 v_cvt_pk_bf16_f32 v105, v134, v135
 v_mfma_f32_16x16x32_bf16 v[176:179], a[188:191], v[252:255], v[176:179]
 v_exp_f32 v167, v167
 v_mfma_f32_16x16x32_bf16 v[180:183], a[188:191], v[248:251], v[56:59]
 ds_read_b64_tr_b16 a[200:201], v10 offset:16384
 v_cvt_pk_bf16_f32 v112, v136, v137
 v_mfma_f32_16x16x32_bf16 v[180:183], a[184:187], v[232:235], v[180:183]
 v_exp_f32 v168, v168
 v_mfma_f32_16x16x32_bf16 v[180:183], a[180:183], v[216:219], v[180:183]
 ds_read_b64_tr_b16 a[202:203], v10 offset:20480
 v_cvt_pk_bf16_f32 v113, v138, v139
 v_mfma_f32_16x16x32_bf16 v[180:183], a[176:179], v[200:203], v[180:183]
 v_exp_f32 v169, v169
 v_mfma_f32_16x16x32_bf16 v[184:187], a[176:179], v[196:199], v[52:55]
 ds_read_b64_tr_b16 a[204:205], v10 offset:24576
 v_cvt_pk_bf16_f32 v120, v140, v141
 v_mfma_f32_16x16x32_bf16 v[184:187], a[180:183], v[212:215], v[184:187]
 v_exp_f32 v170, v170
 v_mfma_f32_16x16x32_bf16 v[184:187], a[184:187], v[228:231], v[184:187]
 ds_read_b64_tr_b16 a[206:207], v10 offset:28672
 v_cvt_pk_bf16_f32 v121, v142, v143
 v_mfma_f32_16x16x32_bf16 v[184:187], a[188:191], v[244:247], v[184:187]
 v_exp_f32 v171, v171
 v_mfma_f32_16x16x32_bf16 v[188:191], a[188:191], v[240:243], v[48:51]
 v_exp_f32 v172, v172
 v_mfma_f32_16x16x32_bf16 v[188:191], a[184:187], v[224:227], v[188:191]
 v_exp_f32 v173, v173
 v_mfma_f32_16x16x32_bf16 v[188:191], a[180:183], v[208:211], v[188:191]
 s_waitcnt vmcnt(16)
 v_exp_f32 v174, v174
 v_mfma_f32_16x16x32_bf16 v[188:191], a[176:179], v[192:195], v[188:191]
 s_barrier
 v_exp_f32 v175, v175
 v_smfmac_f32_16x16x64_bf16 v[32:35], a[224:227], v[64:71], v17
 v_exp_f32 v176, v176
 v_smfmac_f32_16x16x64_bf16 v[36:39], a[224:227], v[72:79], v17
 v_exp_f32 v177, v177
 v_smfmac_f32_16x16x64_bf16 v[40:43], a[224:227], v[80:87], v17
 v_exp_f32 v178, v178
 buffer_load_dwordx4 a[128:131], v21, s[32:35], s52 offen offset:0 sc1
 v_smfmac_f32_16x16x64_bf16 v[44:47], a[224:227], v[88:95], v17
 s_waitcnt lgkmcnt(4)
 v_exp_f32 v179, v179
 v_mfma_f32_16x16x32_bf16 a[0:3], a[192:195], v[64:67], a[0:3]
 s_add_u32 s91, s56, 49152
 s_add_u32 m0, s47, 98304
 ds_read_b64_tr_b16 a[208:209], v11 offset:16384
 ds_read_b64_tr_b16 a[210:211], v11 offset:20480
 v_mfma_f32_16x16x32_bf16 a[0:3], a[196:199], v[68:71], a[0:3]
 buffer_load_dwordx4 v18, s[24:27], s91 offen offset:0 sc1 lds
 v_mfma_f32_16x16x32_bf16 a[4:7], a[196:199], v[76:79], a[4:7]
 ds_read_b64_tr_b16 a[212:213], v11 offset:24576
 ds_read_b64_tr_b16 a[214:215], v11 offset:28672
 v_mfma_f32_16x16x32_bf16 a[4:7], a[192:195], v[72:75], a[4:7]
 v_exp_f32 v180, v180
 v_mfma_f32_16x16x32_bf16 a[8:11], a[192:195], v[80:83], a[8:11]
 v_exp_f32 v181, v181
 buffer_load_dwordx4 a[132:135], v21, s[32:35], s52 offen offset:1024 sc1
 v_mfma_f32_16x16x32_bf16 a[8:11], a[196:199], v[84:87], a[8:11]
 v_exp_f32 v182, v182
 v_mfma_f32_16x16x32_bf16 a[12:15], a[196:199], v[92:95], a[12:15]
 v_exp_f32 v183, v183
 buffer_load_dwordx4 a[136:139], v22, s[32:35], s52 offen offset:0 sc1
 v_mfma_f32_16x16x32_bf16 a[12:15], a[192:195], v[88:91], a[12:15]
 s_waitcnt lgkmcnt(4)
 v_exp_f32 v184, v184
 v_mfma_f32_16x16x32_bf16 a[28:31], a[200:203], v[88:91], a[28:31]
 ds_read_b64_tr_b16 a[216:217], v12 offset:16384
 ds_read_b64_tr_b16 a[218:219], v12 offset:20480
 v_mfma_f32_16x16x32_bf16 a[28:31], a[204:207], v[92:95], a[28:31]
 buffer_load_dwordx4 v18, s[24:27], s91 offen offset:1024 sc1 lds
 v_mfma_f32_16x16x32_bf16 a[24:27], a[204:207], v[84:87], a[24:27]
 ds_read_b64_tr_b16 a[220:221], v12 offset:24576
 ds_read_b64_tr_b16 a[222:223], v12 offset:28672
 v_mfma_f32_16x16x32_bf16 a[24:27], a[200:203], v[80:83], a[24:27]
 v_exp_f32 v185, v185
 v_mfma_f32_16x16x32_bf16 a[20:23], a[200:203], v[72:75], a[20:23]
 v_exp_f32 v186, v186
 buffer_load_dwordx4 a[140:143], v22, s[32:35], s52 offen offset:1024 sc1
 v_mfma_f32_16x16x32_bf16 a[20:23], a[204:207], v[76:79], a[20:23]
 s_add_u32 s52, s52, 2048
 v_exp_f32 v187, v187
 v_mfma_f32_16x16x32_bf16 a[16:19], a[204:207], v[68:71], a[16:19]
 v_exp_f32 v188, v188
 buffer_load_dwordx4 a[144:147], v21, s[32:35], s52 offen offset:0 sc1
 v_mfma_f32_16x16x32_bf16 a[16:19], a[200:203], v[64:67], a[16:19]
 s_waitcnt lgkmcnt(4)
 v_exp_f32 v189, v189
 v_mfma_f32_16x16x32_bf16 a[32:35], a[208:211], v[64:67], a[32:35]
 ds_read_b64_tr_b16 a[192:193], v13 offset:16384
 ds_read_b64_tr_b16 a[194:195], v13 offset:20480
 v_mfma_f32_16x16x32_bf16 a[32:35], a[212:215], v[68:71], a[32:35]
 buffer_load_dwordx4 v18, s[24:27], s91 offen offset:2048 sc1 lds
 v_mfma_f32_16x16x32_bf16 a[36:39], a[212:215], v[76:79], a[36:39]
 ds_read_b64_tr_b16 a[196:197], v13 offset:24576
 ds_read_b64_tr_b16 a[198:199], v13 offset:28672
 v_mfma_f32_16x16x32_bf16 a[36:39], a[208:211], v[72:75], a[36:39]
 v_exp_f32 v190, v190
 v_mfma_f32_16x16x32_bf16 a[40:43], a[208:211], v[80:83], a[40:43]
 v_exp_f32 v191, v191
 buffer_load_dwordx4 a[148:151], v21, s[32:35], s52 offen offset:1024 sc1
 v_mfma_f32_16x16x32_bf16 a[40:43], a[212:215], v[84:87], a[40:43]
 v_cvt_pk_bf16_f32 v122, v144, v145
 v_cvt_pk_bf16_f32 v123, v146, v147
 v_mfma_f32_16x16x32_bf16 a[44:47], a[212:215], v[92:95], a[44:47]
 v_cvt_pk_bf16_f32 v114, v148, v149
 v_cvt_pk_bf16_f32 v115, v150, v151
 buffer_load_dwordx4 a[152:155], v22, s[32:35], s52 offen offset:0 sc1
 v_mfma_f32_16x16x32_bf16 a[44:47], a[208:211], v[88:91], a[44:47]
 s_waitcnt lgkmcnt(4)
 v_cvt_pk_bf16_f32 v106, v152, v153
 v_cvt_pk_bf16_f32 v107, v154, v155
 v_mfma_f32_16x16x32_bf16 a[60:63], a[216:219], v[88:91], a[60:63]
 ds_read_b64_tr_b16 a[200:201], v14 offset:16384
 ds_read_b64_tr_b16 a[202:203], v14 offset:20480
 v_mfma_f32_16x16x32_bf16 a[60:63], a[220:223], v[92:95], a[60:63]
 buffer_load_dwordx4 v18, s[24:27], s91 offen offset:3072 sc1 lds
 v_mfma_f32_16x16x32_bf16 a[56:59], a[220:223], v[84:87], a[56:59]
 ds_read_b64_tr_b16 a[204:205], v14 offset:24576
 ds_read_b64_tr_b16 a[206:207], v14 offset:28672
 v_mfma_f32_16x16x32_bf16 a[56:59], a[216:219], v[80:83], a[56:59]
 v_cvt_pk_bf16_f32 v98, v156, v157
 v_cvt_pk_bf16_f32 v99, v158, v159
 v_mfma_f32_16x16x32_bf16 a[52:55], a[216:219], v[72:75], a[52:55]
 v_cvt_pk_bf16_f32 v100, v160, v161
 v_cvt_pk_bf16_f32 v101, v162, v163
 buffer_load_dwordx4 a[156:159], v22, s[32:35], s52 offen offset:1024 sc1
 v_mfma_f32_16x16x32_bf16 a[52:55], a[220:223], v[76:79], a[52:55]
 s_add_u32 s52, s52, 2048
 v_cvt_pk_bf16_f32 v108, v164, v165
 v_cvt_pk_bf16_f32 v109, v166, v167
 v_mfma_f32_16x16x32_bf16 a[48:51], a[220:223], v[68:71], a[48:51]
 v_cvt_pk_bf16_f32 v116, v168, v169
 v_cvt_pk_bf16_f32 v117, v170, v171
 buffer_load_dwordx4 a[160:163], v21, s[32:35], s52 offen offset:0 sc1
 v_mfma_f32_16x16x32_bf16 a[48:51], a[216:219], v[64:67], a[48:51]
 s_waitcnt lgkmcnt(4)
 v_cvt_pk_bf16_f32 v124, v172, v173
 v_cvt_pk_bf16_f32 v125, v174, v175
 v_mfma_f32_16x16x32_bf16 a[64:67], a[192:195], v[64:67], a[64:67]
 s_add_u32 s91, s51, 24576
 s_add_u32 m0, s47, 49152
 ds_read_b64_tr_b16 a[208:209], v15 offset:16384
 ds_read_b64_tr_b16 a[210:211], v15 offset:20480
 v_mfma_f32_16x16x32_bf16 a[64:67], a[196:199], v[68:71], a[64:67]
 buffer_load_dwordx4 v18, s[24:27], s91 offen offset:0 sc1 lds
 v_mfma_f32_16x16x32_bf16 a[68:71], a[196:199], v[76:79], a[68:71]
 ds_read_b64_tr_b16 a[212:213], v15 offset:24576
 ds_read_b64_tr_b16 a[214:215], v15 offset:28672
 v_mfma_f32_16x16x32_bf16 a[68:71], a[192:195], v[72:75], a[68:71]
 v_cvt_pk_bf16_f32 v126, v176, v177
 v_cvt_pk_bf16_f32 v127, v178, v179
 v_mfma_f32_16x16x32_bf16 a[72:75], a[192:195], v[80:83], a[72:75]
 v_cvt_pk_bf16_f32 v118, v180, v181
 v_cvt_pk_bf16_f32 v119, v182, v183
 buffer_load_dwordx4 a[164:167], v21, s[32:35], s52 offen offset:1024 sc1
 v_mfma_f32_16x16x32_bf16 a[72:75], a[196:199], v[84:87], a[72:75]
 v_cvt_pk_bf16_f32 v110, v184, v185
 v_cvt_pk_bf16_f32 v111, v186, v187
 v_mfma_f32_16x16x32_bf16 a[76:79], a[196:199], v[92:95], a[76:79]
 v_cvt_pk_bf16_f32 v102, v188, v189
 v_cvt_pk_bf16_f32 v103, v190, v191
 buffer_load_dwordx4 a[168:171], v22, s[32:35], s52 offen offset:0 sc1
 v_mfma_f32_16x16x32_bf16 a[76:79], a[192:195], v[88:91], a[76:79]
 s_waitcnt lgkmcnt(4)
 v_mfma_f32_16x16x32_bf16 a[92:95], a[200:203], v[88:91], a[92:95]
 ds_read_b64_tr_b16 a[216:217], v16 offset:16384
 ds_read_b64_tr_b16 a[218:219], v16 offset:20480
 v_mfma_f32_16x16x32_bf16 a[92:95], a[204:207], v[92:95], a[92:95]
 buffer_load_dwordx4 v18, s[24:27], s91 offen offset:1024 sc1 lds
 v_mfma_f32_16x16x32_bf16 a[88:91], a[204:207], v[84:87], a[88:91]
 ds_read_b64_tr_b16 a[220:221], v16 offset:24576
 ds_read_b64_tr_b16 a[222:223], v16 offset:28672
 v_mfma_f32_16x16x32_bf16 a[88:91], a[200:203], v[80:83], a[88:91]
 v_mfma_f32_16x16x32_bf16 a[84:87], a[200:203], v[72:75], a[84:87]
 buffer_load_dwordx4 a[172:175], v22, s[32:35], s52 offen offset:1024 sc1
 v_mfma_f32_16x16x32_bf16 a[84:87], a[204:207], v[76:79], a[84:87]
 s_add_u32 s52, s52, 2048
 v_mfma_f32_16x16x32_bf16 a[80:83], a[204:207], v[68:71], a[80:83]
 buffer_load_dwordx4 a[176:179], v21, s[32:35], s52 offen offset:0 sc1
 v_mfma_f32_16x16x32_bf16 a[80:83], a[200:203], v[64:67], a[80:83]
 s_waitcnt lgkmcnt(4)
 v_mfma_f32_16x16x32_bf16 a[96:99], a[208:211], v[64:67], a[96:99]
 v_mfma_f32_16x16x32_bf16 a[96:99], a[212:215], v[68:71], a[96:99]
 buffer_load_dwordx4 v18, s[24:27], s91 offen offset:2048 sc1 lds
 v_mfma_f32_16x16x32_bf16 a[100:103], a[212:215], v[76:79], a[100:103]
 v_mfma_f32_16x16x32_bf16 a[100:103], a[208:211], v[72:75], a[100:103]
 buffer_load_dwordx4 a[180:183], v21, s[32:35], s52 offen offset:1024 sc1
 v_mfma_f32_16x16x32_bf16 a[104:107], a[208:211], v[80:83], a[104:107]
 v_mfma_f32_16x16x32_bf16 a[104:107], a[212:215], v[84:87], a[104:107]
 v_mfma_f32_16x16x32_bf16 a[108:111], a[212:215], v[92:95], a[108:111]
 buffer_load_dwordx4 a[184:187], v22, s[32:35], s52 offen offset:0 sc1
 v_mfma_f32_16x16x32_bf16 a[108:111], a[208:211], v[88:91], a[108:111]
 s_waitcnt lgkmcnt(0)
 v_mfma_f32_16x16x32_bf16 a[124:127], a[216:219], v[88:91], a[124:127]
 v_mfma_f32_16x16x32_bf16 a[124:127], a[220:223], v[92:95], a[124:127]
 buffer_load_dwordx4 v18, s[24:27], s91 offen offset:3072 sc1 lds
 v_mfma_f32_16x16x32_bf16 a[120:123], a[220:223], v[84:87], a[120:123]
 v_mfma_f32_16x16x32_bf16 a[120:123], a[216:219], v[80:83], a[120:123]
 v_mfma_f32_16x16x32_bf16 a[116:119], a[216:219], v[72:75], a[116:119]
 buffer_load_dwordx4 a[188:191], v22, s[32:35], s52 offen offset:1024 sc1
 v_mfma_f32_16x16x32_bf16 a[116:119], a[220:223], v[76:79], a[116:119]
 s_add_u32 s52, s52, 2048
 v_mfma_f32_16x16x32_bf16 a[112:115], a[220:223], v[68:71], a[112:115]
 v_mfma_f32_16x16x32_bf16 a[112:115], a[216:219], v[64:67], a[112:115]
 ds_read_b64_tr_b16 a[192:193], v9 offset:32768
 ds_read_b64_tr_b16 a[194:195], v9 offset:36864
 ds_read_b64_tr_b16 a[196:197], v9 offset:40960
 ds_read_b64_tr_b16 a[198:199], v9 offset:45056
 ds_read_b64_tr_b16 a[200:201], v10 offset:32768
 ds_read_b64_tr_b16 a[202:203], v10 offset:36864
 ds_read_b64_tr_b16 a[204:205], v10 offset:40960
 ds_read_b64_tr_b16 a[206:207], v10 offset:45056
 v_smfmac_f32_16x16x64_bf16 v[32:35], a[224:227], v[96:103], v17
 v_mov_b32 v23, v18
 v_add_u32 v24, 131072, v18
 v_smfmac_f32_16x16x64_bf16 v[36:39], a[224:227], v[104:111], v17
 v_add_u32 v25, 0x10000, v18
 v_add_u32 v76, 0, v18
 v_smfmac_f32_16x16x64_bf16 v[40:43], a[224:227], v[112:119], v17
 v_mov_b32 v80, 0
 v_mov_b32 v81, 0
 v_smfmac_f32_16x16x64_bf16 v[44:47], a[224:227], v[120:127], v17
 s_waitcnt lgkmcnt(4)
 v_add_u32 v77, 131072, v18
 v_mov_b32 v82, 0
 v_mfma_f32_16x16x32_bf16 a[0:3], a[192:195], v[96:99], a[0:3]
 ds_read_b64_tr_b16 a[208:209], v11 offset:32768
 ds_read_b64_tr_b16 a[210:211], v11 offset:36864
 v_mfma_f32_16x16x32_bf16 a[0:3], a[196:199], v[100:103], a[0:3]
 v_mov_b32 v83, 0
 v_add_u32 v78, 262144, v18
 v_mfma_f32_16x16x32_bf16 a[4:7], a[196:199], v[108:111], a[4:7]
 ds_read_b64_tr_b16 a[212:213], v11 offset:40960
 ds_read_b64_tr_b16 a[214:215], v11 offset:45056
 v_mfma_f32_16x16x32_bf16 a[4:7], a[192:195], v[104:107], a[4:7]
 v_mov_b32 v84, 0
 v_mov_b32 v85, 0
 v_mfma_f32_16x16x32_bf16 a[8:11], a[192:195], v[112:115], a[8:11]
 s_lshl_b32 s58, s46, 2
 v_add_u32 v79, 393216, v18
 v_mov_b32 v86, 0
 v_mfma_f32_16x16x32_bf16 a[8:11], a[196:199], v[116:119], a[8:11]
 s_add_u32 s58, s58, s44
 v_mov_b32 v87, 0
 v_add_f32 v64, v32, v33
 v_mfma_f32_16x16x32_bf16 a[12:15], a[196:199], v[124:127], a[12:15]
 s_lshl_b32 s58, s58, 19
 v_add_f32 v65, v36, v37
 v_add_f32 v66, v40, v41
 v_mfma_f32_16x16x32_bf16 a[12:15], a[192:195], v[120:123], a[12:15]
 s_waitcnt lgkmcnt(4)
 v_add_f32 v67, v44, v45
 v_mov_b32 v68, v64
 v_mfma_f32_16x16x32_bf16 a[28:31], a[200:203], v[120:123], a[28:31]
 s_lshl_b32 s59, s45, 12
 ds_read_b64_tr_b16 a[216:217], v12 offset:32768
 ds_read_b64_tr_b16 a[218:219], v12 offset:36864
 v_mfma_f32_16x16x32_bf16 a[28:31], a[204:207], v[124:127], a[28:31]
 s_add_u32 s58, s58, s59
 v_mov_b32 v69, v65
 v_mov_b32 v70, v66
 v_mfma_f32_16x16x32_bf16 a[24:27], a[204:207], v[116:119], a[24:27]
 ds_read_b64_tr_b16 a[220:221], v12 offset:40960
 ds_read_b64_tr_b16 a[222:223], v12 offset:45056
 v_mfma_f32_16x16x32_bf16 a[24:27], a[200:203], v[112:115], a[24:27]
 v_mov_b32 v71, v67
 v_permlane16_swap_b32 v64, v68
 v_mfma_f32_16x16x32_bf16 a[20:23], a[200:203], v[104:107], a[20:23]
 v_permlane16_swap_b32 v65, v69
 v_permlane16_swap_b32 v66, v70
 v_mfma_f32_16x16x32_bf16 a[20:23], a[204:207], v[108:111], a[20:23]
 v_permlane16_swap_b32 v67, v71
 v_add_f32 v64, v64, v68
 v_mfma_f32_16x16x32_bf16 a[16:19], a[204:207], v[100:103], a[16:19]
 v_add_f32 v65, v65, v69
 v_add_f32 v66, v66, v70
 v_mfma_f32_16x16x32_bf16 a[16:19], a[200:203], v[96:99], a[16:19]
 s_waitcnt lgkmcnt(4)
 v_add_f32 v67, v67, v71
 v_mov_b32 v68, v64
 v_mfma_f32_16x16x32_bf16 a[32:35], a[208:211], v[96:99], a[32:35]
 ds_read_b64_tr_b16 a[192:193], v13 offset:32768
 ds_read_b64_tr_b16 a[194:195], v13 offset:36864
 v_mfma_f32_16x16x32_bf16 a[32:35], a[212:215], v[100:103], a[32:35]
 v_mov_b32 v69, v65
 v_mov_b32 v70, v66
 v_mfma_f32_16x16x32_bf16 a[36:39], a[212:215], v[108:111], a[36:39]
 ds_read_b64_tr_b16 a[196:197], v13 offset:40960
 ds_read_b64_tr_b16 a[198:199], v13 offset:45056
 v_mfma_f32_16x16x32_bf16 a[36:39], a[208:211], v[104:107], a[36:39]
 v_mov_b32 v71, v67
 v_permlane32_swap_b32 v64, v68
 v_mfma_f32_16x16x32_bf16 a[40:43], a[208:211], v[112:115], a[40:43]
 v_permlane32_swap_b32 v65, v69
 v_permlane32_swap_b32 v66, v70
 v_mfma_f32_16x16x32_bf16 a[40:43], a[212:215], v[116:119], a[40:43]
 v_permlane32_swap_b32 v67, v71
 v_add_f32 v64, v64, v68
 v_mfma_f32_16x16x32_bf16 a[44:47], a[212:215], v[124:127], a[44:47]
 v_add_f32 v65, v65, v69
 v_add_f32 v66, v66, v70
 v_mfma_f32_16x16x32_bf16 a[44:47], a[208:211], v[120:123], a[44:47]
 s_waitcnt lgkmcnt(4)
 v_add_f32 v67, v67, v71
 v_rcp_f32 v68, v64
 v_mfma_f32_16x16x32_bf16 a[60:63], a[216:219], v[120:123], a[60:63]
 ds_read_b64_tr_b16 a[200:201], v14 offset:32768
 ds_read_b64_tr_b16 a[202:203], v14 offset:36864
 v_mfma_f32_16x16x32_bf16 a[60:63], a[220:223], v[124:127], a[60:63]
 v_rcp_f32 v70, v65
 v_rcp_f32 v72, v66
 v_mfma_f32_16x16x32_bf16 a[56:59], a[220:223], v[116:119], a[56:59]
 ds_read_b64_tr_b16 a[204:205], v14 offset:40960
 ds_read_b64_tr_b16 a[206:207], v14 offset:45056
 v_mfma_f32_16x16x32_bf16 a[56:59], a[216:219], v[112:115], a[56:59]
 v_rcp_f32 v74, v67
 v_accvgpr_read_b32 v32, a0
 v_mfma_f32_16x16x32_bf16 a[52:55], a[216:219], v[104:107], a[52:55]
 v_accvgpr_read_b32 v33, a1
 v_accvgpr_read_b32 v34, a2
 v_mfma_f32_16x16x32_bf16 a[52:55], a[220:223], v[108:111], a[52:55]
 v_accvgpr_read_b32 v35, a3
 v_accvgpr_read_b32 v36, a16
 v_mfma_f32_16x16x32_bf16 a[48:51], a[220:223], v[100:103], a[48:51]
 v_accvgpr_read_b32 v37, a17
 v_accvgpr_read_b32 v38, a18
 v_mfma_f32_16x16x32_bf16 a[48:51], a[216:219], v[96:99], a[48:51]
 s_waitcnt lgkmcnt(4)
 v_accvgpr_read_b32 v39, a19
 v_mul_f32 v32, v32, v68
 v_mfma_f32_16x16x32_bf16 a[64:67], a[192:195], v[96:99], a[64:67]
 ds_read_b64_tr_b16 a[208:209], v15 offset:32768
 ds_read_b64_tr_b16 a[210:211], v15 offset:36864
 v_mfma_f32_16x16x32_bf16 a[64:67], a[196:199], v[100:103], a[64:67]
 v_mul_f32 v33, v33, v68
 v_mul_f32 v34, v34, v68
 v_mfma_f32_16x16x32_bf16 a[68:71], a[196:199], v[108:111], a[68:71]
 ds_read_b64_tr_b16 a[212:213], v15 offset:40960
 ds_read_b64_tr_b16 a[214:215], v15 offset:45056
 v_mfma_f32_16x16x32_bf16 a[68:71], a[192:195], v[104:107], a[68:71]
 v_mul_f32 v35, v35, v68
 v_mul_f32 v36, v36, v68
 v_mfma_f32_16x16x32_bf16 a[72:75], a[192:195], v[112:115], a[72:75]
 v_mul_f32 v37, v37, v68
 v_mul_f32 v38, v38, v68
 v_mfma_f32_16x16x32_bf16 a[72:75], a[196:199], v[116:119], a[72:75]
 v_mul_f32 v39, v39, v68
 v_cvt_pk_bf16_f32 v192, v32, v33
 v_mfma_f32_16x16x32_bf16 a[76:79], a[196:199], v[124:127], a[76:79]
 v_cvt_pk_bf16_f32 v193, v34, v35
 v_cvt_pk_bf16_f32 v194, v36, v37
 v_mfma_f32_16x16x32_bf16 a[76:79], a[192:195], v[120:123], a[76:79]
 s_waitcnt lgkmcnt(4)
 v_cvt_pk_bf16_f32 v195, v38, v39
 v_accvgpr_read_b32 v40, a4
 v_mfma_f32_16x16x32_bf16 a[92:95], a[200:203], v[120:123], a[92:95]
 ds_read_b64_tr_b16 a[216:217], v16 offset:32768
 ds_read_b64_tr_b16 a[218:219], v16 offset:36864
 v_mfma_f32_16x16x32_bf16 a[92:95], a[204:207], v[124:127], a[92:95]
 buffer_store_dwordx4 v[192:195], v76, s[36:39], s58 offen offset:0 sc1
 v_mfma_f32_16x16x32_bf16 a[88:91], a[204:207], v[116:119], a[88:91]
 ds_read_b64_tr_b16 a[220:221], v16 offset:40960
 ds_read_b64_tr_b16 a[222:223], v16 offset:45056
 v_mfma_f32_16x16x32_bf16 a[88:91], a[200:203], v[112:115], a[88:91]
 v_accvgpr_read_b32 v41, a5
 v_accvgpr_read_b32 v42, a6
 v_mfma_f32_16x16x32_bf16 a[84:87], a[200:203], v[104:107], a[84:87]
 v_accvgpr_read_b32 v43, a7
 v_accvgpr_read_b32 v44, a20
 v_mfma_f32_16x16x32_bf16 a[84:87], a[204:207], v[108:111], a[84:87]
 v_accvgpr_read_b32 v45, a21
 v_accvgpr_read_b32 v46, a22
 v_mfma_f32_16x16x32_bf16 a[80:83], a[204:207], v[100:103], a[80:83]
 v_accvgpr_read_b32 v47, a23
 v_mul_f32 v40, v40, v70
 v_mfma_f32_16x16x32_bf16 a[80:83], a[200:203], v[96:99], a[80:83]
 s_waitcnt lgkmcnt(4)
 v_mul_f32 v41, v41, v70
 v_mul_f32 v42, v42, v70
 v_mfma_f32_16x16x32_bf16 a[96:99], a[208:211], v[96:99], a[96:99]
 v_mul_f32 v43, v43, v70
 v_mul_f32 v44, v44, v70
 v_mfma_f32_16x16x32_bf16 a[96:99], a[212:215], v[100:103], a[96:99]
 v_mul_f32 v45, v45, v70
 v_mul_f32 v46, v46, v70
 v_mfma_f32_16x16x32_bf16 a[100:103], a[212:215], v[108:111], a[100:103]
 v_mul_f32 v47, v47, v70
 v_cvt_pk_bf16_f32 v196, v40, v41
 v_mfma_f32_16x16x32_bf16 a[100:103], a[208:211], v[104:107], a[100:103]
 v_cvt_pk_bf16_f32 v197, v42, v43
 v_cvt_pk_bf16_f32 v198, v44, v45
 v_mfma_f32_16x16x32_bf16 a[104:107], a[208:211], v[112:115], a[104:107]
 v_cvt_pk_bf16_f32 v199, v46, v47
 v_mfma_f32_16x16x32_bf16 a[104:107], a[212:215], v[116:119], a[104:107]
 buffer_store_dwordx4 v[196:199], v77, s[36:39], s58 offen offset:0 sc1
 v_mfma_f32_16x16x32_bf16 a[108:111], a[212:215], v[124:127], a[108:111]
 v_accvgpr_read_b32 v32, a8
 v_accvgpr_read_b32 v33, a9
 v_mfma_f32_16x16x32_bf16 a[108:111], a[208:211], v[120:123], a[108:111]
 s_waitcnt lgkmcnt(0)
 v_accvgpr_read_b32 v34, a10
 v_accvgpr_read_b32 v35, a11
 v_mfma_f32_16x16x32_bf16 a[124:127], a[216:219], v[120:123], a[124:127]
 v_accvgpr_read_b32 v36, a24
 v_accvgpr_read_b32 v37, a25
 v_mfma_f32_16x16x32_bf16 a[124:127], a[220:223], v[124:127], a[124:127]
 v_accvgpr_read_b32 v38, a26
 v_accvgpr_read_b32 v39, a27
 v_mfma_f32_16x16x32_bf16 a[120:123], a[220:223], v[116:119], a[120:123]
 v_mul_f32 v32, v32, v72
 v_mul_f32 v33, v33, v72
 v_mfma_f32_16x16x32_bf16 a[120:123], a[216:219], v[112:115], a[120:123]
 v_mul_f32 v34, v34, v72
 v_mul_f32 v35, v35, v72
 v_mfma_f32_16x16x32_bf16 a[116:119], a[216:219], v[104:107], a[116:119]
 v_mul_f32 v36, v36, v72
 v_mul_f32 v37, v37, v72
 v_mfma_f32_16x16x32_bf16 a[116:119], a[220:223], v[108:111], a[116:119]
 v_mul_f32 v38, v38, v72
 v_mul_f32 v39, v39, v72
 v_mfma_f32_16x16x32_bf16 a[112:115], a[220:223], v[100:103], a[112:115]
 v_cvt_pk_bf16_f32 v200, v32, v33
 v_cvt_pk_bf16_f32 v201, v34, v35
 v_mfma_f32_16x16x32_bf16 a[112:115], a[216:219], v[96:99], a[112:115]
 v_cvt_pk_bf16_f32 v202, v36, v37
 v_cvt_pk_bf16_f32 v203, v38, v39
 buffer_store_dwordx4 v[200:203], v78, s[36:39], s58 offen offset:0 sc1
 v_accvgpr_read_b32 v40, a12
 v_accvgpr_read_b32 v41, a13
 v_accvgpr_read_b32 v42, a14
 v_accvgpr_read_b32 v43, a15
 v_accvgpr_read_b32 v44, a28
 v_accvgpr_read_b32 v45, a29
 v_accvgpr_read_b32 v46, a30
 v_accvgpr_read_b32 v47, a31
 v_mul_f32 v40, v40, v74
 v_mul_f32 v41, v41, v74
 v_mul_f32 v42, v42, v74
 v_mul_f32 v43, v43, v74
 v_mul_f32 v44, v44, v74
 v_mul_f32 v45, v45, v74
 v_mul_f32 v46, v46, v74
 v_mul_f32 v47, v47, v74
 v_cvt_pk_bf16_f32 v204, v40, v41
 v_cvt_pk_bf16_f32 v205, v42, v43
 v_cvt_pk_bf16_f32 v206, v44, v45
 v_cvt_pk_bf16_f32 v207, v46, v47
 buffer_store_dwordx4 v[204:207], v79, s[36:39], s58 offen offset:0 sc1
 v_accvgpr_read_b32 v32, a32
 v_accvgpr_read_b32 v33, a33
 v_accvgpr_read_b32 v34, a34
 v_accvgpr_read_b32 v35, a35
 v_accvgpr_read_b32 v36, a48
 v_accvgpr_read_b32 v37, a49
 v_accvgpr_read_b32 v38, a50
 v_accvgpr_read_b32 v39, a51
 v_mul_f32 v32, v32, v68
 v_mul_f32 v33, v33, v68
 v_mul_f32 v34, v34, v68
 v_mul_f32 v35, v35, v68
 v_mul_f32 v36, v36, v68
 v_mul_f32 v37, v37, v68
 v_mul_f32 v38, v38, v68
 v_mul_f32 v39, v39, v68
 v_cvt_pk_bf16_f32 v208, v32, v33
 v_cvt_pk_bf16_f32 v209, v34, v35
 v_cvt_pk_bf16_f32 v210, v36, v37
 v_cvt_pk_bf16_f32 v211, v38, v39
 buffer_store_dwordx4 v[208:211], v76, s[36:39], s58 offen offset:1024 sc1
 v_accvgpr_read_b32 v40, a36
 v_accvgpr_read_b32 v41, a37
 v_accvgpr_read_b32 v42, a38
 v_accvgpr_read_b32 v43, a39
 v_accvgpr_read_b32 v44, a52
 v_accvgpr_read_b32 v45, a53
 v_accvgpr_read_b32 v46, a54
 v_accvgpr_read_b32 v47, a55
 v_pk_mul_f32 v[40:41], v[40:41], v[70:71] op_sel_hi:[1,0]
 v_pk_mul_f32 v[42:43], v[42:43], v[70:71] op_sel_hi:[1,0]
 v_pk_mul_f32 v[44:45], v[44:45], v[70:71] op_sel_hi:[1,0]
 v_pk_mul_f32 v[46:47], v[46:47], v[70:71] op_sel_hi:[1,0]
 v_cvt_pk_bf16_f32 v212, v40, v41
 v_cvt_pk_bf16_f32 v213, v42, v43
 v_cvt_pk_bf16_f32 v214, v44, v45
 v_cvt_pk_bf16_f32 v215, v46, v47
 buffer_store_dwordx4 v[212:215], v77, s[36:39], s58 offen offset:1024 sc1
 v_accvgpr_read_b32 v32, a40
 v_accvgpr_read_b32 v33, a41
 v_accvgpr_read_b32 v34, a42
 v_accvgpr_read_b32 v35, a43
 v_accvgpr_read_b32 v36, a56
 v_accvgpr_read_b32 v37, a57
 v_accvgpr_read_b32 v38, a58
 v_accvgpr_read_b32 v39, a59
 v_pk_mul_f32 v[32:33], v[32:33], v[72:73] op_sel_hi:[1,0]
 v_pk_mul_f32 v[34:35], v[34:35], v[72:73] op_sel_hi:[1,0]
 v_pk_mul_f32 v[36:37], v[36:37], v[72:73] op_sel_hi:[1,0]
 v_pk_mul_f32 v[38:39], v[38:39], v[72:73] op_sel_hi:[1,0]
 v_cvt_pk_bf16_f32 v216, v32, v33
 v_cvt_pk_bf16_f32 v217, v34, v35
 v_cvt_pk_bf16_f32 v218, v36, v37
 v_cvt_pk_bf16_f32 v219, v38, v39
 buffer_store_dwordx4 v[216:219], v78, s[36:39], s58 offen offset:1024 sc1
 v_accvgpr_read_b32 v40, a44
 v_accvgpr_read_b32 v41, a45
 v_accvgpr_read_b32 v42, a46
 v_accvgpr_read_b32 v43, a47
 v_accvgpr_read_b32 v44, a60
 v_accvgpr_read_b32 v45, a61
 v_accvgpr_read_b32 v46, a62
 v_accvgpr_read_b32 v47, a63
 v_pk_mul_f32 v[40:41], v[40:41], v[74:75] op_sel_hi:[1,0]
 v_pk_mul_f32 v[42:43], v[42:43], v[74:75] op_sel_hi:[1,0]
 v_pk_mul_f32 v[44:45], v[44:45], v[74:75] op_sel_hi:[1,0]
 v_pk_mul_f32 v[46:47], v[46:47], v[74:75] op_sel_hi:[1,0]
 v_cvt_pk_bf16_f32 v220, v40, v41
 v_cvt_pk_bf16_f32 v221, v42, v43
 v_cvt_pk_bf16_f32 v222, v44, v45
 v_cvt_pk_bf16_f32 v223, v46, v47
 buffer_store_dwordx4 v[220:223], v79, s[36:39], s58 offen offset:1024 sc1
 v_accvgpr_read_b32 v32, a64
 v_accvgpr_read_b32 v33, a65
 v_accvgpr_read_b32 v34, a66
 v_accvgpr_read_b32 v35, a67
 v_accvgpr_read_b32 v36, a80
 v_accvgpr_read_b32 v37, a81
 v_accvgpr_read_b32 v38, a82
 v_accvgpr_read_b32 v39, a83
 v_pk_mul_f32 v[32:33], v[32:33], v[68:69] op_sel_hi:[1,0]
 v_pk_mul_f32 v[34:35], v[34:35], v[68:69] op_sel_hi:[1,0]
 v_pk_mul_f32 v[36:37], v[36:37], v[68:69] op_sel_hi:[1,0]
 v_pk_mul_f32 v[38:39], v[38:39], v[68:69] op_sel_hi:[1,0]
 v_cvt_pk_bf16_f32 v224, v32, v33
 v_cvt_pk_bf16_f32 v225, v34, v35
 v_cvt_pk_bf16_f32 v226, v36, v37
 v_cvt_pk_bf16_f32 v227, v38, v39
 buffer_store_dwordx4 v[224:227], v76, s[36:39], s58 offen offset:2048 sc1
 v_accvgpr_read_b32 v40, a68
 v_accvgpr_read_b32 v41, a69
 v_accvgpr_read_b32 v42, a70
 v_accvgpr_read_b32 v43, a71
 v_accvgpr_read_b32 v44, a84
 v_accvgpr_read_b32 v45, a85
 v_accvgpr_read_b32 v46, a86
 v_accvgpr_read_b32 v47, a87
 v_pk_mul_f32 v[40:41], v[40:41], v[70:71] op_sel_hi:[1,0]
 v_pk_mul_f32 v[42:43], v[42:43], v[70:71] op_sel_hi:[1,0]
 v_pk_mul_f32 v[44:45], v[44:45], v[70:71] op_sel_hi:[1,0]
 v_pk_mul_f32 v[46:47], v[46:47], v[70:71] op_sel_hi:[1,0]
 v_cvt_pk_bf16_f32 v228, v40, v41
 v_cvt_pk_bf16_f32 v229, v42, v43
 v_cvt_pk_bf16_f32 v230, v44, v45
 v_cvt_pk_bf16_f32 v231, v46, v47
 buffer_store_dwordx4 v[228:231], v77, s[36:39], s58 offen offset:2048 sc1
 v_accvgpr_read_b32 v32, a72
 v_accvgpr_read_b32 v33, a73
 v_accvgpr_read_b32 v34, a74
 v_accvgpr_read_b32 v35, a75
 v_accvgpr_read_b32 v36, a88
 v_accvgpr_read_b32 v37, a89
 v_accvgpr_read_b32 v38, a90
 v_accvgpr_read_b32 v39, a91
 v_pk_mul_f32 v[32:33], v[32:33], v[72:73] op_sel_hi:[1,0]
 v_pk_mul_f32 v[34:35], v[34:35], v[72:73] op_sel_hi:[1,0]
 v_pk_mul_f32 v[36:37], v[36:37], v[72:73] op_sel_hi:[1,0]
 v_pk_mul_f32 v[38:39], v[38:39], v[72:73] op_sel_hi:[1,0]
 v_cvt_pk_bf16_f32 v232, v32, v33
 v_cvt_pk_bf16_f32 v233, v34, v35
 v_cvt_pk_bf16_f32 v234, v36, v37
 v_cvt_pk_bf16_f32 v235, v38, v39
 buffer_store_dwordx4 v[232:235], v78, s[36:39], s58 offen offset:2048 sc1
 v_accvgpr_read_b32 v40, a76
 v_accvgpr_read_b32 v41, a77
 v_accvgpr_read_b32 v42, a78
 v_accvgpr_read_b32 v43, a79
 v_accvgpr_read_b32 v44, a92
 v_accvgpr_read_b32 v45, a93
 v_accvgpr_read_b32 v46, a94
 v_accvgpr_read_b32 v47, a95
 v_pk_mul_f32 v[40:41], v[40:41], v[74:75] op_sel_hi:[1,0]
 v_pk_mul_f32 v[42:43], v[42:43], v[74:75] op_sel_hi:[1,0]
 v_pk_mul_f32 v[44:45], v[44:45], v[74:75] op_sel_hi:[1,0]
 v_pk_mul_f32 v[46:47], v[46:47], v[74:75] op_sel_hi:[1,0]
 v_cvt_pk_bf16_f32 v236, v40, v41
 v_cvt_pk_bf16_f32 v237, v42, v43
 v_cvt_pk_bf16_f32 v238, v44, v45
 v_cvt_pk_bf16_f32 v239, v46, v47
 buffer_store_dwordx4 v[236:239], v79, s[36:39], s58 offen offset:2048 sc1
 v_accvgpr_read_b32 v32, a96
 v_accvgpr_read_b32 v33, a97
 v_accvgpr_read_b32 v34, a98
 v_accvgpr_read_b32 v35, a99
 v_accvgpr_read_b32 v36, a112
 v_accvgpr_read_b32 v37, a113
 v_accvgpr_read_b32 v38, a114
 v_accvgpr_read_b32 v39, a115
 v_pk_mul_f32 v[32:33], v[32:33], v[68:69] op_sel_hi:[1,0]
 v_pk_mul_f32 v[34:35], v[34:35], v[68:69] op_sel_hi:[1,0]
 v_pk_mul_f32 v[36:37], v[36:37], v[68:69] op_sel_hi:[1,0]
 v_pk_mul_f32 v[38:39], v[38:39], v[68:69] op_sel_hi:[1,0]
 v_cvt_pk_bf16_f32 v240, v32, v33
 v_cvt_pk_bf16_f32 v241, v34, v35
 v_cvt_pk_bf16_f32 v242, v36, v37
 v_cvt_pk_bf16_f32 v243, v38, v39
 buffer_store_dwordx4 v[240:243], v76, s[36:39], s58 offen offset:3072 sc1
 v_accvgpr_read_b32 v40, a100
 v_accvgpr_read_b32 v41, a101
 v_accvgpr_read_b32 v42, a102
 v_accvgpr_read_b32 v43, a103
 v_accvgpr_read_b32 v44, a116
 v_accvgpr_read_b32 v45, a117
 v_accvgpr_read_b32 v46, a118
 v_accvgpr_read_b32 v47, a119
 v_pk_mul_f32 v[40:41], v[40:41], v[70:71] op_sel_hi:[1,0]
 v_pk_mul_f32 v[42:43], v[42:43], v[70:71] op_sel_hi:[1,0]
 v_pk_mul_f32 v[44:45], v[44:45], v[70:71] op_sel_hi:[1,0]
 v_pk_mul_f32 v[46:47], v[46:47], v[70:71] op_sel_hi:[1,0]
 v_cvt_pk_bf16_f32 v244, v40, v41
 v_cvt_pk_bf16_f32 v245, v42, v43
 v_cvt_pk_bf16_f32 v246, v44, v45
 v_cvt_pk_bf16_f32 v247, v46, v47
 buffer_store_dwordx4 v[244:247], v77, s[36:39], s58 offen offset:3072 sc1
 v_accvgpr_read_b32 v32, a104
 v_accvgpr_read_b32 v33, a105
 v_accvgpr_read_b32 v34, a106
 v_accvgpr_read_b32 v35, a107
 v_accvgpr_read_b32 v36, a120
 v_accvgpr_read_b32 v37, a121
 v_accvgpr_read_b32 v38, a122
 v_accvgpr_read_b32 v39, a123
 v_pk_mul_f32 v[32:33], v[32:33], v[72:73] op_sel_hi:[1,0]
 v_pk_mul_f32 v[34:35], v[34:35], v[72:73] op_sel_hi:[1,0]
 v_pk_mul_f32 v[36:37], v[36:37], v[72:73] op_sel_hi:[1,0]
 v_pk_mul_f32 v[38:39], v[38:39], v[72:73] op_sel_hi:[1,0]
 v_cvt_pk_bf16_f32 v248, v32, v33
 v_cvt_pk_bf16_f32 v249, v34, v35
 v_cvt_pk_bf16_f32 v250, v36, v37
 v_cvt_pk_bf16_f32 v251, v38, v39
 buffer_store_dwordx4 v[248:251], v78, s[36:39], s58 offen offset:3072 sc1
 v_accvgpr_read_b32 v40, a108
 v_accvgpr_read_b32 v41, a109
 v_accvgpr_read_b32 v42, a110
 v_accvgpr_read_b32 v43, a111
 v_accvgpr_read_b32 v44, a124
 v_accvgpr_read_b32 v45, a125
 v_accvgpr_read_b32 v46, a126
 v_accvgpr_read_b32 v47, a127
 v_pk_mul_f32 v[40:41], v[40:41], v[74:75] op_sel_hi:[1,0]
 v_pk_mul_f32 v[42:43], v[42:43], v[74:75] op_sel_hi:[1,0]
 v_pk_mul_f32 v[44:45], v[44:45], v[74:75] op_sel_hi:[1,0]
 v_pk_mul_f32 v[46:47], v[46:47], v[74:75] op_sel_hi:[1,0]
 v_cvt_pk_bf16_f32 v252, v40, v41
 v_cvt_pk_bf16_f32 v253, v42, v43
 v_cvt_pk_bf16_f32 v254, v44, v45
 v_cvt_pk_bf16_f32 v255, v46, v47
 buffer_store_dwordx4 v[252:255], v79, s[36:39], s58 offen offset:3072 sc1
 v_mfma_f32_16x16x32_bf16 v[84:87], v[80:83], v[192:195], v[84:87]
 v_mfma_f32_16x16x32_bf16 v[84:87], v[80:83], v[196:199], v[84:87]
 v_mfma_f32_16x16x32_bf16 v[84:87], v[80:83], v[200:203], v[84:87]
 v_mfma_f32_16x16x32_bf16 v[84:87], v[80:83], v[204:207], v[84:87]
 v_mfma_f32_16x16x32_bf16 v[84:87], v[80:83], v[208:211], v[84:87]
 v_mfma_f32_16x16x32_bf16 v[84:87], v[80:83], v[212:215], v[84:87]
 v_mfma_f32_16x16x32_bf16 v[84:87], v[80:83], v[216:219], v[84:87]
 v_mfma_f32_16x16x32_bf16 v[84:87], v[80:83], v[220:223], v[84:87]
 v_mfma_f32_16x16x32_bf16 v[84:87], v[80:83], v[224:227], v[84:87]
 v_mfma_f32_16x16x32_bf16 v[84:87], v[80:83], v[228:231], v[84:87]
 v_mfma_f32_16x16x32_bf16 v[84:87], v[80:83], v[232:235], v[84:87]
 v_mfma_f32_16x16x32_bf16 v[84:87], v[80:83], v[236:239], v[84:87]
 v_mfma_f32_16x16x32_bf16 v[84:87], v[80:83], v[240:243], v[84:87]
 v_mfma_f32_16x16x32_bf16 v[84:87], v[80:83], v[244:247], v[84:87]
 v_mfma_f32_16x16x32_bf16 v[84:87], v[80:83], v[248:251], v[84:87]
 v_mfma_f32_16x16x32_bf16 v[84:87], v[80:83], v[252:255], v[84:87]
 s_mov_b32 s3, 0x33800000
 s_mov_b32 s4, 0x57800000
 s_mov_b64 s[60:61], -1
 v_cmp_le_f32 vcc, s3, v64
 s_nop 0
 s_and_b64 s[60:61], s[60:61], vcc
 v_cmp_ge_f32 vcc, s4, v64
 s_nop 0
 s_and_b64 s[60:61], s[60:61], vcc
 v_cmp_le_f32 vcc, s3, v65
 s_nop 0
 s_and_b64 s[60:61], s[60:61], vcc
 v_cmp_ge_f32 vcc, s4, v65
 s_nop 0
 s_and_b64 s[60:61], s[60:61], vcc
 v_cmp_le_f32 vcc, s3, v66
 s_nop 0
 s_and_b64 s[60:61], s[60:61], vcc
 v_cmp_ge_f32 vcc, s4, v66
 s_nop 0
 s_and_b64 s[60:61], s[60:61], vcc
 v_cmp_le_f32 vcc, s3, v67
 s_nop 0
 s_and_b64 s[60:61], s[60:61], vcc
 v_cmp_ge_f32 vcc, s4, v67
 s_nop 0
 s_and_b64 s[60:61], s[60:61], vcc
 s_lshl_b32 s4, s44, 2
 s_add_u32 s4, s4, 163776
 v_mov_b32 v66, s4
 v_mov_b32 v63, 163776
 v_cmp_o_f32 vcc, v84, v84
 s_nop 0
 s_and_b64 s[60:61], s[60:61], vcc
 s_cmp_eq_u64 s[60:61], -1
 s_cselect_b32 s3, 0, 1
 v_mov_b32 v64, s3
 ds_write_b32 v66, v64
 s_lshr_b32 s3, s45, 2
 s_lshl_b32 s4, s46, 3
 s_add_u32 s3, s3, s4
 s_add_u32 s3, s3, 8
 s_lshl_b32 s3, s3, 8
 s_lshl_b32 s5, s44, 17
 s_add_u32 s3, s3, s5
 v_lshlrev_b32 v29, 13, v18
 v_add_u32 v29, s3, v29
 s_lshr_b32 s3, s53, 1
 s_lshl_b32 s3, s3, 2
 s_add_u32 s3, s3, s55
 s_lshl_b32 s3, s3, 1
 s_add_u32 s3, s3, 8
 s_lshl_b32 s3, s3, 8
 s_add_u32 s3, s3, s5
 v_mov_b32 v20, s3
 s_lshr_b32 s62, s62, 3
 s_waitcnt vmcnt(34)
 s_waitcnt lgkmcnt(0)
 s_barrier
 ds_read_b128 v[64:67], v63
 ds_read_b128 a[0:3], v18 offset:0
 ds_read_b128 a[4:7], v18 offset:4096
 ds_read_b128 a[8:11], v18 offset:1024
 ds_read_b128 a[12:15], v18 offset:5120
 ds_read_b128 a[16:19], v18 offset:2048
 ds_read_b128 a[20:23], v18 offset:6144
 ds_read_b128 a[24:27], v18 offset:3072
 ds_read_b128 a[28:31], v18 offset:7168
 s_waitcnt lgkmcnt(8)
 v_or_b32 v64, v64, v65
 v_or3_b32 v64, v64, v66, v67
 s_lshr_b32 s4, s57, 1
 v_readfirstlane_b32 s3, v64
 s_nop 0
 s_cmp_gt_u32 s3, s4
 s_cbranch_scc1 fb_restart
out_a:
 s_waitcnt lgkmcnt(4)
 s_bitcmp1_b32 s2, 0
 s_cbranch_scc1 outo_a
oute_a:
 v_mfma_f32_16x16x32_bf16 v[128:131], a[0:3], a[128:131], 0
 s_add_u32 s20, s86, 67108864
 s_addc_u32 s21, s87, 0
 ds_read_b128 a[32:35], v18 offset:8192
 ds_read_b128 a[36:39], v18 offset:12288
 v_mfma_f32_16x16x32_bf16 v[128:131], a[4:7], a[132:135], v[128:131]
 s_mov_b32 s22, 16777216
 buffer_load_dwordx4 a[192:195], v21, s[32:35], s52 offen offset:0 sc1
 v_mfma_f32_16x16x32_bf16 v[132:135], a[4:7], a[140:143], 0
 s_mov_b32 s23, 0x00020000
 v_mfma_f32_16x16x32_bf16 v[132:135], a[0:3], a[136:139], v[132:135]
 s_mov_b32 s16, s64
 buffer_load_dwordx4 a[196:199], v21, s[32:35], s52 offen offset:1024 sc1
 v_mfma_f32_16x16x32_bf16 v[140:143], a[8:11], a[136:139], 0
 s_mov_b32 s17, s65
 ds_read_b128 a[40:43], v18 offset:9216
 ds_read_b128 a[44:47], v18 offset:13312
 v_mfma_f32_16x16x32_bf16 v[140:143], a[12:15], a[140:143], v[140:143]
 s_mov_b32 s18, 2097152
 v_mfma_f32_16x16x32_bf16 v[136:139], a[12:15], a[132:135], 0
 s_mov_b32 s19, 0x00020000
 v_mfma_f32_16x16x32_bf16 v[136:139], a[8:11], a[128:131], v[136:139]
 s_waitcnt lgkmcnt(4)
 s_mov_b32 s28, s82
 buffer_load_dwordx4 a[200:203], v22, s[32:35], s52 offen offset:0 sc1
 v_mfma_f32_16x16x32_bf16 v[144:147], a[16:19], a[128:131], 0
 s_mov_b32 s29, s83
 ds_read_b128 a[48:51], v18 offset:10240
 ds_read_b128 a[52:55], v18 offset:14336
 v_mfma_f32_16x16x32_bf16 v[144:147], a[20:23], a[132:135], v[144:147]
 s_mov_b32 s30, 2097152
 v_mfma_f32_16x16x32_bf16 v[148:151], a[20:23], a[140:143], 0
 s_mov_b32 s31, 0x00020000
 v_mfma_f32_16x16x32_bf16 v[148:151], a[16:19], a[136:139], v[148:151]
 s_lshl_b32 s3, s53, 2
 buffer_load_dwordx4 a[204:207], v22, s[32:35], s52 offen offset:1024 sc1
 v_mfma_f32_16x16x32_bf16 v[156:159], a[24:27], a[136:139], 0
 s_add_u32 s52, s52, 2048
 s_bfe_u32 s4, s2, 0x20003
 ds_read_b128 a[56:59], v18 offset:11264
 ds_read_b128 a[60:63], v18 offset:15360
 v_mfma_f32_16x16x32_bf16 v[156:159], a[28:31], a[140:143], v[156:159]
 s_add_u32 s3, s3, s4
 v_mfma_f32_16x16x32_bf16 v[152:155], a[28:31], a[132:135], 0
 s_lshl_b32 s5, s3, 2
 v_mfma_f32_16x16x32_bf16 v[152:155], a[24:27], a[128:131], v[152:155]
 s_waitcnt lgkmcnt(4)
 s_lshl_b32 s54, s3, 17
 v_mfma_f32_16x16x32_bf16 v[160:163], a[32:35], a[128:131], 0
 s_lshr_b32 s6, s44, 1
 ds_read_b128 a[0:3], v18 offset:16384
 ds_read_b128 a[4:7], v18 offset:20480
 v_mfma_f32_16x16x32_bf16 v[160:163], a[36:39], a[132:135], v[160:163]
 s_lshl_b32 s3, s6, 16
 buffer_load_dwordx4 a[208:211], v21, s[32:35], s52 offen offset:0 sc1
 v_mfma_f32_16x16x32_bf16 v[164:167], a[36:39], a[140:143], 0
 s_add_u32 s54, s54, s3
 v_mfma_f32_16x16x32_bf16 v[164:167], a[32:35], a[136:139], v[164:167]
 s_and_b32 s3, s47, 4096
 v_mfma_f32_16x16x32_bf16 v[172:175], a[40:43], a[136:139], 0
 s_lshl_b32 s3, s3, 2
 ds_read_b128 a[8:11], v18 offset:17408
 ds_read_b128 a[12:15], v18 offset:21504
 v_mfma_f32_16x16x32_bf16 v[172:175], a[44:47], a[140:143], v[172:175]
 s_add_u32 s54, s54, s3
 buffer_load_dwordx4 a[212:215], v21, s[32:35], s52 offen offset:1024 sc1
 v_mfma_f32_16x16x32_bf16 v[168:171], a[44:47], a[132:135], 0
 s_lshl_b32 s3, s55, 11
 v_mfma_f32_16x16x32_bf16 v[168:171], a[40:43], a[128:131], v[168:171]
 s_waitcnt lgkmcnt(4)
 s_add_u32 s54, s54, s3
 v_mfma_f32_16x16x32_bf16 v[176:179], a[48:51], a[128:131], 0
 s_lshl_b32 s6, s6, 1
 ds_read_b128 a[16:19], v18 offset:18432
 ds_read_b128 a[20:23], v18 offset:22528
 v_mfma_f32_16x16x32_bf16 v[176:179], a[52:55], a[132:135], v[176:179]
 s_add_u32 s6, s6, s5
 buffer_load_dwordx4 a[216:219], v22, s[32:35], s52 offen offset:0 sc1
 v_mfma_f32_16x16x32_bf16 v[180:183], a[52:55], a[140:143], 0
 s_add_u32 s6, s6, 72
 v_mfma_f32_16x16x32_bf16 v[180:183], a[48:51], a[136:139], v[180:183]
 s_lshl_b32 s6, s6, 8
 v_mfma_f32_16x16x32_bf16 v[188:191], a[56:59], a[136:139], 0
 ds_read_b128 a[24:27], v18 offset:19456
 ds_read_b128 a[28:31], v18 offset:23552
 v_mfma_f32_16x16x32_bf16 v[188:191], a[60:63], a[140:143], v[188:191]
 buffer_load_dwordx4 a[220:223], v22, s[32:35], s52 offen offset:1024 sc1
 v_mfma_f32_16x16x32_bf16 v[184:187], a[60:63], a[132:135], 0
 s_add_u32 s52, s52, 2048
 v_mfma_f32_16x16x32_bf16 v[184:187], a[56:59], a[128:131], v[184:187]
 s_waitcnt lgkmcnt(4)
 s_waitcnt vmcnt(36)
 v_mfma_f32_16x16x32_bf16 v[128:131], a[0:3], a[144:147], v[128:131]
 ds_read_b128 a[32:35], v18 offset:24576
 ds_read_b128 a[36:39], v18 offset:28672
 v_mfma_f32_16x16x32_bf16 v[128:131], a[4:7], a[148:151], v[128:131]
 buffer_load_dwordx4 a[224:227], v21, s[32:35], s52 offen offset:0 sc1
 v_mfma_f32_16x16x32_bf16 v[132:135], a[4:7], a[156:159], v[132:135]
 v_mfma_f32_16x16x32_bf16 v[132:135], a[0:3], a[152:155], v[132:135]
 buffer_load_dwordx4 a[228:231], v21, s[32:35], s52 offen offset:1024 sc1
 v_mfma_f32_16x16x32_bf16 v[140:143], a[8:11], a[152:155], v[140:143]
 ds_read_b128 a[40:43], v18 offset:25600
 ds_read_b128 a[44:47], v18 offset:29696
 v_mfma_f32_16x16x32_bf16 v[140:143], a[12:15], a[156:159], v[140:143]
 v_mfma_f32_16x16x32_bf16 v[136:139], a[12:15], a[148:151], v[136:139]
 v_mfma_f32_16x16x32_bf16 v[136:139], a[8:11], a[144:147], v[136:139]
 s_waitcnt lgkmcnt(4)
 buffer_load_dwordx4 a[232:235], v22, s[32:35], s52 offen offset:0 sc1
 v_mfma_f32_16x16x32_bf16 v[144:147], a[16:19], a[144:147], v[144:147]
 ds_read_b128 a[48:51], v18 offset:26624
 ds_read_b128 a[52:55], v18 offset:30720
 v_mfma_f32_16x16x32_bf16 v[144:147], a[20:23], a[148:151], v[144:147]
 v_mfma_f32_16x16x32_bf16 v[148:151], a[20:23], a[156:159], v[148:151]
 v_mfma_f32_16x16x32_bf16 v[148:151], a[16:19], a[152:155], v[148:151]
 buffer_load_dwordx4 a[236:239], v22, s[32:35], s52 offen offset:1024 sc1
 v_mfma_f32_16x16x32_bf16 v[156:159], a[24:27], a[152:155], v[156:159]
 s_add_u32 s52, s52, 2048
 ds_read_b128 a[56:59], v18 offset:27648
 ds_read_b128 a[60:63], v18 offset:31744
 v_mfma_f32_16x16x32_bf16 v[156:159], a[28:31], a[156:159], v[156:159]
 v_mfma_f32_16x16x32_bf16 v[152:155], a[28:31], a[148:151], v[152:155]
 s_waitcnt vmcnt(12)
 v_mfma_f32_16x16x32_bf16 v[152:155], a[24:27], a[144:147], v[152:155]
 s_waitcnt lgkmcnt(4)
 s_barrier
 v_mfma_f32_16x16x32_bf16 v[160:163], a[32:35], a[144:147], v[160:163]
 ds_read_b128 a[0:3], v18 offset:32768
 ds_read_b128 a[4:7], v18 offset:36864
 v_mfma_f32_16x16x32_bf16 v[160:163], a[36:39], a[148:151], v[160:163]
 buffer_atomic_add v30, v29, s[40:43], 0 offen sc1
 v_mfma_f32_16x16x32_bf16 v[164:167], a[36:39], a[156:159], v[164:167]
 s_add_u32 s91, s51, 57344
 s_add_u32 m0, s47, 114688
 v_mfma_f32_16x16x32_bf16 v[164:167], a[32:35], a[152:155], v[164:167]
 buffer_load_dwordx4 v18, s[24:27], s91 offen offset:0 sc1 lds
 v_mfma_f32_16x16x32_bf16 v[172:175], a[40:43], a[152:155], v[172:175]
 ds_read_b128 a[8:11], v18 offset:33792
 ds_read_b128 a[12:15], v18 offset:37888
 v_mfma_f32_16x16x32_bf16 v[172:175], a[44:47], a[156:159], v[172:175]
 v_mfma_f32_16x16x32_bf16 v[168:171], a[44:47], a[148:151], v[168:171]
 v_mfma_f32_16x16x32_bf16 v[168:171], a[40:43], a[144:147], v[168:171]
 s_waitcnt lgkmcnt(4)
 buffer_load_dwordx4 v18, s[24:27], s91 offen offset:1024 sc1 lds
 v_mfma_f32_16x16x32_bf16 v[176:179], a[48:51], a[144:147], v[176:179]
 ds_read_b128 a[16:19], v18 offset:34816
 ds_read_b128 a[20:23], v18 offset:38912
 v_mfma_f32_16x16x32_bf16 v[176:179], a[52:55], a[148:151], v[176:179]
 buffer_load_dwordx4 v18, s[24:27], s91 offen offset:2048 sc1 lds
 v_mfma_f32_16x16x32_bf16 v[180:183], a[52:55], a[156:159], v[180:183]
 v_mfma_f32_16x16x32_bf16 v[180:183], a[48:51], a[152:155], v[180:183]
 v_mfma_f32_16x16x32_bf16 v[188:191], a[56:59], a[152:155], v[188:191]
 ds_read_b128 a[24:27], v18 offset:35840
 ds_read_b128 a[28:31], v18 offset:39936
 v_mfma_f32_16x16x32_bf16 v[188:191], a[60:63], a[156:159], v[188:191]
 buffer_load_dwordx4 v18, s[24:27], s91 offen offset:3072 sc1 lds
 v_mfma_f32_16x16x32_bf16 v[184:187], a[60:63], a[148:151], v[184:187]
 v_mfma_f32_16x16x32_bf16 v[184:187], a[56:59], a[144:147], v[184:187]
 s_waitcnt lgkmcnt(4)
 v_mfma_f32_16x16x32_bf16 v[128:131], a[0:3], a[160:163], v[128:131]
 s_add_u32 s5, s5, s55
 ds_read_b128 a[32:35], v18 offset:40960
 ds_read_b128 a[36:39], v18 offset:45056
 v_mfma_f32_16x16x32_bf16 v[128:131], a[4:7], a[164:167], v[128:131]
 s_lshl_b32 s59, s5, 15
 buffer_load_dwordx4 a[240:243], v21, s[32:35], s52 offen offset:0 sc1
 v_mfma_f32_16x16x32_bf16 v[132:135], a[4:7], a[172:175], v[132:135]
 s_lshl_b32 s3, s47, 1
 buffer_load_dwordx4 a[244:247], v21, s[32:35], s52 offen offset:1024 sc1
 v_mov_b32 v48, v18
 v_mfma_f32_16x16x32_bf16 v[132:135], a[0:3], a[168:171], v[132:135]
 s_add_u32 s59, s59, s3
 buffer_load_dwordx4 a[248:251], v22, s[32:35], s52 offen offset:0 sc1
 v_mfma_f32_16x16x32_bf16 v[140:143], a[8:11], a[168:171], v[140:143]
 s_add_u32 s5, s5, 72
 ds_read_b128 a[40:43], v18 offset:41984
 ds_read_b128 a[44:47], v18 offset:46080
 v_add_u32 v49, 8192, v18
 v_mfma_f32_16x16x32_bf16 v[140:143], a[12:15], a[172:175], v[140:143]
 s_lshl_b32 s5, s5, 8
 buffer_load_dwordx4 a[252:255], v22, s[32:35], s52 offen offset:1024 sc1
 v_mfma_f32_16x16x32_bf16 v[136:139], a[12:15], a[164:167], v[136:139]
 s_add_u32 s52, s52, 2048
 s_add_u32 s91, s51, 65536
 s_add_u32 m0, s47, 0
 s_lshl_b32 s3, s44, 17
 v_add_u32 v50, 32768, v18
 v_mfma_f32_16x16x32_bf16 v[136:139], a[8:11], a[160:163], v[136:139]
 s_waitcnt lgkmcnt(4)
 s_add_u32 s88, s5, s3
 buffer_load_dwordx4 v18, s[24:27], s91 offen offset:0 sc1 lds
 v_mfma_f32_16x16x32_bf16 v[144:147], a[16:19], a[160:163], v[144:147]
 s_lshl_b32 s3, s53, 1
 ds_read_b128 a[48:51], v18 offset:43008
 ds_read_b128 a[52:55], v18 offset:47104
 v_add_u32 v51, 40960, v18
 v_mfma_f32_16x16x32_bf16 v[144:147], a[20:23], a[164:167], v[144:147]
 s_lshr_b32 s5, s55, 1
 buffer_load_dwordx4 v18, s[24:27], s91 offen offset:1024 sc1 lds
 v_mfma_f32_16x16x32_bf16 v[148:151], a[20:23], a[172:175], v[148:151]
 s_add_u32 s3, s3, s5
 v_lshrrev_b32 v31, 5, v18
 v_mfma_f32_16x16x32_bf16 v[148:151], a[16:19], a[168:171], v[148:151]
 s_lshl_b32 s3, s3, 2
 buffer_load_dwordx4 v18, s[24:27], s91 offen offset:2048 sc1 lds
 v_mfma_f32_16x16x32_bf16 v[156:159], a[24:27], a[168:171], v[156:159]
 s_add_u32 s3, s3, s44
 ds_read_b128 a[56:59], v18 offset:44032
 ds_read_b128 a[60:63], v18 offset:48128
 v_lshlrev_b32 v31, 17, v31
 v_mfma_f32_16x16x32_bf16 v[156:159], a[28:31], a[172:175], v[156:159]
 s_lshl_b32 s3, s3, 14
 buffer_load_dwordx4 v18, s[24:27], s91 offen offset:3072 sc1 lds
 v_mfma_f32_16x16x32_bf16 v[152:155], a[28:31], a[164:167], v[152:155]
 s_bfe_u32 s5, s2, 0x20003
 v_lshl_add_u32 v31, v18, 4, v31
 v_mfma_f32_16x16x32_bf16 v[152:155], a[24:27], a[160:163], v[152:155]
 s_waitcnt lgkmcnt(4)
 s_lshl_b32 s5, s5, 8
 v_mfma_f32_16x16x32_bf16 v[160:163], a[32:35], a[160:163], v[160:163]
 s_add_u32 s3, s3, s5
 ds_read_b128 a[0:3], v18 offset:49152
 ds_read_b128 a[4:7], v18 offset:53248
 v_add_u32 v31, s6, v31
 v_mfma_f32_16x16x32_bf16 v[160:163], a[36:39], a[164:167], v[160:163]
 s_and_b32 s5, s55, 1
 v_mfma_f32_16x16x32_bf16 v[164:167], a[36:39], a[172:175], v[164:167]
 s_lshl_b32 s5, s5, 7
 v_mov_b32 v52, 256
 v_mfma_f32_16x16x32_bf16 v[164:167], a[32:35], a[168:171], v[164:167]
 s_add_u32 s58, s3, s5
 v_mfma_f32_16x16x32_bf16 v[172:175], a[40:43], a[168:171], v[172:175]
 ds_read_b128 a[8:11], v18 offset:50176
 ds_read_b128 a[12:15], v18 offset:54272
 v_add_u32 v61, 4096, v18
 v_mfma_f32_16x16x32_bf16 v[172:175], a[44:47], a[172:175], v[172:175]
 v_mfma_f32_16x16x32_bf16 v[168:171], a[44:47], a[164:167], v[168:171]
 v_bfe_u32 v60, v18, 4, 4
 v_mfma_f32_16x16x32_bf16 v[168:171], a[40:43], a[160:163], v[168:171]
 s_waitcnt lgkmcnt(4)
 v_mfma_f32_16x16x32_bf16 v[176:179], a[48:51], a[160:163], v[176:179]
 ds_read_b128 a[16:19], v18 offset:51200
 ds_read_b128 a[20:23], v18 offset:55296
 v_lshrrev_b32 v62, 8, v18
 v_mfma_f32_16x16x32_bf16 v[176:179], a[52:55], a[164:167], v[176:179]
 v_mfma_f32_16x16x32_bf16 v[180:183], a[52:55], a[172:175], v[180:183]
 v_lshlrev_b32 v62, 3, v62
 v_mfma_f32_16x16x32_bf16 v[180:183], a[48:51], a[168:171], v[180:183]
 v_mfma_f32_16x16x32_bf16 v[188:191], a[56:59], a[168:171], v[188:191]
 ds_read_b128 a[24:27], v18 offset:52224
 ds_read_b128 a[28:31], v18 offset:56320
 v_lshl_add_u32 v60, v60, 10, v62
 v_mfma_f32_16x16x32_bf16 v[188:191], a[60:63], a[172:175], v[188:191]
 v_mfma_f32_16x16x32_bf16 v[184:187], a[60:63], a[164:167], v[184:187]
 v_mfma_f32_16x16x32_bf16 v[184:187], a[56:59], a[160:163], v[184:187]
 s_waitcnt lgkmcnt(4)
 v_mfma_f32_16x16x32_bf16 v[128:131], a[0:3], a[176:179], v[128:131]
 s_and_b32 s3, s44, 2
 ds_read_b128 a[32:35], v18 offset:57344
 ds_read_b128 a[36:39], v18 offset:61440
 v_mfma_f32_16x16x32_bf16 v[128:131], a[4:7], a[180:183], v[128:131]
 s_and_b32 s5, s47, 4096
 buffer_load_dwordx4 a[128:131], v21, s[32:35], s52 offen offset:0 sc1
 v_mfma_f32_16x16x32_bf16 v[132:135], a[4:7], a[188:191], v[132:135]
 s_add_u32 s5, s5, 131072
 v_mfma_f32_16x16x32_bf16 v[132:135], a[0:3], a[184:187], v[132:135]
 s_mov_b32 s6, 147456
 buffer_load_dwordx4 a[132:135], v21, s[32:35], s52 offen offset:1024 sc1
 v_mfma_f32_16x16x32_bf16 v[140:143], a[8:11], a[184:187], v[140:143]
 s_cmp_eq_u32 s3, s55
 s_cselect_b32 s60, s5, s6
 s_cselect_b32 s7, 0x40000000, 0
 ds_read_b128 a[40:43], v18 offset:58368
 ds_read_b128 a[44:47], v18 offset:62464
 v_mfma_f32_16x16x32_bf16 v[140:143], a[12:15], a[188:191], v[140:143]
 s_add_u32 s3, s3, 1
 s_cmp_eq_u32 s3, s55
 s_cselect_b32 s61, s5, s6
 s_cselect_b32 s6, 0x40000000, 0
 v_mfma_f32_16x16x32_bf16 v[136:139], a[12:15], a[180:183], v[136:139]
 s_add_u32 s56, s54, s6
 v_mfma_f32_16x16x32_bf16 v[136:139], a[8:11], a[176:179], v[136:139]
 s_waitcnt lgkmcnt(4)
 s_add_u32 s54, s54, s7
 buffer_load_dwordx4 a[136:139], v22, s[32:35], s52 offen offset:0 sc1
 v_mfma_f32_16x16x32_bf16 v[144:147], a[16:19], a[176:179], v[144:147]
 s_add_u32 s5, s48, 131072
 ds_read_b128 a[48:51], v18 offset:59392
 ds_read_b128 a[52:55], v18 offset:63488
 v_mfma_f32_16x16x32_bf16 v[144:147], a[20:23], a[180:183], v[144:147]
 v_mfma_f32_16x16x32_bf16 v[148:151], a[20:23], a[188:191], v[148:151]
 v_mfma_f32_16x16x32_bf16 v[148:151], a[16:19], a[184:187], v[148:151]
 buffer_load_dwordx4 a[140:143], v22, s[32:35], s52 offen offset:1024 sc1
 v_mfma_f32_16x16x32_bf16 v[156:159], a[24:27], a[184:187], v[156:159]
 s_add_u32 s52, s52, 2048
 ds_read_b128 a[56:59], v18 offset:60416
 ds_read_b128 a[60:63], v18 offset:64512
 v_mfma_f32_16x16x32_bf16 v[156:159], a[28:31], a[188:191], v[156:159]
 v_mfma_f32_16x16x32_bf16 v[152:155], a[28:31], a[180:183], v[152:155]
 v_mfma_f32_16x16x32_bf16 v[152:155], a[24:27], a[176:179], v[152:155]
 s_waitcnt lgkmcnt(4)
 s_barrier
 v_mfma_f32_16x16x32_bf16 v[160:163], a[32:35], a[176:179], v[160:163]
 s_add_u32 s91, s51, 73728
 s_add_u32 m0, s47, 16384
 s_add_u32 s3, s55, 1
 ds_read_b128 a[0:3], v25 offset:0
 ds_read_b128 a[4:7], v25 offset:4096
 v_mfma_f32_16x16x32_bf16 v[160:163], a[36:39], a[180:183], v[160:163]
 s_and_b32 s3, s3, 3
 buffer_load_dwordx4 v18, s[24:27], s91 offen offset:0 sc1 lds
 v_mfma_f32_16x16x32_bf16 v[164:167], a[36:39], a[188:191], v[164:167]
 s_lshl_b32 s3, s3, 11
 v_add_u32 v53, s60, v18
 v_mfma_f32_16x16x32_bf16 v[164:167], a[32:35], a[184:187], v[164:167]
 s_add_u32 s90, s59, s3
 v_mfma_f32_16x16x32_bf16 v[172:175], a[40:43], a[184:187], v[172:175]
 s_add_u32 s3, s55, 2
 ds_read_b128 a[8:11], v25 offset:1024
 ds_read_b128 a[12:15], v25 offset:5120
 v_add_u32 v54, s61, v18
 v_mfma_f32_16x16x32_bf16 v[172:175], a[44:47], a[188:191], v[172:175]
 s_and_b32 s3, s3, 3
 buffer_load_dwordx4 v18, s[24:27], s91 offen offset:1024 sc1 lds
 v_mfma_f32_16x16x32_bf16 v[168:171], a[44:47], a[180:183], v[168:171]
 s_lshl_b32 s3, s3, 11
 v_add_u32 v55, s5, v18
 v_mfma_f32_16x16x32_bf16 v[168:171], a[40:43], a[176:179], v[168:171]
 s_waitcnt lgkmcnt(4)
 s_add_u32 s49, s59, s3
 v_mfma_f32_16x16x32_bf16 v[176:179], a[48:51], a[176:179], v[176:179]
 s_add_u32 s3, s55, 3
 ds_read_b128 a[16:19], v25 offset:2048
 ds_read_b128 a[20:23], v25 offset:6144
 v_mfma_f32_16x16x32_bf16 v[176:179], a[52:55], a[180:183], v[176:179]
 s_and_b32 s3, s3, 3
 buffer_load_dwordx4 v18, s[24:27], s91 offen offset:2048 sc1 lds
 v_mfma_f32_16x16x32_bf16 v[180:183], a[52:55], a[188:191], v[180:183]
 s_lshl_b32 s3, s3, 11
 v_mfma_f32_16x16x32_bf16 v[180:183], a[48:51], a[184:187], v[180:183]
 s_add_u32 s50, s59, s3
 v_mfma_f32_16x16x32_bf16 v[188:191], a[56:59], a[184:187], v[188:191]
 ds_read_b128 a[24:27], v25 offset:3072
 ds_read_b128 a[28:31], v25 offset:7168
 v_mfma_f32_16x16x32_bf16 v[188:191], a[60:63], a[188:191], v[188:191]
 buffer_load_dwordx4 v18, s[24:27], s91 offen offset:3072 sc1 lds
 v_mfma_f32_16x16x32_bf16 v[184:187], a[60:63], a[180:183], v[184:187]
 v_mfma_f32_16x16x32_bf16 v[184:187], a[56:59], a[176:179], v[184:187]
 s_waitcnt lgkmcnt(4)
 s_waitcnt vmcnt(29)
 v_mfma_f32_16x16x32_bf16 v[128:131], a[0:3], a[192:195], v[128:131]
 ds_read_b128 a[32:35], v25 offset:8192
 ds_read_b128 a[36:39], v25 offset:12288
 v_mfma_f32_16x16x32_bf16 v[128:131], a[4:7], a[196:199], v[128:131]
 buffer_load_dword v19, v20, s[40:43], 0 offen sc1
 v_mfma_f32_16x16x32_bf16 v[132:135], a[4:7], a[204:207], v[132:135]
 buffer_load_dwordx4 a[144:147], v21, s[32:35], s52 offen offset:0 sc1
 v_mfma_f32_16x16x32_bf16 v[132:135], a[0:3], a[200:203], v[132:135]
 buffer_load_dwordx4 a[148:151], v21, s[32:35], s52 offen offset:1024 sc1
 v_mfma_f32_16x16x32_bf16 v[140:143], a[8:11], a[200:203], v[140:143]
 ds_read_b128 a[40:43], v25 offset:9216
 ds_read_b128 a[44:47], v25 offset:13312
 v_mfma_f32_16x16x32_bf16 v[140:143], a[12:15], a[204:207], v[140:143]
 buffer_load_dwordx4 a[152:155], v22, s[32:35], s52 offen offset:0 sc1
 v_mfma_f32_16x16x32_bf16 v[136:139], a[12:15], a[196:199], v[136:139]
 buffer_load_dwordx4 a[156:159], v22, s[32:35], s52 offen offset:1024 sc1
 v_mfma_f32_16x16x32_bf16 v[136:139], a[8:11], a[192:195], v[136:139]
 s_waitcnt lgkmcnt(4)
 s_add_u32 s52, s52, 2048
 s_add_u32 s91, s89, 0
 s_add_u32 m0, s47, 32768
 s_nop 0
 buffer_load_dwordx4 v18, s[24:27], s91 offen offset:0 sc1 lds
 v_mfma_f32_16x16x32_bf16 v[144:147], a[16:19], a[192:195], v[144:147]
 ds_read_b128 a[48:51], v25 offset:10240
 ds_read_b128 a[52:55], v25 offset:14336
 v_mfma_f32_16x16x32_bf16 v[144:147], a[20:23], a[196:199], v[144:147]
 buffer_load_dwordx4 v18, s[24:27], s91 offen offset:1024 sc1 lds
 v_mfma_f32_16x16x32_bf16 v[148:151], a[20:23], a[204:207], v[148:151]
 v_mfma_f32_16x16x32_bf16 v[148:151], a[16:19], a[200:203], v[148:151]
 buffer_load_dwordx4 v18, s[24:27], s91 offen offset:2048 sc1 lds
 v_mfma_f32_16x16x32_bf16 v[156:159], a[24:27], a[200:203], v[156:159]
 ds_read_b128 a[56:59], v25 offset:11264
 ds_read_b128 a[60:63], v25 offset:15360
 v_mfma_f32_16x16x32_bf16 v[156:159], a[28:31], a[204:207], v[156:159]
 buffer_load_dwordx4 v18, s[24:27], s91 offen offset:3072 sc1 lds
 v_mfma_f32_16x16x32_bf16 v[152:155], a[28:31], a[196:199], v[152:155]
 v_mfma_f32_16x16x32_bf16 v[152:155], a[24:27], a[192:195], v[152:155]
 s_waitcnt lgkmcnt(4)
 v_mfma_f32_16x16x32_bf16 v[160:163], a[32:35], a[192:195], v[160:163]
 ds_read_b128 a[0:3], v25 offset:16384
 ds_read_b128 a[4:7], v25 offset:20480
 v_mfma_f32_16x16x32_bf16 v[160:163], a[36:39], a[196:199], v[160:163]
 v_mfma_f32_16x16x32_bf16 v[164:167], a[36:39], a[204:207], v[164:167]
 v_mfma_f32_16x16x32_bf16 v[164:167], a[32:35], a[200:203], v[164:167]
 v_mfma_f32_16x16x32_bf16 v[172:175], a[40:43], a[200:203], v[172:175]
 ds_read_b128 a[8:11], v25 offset:17408
 ds_read_b128 a[12:15], v25 offset:21504
 v_mfma_f32_16x16x32_bf16 v[172:175], a[44:47], a[204:207], v[172:175]
 v_mfma_f32_16x16x32_bf16 v[168:171], a[44:47], a[196:199], v[168:171]
 v_mfma_f32_16x16x32_bf16 v[168:171], a[40:43], a[192:195], v[168:171]
 s_waitcnt lgkmcnt(4)
 v_mfma_f32_16x16x32_bf16 v[176:179], a[48:51], a[192:195], v[176:179]
 ds_read_b128 a[16:19], v25 offset:18432
 ds_read_b128 a[20:23], v25 offset:22528
 v_mfma_f32_16x16x32_bf16 v[176:179], a[52:55], a[196:199], v[176:179]
 v_mfma_f32_16x16x32_bf16 v[180:183], a[52:55], a[204:207], v[180:183]
 v_mfma_f32_16x16x32_bf16 v[180:183], a[48:51], a[200:203], v[180:183]
 v_mfma_f32_16x16x32_bf16 v[188:191], a[56:59], a[200:203], v[188:191]
 ds_read_b128 a[24:27], v25 offset:19456
 ds_read_b128 a[28:31], v25 offset:23552
 v_mfma_f32_16x16x32_bf16 v[188:191], a[60:63], a[204:207], v[188:191]
 v_mfma_f32_16x16x32_bf16 v[184:187], a[60:63], a[196:199], v[184:187]
 v_mfma_f32_16x16x32_bf16 v[184:187], a[56:59], a[192:195], v[184:187]
 s_waitcnt lgkmcnt(4)
 s_waitcnt vmcnt(34)
 v_mfma_f32_16x16x32_bf16 v[128:131], a[0:3], a[208:211], v[128:131]
 ds_read_b128 a[32:35], v25 offset:24576
 ds_read_b128 a[36:39], v25 offset:28672
 v_mfma_f32_16x16x32_bf16 v[128:131], a[4:7], a[212:215], v[128:131]
 v_mfma_f32_16x16x32_bf16 v[132:135], a[4:7], a[220:223], v[132:135]
 v_mfma_f32_16x16x32_bf16 v[132:135], a[0:3], a[216:219], v[132:135]
 v_mfma_f32_16x16x32_bf16 v[140:143], a[8:11], a[216:219], v[140:143]
 ds_read_b128 a[40:43], v25 offset:25600
 ds_read_b128 a[44:47], v25 offset:29696
 v_mfma_f32_16x16x32_bf16 v[140:143], a[12:15], a[220:223], v[140:143]
 v_mfma_f32_16x16x32_bf16 v[136:139], a[12:15], a[212:215], v[136:139]
 v_mfma_f32_16x16x32_bf16 v[136:139], a[8:11], a[208:211], v[136:139]
 s_waitcnt lgkmcnt(4)
 v_mfma_f32_16x16x32_bf16 v[144:147], a[16:19], a[208:211], v[144:147]
 ds_read_b128 a[48:51], v25 offset:26624
 ds_read_b128 a[52:55], v25 offset:30720
 v_mfma_f32_16x16x32_bf16 v[144:147], a[20:23], a[212:215], v[144:147]
 v_mfma_f32_16x16x32_bf16 v[148:151], a[20:23], a[220:223], v[148:151]
 v_mfma_f32_16x16x32_bf16 v[148:151], a[16:19], a[216:219], v[148:151]
 v_mfma_f32_16x16x32_bf16 v[156:159], a[24:27], a[216:219], v[156:159]
 ds_read_b128 a[56:59], v25 offset:27648
 ds_read_b128 a[60:63], v25 offset:31744
 v_mfma_f32_16x16x32_bf16 v[156:159], a[28:31], a[220:223], v[156:159]
 v_mfma_f32_16x16x32_bf16 v[152:155], a[28:31], a[212:215], v[152:155]
 s_waitcnt vmcnt(8)
 v_cmp_gt_u32 vcc, s62, v19
 v_mfma_f32_16x16x32_bf16 v[152:155], a[24:27], a[208:211], v[152:155]
 s_waitcnt lgkmcnt(4)
 s_cbranch_vccnz ae_spin
ae_ok:
 s_barrier
 v_mfma_f32_16x16x32_bf16 v[160:163], a[32:35], a[208:211], v[160:163]
 s_lshl_b32 s7, s53, 2
 s_add_u32 s7, s7, s44
 s_lshl_b32 s7, s7, 18
 s_lshl_b32 s52, s55, 15
 s_add_u32 s52, s52, s7
 ds_read_b128 a[0:3], v25 offset:32768
 ds_read_b128 a[4:7], v25 offset:36864
 v_mfma_f32_16x16x32_bf16 v[160:163], a[36:39], a[212:215], v[160:163]
 buffer_load_dwordx4 a[160:163], v23, s[36:39], s52 offen offset:0 sc1
 v_mfma_f32_16x16x32_bf16 v[164:167], a[36:39], a[220:223], v[164:167]
 v_add_u32 v20, 256, v20
 v_mfma_f32_16x16x32_bf16 v[164:167], a[32:35], a[216:219], v[164:167]
 buffer_load_dwordx4 a[164:167], v23, s[36:39], s52 offen offset:1024 sc1
 v_mfma_f32_16x16x32_bf16 v[172:175], a[40:43], a[216:219], v[172:175]
 ds_read_b128 a[8:11], v25 offset:33792
 ds_read_b128 a[12:15], v25 offset:37888
 v_mfma_f32_16x16x32_bf16 v[172:175], a[44:47], a[220:223], v[172:175]
 buffer_load_dwordx4 a[168:171], v24, s[36:39], s52 offen offset:0 sc1
 v_mfma_f32_16x16x32_bf16 v[168:171], a[44:47], a[212:215], v[168:171]
 v_mfma_f32_16x16x32_bf16 v[168:171], a[40:43], a[208:211], v[168:171]
 s_waitcnt lgkmcnt(4)
 buffer_load_dwordx4 a[172:175], v24, s[36:39], s52 offen offset:1024 sc1
 v_mfma_f32_16x16x32_bf16 v[176:179], a[48:51], a[208:211], v[176:179]
 s_add_u32 s52, s52, 2048
 s_add_u32 s91, s89, 8192
 s_add_u32 m0, s47, 49152
 ds_read_b128 a[16:19], v25 offset:34816
 ds_read_b128 a[20:23], v25 offset:38912
 v_mfma_f32_16x16x32_bf16 v[176:179], a[52:55], a[212:215], v[176:179]
 buffer_load_dwordx4 v18, s[24:27], s91 offen offset:0 sc1 lds
 v_mfma_f32_16x16x32_bf16 v[180:183], a[52:55], a[220:223], v[180:183]
 v_mfma_f32_16x16x32_bf16 v[180:183], a[48:51], a[216:219], v[180:183]
 buffer_load_dwordx4 v18, s[24:27], s91 offen offset:1024 sc1 lds
 v_mfma_f32_16x16x32_bf16 v[188:191], a[56:59], a[216:219], v[188:191]
 ds_read_b128 a[24:27], v25 offset:35840
 ds_read_b128 a[28:31], v25 offset:39936
 v_mfma_f32_16x16x32_bf16 v[188:191], a[60:63], a[220:223], v[188:191]
 buffer_load_dwordx4 v18, s[24:27], s91 offen offset:2048 sc1 lds
 v_mfma_f32_16x16x32_bf16 v[184:187], a[60:63], a[212:215], v[184:187]
 v_mfma_f32_16x16x32_bf16 v[184:187], a[56:59], a[208:211], v[184:187]
 s_waitcnt lgkmcnt(4)
 buffer_load_dwordx4 v18, s[24:27], s91 offen offset:3072 sc1 lds
 v_mfma_f32_16x16x32_bf16 v[128:131], a[0:3], a[224:227], v[128:131]
 ds_read_b128 a[32:35], v25 offset:40960
 ds_read_b128 a[36:39], v25 offset:45056
 v_mfma_f32_16x16x32_bf16 v[128:131], a[4:7], a[228:231], v[128:131]
 buffer_load_dwordx4 a[176:179], v23, s[36:39], s52 offen offset:0 sc1
 v_mfma_f32_16x16x32_bf16 v[132:135], a[4:7], a[236:239], v[132:135]
 buffer_load_dwordx4 a[180:183], v23, s[36:39], s52 offen offset:1024 sc1
 v_mfma_f32_16x16x32_bf16 v[132:135], a[0:3], a[232:235], v[132:135]
 buffer_load_dwordx4 a[184:187], v24, s[36:39], s52 offen offset:0 sc1
 v_mfma_f32_16x16x32_bf16 v[140:143], a[8:11], a[232:235], v[140:143]
 ds_read_b128 a[40:43], v25 offset:41984
 ds_read_b128 a[44:47], v25 offset:46080
 v_mfma_f32_16x16x32_bf16 v[140:143], a[12:15], a[236:239], v[140:143]
 buffer_load_dwordx4 a[188:191], v24, s[36:39], s52 offen offset:1024 sc1
 v_mfma_f32_16x16x32_bf16 v[136:139], a[12:15], a[228:231], v[136:139]
 s_add_u32 s52, s52, 2048
 s_add_u32 s91, s89, 16384
 s_add_u32 m0, s47, 65536
 v_mfma_f32_16x16x32_bf16 v[136:139], a[8:11], a[224:227], v[136:139]
 s_waitcnt lgkmcnt(4)
 buffer_load_dwordx4 v18, s[24:27], s91 offen offset:0 sc1 lds
 v_mfma_f32_16x16x32_bf16 v[144:147], a[16:19], a[224:227], v[144:147]
 ds_read_b128 a[48:51], v25 offset:43008
 ds_read_b128 a[52:55], v25 offset:47104
 v_mfma_f32_16x16x32_bf16 v[144:147], a[20:23], a[228:231], v[144:147]
 buffer_load_dwordx4 v18, s[24:27], s91 offen offset:1024 sc1 lds
 v_mfma_f32_16x16x32_bf16 v[148:151], a[20:23], a[236:239], v[148:151]
 v_mfma_f32_16x16x32_bf16 v[148:151], a[16:19], a[232:235], v[148:151]
 buffer_load_dwordx4 v18, s[24:27], s91 offen offset:2048 sc1 lds
 v_mfma_f32_16x16x32_bf16 v[156:159], a[24:27], a[232:235], v[156:159]
 ds_read_b128 a[56:59], v25 offset:44032
 ds_read_b128 a[60:63], v25 offset:48128
 v_mfma_f32_16x16x32_bf16 v[156:159], a[28:31], a[236:239], v[156:159]
 buffer_load_dwordx4 v18, s[24:27], s91 offen offset:3072 sc1 lds
 v_mfma_f32_16x16x32_bf16 v[152:155], a[28:31], a[228:231], v[152:155]
 v_mfma_f32_16x16x32_bf16 v[152:155], a[24:27], a[224:227], v[152:155]
 s_waitcnt lgkmcnt(4)
 v_mfma_f32_16x16x32_bf16 v[160:163], a[32:35], a[224:227], v[160:163]
 ds_read_b128 a[0:3], v25 offset:49152
 ds_read_b128 a[4:7], v25 offset:53248
 v_mfma_f32_16x16x32_bf16 v[160:163], a[36:39], a[228:231], v[160:163]
 v_mfma_f32_16x16x32_bf16 v[164:167], a[36:39], a[236:239], v[164:167]
 v_mfma_f32_16x16x32_bf16 v[164:167], a[32:35], a[232:235], v[164:167]
 v_mfma_f32_16x16x32_bf16 v[172:175], a[40:43], a[232:235], v[172:175]
 ds_read_b128 a[8:11], v25 offset:50176
 ds_read_b128 a[12:15], v25 offset:54272
 v_mfma_f32_16x16x32_bf16 v[172:175], a[44:47], a[236:239], v[172:175]
 v_mfma_f32_16x16x32_bf16 v[168:171], a[44:47], a[228:231], v[168:171]
 v_mfma_f32_16x16x32_bf16 v[168:171], a[40:43], a[224:227], v[168:171]
 s_waitcnt lgkmcnt(4)
 v_mfma_f32_16x16x32_bf16 v[176:179], a[48:51], a[224:227], v[176:179]
 ds_read_b128 a[16:19], v25 offset:51200
 ds_read_b128 a[20:23], v25 offset:55296
 v_mfma_f32_16x16x32_bf16 v[176:179], a[52:55], a[228:231], v[176:179]
 v_mfma_f32_16x16x32_bf16 v[180:183], a[52:55], a[236:239], v[180:183]
 v_mfma_f32_16x16x32_bf16 v[180:183], a[48:51], a[232:235], v[180:183]
 v_mfma_f32_16x16x32_bf16 v[188:191], a[56:59], a[232:235], v[188:191]
 ds_read_b128 a[24:27], v25 offset:52224
 ds_read_b128 a[28:31], v25 offset:56320
 v_mfma_f32_16x16x32_bf16 v[188:191], a[60:63], a[236:239], v[188:191]
 v_mfma_f32_16x16x32_bf16 v[184:187], a[60:63], a[228:231], v[184:187]
 v_mfma_f32_16x16x32_bf16 v[184:187], a[56:59], a[224:227], v[184:187]
 s_waitcnt lgkmcnt(4)
 v_mfma_f32_16x16x32_bf16 v[128:131], a[0:3], a[240:243], v[128:131]
 ds_read_b128 a[32:35], v25 offset:57344
 ds_read_b128 a[36:39], v25 offset:61440
 v_mfma_f32_16x16x32_bf16 v[128:131], a[4:7], a[244:247], v[128:131]
 buffer_load_dwordx4 a[192:195], v23, s[36:39], s52 offen offset:0 sc1
 v_mfma_f32_16x16x32_bf16 v[132:135], a[4:7], a[252:255], v[132:135]
 v_mfma_f32_16x16x32_bf16 v[132:135], a[0:3], a[248:251], v[132:135]
 buffer_load_dwordx4 a[196:199], v23, s[36:39], s52 offen offset:1024 sc1
 v_mfma_f32_16x16x32_bf16 v[140:143], a[8:11], a[248:251], v[140:143]
 ds_read_b128 a[40:43], v25 offset:58368
 ds_read_b128 a[44:47], v25 offset:62464
 v_mfma_f32_16x16x32_bf16 v[140:143], a[12:15], a[252:255], v[140:143]
 v_mfma_f32_16x16x32_bf16 v[136:139], a[12:15], a[244:247], v[136:139]
 v_mfma_f32_16x16x32_bf16 v[136:139], a[8:11], a[240:243], v[136:139]
 s_waitcnt lgkmcnt(4)
 buffer_load_dwordx4 a[200:203], v24, s[36:39], s52 offen offset:0 sc1
 v_mfma_f32_16x16x32_bf16 v[144:147], a[16:19], a[240:243], v[144:147]
 ds_read_b128 a[48:51], v25 offset:59392
 ds_read_b128 a[52:55], v25 offset:63488
 v_mfma_f32_16x16x32_bf16 v[144:147], a[20:23], a[244:247], v[144:147]
 v_mfma_f32_16x16x32_bf16 v[148:151], a[20:23], a[252:255], v[148:151]
 v_mfma_f32_16x16x32_bf16 v[148:151], a[16:19], a[248:251], v[148:151]
 buffer_load_dwordx4 a[204:207], v24, s[36:39], s52 offen offset:1024 sc1
 v_mfma_f32_16x16x32_bf16 v[156:159], a[24:27], a[248:251], v[156:159]
 s_add_u32 s52, s52, 2048
 ds_read_b128 a[56:59], v25 offset:60416
 ds_read_b128 a[60:63], v25 offset:64512
 v_mfma_f32_16x16x32_bf16 v[156:159], a[28:31], a[252:255], v[156:159]
 v_mfma_f32_16x16x32_bf16 v[152:155], a[28:31], a[244:247], v[152:155]
 v_mfma_f32_16x16x32_bf16 v[152:155], a[24:27], a[240:243], v[152:155]
 s_waitcnt lgkmcnt(4)
 s_barrier
 v_mfma_f32_16x16x32_bf16 v[160:163], a[32:35], a[240:243], v[160:163]
 s_add_u32 s91, s89, 24576
 s_add_u32 m0, s47, 81920
 ds_read_b128 a[0:3], v18 offset:0
 ds_read_b128 a[4:7], v18 offset:4096
 v_mfma_f32_16x16x32_bf16 v[160:163], a[36:39], a[244:247], v[160:163]
 buffer_load_dwordx4 v18, s[24:27], s91 offen offset:0 sc1 lds
 v_mfma_f32_16x16x32_bf16 v[164:167], a[36:39], a[252:255], v[164:167]
 v_mfma_f32_16x16x32_bf16 v[164:167], a[32:35], a[248:251], v[164:167]
 v_mfma_f32_16x16x32_bf16 v[172:175], a[40:43], a[248:251], v[172:175]
 ds_read_b128 a[8:11], v18 offset:1024
 ds_read_b128 a[12:15], v18 offset:5120
 v_mfma_f32_16x16x32_bf16 v[172:175], a[44:47], a[252:255], v[172:175]
 buffer_load_dwordx4 v18, s[24:27], s91 offen offset:1024 sc1 lds
 v_mfma_f32_16x16x32_bf16 v[168:171], a[44:47], a[244:247], v[168:171]
 v_mfma_f32_16x16x32_bf16 v[168:171], a[40:43], a[240:243], v[168:171]
 s_waitcnt lgkmcnt(4)
 v_mfma_f32_16x16x32_bf16 v[176:179], a[48:51], a[240:243], v[176:179]
 ds_read_b128 a[16:19], v18 offset:2048
 ds_read_b128 a[20:23], v18 offset:6144
 v_mfma_f32_16x16x32_bf16 v[176:179], a[52:55], a[244:247], v[176:179]
 buffer_load_dwordx4 v18, s[24:27], s91 offen offset:2048 sc1 lds
 v_mfma_f32_16x16x32_bf16 v[180:183], a[52:55], a[252:255], v[180:183]
 v_mfma_f32_16x16x32_bf16 v[180:183], a[48:51], a[248:251], v[180:183]
 v_mfma_f32_16x16x32_bf16 v[188:191], a[56:59], a[248:251], v[188:191]
 ds_read_b128 a[24:27], v18 offset:3072
 ds_read_b128 a[28:31], v18 offset:7168
 v_mfma_f32_16x16x32_bf16 v[188:191], a[60:63], a[252:255], v[188:191]
 buffer_load_dwordx4 v18, s[24:27], s91 offen offset:3072 sc1 lds
 v_mfma_f32_16x16x32_bf16 v[184:187], a[60:63], a[244:247], v[184:187]
 v_mfma_f32_16x16x32_bf16 v[184:187], a[56:59], a[240:243], v[184:187]
 s_waitcnt lgkmcnt(4)
 v_mfma_f32_16x16x32_bf16 v[128:131], a[0:3], a[128:131], v[128:131]
 ds_read_b128 a[32:35], v18 offset:8192
 ds_read_b128 a[36:39], v18 offset:12288
 v_mfma_f32_16x16x32_bf16 v[128:131], a[4:7], a[132:135], v[128:131]
 buffer_load_dwordx4 a[208:211], v23, s[36:39], s52 offen offset:0 sc1
 v_mfma_f32_16x16x32_bf16 v[132:135], a[4:7], a[140:143], v[132:135]
 buffer_load_dwordx4 a[212:215], v23, s[36:39], s52 offen offset:1024 sc1
 v_mfma_f32_16x16x32_bf16 v[132:135], a[0:3], a[136:139], v[132:135]
 buffer_load_dwordx4 a[216:219], v24, s[36:39], s52 offen offset:0 sc1
 v_mfma_f32_16x16x32_bf16 v[140:143], a[8:11], a[136:139], v[140:143]
 ds_read_b128 a[40:43], v18 offset:9216
 ds_read_b128 a[44:47], v18 offset:13312
 v_mfma_f32_16x16x32_bf16 v[140:143], a[12:15], a[140:143], v[140:143]
 buffer_load_dwordx4 a[220:223], v24, s[36:39], s52 offen offset:1024 sc1
 v_mfma_f32_16x16x32_bf16 v[136:139], a[12:15], a[132:135], v[136:139]
 s_add_u32 s52, s52, 2048
 s_add_u32 s91, s89, 32768
 s_add_u32 m0, s47, 98304
 v_mfma_f32_16x16x32_bf16 v[136:139], a[8:11], a[128:131], v[136:139]
 s_waitcnt lgkmcnt(4)
 buffer_load_dwordx4 v18, s[24:27], s91 offen offset:0 sc1 lds
 v_mfma_f32_16x16x32_bf16 v[144:147], a[16:19], a[128:131], v[144:147]
 ds_read_b128 a[48:51], v18 offset:10240
 ds_read_b128 a[52:55], v18 offset:14336
 v_mfma_f32_16x16x32_bf16 v[144:147], a[20:23], a[132:135], v[144:147]
 buffer_load_dwordx4 v18, s[24:27], s91 offen offset:1024 sc1 lds
 v_mfma_f32_16x16x32_bf16 v[148:151], a[20:23], a[140:143], v[148:151]
 v_mfma_f32_16x16x32_bf16 v[148:151], a[16:19], a[136:139], v[148:151]
 buffer_load_dwordx4 v18, s[24:27], s91 offen offset:2048 sc1 lds
 v_mfma_f32_16x16x32_bf16 v[156:159], a[24:27], a[136:139], v[156:159]
 ds_read_b128 a[56:59], v18 offset:11264
 ds_read_b128 a[60:63], v18 offset:15360
 v_mfma_f32_16x16x32_bf16 v[156:159], a[28:31], a[140:143], v[156:159]
 buffer_load_dwordx4 v18, s[24:27], s91 offen offset:3072 sc1 lds
 v_mfma_f32_16x16x32_bf16 v[152:155], a[28:31], a[132:135], v[152:155]
 v_mfma_f32_16x16x32_bf16 v[152:155], a[24:27], a[128:131], v[152:155]
 s_waitcnt lgkmcnt(4)
 v_mfma_f32_16x16x32_bf16 v[160:163], a[32:35], a[128:131], v[160:163]
 ds_read_b128 a[0:3], v18 offset:16384
 ds_read_b128 a[4:7], v18 offset:20480
 v_mfma_f32_16x16x32_bf16 v[160:163], a[36:39], a[132:135], v[160:163]
 v_mfma_f32_16x16x32_bf16 v[164:167], a[36:39], a[140:143], v[164:167]
 v_mfma_f32_16x16x32_bf16 v[164:167], a[32:35], a[136:139], v[164:167]
 v_mfma_f32_16x16x32_bf16 v[172:175], a[40:43], a[136:139], v[172:175]
 ds_read_b128 a[8:11], v18 offset:17408
 ds_read_b128 a[12:15], v18 offset:21504
 v_mfma_f32_16x16x32_bf16 v[172:175], a[44:47], a[140:143], v[172:175]
 v_mfma_f32_16x16x32_bf16 v[168:171], a[44:47], a[132:135], v[168:171]
 v_mfma_f32_16x16x32_bf16 v[168:171], a[40:43], a[128:131], v[168:171]
 s_waitcnt lgkmcnt(4)
 v_mfma_f32_16x16x32_bf16 v[176:179], a[48:51], a[128:131], v[176:179]
 ds_read_b128 a[16:19], v18 offset:18432
 ds_read_b128 a[20:23], v18 offset:22528
 v_mfma_f32_16x16x32_bf16 v[176:179], a[52:55], a[132:135], v[176:179]
 v_mfma_f32_16x16x32_bf16 v[180:183], a[52:55], a[140:143], v[180:183]
 v_mfma_f32_16x16x32_bf16 v[180:183], a[48:51], a[136:139], v[180:183]
 v_mfma_f32_16x16x32_bf16 v[188:191], a[56:59], a[136:139], v[188:191]
 ds_read_b128 a[24:27], v18 offset:19456
 ds_read_b128 a[28:31], v18 offset:23552
 v_mfma_f32_16x16x32_bf16 v[188:191], a[60:63], a[140:143], v[188:191]
 v_mfma_f32_16x16x32_bf16 v[184:187], a[60:63], a[132:135], v[184:187]
 v_mfma_f32_16x16x32_bf16 v[184:187], a[56:59], a[128:131], v[184:187]
 s_waitcnt lgkmcnt(4)
 s_waitcnt vmcnt(36)
 v_mfma_f32_16x16x32_bf16 v[128:131], a[0:3], a[144:147], v[128:131]
 ds_read_b128 a[32:35], v18 offset:24576
 ds_read_b128 a[36:39], v18 offset:28672
 v_mfma_f32_16x16x32_bf16 v[128:131], a[4:7], a[148:151], v[128:131]
 buffer_load_dwordx4 a[224:227], v23, s[36:39], s52 offen offset:0 sc1
 v_mfma_f32_16x16x32_bf16 v[132:135], a[4:7], a[156:159], v[132:135]
 v_mfma_f32_16x16x32_bf16 v[132:135], a[0:3], a[152:155], v[132:135]
 buffer_load_dwordx4 a[228:231], v23, s[36:39], s52 offen offset:1024 sc1
 v_mfma_f32_16x16x32_bf16 v[140:143], a[8:11], a[152:155], v[140:143]
 ds_read_b128 a[40:43], v18 offset:25600
 ds_read_b128 a[44:47], v18 offset:29696
 v_mfma_f32_16x16x32_bf16 v[140:143], a[12:15], a[156:159], v[140:143]
 v_mfma_f32_16x16x32_bf16 v[136:139], a[12:15], a[148:151], v[136:139]
 v_mfma_f32_16x16x32_bf16 v[136:139], a[8:11], a[144:147], v[136:139]
 s_waitcnt lgkmcnt(4)
 buffer_load_dwordx4 a[232:235], v24, s[36:39], s52 offen offset:0 sc1
 v_mfma_f32_16x16x32_bf16 v[144:147], a[16:19], a[144:147], v[144:147]
 ds_read_b128 a[48:51], v18 offset:26624
 ds_read_b128 a[52:55], v18 offset:30720
 v_mfma_f32_16x16x32_bf16 v[144:147], a[20:23], a[148:151], v[144:147]
 v_mfma_f32_16x16x32_bf16 v[148:151], a[20:23], a[156:159], v[148:151]
 v_mfma_f32_16x16x32_bf16 v[148:151], a[16:19], a[152:155], v[148:151]
 buffer_load_dwordx4 a[236:239], v24, s[36:39], s52 offen offset:1024 sc1
 v_mfma_f32_16x16x32_bf16 v[156:159], a[24:27], a[152:155], v[156:159]
 s_add_u32 s52, s52, 2048
 ds_read_b128 a[56:59], v18 offset:27648
 ds_read_b128 a[60:63], v18 offset:31744
 v_mfma_f32_16x16x32_bf16 v[156:159], a[28:31], a[156:159], v[156:159]
 v_mfma_f32_16x16x32_bf16 v[152:155], a[28:31], a[148:151], v[152:155]
 s_waitcnt vmcnt(28)
 v_mfma_f32_16x16x32_bf16 v[152:155], a[24:27], a[144:147], v[152:155]
 s_waitcnt lgkmcnt(4)
 s_barrier
 v_mfma_f32_16x16x32_bf16 v[160:163], a[32:35], a[144:147], v[160:163]
 s_add_u32 s91, s89, 40960
 s_add_u32 m0, s47, 114688
 ds_read_b128 a[0:3], v18 offset:32768
 ds_read_b128 a[4:7], v18 offset:36864
 v_mfma_f32_16x16x32_bf16 v[160:163], a[36:39], a[148:151], v[160:163]
 buffer_load_dwordx4 v18, s[24:27], s91 offen offset:0 sc1 lds
 v_mfma_f32_16x16x32_bf16 v[164:167], a[36:39], a[156:159], v[164:167]
 v_mfma_f32_16x16x32_bf16 v[164:167], a[32:35], a[152:155], v[164:167]
 v_mfma_f32_16x16x32_bf16 v[172:175], a[40:43], a[152:155], v[172:175]
 ds_read_b128 a[8:11], v18 offset:33792
 ds_read_b128 a[12:15], v18 offset:37888
 v_mfma_f32_16x16x32_bf16 v[172:175], a[44:47], a[156:159], v[172:175]
 buffer_load_dwordx4 v18, s[24:27], s91 offen offset:1024 sc1 lds
 v_mfma_f32_16x16x32_bf16 v[168:171], a[44:47], a[148:151], v[168:171]
 v_mfma_f32_16x16x32_bf16 v[168:171], a[40:43], a[144:147], v[168:171]
 s_waitcnt lgkmcnt(4)
 v_mfma_f32_16x16x32_bf16 v[176:179], a[48:51], a[144:147], v[176:179]
 ds_read_b128 a[16:19], v18 offset:34816
 ds_read_b128 a[20:23], v18 offset:38912
 v_mfma_f32_16x16x32_bf16 v[176:179], a[52:55], a[148:151], v[176:179]
 buffer_load_dwordx4 v18, s[24:27], s91 offen offset:2048 sc1 lds
 v_mfma_f32_16x16x32_bf16 v[180:183], a[52:55], a[156:159], v[180:183]
 v_mfma_f32_16x16x32_bf16 v[180:183], a[48:51], a[152:155], v[180:183]
 v_mfma_f32_16x16x32_bf16 v[188:191], a[56:59], a[152:155], v[188:191]
 ds_read_b128 a[24:27], v18 offset:35840
 ds_read_b128 a[28:31], v18 offset:39936
 v_mfma_f32_16x16x32_bf16 v[188:191], a[60:63], a[156:159], v[188:191]
 buffer_load_dwordx4 v18, s[24:27], s91 offen offset:3072 sc1 lds
 v_mfma_f32_16x16x32_bf16 v[184:187], a[60:63], a[148:151], v[184:187]
 v_mfma_f32_16x16x32_bf16 v[184:187], a[56:59], a[144:147], v[184:187]
 s_waitcnt lgkmcnt(4)
 v_mfma_f32_16x16x32_bf16 v[192:195], a[0:3], a[160:163], 0
 ds_read_b128 a[32:35], v18 offset:40960
 ds_read_b128 a[36:39], v18 offset:45056
 v_mfma_f32_16x16x32_bf16 v[192:195], a[4:7], a[164:167], v[192:195]
 buffer_load_dwordx4 a[240:243], v23, s[36:39], s52 offen offset:0 sc1
 v_cvt_pk_bf16_f32 v128, v128, v129
 v_cvt_pk_bf16_f32 v129, v130, v131
 v_mfma_f32_16x16x32_bf16 v[196:199], a[4:7], a[172:175], 0
 buffer_load_dwordx4 a[244:247], v23, s[36:39], s52 offen offset:1024 sc1
 v_cvt_pk_bf16_f32 v130, v136, v137
 v_cvt_pk_bf16_f32 v131, v138, v139
 v_mfma_f32_16x16x32_bf16 v[196:199], a[0:3], a[168:171], v[196:199]
 buffer_load_dwordx4 a[248:251], v24, s[36:39], s52 offen offset:0 sc1
 ds_write_b128 v53, v[128:131] offset:0
 v_mfma_f32_16x16x32_bf16 v[204:207], a[8:11], a[168:171], 0
 ds_read_b128 a[40:43], v18 offset:41984
 ds_read_b128 a[44:47], v18 offset:46080
 v_mfma_f32_16x16x32_bf16 v[204:207], a[12:15], a[172:175], v[204:207]
 buffer_load_dwordx4 a[252:255], v24, s[36:39], s52 offen offset:1024 sc1
 v_cvt_pk_bf16_f32 v132, v132, v133
 v_cvt_pk_bf16_f32 v133, v134, v135
 v_mfma_f32_16x16x32_bf16 v[200:203], a[12:15], a[164:167], 0
 s_add_u32 s52, s52, 2048
 s_add_u32 s91, s89, 49152
 s_add_u32 m0, s47, 0
 v_cvt_pk_bf16_f32 v134, v140, v141
 v_cvt_pk_bf16_f32 v135, v142, v143
 v_mfma_f32_16x16x32_bf16 v[200:203], a[8:11], a[160:163], v[200:203]
 s_waitcnt lgkmcnt(5)
 buffer_load_dwordx4 v18, s[24:27], s91 offen offset:0 sc1 lds
 ds_write_b128 v53, v[132:135] offset:2048
 v_mfma_f32_16x16x32_bf16 v[208:211], a[16:19], a[160:163], 0
 ds_read_b128 a[48:51], v18 offset:43008
 ds_read_b128 a[52:55], v18 offset:47104
 v_mfma_f32_16x16x32_bf16 v[208:211], a[20:23], a[164:167], v[208:211]
 buffer_load_dwordx4 v18, s[24:27], s91 offen offset:1024 sc1 lds
 v_cvt_pk_bf16_f32 v144, v144, v145
 v_cvt_pk_bf16_f32 v145, v146, v147
 v_mfma_f32_16x16x32_bf16 v[212:215], a[20:23], a[172:175], 0
 v_cvt_pk_bf16_f32 v146, v152, v153
 v_cvt_pk_bf16_f32 v147, v154, v155
 v_mfma_f32_16x16x32_bf16 v[212:215], a[16:19], a[168:171], v[212:215]
 buffer_load_dwordx4 v18, s[24:27], s91 offen offset:2048 sc1 lds
 ds_write_b128 v53, v[144:147] offset:1024
 v_mfma_f32_16x16x32_bf16 v[220:223], a[24:27], a[168:171], 0
 ds_read_b128 a[56:59], v18 offset:44032
 ds_read_b128 a[60:63], v18 offset:48128
 v_mfma_f32_16x16x32_bf16 v[220:223], a[28:31], a[172:175], v[220:223]
 buffer_load_dwordx4 v18, s[24:27], s91 offen offset:3072 sc1 lds
 v_cvt_pk_bf16_f32 v148, v148, v149
 v_cvt_pk_bf16_f32 v149, v150, v151
 v_mfma_f32_16x16x32_bf16 v[216:219], a[28:31], a[164:167], 0
 v_cvt_pk_bf16_f32 v150, v156, v157
 v_cvt_pk_bf16_f32 v151, v158, v159
 v_mfma_f32_16x16x32_bf16 v[216:219], a[24:27], a[160:163], v[216:219]
 s_waitcnt lgkmcnt(6)
 ds_write_b128 v53, v[148:151] offset:3072
 v_mfma_f32_16x16x32_bf16 v[224:227], a[32:35], a[160:163], 0
 ds_read_b128 a[0:3], v18 offset:49152
 ds_read_b128 a[4:7], v18 offset:53248
 v_mfma_f32_16x16x32_bf16 v[224:227], a[36:39], a[164:167], v[224:227]
 v_cvt_pk_bf16_f32 v160, v160, v161
 v_cvt_pk_bf16_f32 v161, v162, v163
 v_mfma_f32_16x16x32_bf16 v[228:231], a[36:39], a[172:175], 0
 v_cvt_pk_bf16_f32 v162, v168, v169
 v_cvt_pk_bf16_f32 v163, v170, v171
 v_mfma_f32_16x16x32_bf16 v[228:231], a[32:35], a[168:171], v[228:231]
 ds_write_b128 v54, v[160:163] offset:0
 v_mfma_f32_16x16x32_bf16 v[236:239], a[40:43], a[168:171], 0
 ds_read_b128 a[8:11], v18 offset:50176
 ds_read_b128 a[12:15], v18 offset:54272
 v_mfma_f32_16x16x32_bf16 v[236:239], a[44:47], a[172:175], v[236:239]
 v_cvt_pk_bf16_f32 v164, v164, v165
 v_cvt_pk_bf16_f32 v165, v166, v167
 v_mfma_f32_16x16x32_bf16 v[232:235], a[44:47], a[164:167], 0
 v_cvt_pk_bf16_f32 v166, v172, v173
 v_cvt_pk_bf16_f32 v167, v174, v175
 v_mfma_f32_16x16x32_bf16 v[232:235], a[40:43], a[160:163], v[232:235]
 s_waitcnt lgkmcnt(6)
 ds_write_b128 v54, v[164:167] offset:2048
 v_mfma_f32_16x16x32_bf16 v[240:243], a[48:51], a[160:163], 0
 ds_read_b128 a[16:19], v18 offset:51200
 ds_read_b128 a[20:23], v18 offset:55296
 v_mfma_f32_16x16x32_bf16 v[240:243], a[52:55], a[164:167], v[240:243]
 v_cvt_pk_bf16_f32 v176, v176, v177
 v_cvt_pk_bf16_f32 v177, v178, v179
 v_mfma_f32_16x16x32_bf16 v[244:247], a[52:55], a[172:175], 0
 v_cvt_pk_bf16_f32 v178, v184, v185
 v_cvt_pk_bf16_f32 v179, v186, v187
 v_mfma_f32_16x16x32_bf16 v[244:247], a[48:51], a[168:171], v[244:247]
 ds_write_b128 v54, v[176:179] offset:1024
 v_mfma_f32_16x16x32_bf16 v[252:255], a[56:59], a[168:171], 0
 ds_read_b128 a[24:27], v18 offset:52224
 ds_read_b128 a[28:31], v18 offset:56320
 v_mfma_f32_16x16x32_bf16 v[252:255], a[60:63], a[172:175], v[252:255]
 v_cvt_pk_bf16_f32 v180, v180, v181
 v_cvt_pk_bf16_f32 v181, v182, v183
 v_mfma_f32_16x16x32_bf16 v[248:251], a[60:63], a[164:167], 0
 v_cvt_pk_bf16_f32 v182, v188, v189
 v_cvt_pk_bf16_f32 v183, v190, v191
 v_mfma_f32_16x16x32_bf16 v[248:251], a[56:59], a[160:163], v[248:251]
 s_waitcnt lgkmcnt(6)
 ds_write_b128 v54, v[180:183] offset:3072
 s_waitcnt vmcnt(36)
 v_mfma_f32_16x16x32_bf16 v[192:195], a[0:3], a[176:179], v[192:195]
 ds_read_b128 a[32:35], v18 offset:57344
 ds_read_b128 a[36:39], v18 offset:61440
 v_mfma_f32_16x16x32_bf16 v[192:195], a[4:7], a[180:183], v[192:195]
 buffer_load_dwordx4 a[128:131], v23, s[36:39], s52 offen offset:0 sc1
 v_mfma_f32_16x16x32_bf16 v[196:199], a[4:7], a[188:191], v[196:199]
 v_mfma_f32_16x16x32_bf16 v[196:199], a[0:3], a[184:187], v[196:199]
 buffer_load_dwordx4 a[132:135], v23, s[36:39], s52 offen offset:1024 sc1
 v_mfma_f32_16x16x32_bf16 v[204:207], a[8:11], a[184:187], v[204:207]
 ds_read_b128 a[40:43], v18 offset:58368
 ds_read_b128 a[44:47], v18 offset:62464
 v_mfma_f32_16x16x32_bf16 v[204:207], a[12:15], a[188:191], v[204:207]
 buffer_load_dwordx4 a[136:139], v24, s[36:39], s52 offen offset:0 sc1
 v_mfma_f32_16x16x32_bf16 v[200:203], a[12:15], a[180:183], v[200:203]
 v_mfma_f32_16x16x32_bf16 v[200:203], a[8:11], a[176:179], v[200:203]
 s_waitcnt lgkmcnt(5)
 v_mfma_f32_16x16x32_bf16 v[208:211], a[16:19], a[176:179], v[208:211]
 ds_read_b128 a[48:51], v18 offset:59392
 ds_read_b128 a[52:55], v18 offset:63488
 v_mfma_f32_16x16x32_bf16 v[208:211], a[20:23], a[180:183], v[208:211]
 buffer_load_dwordx4 a[140:143], v24, s[36:39], s52 offen offset:1024 sc1
 v_mfma_f32_16x16x32_bf16 v[212:215], a[20:23], a[188:191], v[212:215]
 s_add_u32 s52, s52, 2048
 v_mfma_f32_16x16x32_bf16 v[212:215], a[16:19], a[184:187], v[212:215]
 buffer_store_dwordx4 v[128:131], v48, s[20:23], s54 offen offset:0 sc1
 v_mfma_f32_16x16x32_bf16 v[220:223], a[24:27], a[184:187], v[220:223]
 ds_read_b128 a[56:59], v18 offset:60416
 ds_read_b128 a[60:63], v18 offset:64512
 v_mfma_f32_16x16x32_bf16 v[220:223], a[28:31], a[188:191], v[220:223]
 v_mfma_f32_16x16x32_bf16 v[216:219], a[28:31], a[180:183], v[216:219]
 s_waitcnt vmcnt(29)
 v_mfma_f32_16x16x32_bf16 v[216:219], a[24:27], a[176:179], v[216:219]
 s_waitcnt lgkmcnt(4)
 s_barrier
 v_mfma_f32_16x16x32_bf16 v[224:227], a[32:35], a[176:179], v[224:227]
 s_add_u32 s91, s89, 57344
 s_add_u32 m0, s47, 16384
 ds_read_b128 a[0:3], v25 offset:0
 ds_read_b128 a[4:7], v25 offset:4096
 v_mfma_f32_16x16x32_bf16 v[224:227], a[36:39], a[180:183], v[224:227]
 buffer_load_dwordx4 v18, s[24:27], s91 offen offset:0 sc1 lds
 v_mfma_f32_16x16x32_bf16 v[228:231], a[36:39], a[188:191], v[228:231]
 v_mfma_f32_16x16x32_bf16 v[228:231], a[32:35], a[184:187], v[228:231]
 buffer_load_dwordx4 v18, s[24:27], s91 offen offset:1024 sc1 lds
 v_mfma_f32_16x16x32_bf16 v[236:239], a[40:43], a[184:187], v[236:239]
 ds_read_b128 a[8:11], v25 offset:1024
 ds_read_b128 a[12:15], v25 offset:5120
 v_mfma_f32_16x16x32_bf16 v[236:239], a[44:47], a[188:191], v[236:239]
 v_mfma_f32_16x16x32_bf16 v[232:235], a[44:47], a[180:183], v[232:235]
 v_mfma_f32_16x16x32_bf16 v[232:235], a[40:43], a[176:179], v[232:235]
 s_waitcnt lgkmcnt(4)
 buffer_load_dwordx4 v18, s[24:27], s91 offen offset:2048 sc1 lds
 v_mfma_f32_16x16x32_bf16 v[240:243], a[48:51], a[176:179], v[240:243]
 ds_read_b128 a[16:19], v25 offset:2048
 ds_read_b128 a[20:23], v25 offset:6144
 v_mfma_f32_16x16x32_bf16 v[240:243], a[52:55], a[180:183], v[240:243]
 buffer_load_dwordx4 v18, s[24:27], s91 offen offset:3072 sc1 lds
 v_mfma_f32_16x16x32_bf16 v[244:247], a[52:55], a[188:191], v[244:247]
 v_mfma_f32_16x16x32_bf16 v[244:247], a[48:51], a[184:187], v[244:247]
 v_mfma_f32_16x16x32_bf16 v[252:255], a[56:59], a[184:187], v[252:255]
 ds_read_b128 a[24:27], v25 offset:3072
 ds_read_b128 a[28:31], v25 offset:7168
 v_mfma_f32_16x16x32_bf16 v[252:255], a[60:63], a[188:191], v[252:255]
 buffer_store_dwordx4 v[160:163], v50, s[20:23], s56 offen offset:0 sc1
 v_mfma_f32_16x16x32_bf16 v[248:251], a[60:63], a[180:183], v[248:251]
 v_mfma_f32_16x16x32_bf16 v[248:251], a[56:59], a[176:179], v[248:251]
 s_waitcnt lgkmcnt(4)
 v_mfma_f32_16x16x32_bf16 v[192:195], a[0:3], a[192:195], v[192:195]
 ds_read_b128 a[32:35], v25 offset:8192
 ds_read_b128 a[36:39], v25 offset:12288
 v_mfma_f32_16x16x32_bf16 v[192:195], a[4:7], a[196:199], v[192:195]
 buffer_load_dword v19, v20, s[40:43], 0 offen sc1
 v_mfma_f32_16x16x32_bf16 v[196:199], a[4:7], a[204:207], v[196:199]
 buffer_load_dwordx4 a[144:147], v23, s[36:39], s52 offen offset:0 sc1
 v_mfma_f32_16x16x32_bf16 v[196:199], a[0:3], a[200:203], v[196:199]
 buffer_load_dwordx4 a[148:151], v23, s[36:39], s52 offen offset:1024 sc1
 v_mfma_f32_16x16x32_bf16 v[204:207], a[8:11], a[200:203], v[204:207]
 ds_read_b128 a[40:43], v25 offset:9216
 ds_read_b128 a[44:47], v25 offset:13312
 v_mfma_f32_16x16x32_bf16 v[204:207], a[12:15], a[204:207], v[204:207]
 buffer_load_dwordx4 a[152:155], v24, s[36:39], s52 offen offset:0 sc1
 v_mfma_f32_16x16x32_bf16 v[200:203], a[12:15], a[196:199], v[200:203]
 buffer_load_dwordx4 a[156:159], v24, s[36:39], s52 offen offset:1024 sc1
 v_mfma_f32_16x16x32_bf16 v[200:203], a[8:11], a[192:195], v[200:203]
 s_waitcnt lgkmcnt(4)
 s_add_u32 s52, s52, 2048
 s_add_u32 s91, s89, 65536
 s_add_u32 m0, s47, 32768
 s_nop 0
 buffer_load_dwordx4 v18, s[24:27], s91 offen offset:0 sc1 lds
 v_mfma_f32_16x16x32_bf16 v[208:211], a[16:19], a[192:195], v[208:211]
 ds_read_b128 a[48:51], v25 offset:10240
 ds_read_b128 a[52:55], v25 offset:14336
 v_mfma_f32_16x16x32_bf16 v[208:211], a[20:23], a[196:199], v[208:211]
 buffer_load_dwordx4 v18, s[24:27], s91 offen offset:1024 sc1 lds
 v_mfma_f32_16x16x32_bf16 v[212:215], a[20:23], a[204:207], v[212:215]
 buffer_load_dwordx4 v18, s[24:27], s91 offen offset:2048 sc1 lds
 v_mfma_f32_16x16x32_bf16 v[212:215], a[16:19], a[200:203], v[212:215]
 buffer_load_dwordx4 v18, s[24:27], s91 offen offset:3072 sc1 lds
 v_mfma_f32_16x16x32_bf16 v[220:223], a[24:27], a[200:203], v[220:223]
 ds_read_b128 a[56:59], v25 offset:11264
 ds_read_b128 a[60:63], v25 offset:15360
 v_mfma_f32_16x16x32_bf16 v[220:223], a[28:31], a[204:207], v[220:223]
 buffer_store_dwordx4 v[132:135], v49, s[20:23], s54 offen offset:0 sc1
 v_mfma_f32_16x16x32_bf16 v[216:219], a[28:31], a[196:199], v[216:219]
 v_mfma_f32_16x16x32_bf16 v[216:219], a[24:27], a[192:195], v[216:219]
 s_waitcnt lgkmcnt(4)
 v_mfma_f32_16x16x32_bf16 v[224:227], a[32:35], a[192:195], v[224:227]
 ds_read_b128 a[0:3], v25 offset:16384
 ds_read_b128 a[4:7], v25 offset:20480
 v_mfma_f32_16x16x32_bf16 v[224:227], a[36:39], a[196:199], v[224:227]
 buffer_store_dwordx4 v[164:167], v51, s[20:23], s56 offen offset:0 sc1
 v_mfma_f32_16x16x32_bf16 v[228:231], a[36:39], a[204:207], v[228:231]
 v_mfma_f32_16x16x32_bf16 v[228:231], a[32:35], a[200:203], v[228:231]
 v_mfma_f32_16x16x32_bf16 v[236:239], a[40:43], a[200:203], v[236:239]
 ds_read_b128 a[8:11], v25 offset:17408
 ds_read_b128 a[12:15], v25 offset:21504
 v_mfma_f32_16x16x32_bf16 v[236:239], a[44:47], a[204:207], v[236:239]
 v_mfma_f32_16x16x32_bf16 v[232:235], a[44:47], a[196:199], v[232:235]
 v_mfma_f32_16x16x32_bf16 v[232:235], a[40:43], a[192:195], v[232:235]
 s_waitcnt lgkmcnt(4)
 v_mfma_f32_16x16x32_bf16 v[240:243], a[48:51], a[192:195], v[240:243]
 ds_read_b128 a[16:19], v25 offset:18432
 ds_read_b128 a[20:23], v25 offset:22528
 v_mfma_f32_16x16x32_bf16 v[240:243], a[52:55], a[196:199], v[240:243]
 v_mfma_f32_16x16x32_bf16 v[244:247], a[52:55], a[204:207], v[244:247]
 v_mfma_f32_16x16x32_bf16 v[244:247], a[48:51], a[200:203], v[244:247]
 v_mfma_f32_16x16x32_bf16 v[252:255], a[56:59], a[200:203], v[252:255]
 ds_read_b128 a[24:27], v25 offset:19456
 ds_read_b128 a[28:31], v25 offset:23552
 v_mfma_f32_16x16x32_bf16 v[252:255], a[60:63], a[204:207], v[252:255]
 v_mfma_f32_16x16x32_bf16 v[248:251], a[60:63], a[196:199], v[248:251]
 v_mfma_f32_16x16x32_bf16 v[248:251], a[56:59], a[192:195], v[248:251]
 s_waitcnt lgkmcnt(4)
 s_waitcnt vmcnt(41)
 v_mfma_f32_16x16x32_bf16 v[192:195], a[0:3], a[208:211], v[192:195]
 ds_read_b128 a[32:35], v25 offset:24576
 ds_read_b128 a[36:39], v25 offset:28672
 v_mfma_f32_16x16x32_bf16 v[192:195], a[4:7], a[212:215], v[192:195]
 buffer_store_dwordx4 v[144:147], v48, s[20:23], s54 offen offset:1024 sc1
 v_mfma_f32_16x16x32_bf16 v[196:199], a[4:7], a[220:223], v[196:199]
 v_mfma_f32_16x16x32_bf16 v[196:199], a[0:3], a[216:219], v[196:199]
 v_mfma_f32_16x16x32_bf16 v[204:207], a[8:11], a[216:219], v[204:207]
 ds_read_b128 a[40:43], v25 offset:25600
 ds_read_b128 a[44:47], v25 offset:29696
 v_mfma_f32_16x16x32_bf16 v[204:207], a[12:15], a[220:223], v[204:207]
 v_mfma_f32_16x16x32_bf16 v[200:203], a[12:15], a[212:215], v[200:203]
 v_mfma_f32_16x16x32_bf16 v[200:203], a[8:11], a[208:211], v[200:203]
 s_waitcnt lgkmcnt(4)
 v_mfma_f32_16x16x32_bf16 v[208:211], a[16:19], a[208:211], v[208:211]
 ds_read_b128 a[48:51], v25 offset:26624
 ds_read_b128 a[52:55], v25 offset:30720
 v_mfma_f32_16x16x32_bf16 v[208:211], a[20:23], a[212:215], v[208:211]
 v_mfma_f32_16x16x32_bf16 v[212:215], a[20:23], a[220:223], v[212:215]
 v_mfma_f32_16x16x32_bf16 v[212:215], a[16:19], a[216:219], v[212:215]
 v_mfma_f32_16x16x32_bf16 v[220:223], a[24:27], a[216:219], v[220:223]
 ds_read_b128 a[56:59], v25 offset:27648
 ds_read_b128 a[60:63], v25 offset:31744
 v_mfma_f32_16x16x32_bf16 v[220:223], a[28:31], a[220:223], v[220:223]
 v_mfma_f32_16x16x32_bf16 v[216:219], a[28:31], a[212:215], v[216:219]
 s_waitcnt vmcnt(11)
 v_cmp_gt_u32 vcc, s62, v19
 v_mfma_f32_16x16x32_bf16 v[216:219], a[24:27], a[208:211], v[216:219]
 s_waitcnt lgkmcnt(4)
 s_cbranch_vccnz be_spin
be_ok:
 s_barrier
 v_mfma_f32_16x16x32_bf16 v[224:227], a[32:35], a[208:211], v[224:227]
 ds_read_b128 a[0:3], v25 offset:32768
 ds_read_b128 a[4:7], v25 offset:36864
 v_mfma_f32_16x16x32_bf16 v[224:227], a[36:39], a[212:215], v[224:227]
 buffer_load_dwordx4 a[160:163], v23, s[36:39], s52 offen offset:0 sc1
 v_mfma_f32_16x16x32_bf16 v[228:231], a[36:39], a[220:223], v[228:231]
 s_lshl_b32 s62, s62, 1
 v_mov_b32 v20, s88
 buffer_load_dwordx4 a[164:167], v23, s[36:39], s52 offen offset:1024 sc1
 v_mfma_f32_16x16x32_bf16 v[228:231], a[32:35], a[216:219], v[228:231]
 buffer_load_dwordx4 a[168:171], v24, s[36:39], s52 offen offset:0 sc1
 v_mfma_f32_16x16x32_bf16 v[236:239], a[40:43], a[216:219], v[236:239]
 ds_read_b128 a[8:11], v25 offset:33792
 ds_read_b128 a[12:15], v25 offset:37888
 v_mfma_f32_16x16x32_bf16 v[236:239], a[44:47], a[220:223], v[236:239]
 buffer_load_dwordx4 a[172:175], v24, s[36:39], s52 offen offset:1024 sc1
 v_mfma_f32_16x16x32_bf16 v[232:235], a[44:47], a[212:215], v[232:235]
 s_add_u32 s52, s52, 2048
 s_add_u32 s91, s89, 73728
 s_add_u32 m0, s47, 49152
 v_mfma_f32_16x16x32_bf16 v[232:235], a[40:43], a[208:211], v[232:235]
 s_waitcnt lgkmcnt(4)
 buffer_load_dwordx4 v18, s[24:27], s91 offen offset:0 sc1 lds
 v_mfma_f32_16x16x32_bf16 v[240:243], a[48:51], a[208:211], v[240:243]
 ds_read_b128 a[16:19], v25 offset:34816
 ds_read_b128 a[20:23], v25 offset:38912
 v_mfma_f32_16x16x32_bf16 v[240:243], a[52:55], a[212:215], v[240:243]
 buffer_load_dwordx4 v18, s[24:27], s91 offen offset:1024 sc1 lds
 v_mfma_f32_16x16x32_bf16 v[244:247], a[52:55], a[220:223], v[244:247]
 v_mfma_f32_16x16x32_bf16 v[244:247], a[48:51], a[216:219], v[244:247]
 buffer_load_dwordx4 v18, s[24:27], s91 offen offset:2048 sc1 lds
 v_mfma_f32_16x16x32_bf16 v[252:255], a[56:59], a[216:219], v[252:255]
 ds_read_b128 a[24:27], v25 offset:35840
 ds_read_b128 a[28:31], v25 offset:39936
 v_mfma_f32_16x16x32_bf16 v[252:255], a[60:63], a[220:223], v[252:255]
 buffer_load_dwordx4 v18, s[24:27], s91 offen offset:3072 sc1 lds
 v_mfma_f32_16x16x32_bf16 v[248:251], a[60:63], a[212:215], v[248:251]
 v_mfma_f32_16x16x32_bf16 v[248:251], a[56:59], a[208:211], v[248:251]
 s_waitcnt lgkmcnt(4)
 buffer_store_dwordx4 v[176:179], v50, s[20:23], s56 offen offset:1024 sc1
 v_mfma_f32_16x16x32_bf16 v[192:195], a[0:3], a[224:227], v[192:195]
 ds_read_b128 a[32:35], v25 offset:40960
 ds_read_b128 a[36:39], v25 offset:45056
 v_mfma_f32_16x16x32_bf16 v[192:195], a[4:7], a[228:231], v[192:195]
 buffer_load_dwordx4 a[176:179], v23, s[36:39], s52 offen offset:0 sc1
 v_mfma_f32_16x16x32_bf16 v[196:199], a[4:7], a[236:239], v[196:199]
 buffer_load_dwordx4 a[180:183], v23, s[36:39], s52 offen offset:1024 sc1
 v_mfma_f32_16x16x32_bf16 v[196:199], a[0:3], a[232:235], v[196:199]
 buffer_load_dwordx4 a[184:187], v24, s[36:39], s52 offen offset:0 sc1
 v_mfma_f32_16x16x32_bf16 v[204:207], a[8:11], a[232:235], v[204:207]
 ds_read_b128 a[40:43], v25 offset:41984
 ds_read_b128 a[44:47], v25 offset:46080
 v_mfma_f32_16x16x32_bf16 v[204:207], a[12:15], a[236:239], v[204:207]
 buffer_load_dwordx4 a[188:191], v24, s[36:39], s52 offen offset:1024 sc1
 v_mfma_f32_16x16x32_bf16 v[200:203], a[12:15], a[228:231], v[200:203]
 s_add_u32 s52, s52, 2048
 s_add_u32 s91, s89, 81920
 s_add_u32 m0, s47, 65536
 s_nop 0
 buffer_load_dwordx4 v18, s[24:27], s91 offen offset:0 sc1 lds
 v_mfma_f32_16x16x32_bf16 v[200:203], a[8:11], a[224:227], v[200:203]
 s_waitcnt lgkmcnt(4)
 buffer_load_dwordx4 v18, s[24:27], s91 offen offset:1024 sc1 lds
 v_mfma_f32_16x16x32_bf16 v[208:211], a[16:19], a[224:227], v[208:211]
 ds_read_b128 a[48:51], v25 offset:43008
 ds_read_b128 a[52:55], v25 offset:47104
 v_mfma_f32_16x16x32_bf16 v[208:211], a[20:23], a[228:231], v[208:211]
 buffer_load_dwordx4 v18, s[24:27], s91 offen offset:2048 sc1 lds
 v_mfma_f32_16x16x32_bf16 v[212:215], a[20:23], a[236:239], v[212:215]
 v_mfma_f32_16x16x32_bf16 v[212:215], a[16:19], a[232:235], v[212:215]
 buffer_load_dwordx4 v18, s[24:27], s91 offen offset:3072 sc1 lds
 v_mfma_f32_16x16x32_bf16 v[220:223], a[24:27], a[232:235], v[220:223]
 ds_read_b128 a[56:59], v25 offset:44032
 ds_read_b128 a[60:63], v25 offset:48128
 v_mfma_f32_16x16x32_bf16 v[220:223], a[28:31], a[236:239], v[220:223]
 buffer_store_dwordx4 v[148:151], v49, s[20:23], s54 offen offset:1024 sc1
 v_mfma_f32_16x16x32_bf16 v[216:219], a[28:31], a[228:231], v[216:219]
 v_mfma_f32_16x16x32_bf16 v[216:219], a[24:27], a[224:227], v[216:219]
 s_waitcnt lgkmcnt(4)
 v_mfma_f32_16x16x32_bf16 v[224:227], a[32:35], a[224:227], v[224:227]
 ds_read_b128 a[0:3], v25 offset:49152
 ds_read_b128 a[4:7], v25 offset:53248
 v_mfma_f32_16x16x32_bf16 v[224:227], a[36:39], a[228:231], v[224:227]
 buffer_store_dwordx4 v[180:183], v51, s[20:23], s56 offen offset:1024 sc1
 v_mfma_f32_16x16x32_bf16 v[228:231], a[36:39], a[236:239], v[228:231]
 v_mfma_f32_16x16x32_bf16 v[228:231], a[32:35], a[232:235], v[228:231]
 v_mfma_f32_16x16x32_bf16 v[236:239], a[40:43], a[232:235], v[236:239]
 ds_read_b128 a[8:11], v25 offset:50176
 ds_read_b128 a[12:15], v25 offset:54272
 v_mfma_f32_16x16x32_bf16 v[236:239], a[44:47], a[236:239], v[236:239]
 v_mfma_f32_16x16x32_bf16 v[232:235], a[44:47], a[228:231], v[232:235]
 v_mfma_f32_16x16x32_bf16 v[232:235], a[40:43], a[224:227], v[232:235]
 s_waitcnt lgkmcnt(4)
 v_mfma_f32_16x16x32_bf16 v[240:243], a[48:51], a[224:227], v[240:243]
 ds_read_b128 a[16:19], v25 offset:51200
 ds_read_b128 a[20:23], v25 offset:55296
 v_mfma_f32_16x16x32_bf16 v[240:243], a[52:55], a[228:231], v[240:243]
 v_mfma_f32_16x16x32_bf16 v[244:247], a[52:55], a[236:239], v[244:247]
 v_mfma_f32_16x16x32_bf16 v[244:247], a[48:51], a[232:235], v[244:247]
 v_mfma_f32_16x16x32_bf16 v[252:255], a[56:59], a[232:235], v[252:255]
 ds_read_b128 a[24:27], v25 offset:52224
 ds_read_b128 a[28:31], v25 offset:56320
 v_mfma_f32_16x16x32_bf16 v[252:255], a[60:63], a[236:239], v[252:255]
 v_mfma_f32_16x16x32_bf16 v[248:251], a[60:63], a[228:231], v[248:251]
 v_mfma_f32_16x16x32_bf16 v[248:251], a[56:59], a[224:227], v[248:251]
 s_waitcnt lgkmcnt(4)
 v_mfma_f32_16x16x32_bf16 v[192:195], a[0:3], a[240:243], v[192:195]
 ds_read_b128 a[32:35], v25 offset:57344
 ds_read_b128 a[36:39], v25 offset:61440
 v_mfma_f32_16x16x32_bf16 v[192:195], a[4:7], a[244:247], v[192:195]
 buffer_load_dwordx4 a[192:195], v23, s[36:39], s52 offen offset:0 sc1
 v_mfma_f32_16x16x32_bf16 v[196:199], a[4:7], a[252:255], v[196:199]
 v_mfma_f32_16x16x32_bf16 v[196:199], a[0:3], a[248:251], v[196:199]
 buffer_load_dwordx4 a[196:199], v23, s[36:39], s52 offen offset:1024 sc1
 v_mfma_f32_16x16x32_bf16 v[204:207], a[8:11], a[248:251], v[204:207]
 ds_read_b128 a[40:43], v25 offset:58368
 ds_read_b128 a[44:47], v25 offset:62464
 v_mfma_f32_16x16x32_bf16 v[204:207], a[12:15], a[252:255], v[204:207]
 v_mfma_f32_16x16x32_bf16 v[200:203], a[12:15], a[244:247], v[200:203]
 v_mfma_f32_16x16x32_bf16 v[200:203], a[8:11], a[240:243], v[200:203]
 s_waitcnt lgkmcnt(4)
 buffer_load_dwordx4 a[200:203], v24, s[36:39], s52 offen offset:0 sc1
 v_mfma_f32_16x16x32_bf16 v[208:211], a[16:19], a[240:243], v[208:211]
 ds_read_b128 a[48:51], v25 offset:59392
 ds_read_b128 a[52:55], v25 offset:63488
 v_mfma_f32_16x16x32_bf16 v[208:211], a[20:23], a[244:247], v[208:211]
 v_mfma_f32_16x16x32_bf16 v[212:215], a[20:23], a[252:255], v[212:215]
 v_mfma_f32_16x16x32_bf16 v[212:215], a[16:19], a[248:251], v[212:215]
 buffer_load_dwordx4 a[204:207], v24, s[36:39], s52 offen offset:1024 sc1
 v_mfma_f32_16x16x32_bf16 v[220:223], a[24:27], a[248:251], v[220:223]
 s_add_u32 s52, s52, 2048
 ds_read_b128 a[56:59], v25 offset:60416
 ds_read_b128 a[60:63], v25 offset:64512
 v_mfma_f32_16x16x32_bf16 v[220:223], a[28:31], a[252:255], v[220:223]
 v_mfma_f32_16x16x32_bf16 v[216:219], a[28:31], a[244:247], v[216:219]
 v_mfma_f32_16x16x32_bf16 v[216:219], a[24:27], a[240:243], v[216:219]
 s_waitcnt lgkmcnt(4)
 s_barrier
 v_mfma_f32_16x16x32_bf16 v[224:227], a[32:35], a[240:243], v[224:227]
 s_add_u32 s91, s89, 90112
 s_add_u32 m0, s47, 81920
 ds_read_b128 a[0:3], v18 offset:0
 ds_read_b128 a[4:7], v18 offset:4096
 v_mfma_f32_16x16x32_bf16 v[224:227], a[36:39], a[244:247], v[224:227]
 buffer_load_dwordx4 v18, s[24:27], s91 offen offset:0 sc1 lds
 v_mfma_f32_16x16x32_bf16 v[228:231], a[36:39], a[252:255], v[228:231]
 v_mfma_f32_16x16x32_bf16 v[228:231], a[32:35], a[248:251], v[228:231]
 v_mfma_f32_16x16x32_bf16 v[236:239], a[40:43], a[248:251], v[236:239]
 ds_read_b128 a[8:11], v18 offset:1024
 ds_read_b128 a[12:15], v18 offset:5120
 v_mfma_f32_16x16x32_bf16 v[236:239], a[44:47], a[252:255], v[236:239]
 buffer_load_dwordx4 v18, s[24:27], s91 offen offset:1024 sc1 lds
 v_mfma_f32_16x16x32_bf16 v[232:235], a[44:47], a[244:247], v[232:235]
 v_mfma_f32_16x16x32_bf16 v[232:235], a[40:43], a[240:243], v[232:235]
 s_waitcnt lgkmcnt(4)
 v_mfma_f32_16x16x32_bf16 v[240:243], a[48:51], a[240:243], v[240:243]
 ds_read_b128 a[16:19], v18 offset:2048
 ds_read_b128 a[20:23], v18 offset:6144
 v_mfma_f32_16x16x32_bf16 v[240:243], a[52:55], a[244:247], v[240:243]
 buffer_load_dwordx4 v18, s[24:27], s91 offen offset:2048 sc1 lds
 v_mfma_f32_16x16x32_bf16 v[244:247], a[52:55], a[252:255], v[244:247]
 v_mfma_f32_16x16x32_bf16 v[244:247], a[48:51], a[248:251], v[244:247]
 v_mfma_f32_16x16x32_bf16 v[252:255], a[56:59], a[248:251], v[252:255]
 ds_read_b128 a[24:27], v18 offset:3072
 ds_read_b128 a[28:31], v18 offset:7168
 v_mfma_f32_16x16x32_bf16 v[252:255], a[60:63], a[252:255], v[252:255]
 buffer_load_dwordx4 v18, s[24:27], s91 offen offset:3072 sc1 lds
 v_mfma_f32_16x16x32_bf16 v[248:251], a[60:63], a[244:247], v[248:251]
 v_mfma_f32_16x16x32_bf16 v[248:251], a[56:59], a[240:243], v[248:251]
 s_waitcnt lgkmcnt(4)
 v_mfma_f32_16x16x32_bf16 v[192:195], a[0:3], a[128:131], v[192:195]
 ds_read_b128 a[32:35], v18 offset:8192
 ds_read_b128 a[36:39], v18 offset:12288
 v_mfma_f32_16x16x32_bf16 v[192:195], a[4:7], a[132:135], v[192:195]
 buffer_load_dwordx4 a[208:211], v23, s[36:39], s52 offen offset:0 sc1
 v_mfma_f32_16x16x32_bf16 v[196:199], a[4:7], a[140:143], v[196:199]
 buffer_load_dwordx4 a[212:215], v23, s[36:39], s52 offen offset:1024 sc1
 v_mfma_f32_16x16x32_bf16 v[196:199], a[0:3], a[136:139], v[196:199]
 buffer_load_dwordx4 a[216:219], v24, s[36:39], s52 offen offset:0 sc1
 v_mfma_f32_16x16x32_bf16 v[204:207], a[8:11], a[136:139], v[204:207]
 ds_read_b128 a[40:43], v18 offset:9216
 ds_read_b128 a[44:47], v18 offset:13312
 v_mfma_f32_16x16x32_bf16 v[204:207], a[12:15], a[140:143], v[204:207]
 buffer_load_dwordx4 a[220:223], v24, s[36:39], s52 offen offset:1024 sc1
 v_mfma_f32_16x16x32_bf16 v[200:203], a[12:15], a[132:135], v[200:203]
 s_add_u32 s52, s52, 2048
 s_add_u32 s91, s89, 98304
 s_add_u32 m0, s47, 98304
 v_mfma_f32_16x16x32_bf16 v[200:203], a[8:11], a[128:131], v[200:203]
 s_waitcnt lgkmcnt(4)
 buffer_load_dwordx4 v18, s[24:27], s91 offen offset:0 sc1 lds
 v_mfma_f32_16x16x32_bf16 v[208:211], a[16:19], a[128:131], v[208:211]
 ds_read_b128 a[48:51], v18 offset:10240
 ds_read_b128 a[52:55], v18 offset:14336
 v_mfma_f32_16x16x32_bf16 v[208:211], a[20:23], a[132:135], v[208:211]
 buffer_load_dwordx4 v18, s[24:27], s91 offen offset:1024 sc1 lds
 v_mfma_f32_16x16x32_bf16 v[212:215], a[20:23], a[140:143], v[212:215]
 v_mfma_f32_16x16x32_bf16 v[212:215], a[16:19], a[136:139], v[212:215]
 buffer_load_dwordx4 v18, s[24:27], s91 offen offset:2048 sc1 lds
 v_mfma_f32_16x16x32_bf16 v[220:223], a[24:27], a[136:139], v[220:223]
 ds_read_b128 a[56:59], v18 offset:11264
 ds_read_b128 a[60:63], v18 offset:15360
 v_mfma_f32_16x16x32_bf16 v[220:223], a[28:31], a[140:143], v[220:223]
 buffer_load_dwordx4 v18, s[24:27], s91 offen offset:3072 sc1 lds
 v_mfma_f32_16x16x32_bf16 v[216:219], a[28:31], a[132:135], v[216:219]
 v_mfma_f32_16x16x32_bf16 v[216:219], a[24:27], a[128:131], v[216:219]
 s_waitcnt lgkmcnt(4)
 v_mfma_f32_16x16x32_bf16 v[224:227], a[32:35], a[128:131], v[224:227]
 ds_read_b128 a[0:3], v18 offset:16384
 ds_read_b128 a[4:7], v18 offset:20480
 v_mfma_f32_16x16x32_bf16 v[224:227], a[36:39], a[132:135], v[224:227]
 v_mfma_f32_16x16x32_bf16 v[228:231], a[36:39], a[140:143], v[228:231]
 v_mfma_f32_16x16x32_bf16 v[228:231], a[32:35], a[136:139], v[228:231]
 v_mfma_f32_16x16x32_bf16 v[236:239], a[40:43], a[136:139], v[236:239]
 ds_read_b128 a[8:11], v18 offset:17408
 ds_read_b128 a[12:15], v18 offset:21504
 v_mfma_f32_16x16x32_bf16 v[236:239], a[44:47], a[140:143], v[236:239]
 v_mfma_f32_16x16x32_bf16 v[232:235], a[44:47], a[132:135], v[232:235]
 v_mfma_f32_16x16x32_bf16 v[232:235], a[40:43], a[128:131], v[232:235]
 s_waitcnt lgkmcnt(4)
 v_mfma_f32_16x16x32_bf16 v[240:243], a[48:51], a[128:131], v[240:243]
 ds_read_b128 a[16:19], v18 offset:18432
 ds_read_b128 a[20:23], v18 offset:22528
 v_mfma_f32_16x16x32_bf16 v[240:243], a[52:55], a[132:135], v[240:243]
 v_mfma_f32_16x16x32_bf16 v[244:247], a[52:55], a[140:143], v[244:247]
 v_mfma_f32_16x16x32_bf16 v[244:247], a[48:51], a[136:139], v[244:247]
 v_mfma_f32_16x16x32_bf16 v[252:255], a[56:59], a[136:139], v[252:255]
 ds_read_b128 a[24:27], v18 offset:19456
 ds_read_b128 a[28:31], v18 offset:23552
 v_mfma_f32_16x16x32_bf16 v[252:255], a[60:63], a[140:143], v[252:255]
 v_mfma_f32_16x16x32_bf16 v[248:251], a[60:63], a[132:135], v[248:251]
 v_mfma_f32_16x16x32_bf16 v[248:251], a[56:59], a[128:131], v[248:251]
 s_waitcnt lgkmcnt(4)
 s_waitcnt vmcnt(42)
 v_mfma_f32_16x16x32_bf16 v[192:195], a[0:3], a[144:147], v[192:195]
 ds_read_b128 a[32:35], v18 offset:24576
 ds_read_b128 a[36:39], v18 offset:28672
 v_mfma_f32_16x16x32_bf16 v[192:195], a[4:7], a[148:151], v[192:195]
 buffer_load_dwordx4 a[224:227], v23, s[36:39], s52 offen offset:0 sc1
 v_mfma_f32_16x16x32_bf16 v[196:199], a[4:7], a[156:159], v[196:199]
 v_mfma_f32_16x16x32_bf16 v[196:199], a[0:3], a[152:155], v[196:199]
 buffer_load_dwordx4 a[228:231], v23, s[36:39], s52 offen offset:1024 sc1
 v_mfma_f32_16x16x32_bf16 v[204:207], a[8:11], a[152:155], v[204:207]
 ds_read_b128 a[40:43], v18 offset:25600
 ds_read_b128 a[44:47], v18 offset:29696
 v_mfma_f32_16x16x32_bf16 v[204:207], a[12:15], a[156:159], v[204:207]
 v_mfma_f32_16x16x32_bf16 v[200:203], a[12:15], a[148:151], v[200:203]
 v_mfma_f32_16x16x32_bf16 v[200:203], a[8:11], a[144:147], v[200:203]
 s_waitcnt lgkmcnt(4)
 buffer_load_dwordx4 a[232:235], v24, s[36:39], s52 offen offset:0 sc1
 v_mfma_f32_16x16x32_bf16 v[208:211], a[16:19], a[144:147], v[208:211]
 ds_read_b128 a[48:51], v18 offset:26624
 ds_read_b128 a[52:55], v18 offset:30720
 v_mfma_f32_16x16x32_bf16 v[208:211], a[20:23], a[148:151], v[208:211]
 v_mfma_f32_16x16x32_bf16 v[212:215], a[20:23], a[156:159], v[212:215]
 v_mfma_f32_16x16x32_bf16 v[212:215], a[16:19], a[152:155], v[212:215]
 buffer_load_dwordx4 a[236:239], v24, s[36:39], s52 offen offset:1024 sc1
 v_mfma_f32_16x16x32_bf16 v[220:223], a[24:27], a[152:155], v[220:223]
 s_add_u32 s52, s52, 2048
 ds_read_b128 a[56:59], v18 offset:27648
 ds_read_b128 a[60:63], v18 offset:31744
 v_mfma_f32_16x16x32_bf16 v[220:223], a[28:31], a[156:159], v[220:223]
 v_mfma_f32_16x16x32_bf16 v[216:219], a[28:31], a[148:151], v[216:219]
 s_waitcnt vmcnt(31)
 v_mfma_f32_16x16x32_bf16 v[216:219], a[24:27], a[144:147], v[216:219]
 s_waitcnt lgkmcnt(4)
 s_barrier
 v_mfma_f32_16x16x32_bf16 v[224:227], a[32:35], a[144:147], v[224:227]
 s_add_u32 s91, s89, 106496
 s_add_u32 m0, s47, 114688
 ds_read_b128 a[0:3], v18 offset:32768
 ds_read_b128 a[4:7], v18 offset:36864
 v_mfma_f32_16x16x32_bf16 v[224:227], a[36:39], a[148:151], v[224:227]
 buffer_load_dwordx4 v18, s[24:27], s91 offen offset:0 sc1 lds
 v_mfma_f32_16x16x32_bf16 v[228:231], a[36:39], a[156:159], v[228:231]
 v_mfma_f32_16x16x32_bf16 v[228:231], a[32:35], a[152:155], v[228:231]
 v_mfma_f32_16x16x32_bf16 v[236:239], a[40:43], a[152:155], v[236:239]
 ds_read_b128 a[8:11], v18 offset:33792
 ds_read_b128 a[12:15], v18 offset:37888
 v_mfma_f32_16x16x32_bf16 v[236:239], a[44:47], a[156:159], v[236:239]
 buffer_load_dwordx4 v18, s[24:27], s91 offen offset:1024 sc1 lds
 v_mfma_f32_16x16x32_bf16 v[232:235], a[44:47], a[148:151], v[232:235]
 v_mfma_f32_16x16x32_bf16 v[232:235], a[40:43], a[144:147], v[232:235]
 s_waitcnt lgkmcnt(4)
 v_mfma_f32_16x16x32_bf16 v[240:243], a[48:51], a[144:147], v[240:243]
 ds_read_b128 a[16:19], v18 offset:34816
 ds_read_b128 a[20:23], v18 offset:38912
 v_mfma_f32_16x16x32_bf16 v[240:243], a[52:55], a[148:151], v[240:243]
 buffer_load_dwordx4 v18, s[24:27], s91 offen offset:2048 sc1 lds
 v_mfma_f32_16x16x32_bf16 v[244:247], a[52:55], a[156:159], v[244:247]
 v_mfma_f32_16x16x32_bf16 v[244:247], a[48:51], a[152:155], v[244:247]
 v_mfma_f32_16x16x32_bf16 v[252:255], a[56:59], a[152:155], v[252:255]
 ds_read_b128 a[24:27], v18 offset:35840
 ds_read_b128 a[28:31], v18 offset:39936
 v_mfma_f32_16x16x32_bf16 v[252:255], a[60:63], a[156:159], v[252:255]
 buffer_load_dwordx4 v18, s[24:27], s91 offen offset:3072 sc1 lds
 v_mfma_f32_16x16x32_bf16 v[248:251], a[60:63], a[148:151], v[248:251]
 v_mfma_f32_16x16x32_bf16 v[248:251], a[56:59], a[144:147], v[248:251]
 s_waitcnt lgkmcnt(4)
 v_mfma_f32_16x16x32_bf16 v[192:195], a[0:3], a[160:163], v[192:195]
 s_waitcnt vmcnt(24)
 ds_read_b128 a[32:35], v18 offset:40960
 ds_read_b128 a[36:39], v18 offset:45056
 v_mfma_f32_16x16x32_bf16 v[192:195], a[4:7], a[164:167], v[192:195]
 buffer_atomic_add v30, v31, s[40:43], 0 offen sc1
 v_mfma_f32_16x16x32_bf16 v[196:199], a[4:7], a[172:175], v[196:199]
 buffer_load_dwordx4 a[240:243], v23, s[36:39], s52 offen offset:0 sc1
 v_mfma_f32_16x16x32_bf16 v[196:199], a[0:3], a[168:171], v[196:199]
 buffer_load_dwordx4 a[244:247], v23, s[36:39], s52 offen offset:1024 sc1
 v_mfma_f32_16x16x32_bf16 v[204:207], a[8:11], a[168:171], v[204:207]
 ds_read_b128 a[40:43], v18 offset:41984
 ds_read_b128 a[44:47], v18 offset:46080
 v_mfma_f32_16x16x32_bf16 v[204:207], a[12:15], a[172:175], v[204:207]
 buffer_load_dwordx4 a[248:251], v24, s[36:39], s52 offen offset:0 sc1
 v_mfma_f32_16x16x32_bf16 v[200:203], a[12:15], a[164:167], v[200:203]
 buffer_load_dwordx4 a[252:255], v24, s[36:39], s52 offen offset:1024 sc1
 v_mfma_f32_16x16x32_bf16 v[200:203], a[8:11], a[160:163], v[200:203]
 s_waitcnt lgkmcnt(4)
 s_add_u32 s52, s52, 2048
 s_add_u32 s91, s89, 114688
 s_add_u32 m0, s47, 0
 s_nop 0
 buffer_load_dwordx4 v18, s[24:27], s91 offen offset:0 sc1 lds
 v_mfma_f32_16x16x32_bf16 v[208:211], a[16:19], a[160:163], v[208:211]
 ds_read_b128 a[48:51], v18 offset:43008
 ds_read_b128 a[52:55], v18 offset:47104
 v_mfma_f32_16x16x32_bf16 v[208:211], a[20:23], a[164:167], v[208:211]
 buffer_load_dwordx4 v18, s[24:27], s91 offen offset:1024 sc1 lds
 v_mfma_f32_16x16x32_bf16 v[212:215], a[20:23], a[172:175], v[212:215]
 v_mfma_f32_16x16x32_bf16 v[212:215], a[16:19], a[168:171], v[212:215]
 buffer_load_dwordx4 v18, s[24:27], s91 offen offset:2048 sc1 lds
 v_mfma_f32_16x16x32_bf16 v[220:223], a[24:27], a[168:171], v[220:223]
 ds_read_b128 a[56:59], v18 offset:44032
 ds_read_b128 a[60:63], v18 offset:48128
 v_mfma_f32_16x16x32_bf16 v[220:223], a[28:31], a[172:175], v[220:223]
 buffer_load_dwordx4 v18, s[24:27], s91 offen offset:3072 sc1 lds
 v_mfma_f32_16x16x32_bf16 v[216:219], a[28:31], a[164:167], v[216:219]
 v_mfma_f32_16x16x32_bf16 v[216:219], a[24:27], a[160:163], v[216:219]
 s_waitcnt lgkmcnt(4)
 v_mfma_f32_16x16x32_bf16 v[224:227], a[32:35], a[160:163], v[224:227]
 ds_read_b128 a[0:3], v18 offset:49152
 ds_read_b128 a[4:7], v18 offset:53248
 v_mfma_f32_16x16x32_bf16 v[224:227], a[36:39], a[164:167], v[224:227]
 v_mfma_f32_16x16x32_bf16 v[228:231], a[36:39], a[172:175], v[228:231]
 v_mfma_f32_16x16x32_bf16 v[228:231], a[32:35], a[168:171], v[228:231]
 v_mfma_f32_16x16x32_bf16 v[236:239], a[40:43], a[168:171], v[236:239]
 ds_read_b128 a[8:11], v18 offset:50176
 ds_read_b128 a[12:15], v18 offset:54272
 v_mfma_f32_16x16x32_bf16 v[236:239], a[44:47], a[172:175], v[236:239]
 v_mfma_f32_16x16x32_bf16 v[232:235], a[44:47], a[164:167], v[232:235]
 v_mfma_f32_16x16x32_bf16 v[232:235], a[40:43], a[160:163], v[232:235]
 s_waitcnt lgkmcnt(4)
 v_mfma_f32_16x16x32_bf16 v[240:243], a[48:51], a[160:163], v[240:243]
 ds_read_b128 a[16:19], v18 offset:51200
 ds_read_b128 a[20:23], v18 offset:55296
 v_mfma_f32_16x16x32_bf16 v[240:243], a[52:55], a[164:167], v[240:243]
 v_mfma_f32_16x16x32_bf16 v[244:247], a[52:55], a[172:175], v[244:247]
 v_mfma_f32_16x16x32_bf16 v[244:247], a[48:51], a[168:171], v[244:247]
 v_mfma_f32_16x16x32_bf16 v[252:255], a[56:59], a[168:171], v[252:255]
 ds_read_b128 a[24:27], v18 offset:52224
 ds_read_b128 a[28:31], v18 offset:56320
 v_mfma_f32_16x16x32_bf16 v[252:255], a[60:63], a[172:175], v[252:255]
 v_mfma_f32_16x16x32_bf16 v[248:251], a[60:63], a[164:167], v[248:251]
 v_mfma_f32_16x16x32_bf16 v[248:251], a[56:59], a[160:163], v[248:251]
 s_waitcnt lgkmcnt(4)
 v_mfma_f32_16x16x32_bf16 v[192:195], a[0:3], a[176:179], v[192:195]
 ds_read_b128 a[32:35], v18 offset:57344
 ds_read_b128 a[36:39], v18 offset:61440
 v_mfma_f32_16x16x32_bf16 v[192:195], a[4:7], a[180:183], v[192:195]
 buffer_load_dwordx4 a[128:131], v23, s[36:39], s52 offen offset:0 sc1
 v_mfma_f32_16x16x32_bf16 v[196:199], a[4:7], a[188:191], v[196:199]
 v_mfma_f32_16x16x32_bf16 v[196:199], a[0:3], a[184:187], v[196:199]
 buffer_load_dwordx4 a[132:135], v23, s[36:39], s52 offen offset:1024 sc1
 v_mfma_f32_16x16x32_bf16 v[204:207], a[8:11], a[184:187], v[204:207]
 ds_read_b128 a[40:43], v18 offset:58368
 ds_read_b128 a[44:47], v18 offset:62464
 v_mfma_f32_16x16x32_bf16 v[204:207], a[12:15], a[188:191], v[204:207]
 v_mfma_f32_16x16x32_bf16 v[200:203], a[12:15], a[180:183], v[200:203]
 v_mfma_f32_16x16x32_bf16 v[200:203], a[8:11], a[176:179], v[200:203]
 s_waitcnt lgkmcnt(4)
 buffer_load_dwordx4 a[136:139], v24, s[36:39], s52 offen offset:0 sc1
 v_mfma_f32_16x16x32_bf16 v[208:211], a[16:19], a[176:179], v[208:211]
 ds_read_b128 a[48:51], v18 offset:59392
 ds_read_b128 a[52:55], v18 offset:63488
 v_mfma_f32_16x16x32_bf16 v[208:211], a[20:23], a[180:183], v[208:211]
 v_mfma_f32_16x16x32_bf16 v[212:215], a[20:23], a[188:191], v[212:215]
 v_mfma_f32_16x16x32_bf16 v[212:215], a[16:19], a[184:187], v[212:215]
 buffer_load_dwordx4 a[140:143], v24, s[36:39], s52 offen offset:1024 sc1
 v_mfma_f32_16x16x32_bf16 v[220:223], a[24:27], a[184:187], v[220:223]
 s_add_u32 s52, s52, 2048
 ds_read_b128 a[56:59], v18 offset:60416
 ds_read_b128 a[60:63], v18 offset:64512
 v_mfma_f32_16x16x32_bf16 v[220:223], a[28:31], a[188:191], v[220:223]
 v_mfma_f32_16x16x32_bf16 v[216:219], a[28:31], a[180:183], v[216:219]
 s_waitcnt vmcnt(29)
 v_mfma_f32_16x16x32_bf16 v[216:219], a[24:27], a[176:179], v[216:219]
 s_waitcnt lgkmcnt(4)
 s_barrier
 v_mfma_f32_16x16x32_bf16 v[224:227], a[32:35], a[176:179], v[224:227]
 s_add_u32 s91, s89, 122880
 s_add_u32 m0, s47, 16384
 ds_read_b128 a[0:3], v25 offset:0
 ds_read_b128 a[4:7], v25 offset:4096
 v_mfma_f32_16x16x32_bf16 v[224:227], a[36:39], a[180:183], v[224:227]
 buffer_load_dwordx4 v18, s[24:27], s91 offen offset:0 sc1 lds
 v_mfma_f32_16x16x32_bf16 v[228:231], a[36:39], a[188:191], v[228:231]
 v_mfma_f32_16x16x32_bf16 v[228:231], a[32:35], a[184:187], v[228:231]
 v_mfma_f32_16x16x32_bf16 v[236:239], a[40:43], a[184:187], v[236:239]
 ds_read_b128 a[8:11], v25 offset:1024
 ds_read_b128 a[12:15], v25 offset:5120
 v_mfma_f32_16x16x32_bf16 v[236:239], a[44:47], a[188:191], v[236:239]
 buffer_load_dwordx4 v18, s[24:27], s91 offen offset:1024 sc1 lds
 v_mfma_f32_16x16x32_bf16 v[232:235], a[44:47], a[180:183], v[232:235]
 v_mfma_f32_16x16x32_bf16 v[232:235], a[40:43], a[176:179], v[232:235]
 s_waitcnt lgkmcnt(4)
 v_mfma_f32_16x16x32_bf16 v[240:243], a[48:51], a[176:179], v[240:243]
 ds_read_b128 a[16:19], v25 offset:2048
 ds_read_b128 a[20:23], v25 offset:6144
 v_mfma_f32_16x16x32_bf16 v[240:243], a[52:55], a[180:183], v[240:243]
 buffer_load_dwordx4 v18, s[24:27], s91 offen offset:2048 sc1 lds
 v_mfma_f32_16x16x32_bf16 v[244:247], a[52:55], a[188:191], v[244:247]
 v_mfma_f32_16x16x32_bf16 v[244:247], a[48:51], a[184:187], v[244:247]
 v_mfma_f32_16x16x32_bf16 v[252:255], a[56:59], a[184:187], v[252:255]
 ds_read_b128 a[24:27], v25 offset:3072
 ds_read_b128 a[28:31], v25 offset:7168
 v_mfma_f32_16x16x32_bf16 v[252:255], a[60:63], a[188:191], v[252:255]
 buffer_load_dwordx4 v18, s[24:27], s91 offen offset:3072 sc1 lds
 v_mfma_f32_16x16x32_bf16 v[248:251], a[60:63], a[180:183], v[248:251]
 v_mfma_f32_16x16x32_bf16 v[248:251], a[56:59], a[176:179], v[248:251]
 s_waitcnt lgkmcnt(4)
 v_mfma_f32_16x16x32_bf16 v[192:195], a[0:3], a[192:195], v[192:195]
 ds_read_b128 a[32:35], v25 offset:8192
 ds_read_b128 a[36:39], v25 offset:12288
 v_mfma_f32_16x16x32_bf16 v[192:195], a[4:7], a[196:199], v[192:195]
 buffer_load_dword v19, v20, s[40:43], 0 offen sc1
 v_mfma_f32_16x16x32_bf16 v[196:199], a[4:7], a[204:207], v[196:199]
 buffer_load_dwordx4 a[144:147], v23, s[36:39], s52 offen offset:0 sc1
 v_mfma_f32_16x16x32_bf16 v[196:199], a[0:3], a[200:203], v[196:199]
 buffer_load_dwordx4 a[148:151], v23, s[36:39], s52 offen offset:1024 sc1
 v_mfma_f32_16x16x32_bf16 v[204:207], a[8:11], a[200:203], v[204:207]
 ds_read_b128 a[40:43], v25 offset:9216
 ds_read_b128 a[44:47], v25 offset:13312
 v_mfma_f32_16x16x32_bf16 v[204:207], a[12:15], a[204:207], v[204:207]
 buffer_load_dwordx4 a[152:155], v24, s[36:39], s52 offen offset:0 sc1
 v_mfma_f32_16x16x32_bf16 v[200:203], a[12:15], a[196:199], v[200:203]
 buffer_load_dwordx4 a[156:159], v24, s[36:39], s52 offen offset:1024 sc1
 v_mfma_f32_16x16x32_bf16 v[200:203], a[8:11], a[192:195], v[200:203]
 s_waitcnt lgkmcnt(4)
 s_add_u32 s52, s52, 2048
 buffer_load_dwordx2 v[32:33], v60, s[16:19], s58 offen offset:0
 v_mfma_f32_16x16x32_bf16 v[208:211], a[16:19], a[192:195], v[208:211]
 ds_read_b128 a[48:51], v25 offset:10240
 ds_read_b128 a[52:55], v25 offset:14336
 v_mfma_f32_16x16x32_bf16 v[208:211], a[20:23], a[196:199], v[208:211]
 buffer_load_dwordx2 v[34:35], v60, s[16:19], s58 offen offset:32
 v_mfma_f32_16x16x32_bf16 v[212:215], a[20:23], a[204:207], v[212:215]
 v_mfma_f32_16x16x32_bf16 v[212:215], a[16:19], a[200:203], v[212:215]
 buffer_load_dwordx2 v[36:37], v60, s[16:19], s58 offen offset:64
 v_mfma_f32_16x16x32_bf16 v[220:223], a[24:27], a[200:203], v[220:223]
 ds_read_b128 a[56:59], v25 offset:11264
 ds_read_b128 a[60:63], v25 offset:15360
 v_mfma_f32_16x16x32_bf16 v[220:223], a[28:31], a[204:207], v[220:223]
 buffer_load_dwordx2 v[38:39], v60, s[16:19], s58 offen offset:96
 v_mfma_f32_16x16x32_bf16 v[216:219], a[28:31], a[196:199], v[216:219]
 v_mfma_f32_16x16x32_bf16 v[216:219], a[24:27], a[192:195], v[216:219]
 s_waitcnt lgkmcnt(4)
 v_mfma_f32_16x16x32_bf16 v[224:227], a[32:35], a[192:195], v[224:227]
 ds_read_b128 a[0:3], v25 offset:16384
 ds_read_b128 a[4:7], v25 offset:20480
 v_mfma_f32_16x16x32_bf16 v[224:227], a[36:39], a[196:199], v[224:227]
 v_mfma_f32_16x16x32_bf16 v[228:231], a[36:39], a[204:207], v[228:231]
 v_mfma_f32_16x16x32_bf16 v[228:231], a[32:35], a[200:203], v[228:231]
 v_mfma_f32_16x16x32_bf16 v[236:239], a[40:43], a[200:203], v[236:239]
 s_add_u32 s54, s54, 0x800000
 s_add_u32 s56, s56, 0x800000
 ds_read_b128 a[8:11], v25 offset:17408
 ds_read_b128 a[12:15], v25 offset:21504
 v_mfma_f32_16x16x32_bf16 v[236:239], a[44:47], a[204:207], v[236:239]
 v_mfma_f32_16x16x32_bf16 v[232:235], a[44:47], a[196:199], v[232:235]
 v_mfma_f32_16x16x32_bf16 v[232:235], a[40:43], a[192:195], v[232:235]
 s_waitcnt lgkmcnt(4)
 v_mfma_f32_16x16x32_bf16 v[240:243], a[48:51], a[192:195], v[240:243]
 ds_read_b128 a[16:19], v25 offset:18432
 ds_read_b128 a[20:23], v25 offset:22528
 v_mfma_f32_16x16x32_bf16 v[240:243], a[52:55], a[196:199], v[240:243]
 v_mfma_f32_16x16x32_bf16 v[244:247], a[52:55], a[204:207], v[244:247]
 v_mfma_f32_16x16x32_bf16 v[244:247], a[48:51], a[200:203], v[244:247]
 v_mfma_f32_16x16x32_bf16 v[252:255], a[56:59], a[200:203], v[252:255]
 ds_read_b128 a[24:27], v25 offset:19456
 ds_read_b128 a[28:31], v25 offset:23552
 v_mfma_f32_16x16x32_bf16 v[252:255], a[60:63], a[204:207], v[252:255]
 v_mfma_f32_16x16x32_bf16 v[248:251], a[60:63], a[196:199], v[248:251]
 v_mfma_f32_16x16x32_bf16 v[248:251], a[56:59], a[192:195], v[248:251]
 s_waitcnt lgkmcnt(4)
 s_waitcnt vmcnt(38)
 v_mfma_f32_16x16x32_bf16 v[192:195], a[0:3], a[208:211], v[192:195]
 ds_read_b128 a[32:35], v25 offset:24576
 ds_read_b128 a[36:39], v25 offset:28672
 v_mfma_f32_16x16x32_bf16 v[192:195], a[4:7], a[212:215], v[192:195]
 v_mfma_f32_16x16x32_bf16 v[196:199], a[4:7], a[220:223], v[196:199]
 v_mfma_f32_16x16x32_bf16 v[196:199], a[0:3], a[216:219], v[196:199]
 v_mfma_f32_16x16x32_bf16 v[204:207], a[8:11], a[216:219], v[204:207]
 ds_read_b128 a[40:43], v25 offset:25600
 ds_read_b128 a[44:47], v25 offset:29696
 v_mfma_f32_16x16x32_bf16 v[204:207], a[12:15], a[220:223], v[204:207]
 v_mfma_f32_16x16x32_bf16 v[200:203], a[12:15], a[212:215], v[200:203]
 v_mfma_f32_16x16x32_bf16 v[200:203], a[8:11], a[208:211], v[200:203]
 s_waitcnt lgkmcnt(4)
 v_mfma_f32_16x16x32_bf16 v[208:211], a[16:19], a[208:211], v[208:211]
 ds_read_b128 a[48:51], v25 offset:26624
 ds_read_b128 a[52:55], v25 offset:30720
 v_mfma_f32_16x16x32_bf16 v[208:211], a[20:23], a[212:215], v[208:211]
 v_mfma_f32_16x16x32_bf16 v[212:215], a[20:23], a[220:223], v[212:215]
 v_mfma_f32_16x16x32_bf16 v[212:215], a[16:19], a[216:219], v[212:215]
 v_mfma_f32_16x16x32_bf16 v[220:223], a[24:27], a[216:219], v[220:223]
 ds_read_b128 a[56:59], v25 offset:27648
 ds_read_b128 a[60:63], v25 offset:31744
 v_mfma_f32_16x16x32_bf16 v[220:223], a[28:31], a[220:223], v[220:223]
 v_mfma_f32_16x16x32_bf16 v[216:219], a[28:31], a[212:215], v[216:219]
 s_waitcnt vmcnt(8)
 v_and_b32 v19, 0xff, v19
 v_cmp_gt_u32 vcc, s62, v19
 v_mfma_f32_16x16x32_bf16 v[216:219], a[24:27], a[208:211], v[216:219]
 s_waitcnt lgkmcnt(4)
 s_cbranch_vccnz de_spin
de_ok:
 s_barrier
 v_mfma_f32_16x16x32_bf16 v[224:227], a[32:35], a[208:211], v[224:227]
 ds_read_b128 a[0:3], v25 offset:32768
 ds_read_b128 a[4:7], v25 offset:36864
 v_mfma_f32_16x16x32_bf16 v[224:227], a[36:39], a[212:215], v[224:227]
 buffer_load_dwordx4 v[72:75], v18, s[20:23], s90 offen offset:0 sc1
 v_mfma_f32_16x16x32_bf16 v[228:231], a[36:39], a[220:223], v[228:231]
 ds_read_b128 v[64:67], v55 offset:0
 ds_read_b128 v[68:71], v55 offset:1024
 v_mfma_f32_16x16x32_bf16 v[228:231], a[32:35], a[216:219], v[228:231]
 buffer_load_dwordx4 v[76:79], v18, s[20:23], s90 offen offset:1024 sc1
 v_mfma_f32_16x16x32_bf16 v[236:239], a[40:43], a[216:219], v[236:239]
 ds_read_b128 a[8:11], v25 offset:33792
 ds_read_b128 a[12:15], v25 offset:37888
 v_mfma_f32_16x16x32_bf16 v[236:239], a[44:47], a[220:223], v[236:239]
 buffer_load_dwordx4 v[80:83], v18, s[20:23], s49 offen offset:0 sc1
 v_mfma_f32_16x16x32_bf16 v[232:235], a[44:47], a[212:215], v[232:235]
 v_mfma_f32_16x16x32_bf16 v[232:235], a[40:43], a[208:211], v[232:235]
 s_waitcnt lgkmcnt(6)
 v_mfma_f32_16x16x32_bf16 v[240:243], a[48:51], a[208:211], v[240:243]
 ds_read_b128 a[16:19], v25 offset:34816
 ds_read_b128 a[20:23], v25 offset:38912
 v_mfma_f32_16x16x32_bf16 v[240:243], a[52:55], a[212:215], v[240:243]
 buffer_load_dwordx4 v[84:87], v18, s[20:23], s49 offen offset:1024 sc1
 v_mfma_f32_16x16x32_bf16 v[244:247], a[52:55], a[220:223], v[244:247]
 v_mfma_f32_16x16x32_bf16 v[244:247], a[48:51], a[216:219], v[244:247]
 buffer_load_dwordx4 v[88:91], v18, s[20:23], s50 offen offset:0 sc1
 v_mfma_f32_16x16x32_bf16 v[252:255], a[56:59], a[216:219], v[252:255]
 ds_read_b128 a[24:27], v25 offset:35840
 ds_read_b128 a[28:31], v25 offset:39936
 v_mfma_f32_16x16x32_bf16 v[252:255], a[60:63], a[220:223], v[252:255]
 buffer_load_dwordx4 v[92:95], v18, s[20:23], s50 offen offset:1024 sc1
 v_mfma_f32_16x16x32_bf16 v[248:251], a[60:63], a[212:215], v[248:251]
 v_mfma_f32_16x16x32_bf16 v[248:251], a[56:59], a[208:211], v[248:251]
 s_waitcnt lgkmcnt(4)
 v_mfma_f32_16x16x32_bf16 v[192:195], a[0:3], a[224:227], v[192:195]
 ds_read_b128 a[32:35], v25 offset:40960
 ds_read_b128 a[36:39], v25 offset:45056
 v_mfma_f32_16x16x32_bf16 v[192:195], a[4:7], a[228:231], v[192:195]
 v_mfma_f32_16x16x32_bf16 v[196:199], a[4:7], a[236:239], v[196:199]
 v_mfma_f32_16x16x32_bf16 v[196:199], a[0:3], a[232:235], v[196:199]
 v_mfma_f32_16x16x32_bf16 v[204:207], a[8:11], a[232:235], v[204:207]
 ds_read_b128 a[40:43], v25 offset:41984
 ds_read_b128 a[44:47], v25 offset:46080
 v_mfma_f32_16x16x32_bf16 v[204:207], a[12:15], a[236:239], v[204:207]
 v_mfma_f32_16x16x32_bf16 v[200:203], a[12:15], a[228:231], v[200:203]
 v_mfma_f32_16x16x32_bf16 v[200:203], a[8:11], a[224:227], v[200:203]
 s_waitcnt lgkmcnt(4)
 v_mfma_f32_16x16x32_bf16 v[208:211], a[16:19], a[224:227], v[208:211]
 ds_read_b128 a[48:51], v25 offset:43008
 ds_read_b128 a[52:55], v25 offset:47104
 v_mfma_f32_16x16x32_bf16 v[208:211], a[20:23], a[228:231], v[208:211]
 v_mfma_f32_16x16x32_bf16 v[212:215], a[20:23], a[236:239], v[212:215]
 v_mfma_f32_16x16x32_bf16 v[212:215], a[16:19], a[232:235], v[212:215]
 v_mfma_f32_16x16x32_bf16 v[220:223], a[24:27], a[232:235], v[220:223]
 ds_read_b128 a[56:59], v25 offset:44032
 ds_read_b128 a[60:63], v25 offset:48128
 v_mfma_f32_16x16x32_bf16 v[220:223], a[28:31], a[236:239], v[220:223]
 v_mfma_f32_16x16x32_bf16 v[216:219], a[28:31], a[228:231], v[216:219]
 v_mfma_f32_16x16x32_bf16 v[216:219], a[24:27], a[224:227], v[216:219]
 s_waitcnt lgkmcnt(4)
 v_mfma_f32_16x16x32_bf16 v[224:227], a[32:35], a[224:227], v[224:227]
 ds_read_b128 a[0:3], v25 offset:49152
 ds_read_b128 a[4:7], v25 offset:53248
 v_mfma_f32_16x16x32_bf16 v[224:227], a[36:39], a[228:231], v[224:227]
 v_mfma_f32_16x16x32_bf16 v[228:231], a[36:39], a[236:239], v[228:231]
 v_mfma_f32_16x16x32_bf16 v[228:231], a[32:35], a[232:235], v[228:231]
 v_mfma_f32_16x16x32_bf16 v[236:239], a[40:43], a[232:235], v[236:239]
 ds_read_b128 a[8:11], v25 offset:50176
 ds_read_b128 a[12:15], v25 offset:54272
 v_mfma_f32_16x16x32_bf16 v[236:239], a[44:47], a[236:239], v[236:239]
 v_mfma_f32_16x16x32_bf16 v[232:235], a[44:47], a[228:231], v[232:235]
 v_mfma_f32_16x16x32_bf16 v[232:235], a[40:43], a[224:227], v[232:235]
 s_waitcnt lgkmcnt(4)
 v_mfma_f32_16x16x32_bf16 v[240:243], a[48:51], a[224:227], v[240:243]
 ds_read_b128 a[16:19], v25 offset:51200
 ds_read_b128 a[20:23], v25 offset:55296
 v_mfma_f32_16x16x32_bf16 v[240:243], a[52:55], a[228:231], v[240:243]
 v_mfma_f32_16x16x32_bf16 v[244:247], a[52:55], a[236:239], v[244:247]
 v_mfma_f32_16x16x32_bf16 v[244:247], a[48:51], a[232:235], v[244:247]
 v_mfma_f32_16x16x32_bf16 v[252:255], a[56:59], a[232:235], v[252:255]
 ds_read_b128 a[24:27], v25 offset:52224
 ds_read_b128 a[28:31], v25 offset:56320
 v_mfma_f32_16x16x32_bf16 v[252:255], a[60:63], a[236:239], v[252:255]
 v_mfma_f32_16x16x32_bf16 v[248:251], a[60:63], a[228:231], v[248:251]
 v_mfma_f32_16x16x32_bf16 v[248:251], a[56:59], a[224:227], v[248:251]
 s_waitcnt lgkmcnt(4)
 v_mfma_f32_16x16x32_bf16 v[192:195], a[0:3], a[240:243], v[192:195]
 ds_read_b128 a[32:35], v25 offset:57344
 ds_read_b128 a[36:39], v25 offset:61440
 v_mfma_f32_16x16x32_bf16 v[192:195], a[4:7], a[244:247], v[192:195]
 v_mfma_f32_16x16x32_bf16 v[196:199], a[4:7], a[252:255], v[196:199]
 v_mfma_f32_16x16x32_bf16 v[196:199], a[0:3], a[248:251], v[196:199]
 v_mfma_f32_16x16x32_bf16 v[204:207], a[8:11], a[248:251], v[204:207]
 ds_read_b128 a[40:43], v25 offset:58368
 ds_read_b128 a[44:47], v25 offset:62464
 v_mfma_f32_16x16x32_bf16 v[204:207], a[12:15], a[252:255], v[204:207]
 v_mfma_f32_16x16x32_bf16 v[200:203], a[12:15], a[244:247], v[200:203]
 v_mfma_f32_16x16x32_bf16 v[200:203], a[8:11], a[240:243], v[200:203]
 s_waitcnt lgkmcnt(4)
 v_mfma_f32_16x16x32_bf16 v[208:211], a[16:19], a[240:243], v[208:211]
 ds_read_b128 a[48:51], v25 offset:59392
 ds_read_b128 a[52:55], v25 offset:63488
 v_mfma_f32_16x16x32_bf16 v[208:211], a[20:23], a[244:247], v[208:211]
 v_mfma_f32_16x16x32_bf16 v[212:215], a[20:23], a[252:255], v[212:215]
 v_mfma_f32_16x16x32_bf16 v[212:215], a[16:19], a[248:251], v[212:215]
 v_mfma_f32_16x16x32_bf16 v[220:223], a[24:27], a[248:251], v[220:223]
 ds_read_b128 a[56:59], v25 offset:60416
 ds_read_b128 a[60:63], v25 offset:64512
 v_mfma_f32_16x16x32_bf16 v[220:223], a[28:31], a[252:255], v[220:223]
 v_mfma_f32_16x16x32_bf16 v[216:219], a[28:31], a[244:247], v[216:219]
 v_mfma_f32_16x16x32_bf16 v[216:219], a[24:27], a[240:243], v[216:219]
 s_waitcnt lgkmcnt(4)
 s_barrier
 v_mfma_f32_16x16x32_bf16 v[224:227], a[32:35], a[240:243], v[224:227]
 ds_read_b128 a[0:3], v18 offset:0
 ds_read_b128 a[4:7], v18 offset:4096
 v_mfma_f32_16x16x32_bf16 v[224:227], a[36:39], a[244:247], v[224:227]
 v_mfma_f32_16x16x32_bf16 v[228:231], a[36:39], a[252:255], v[228:231]
 v_mfma_f32_16x16x32_bf16 v[228:231], a[32:35], a[248:251], v[228:231]
 v_mfma_f32_16x16x32_bf16 v[236:239], a[40:43], a[248:251], v[236:239]
 ds_read_b128 a[8:11], v18 offset:1024
 ds_read_b128 a[12:15], v18 offset:5120
 v_mfma_f32_16x16x32_bf16 v[236:239], a[44:47], a[252:255], v[236:239]
 v_mfma_f32_16x16x32_bf16 v[232:235], a[44:47], a[244:247], v[232:235]
 v_mfma_f32_16x16x32_bf16 v[232:235], a[40:43], a[240:243], v[232:235]
 s_waitcnt lgkmcnt(4)
 v_mfma_f32_16x16x32_bf16 v[240:243], a[48:51], a[240:243], v[240:243]
 ds_read_b128 a[16:19], v18 offset:2048
 ds_read_b128 a[20:23], v18 offset:6144
 v_mfma_f32_16x16x32_bf16 v[240:243], a[52:55], a[244:247], v[240:243]
 v_mfma_f32_16x16x32_bf16 v[244:247], a[52:55], a[252:255], v[244:247]
 v_mfma_f32_16x16x32_bf16 v[244:247], a[48:51], a[248:251], v[244:247]
 v_mfma_f32_16x16x32_bf16 v[252:255], a[56:59], a[248:251], v[252:255]
 ds_read_b128 a[24:27], v18 offset:3072
 ds_read_b128 a[28:31], v18 offset:7168
 v_mfma_f32_16x16x32_bf16 v[252:255], a[60:63], a[252:255], v[252:255]
 v_mfma_f32_16x16x32_bf16 v[248:251], a[60:63], a[244:247], v[248:251]
 v_mfma_f32_16x16x32_bf16 v[248:251], a[56:59], a[240:243], v[248:251]
 s_waitcnt lgkmcnt(4)
 v_mfma_f32_16x16x32_bf16 v[192:195], a[0:3], a[128:131], v[192:195]
 ds_read_b128 a[32:35], v18 offset:8192
 ds_read_b128 a[36:39], v18 offset:12288
 v_mfma_f32_16x16x32_bf16 v[192:195], a[4:7], a[132:135], v[192:195]
 v_mfma_f32_16x16x32_bf16 v[196:199], a[4:7], a[140:143], v[196:199]
 v_mfma_f32_16x16x32_bf16 v[196:199], a[0:3], a[136:139], v[196:199]
 v_mfma_f32_16x16x32_bf16 v[204:207], a[8:11], a[136:139], v[204:207]
 ds_read_b128 a[40:43], v18 offset:9216
 ds_read_b128 a[44:47], v18 offset:13312
 v_mfma_f32_16x16x32_bf16 v[204:207], a[12:15], a[140:143], v[204:207]
 v_mfma_f32_16x16x32_bf16 v[200:203], a[12:15], a[132:135], v[200:203]
 v_mfma_f32_16x16x32_bf16 v[200:203], a[8:11], a[128:131], v[200:203]
 s_waitcnt lgkmcnt(4)
 v_mfma_f32_16x16x32_bf16 v[208:211], a[16:19], a[128:131], v[208:211]
 ds_read_b128 a[48:51], v18 offset:10240
 ds_read_b128 a[52:55], v18 offset:14336
 v_mfma_f32_16x16x32_bf16 v[208:211], a[20:23], a[132:135], v[208:211]
 v_mfma_f32_16x16x32_bf16 v[212:215], a[20:23], a[140:143], v[212:215]
 v_mfma_f32_16x16x32_bf16 v[212:215], a[16:19], a[136:139], v[212:215]
 v_mfma_f32_16x16x32_bf16 v[220:223], a[24:27], a[136:139], v[220:223]
 ds_read_b128 a[56:59], v18 offset:11264
 ds_read_b128 a[60:63], v18 offset:15360
 v_mfma_f32_16x16x32_bf16 v[220:223], a[28:31], a[140:143], v[220:223]
 v_mfma_f32_16x16x32_bf16 v[216:219], a[28:31], a[132:135], v[216:219]
 v_mfma_f32_16x16x32_bf16 v[216:219], a[24:27], a[128:131], v[216:219]
 s_waitcnt lgkmcnt(4)
 v_mfma_f32_16x16x32_bf16 v[224:227], a[32:35], a[128:131], v[224:227]
 ds_read_b128 a[0:3], v18 offset:16384
 ds_read_b128 a[4:7], v18 offset:20480
 v_mfma_f32_16x16x32_bf16 v[224:227], a[36:39], a[132:135], v[224:227]
 v_mfma_f32_16x16x32_bf16 v[228:231], a[36:39], a[140:143], v[228:231]
 v_mfma_f32_16x16x32_bf16 v[228:231], a[32:35], a[136:139], v[228:231]
 v_mfma_f32_16x16x32_bf16 v[236:239], a[40:43], a[136:139], v[236:239]
 ds_read_b128 a[8:11], v18 offset:17408
 ds_read_b128 a[12:15], v18 offset:21504
 v_mfma_f32_16x16x32_bf16 v[236:239], a[44:47], a[140:143], v[236:239]
 v_mfma_f32_16x16x32_bf16 v[232:235], a[44:47], a[132:135], v[232:235]
 v_mfma_f32_16x16x32_bf16 v[232:235], a[40:43], a[128:131], v[232:235]
 s_waitcnt lgkmcnt(4)
 v_mfma_f32_16x16x32_bf16 v[240:243], a[48:51], a[128:131], v[240:243]
 ds_read_b128 a[16:19], v18 offset:18432
 ds_read_b128 a[20:23], v18 offset:22528
 v_mfma_f32_16x16x32_bf16 v[240:243], a[52:55], a[132:135], v[240:243]
 v_mfma_f32_16x16x32_bf16 v[244:247], a[52:55], a[140:143], v[244:247]
 v_mfma_f32_16x16x32_bf16 v[244:247], a[48:51], a[136:139], v[244:247]
 v_mfma_f32_16x16x32_bf16 v[252:255], a[56:59], a[136:139], v[252:255]
 ds_read_b128 a[24:27], v18 offset:19456
 ds_read_b128 a[28:31], v18 offset:23552
 v_mfma_f32_16x16x32_bf16 v[252:255], a[60:63], a[140:143], v[252:255]
 v_mfma_f32_16x16x32_bf16 v[248:251], a[60:63], a[132:135], v[248:251]
 v_mfma_f32_16x16x32_bf16 v[248:251], a[56:59], a[128:131], v[248:251]
 s_waitcnt lgkmcnt(4)
 s_waitcnt vmcnt(10)
 v_mfma_f32_16x16x32_bf16 v[192:195], a[0:3], a[144:147], v[192:195]
 ds_read_b128 a[32:35], v18 offset:24576
 ds_read_b128 a[36:39], v18 offset:28672
 v_mfma_f32_16x16x32_bf16 v[192:195], a[4:7], a[148:151], v[192:195]
 v_mfma_f32_16x16x32_bf16 v[196:199], a[4:7], a[156:159], v[196:199]
 v_mfma_f32_16x16x32_bf16 v[196:199], a[0:3], a[152:155], v[196:199]
 v_mfma_f32_16x16x32_bf16 v[204:207], a[8:11], a[152:155], v[204:207]
 ds_read_b128 a[40:43], v18 offset:25600
 ds_read_b128 a[44:47], v18 offset:29696
 v_mfma_f32_16x16x32_bf16 v[204:207], a[12:15], a[156:159], v[204:207]
 v_mfma_f32_16x16x32_bf16 v[200:203], a[12:15], a[148:151], v[200:203]
 v_mfma_f32_16x16x32_bf16 v[200:203], a[8:11], a[144:147], v[200:203]
 s_waitcnt lgkmcnt(4)
 v_mfma_f32_16x16x32_bf16 v[208:211], a[16:19], a[144:147], v[208:211]
 ds_read_b128 a[48:51], v18 offset:26624
 ds_read_b128 a[52:55], v18 offset:30720
 v_mfma_f32_16x16x32_bf16 v[208:211], a[20:23], a[148:151], v[208:211]
 v_mfma_f32_16x16x32_bf16 v[212:215], a[20:23], a[156:159], v[212:215]
 v_mfma_f32_16x16x32_bf16 v[212:215], a[16:19], a[152:155], v[212:215]
 v_mfma_f32_16x16x32_bf16 v[220:223], a[24:27], a[152:155], v[220:223]
 ds_read_b128 a[56:59], v18 offset:27648
 ds_read_b128 a[60:63], v18 offset:31744
 v_cvt_pk_bf16_f32 v192, v192, v193
 v_cvt_pk_bf16_f32 v193, v194, v195
 v_cvt_pk_bf16_f32 v196, v196, v197
 v_cvt_pk_bf16_f32 v197, v198, v199
 v_mfma_f32_16x16x32_bf16 v[220:223], a[28:31], a[156:159], v[220:223]
 v_cvt_pk_bf16_f32 v194, v200, v201
 v_cvt_pk_bf16_f32 v195, v202, v203
 v_cvt_pk_bf16_f32 v198, v204, v205
 v_cvt_pk_bf16_f32 v199, v206, v207
 v_mfma_f32_16x16x32_bf16 v[216:219], a[28:31], a[148:151], v[216:219]
 ds_write_b128 v53, v[192:195] offset:8192
 buffer_store_dwordx4 v[192:195], v48, s[20:23], s54 offen offset:0 sc1
 ds_write_b128 v53, v[196:199] offset:10240
 buffer_store_dwordx4 v[196:199], v49, s[20:23], s54 offen offset:0 sc1
 v_mfma_f32_16x16x32_bf16 v[216:219], a[24:27], a[144:147], v[216:219]
 s_waitcnt lgkmcnt(6)
 v_mfma_f32_16x16x32_bf16 v[224:227], a[32:35], a[144:147], v[224:227]
 v_mfma_f32_16x16x32_bf16 v[224:227], a[36:39], a[148:151], v[224:227]
 v_mfma_f32_16x16x32_bf16 v[228:231], a[36:39], a[156:159], v[228:231]
 v_mfma_f32_16x16x32_bf16 v[228:231], a[32:35], a[152:155], v[228:231]
 v_mfma_f32_16x16x32_bf16 v[236:239], a[40:43], a[152:155], v[236:239]
 v_cvt_pk_bf16_f32 v208, v208, v209
 v_cvt_pk_bf16_f32 v209, v210, v211
 v_cvt_pk_bf16_f32 v212, v212, v213
 v_cvt_pk_bf16_f32 v213, v214, v215
 v_mfma_f32_16x16x32_bf16 v[236:239], a[44:47], a[156:159], v[236:239]
 v_cvt_pk_bf16_f32 v210, v216, v217
 v_cvt_pk_bf16_f32 v211, v218, v219
 v_cvt_pk_bf16_f32 v214, v220, v221
 v_cvt_pk_bf16_f32 v215, v222, v223
 v_mfma_f32_16x16x32_bf16 v[232:235], a[44:47], a[148:151], v[232:235]
 ds_write_b128 v53, v[208:211] offset:9216
 buffer_store_dwordx4 v[208:211], v48, s[20:23], s54 offen offset:1024 sc1
 ds_write_b128 v53, v[212:215] offset:11264
 buffer_store_dwordx4 v[212:215], v49, s[20:23], s54 offen offset:1024 sc1
 v_mfma_f32_16x16x32_bf16 v[232:235], a[40:43], a[144:147], v[232:235]
 s_waitcnt lgkmcnt(4)
 v_mfma_f32_16x16x32_bf16 v[240:243], a[48:51], a[144:147], v[240:243]
 v_mfma_f32_16x16x32_bf16 v[240:243], a[52:55], a[148:151], v[240:243]
 v_mfma_f32_16x16x32_bf16 v[244:247], a[52:55], a[156:159], v[244:247]
 v_mfma_f32_16x16x32_bf16 v[244:247], a[48:51], a[152:155], v[244:247]
 v_mfma_f32_16x16x32_bf16 v[252:255], a[56:59], a[152:155], v[252:255]
 v_cvt_pk_bf16_f32 v224, v224, v225
 v_cvt_pk_bf16_f32 v225, v226, v227
 v_cvt_pk_bf16_f32 v228, v228, v229
 v_cvt_pk_bf16_f32 v229, v230, v231
 v_mfma_f32_16x16x32_bf16 v[252:255], a[60:63], a[156:159], v[252:255]
 v_cvt_pk_bf16_f32 v226, v232, v233
 v_cvt_pk_bf16_f32 v227, v234, v235
 v_cvt_pk_bf16_f32 v230, v236, v237
 v_cvt_pk_bf16_f32 v231, v238, v239
 v_mfma_f32_16x16x32_bf16 v[248:251], a[60:63], a[148:151], v[248:251]
 ds_write_b128 v54, v[224:227] offset:8192
 buffer_store_dwordx4 v[224:227], v50, s[20:23], s56 offen offset:0 sc1
 ds_write_b128 v54, v[228:231] offset:10240
 buffer_store_dwordx4 v[228:231], v51, s[20:23], s56 offen offset:0 sc1
 v_mfma_f32_16x16x32_bf16 v[248:251], a[56:59], a[144:147], v[248:251]
 v_cvt_pk_bf16_f32 v240, v240, v241
 v_cvt_pk_bf16_f32 v241, v242, v243
 s_nop 5
 v_cvt_pk_bf16_f32 v242, v248, v249
 v_cvt_pk_bf16_f32 v243, v250, v251
 ds_write_b128 v54, v[240:243] offset:9216
 buffer_store_dwordx4 v[240:243], v50, s[20:23], s56 offen offset:1024 sc1
 v_cvt_pk_bf16_f32 v244, v244, v245
 v_cvt_pk_bf16_f32 v245, v246, v247
 v_cvt_pk_bf16_f32 v246, v252, v253
 v_cvt_pk_bf16_f32 v247, v254, v255
 ds_write_b128 v54, v[244:247] offset:11264
 buffer_store_dwordx4 v[244:247], v51, s[20:23], s56 offen offset:1024 sc1
fin_a:
 s_waitcnt vmcnt(8)
 s_mov_b32 s4, 0x4275fdf0
 s_mov_b32 s5, 0xbfb8aa3b
 s_lshl_b32 s62, s62, 8
 s_waitcnt lgkmcnt(0)
 s_add_u32 s90, s90, 0x800000
 s_add_u32 s49, s49, 0x800000
 s_add_u32 s50, s50, 0x800000
 v_lshlrev_b32 v128, 16, v64
 v_and_b32 v129, 0xffff0000, v64
 v_lshlrev_b32 v130, 16, v65
 v_and_b32 v131, 0xffff0000, v65
 v_lshlrev_b32 v132, 16, v72
 v_and_b32 v133, 0xffff0000, v72
 v_lshlrev_b32 v134, 16, v73
 v_and_b32 v135, 0xffff0000, v73
 v_lshlrev_b32 v136, 16, v80
 v_and_b32 v137, 0xffff0000, v80
 v_lshlrev_b32 v138, 16, v81
 v_and_b32 v139, 0xffff0000, v81
 v_lshlrev_b32 v140, 16, v88
 v_and_b32 v141, 0xffff0000, v88
 v_lshlrev_b32 v142, 16, v89
 v_and_b32 v143, 0xffff0000, v89
 v_pk_add_f32 v[128:129], v[128:129], v[132:133]
 v_pk_add_f32 v[136:137], v[136:137], v[140:141]
 v_pk_add_f32 v[130:131], v[130:131], v[134:135]
 v_pk_add_f32 v[138:139], v[138:139], v[142:143]
 v_pk_add_f32 v[128:129], v[128:129], v[136:137]
 v_pk_add_f32 v[130:131], v[130:131], v[138:139]
 v_lshlrev_b32 v144, 16, v66
 v_and_b32 v145, 0xffff0000, v66
 v_lshlrev_b32 v146, 16, v67
 v_and_b32 v147, 0xffff0000, v67
 v_lshlrev_b32 v148, 16, v74
 v_and_b32 v149, 0xffff0000, v74
 v_lshlrev_b32 v150, 16, v75
 v_and_b32 v151, 0xffff0000, v75
 v_lshlrev_b32 v152, 16, v82
 v_and_b32 v153, 0xffff0000, v82
 v_lshlrev_b32 v154, 16, v83
 v_and_b32 v155, 0xffff0000, v83
 v_lshlrev_b32 v156, 16, v90
 v_and_b32 v157, 0xffff0000, v90
 v_lshlrev_b32 v158, 16, v91
 v_and_b32 v159, 0xffff0000, v91
 v_pk_add_f32 v[144:145], v[144:145], v[148:149]
 v_pk_add_f32 v[152:153], v[152:153], v[156:157]
 v_pk_add_f32 v[146:147], v[146:147], v[150:151]
 v_pk_add_f32 v[154:155], v[154:155], v[158:159]
 v_pk_add_f32 v[144:145], v[144:145], v[152:153]
 v_pk_add_f32 v[146:147], v[146:147], v[154:155]
 v_lshlrev_b32 v160, 16, v68
 v_and_b32 v161, 0xffff0000, v68
 v_lshlrev_b32 v162, 16, v69
 v_and_b32 v163, 0xffff0000, v69
 v_lshlrev_b32 v164, 16, v76
 v_and_b32 v165, 0xffff0000, v76
 v_lshlrev_b32 v166, 16, v77
 v_and_b32 v167, 0xffff0000, v77
 v_lshlrev_b32 v168, 16, v84
 v_and_b32 v169, 0xffff0000, v84
 v_lshlrev_b32 v170, 16, v85
 v_and_b32 v171, 0xffff0000, v85
 v_lshlrev_b32 v172, 16, v92
 v_and_b32 v173, 0xffff0000, v92
 v_lshlrev_b32 v174, 16, v93
 v_and_b32 v175, 0xffff0000, v93
 v_pk_add_f32 v[160:161], v[160:161], v[164:165]
 v_pk_add_f32 v[168:169], v[168:169], v[172:173]
 v_pk_add_f32 v[162:163], v[162:163], v[166:167]
 v_pk_add_f32 v[170:171], v[170:171], v[174:175]
 v_pk_add_f32 v[160:161], v[160:161], v[168:169]
 v_pk_add_f32 v[162:163], v[162:163], v[170:171]
 v_lshlrev_b32 v176, 16, v70
 v_and_b32 v177, 0xffff0000, v70
 v_lshlrev_b32 v178, 16, v71
 v_and_b32 v179, 0xffff0000, v71
 v_lshlrev_b32 v180, 16, v78
 v_and_b32 v181, 0xffff0000, v78
 v_lshlrev_b32 v182, 16, v79
 v_and_b32 v183, 0xffff0000, v79
 v_lshlrev_b32 v184, 16, v86
 v_and_b32 v185, 0xffff0000, v86
 v_lshlrev_b32 v186, 16, v87
 v_and_b32 v187, 0xffff0000, v87
 v_lshlrev_b32 v188, 16, v94
 v_and_b32 v189, 0xffff0000, v94
 v_lshlrev_b32 v190, 16, v95
 v_and_b32 v191, 0xffff0000, v95
 v_pk_add_f32 v[176:177], v[176:177], v[180:181]
 v_pk_add_f32 v[184:185], v[184:185], v[188:189]
 v_pk_add_f32 v[178:179], v[178:179], v[182:183]
 v_pk_add_f32 v[186:187], v[186:187], v[190:191]
 v_pk_add_f32 v[176:177], v[176:177], v[184:185]
 v_pk_add_f32 v[178:179], v[178:179], v[186:187]
 v_pk_mul_f32 v[128:129], v[128:129], s[4:5] op_sel_hi:[1,0]
 v_pk_mul_f32 v[130:131], v[130:131], s[4:5] op_sel_hi:[1,0]
 v_mul_f32 v132, s5, v128
 v_mul_f32 v133, s5, v129
 v_mul_f32 v134, s5, v130
 v_mul_f32 v135, s5, v131
 v_exp_f32 v132, v132
 v_exp_f32 v133, v133
 v_exp_f32 v134, v134
 v_exp_f32 v135, v135
 v_lshlrev_b32 v136, 16, v32
 v_and_b32 v137, 0xffff0000, v32
 v_lshlrev_b32 v138, 16, v33
 v_and_b32 v139, 0xffff0000, v33
 v_pk_add_f32 v[132:133], v[132:133], 1.0 op_sel_hi:[1,0]
 v_pk_add_f32 v[134:135], v[134:135], 1.0 op_sel_hi:[1,0]
 v_rcp_f32 v132, v132
 v_rcp_f32 v133, v133
 v_rcp_f32 v134, v134
 v_rcp_f32 v135, v135
 v_pk_mul_f32 v[144:145], v[144:145], s[4:5] op_sel_hi:[1,0]
 v_pk_mul_f32 v[146:147], v[146:147], s[4:5] op_sel_hi:[1,0]
 v_mul_f32 v148, s5, v144
 v_mul_f32 v149, s5, v145
 v_mul_f32 v150, s5, v146
 v_mul_f32 v151, s5, v147
 v_exp_f32 v148, v148
 v_exp_f32 v149, v149
 v_exp_f32 v150, v150
 v_exp_f32 v151, v151
 s_waitcnt vmcnt(0)
 buffer_atomic_add v52, v31, s[40:43], 0 offen sc1
 v_lshlrev_b32 v152, 16, v34
 v_and_b32 v153, 0xffff0000, v34
 v_lshlrev_b32 v154, 16, v35
 v_and_b32 v155, 0xffff0000, v35
 v_pk_add_f32 v[148:149], v[148:149], 1.0 op_sel_hi:[1,0]
 v_pk_add_f32 v[150:151], v[150:151], 1.0 op_sel_hi:[1,0]
 v_rcp_f32 v148, v148
 v_rcp_f32 v149, v149
 v_rcp_f32 v150, v150
 v_rcp_f32 v151, v151
 v_pk_mul_f32 v[160:161], v[160:161], s[4:5] op_sel_hi:[1,0]
 v_pk_mul_f32 v[162:163], v[162:163], s[4:5] op_sel_hi:[1,0]
 v_mul_f32 v164, s5, v160
 v_mul_f32 v165, s5, v161
 v_mul_f32 v166, s5, v162
 v_mul_f32 v167, s5, v163
 v_exp_f32 v164, v164
 v_exp_f32 v165, v165
 v_exp_f32 v166, v166
 v_exp_f32 v167, v167
 v_lshlrev_b32 v168, 16, v36
 v_and_b32 v169, 0xffff0000, v36
 v_lshlrev_b32 v170, 16, v37
 v_and_b32 v171, 0xffff0000, v37
 v_pk_add_f32 v[164:165], v[164:165], 1.0 op_sel_hi:[1,0]
 v_pk_add_f32 v[166:167], v[166:167], 1.0 op_sel_hi:[1,0]
 v_rcp_f32 v164, v164
 v_rcp_f32 v165, v165
 v_rcp_f32 v166, v166
 v_rcp_f32 v167, v167
 v_pk_mul_f32 v[176:177], v[176:177], s[4:5] op_sel_hi:[1,0]
 v_pk_mul_f32 v[178:179], v[178:179], s[4:5] op_sel_hi:[1,0]
 v_mul_f32 v180, s5, v176
 v_mul_f32 v181, s5, v177
 v_mul_f32 v182, s5, v178
 v_mul_f32 v183, s5, v179
 v_exp_f32 v180, v180
 v_exp_f32 v181, v181
 v_exp_f32 v182, v182
 v_exp_f32 v183, v183
 v_lshlrev_b32 v184, 16, v38
 v_and_b32 v185, 0xffff0000, v38
 v_lshlrev_b32 v186, 16, v39
 v_and_b32 v187, 0xffff0000, v39
 v_pk_add_f32 v[180:181], v[180:181], 1.0 op_sel_hi:[1,0]
 v_pk_add_f32 v[182:183], v[182:183], 1.0 op_sel_hi:[1,0]
 v_rcp_f32 v180, v180
 v_rcp_f32 v181, v181
 v_rcp_f32 v182, v182
 v_rcp_f32 v183, v183
 v_pk_mul_f32 v[128:129], v[128:129], v[132:133]
 v_pk_mul_f32 v[130:131], v[130:131], v[134:135]
 v_pk_mul_f32 v[144:145], v[144:145], v[148:149]
 v_pk_mul_f32 v[146:147], v[146:147], v[150:151]
 v_pk_mul_f32 v[160:161], v[160:161], v[164:165]
 v_pk_mul_f32 v[162:163], v[162:163], v[166:167]
 v_pk_mul_f32 v[176:177], v[176:177], v[180:181]
 v_pk_mul_f32 v[178:179], v[178:179], v[182:183]
 buffer_load_dword v19, v20, s[40:43], 0 offen sc1
 s_waitcnt vmcnt(0)
 v_cmp_gt_u32 vcc, s62, v19
 s_nop 0
 s_cbranch_vccnz s_spin
s_ok:
 s_barrier
 buffer_load_dwordx4 v[104:107], v18, s[20:23], s90 offen offset:0 sc1
 buffer_load_dwordx4 v[108:111], v18, s[20:23], s90 offen offset:1024 sc1
 buffer_load_dwordx4 v[112:115], v18, s[20:23], s49 offen offset:0 sc1
 buffer_load_dwordx4 v[116:119], v18, s[20:23], s49 offen offset:1024 sc1
 buffer_load_dwordx4 v[120:123], v18, s[20:23], s50 offen offset:0 sc1
 buffer_load_dwordx4 v[124:127], v18, s[20:23], s50 offen offset:1024 sc1
 ds_read_b128 v[96:99], v55 offset:8192
 ds_read_b128 v[100:103], v55 offset:9216
 s_waitcnt vmcnt(0) lgkmcnt(0)
 v_lshlrev_b32 v192, 16, v96
 v_and_b32 v193, 0xffff0000, v96
 v_lshlrev_b32 v194, 16, v97
 v_and_b32 v195, 0xffff0000, v97
 v_lshlrev_b32 v196, 16, v104
 v_and_b32 v197, 0xffff0000, v104
 v_lshlrev_b32 v198, 16, v105
 v_and_b32 v199, 0xffff0000, v105
 v_lshlrev_b32 v200, 16, v112
 v_and_b32 v201, 0xffff0000, v112
 v_lshlrev_b32 v202, 16, v113
 v_and_b32 v203, 0xffff0000, v113
 v_lshlrev_b32 v204, 16, v120
 v_and_b32 v205, 0xffff0000, v120
 v_lshlrev_b32 v206, 16, v121
 v_and_b32 v207, 0xffff0000, v121
 v_pk_add_f32 v[192:193], v[192:193], v[196:197]
 v_pk_add_f32 v[200:201], v[200:201], v[204:205]
 v_pk_add_f32 v[194:195], v[194:195], v[198:199]
 v_pk_add_f32 v[202:203], v[202:203], v[206:207]
 v_pk_add_f32 v[192:193], v[192:193], v[200:201]
 v_pk_add_f32 v[194:195], v[194:195], v[202:203]
 v_pk_fma_f32 v[136:137], v[128:129], v[192:193], v[136:137]
 v_pk_fma_f32 v[138:139], v[130:131], v[194:195], v[138:139]
 v_cvt_pk_bf16_f32 v140, v136, v137
 v_cvt_pk_bf16_f32 v141, v138, v139
 buffer_store_dwordx2 v[140:141], v60, s[28:31], s58 offen offset:0
 v_lshlrev_b32 v208, 16, v98
 v_and_b32 v209, 0xffff0000, v98
 v_lshlrev_b32 v210, 16, v99
 v_and_b32 v211, 0xffff0000, v99
 v_lshlrev_b32 v212, 16, v106
 v_and_b32 v213, 0xffff0000, v106
 v_lshlrev_b32 v214, 16, v107
 v_and_b32 v215, 0xffff0000, v107
 v_lshlrev_b32 v216, 16, v114
 v_and_b32 v217, 0xffff0000, v114
 v_lshlrev_b32 v218, 16, v115
 v_and_b32 v219, 0xffff0000, v115
 v_lshlrev_b32 v220, 16, v122
 v_and_b32 v221, 0xffff0000, v122
 v_lshlrev_b32 v222, 16, v123
 v_and_b32 v223, 0xffff0000, v123
 v_pk_add_f32 v[208:209], v[208:209], v[212:213]
 v_pk_add_f32 v[216:217], v[216:217], v[220:221]
 v_pk_add_f32 v[210:211], v[210:211], v[214:215]
 v_pk_add_f32 v[218:219], v[218:219], v[222:223]
 v_pk_add_f32 v[208:209], v[208:209], v[216:217]
 v_pk_add_f32 v[210:211], v[210:211], v[218:219]
 v_pk_fma_f32 v[152:153], v[144:145], v[208:209], v[152:153]
 v_pk_fma_f32 v[154:155], v[146:147], v[210:211], v[154:155]
 v_cvt_pk_bf16_f32 v156, v152, v153
 v_cvt_pk_bf16_f32 v157, v154, v155
 buffer_store_dwordx2 v[156:157], v60, s[28:31], s58 offen offset:32
 v_lshlrev_b32 v224, 16, v100
 v_and_b32 v225, 0xffff0000, v100
 v_lshlrev_b32 v226, 16, v101
 v_and_b32 v227, 0xffff0000, v101
 v_lshlrev_b32 v228, 16, v108
 v_and_b32 v229, 0xffff0000, v108
 v_lshlrev_b32 v230, 16, v109
 v_and_b32 v231, 0xffff0000, v109
 v_lshlrev_b32 v232, 16, v116
 v_and_b32 v233, 0xffff0000, v116
 v_lshlrev_b32 v234, 16, v117
 v_and_b32 v235, 0xffff0000, v117
 v_lshlrev_b32 v236, 16, v124
 v_and_b32 v237, 0xffff0000, v124
 v_lshlrev_b32 v238, 16, v125
 v_and_b32 v239, 0xffff0000, v125
 v_pk_add_f32 v[224:225], v[224:225], v[228:229]
 v_pk_add_f32 v[232:233], v[232:233], v[236:237]
 v_pk_add_f32 v[226:227], v[226:227], v[230:231]
 v_pk_add_f32 v[234:235], v[234:235], v[238:239]
 v_pk_add_f32 v[224:225], v[224:225], v[232:233]
 v_pk_add_f32 v[226:227], v[226:227], v[234:235]
 v_pk_fma_f32 v[168:169], v[160:161], v[224:225], v[168:169]
 v_pk_fma_f32 v[170:171], v[162:163], v[226:227], v[170:171]
 v_cvt_pk_bf16_f32 v172, v168, v169
 v_cvt_pk_bf16_f32 v173, v170, v171
 buffer_store_dwordx2 v[172:173], v60, s[28:31], s58 offen offset:64
 v_lshlrev_b32 v240, 16, v102
 v_and_b32 v241, 0xffff0000, v102
 v_lshlrev_b32 v242, 16, v103
 v_and_b32 v243, 0xffff0000, v103
 v_lshlrev_b32 v244, 16, v110
 v_and_b32 v245, 0xffff0000, v110
 v_lshlrev_b32 v246, 16, v111
 v_and_b32 v247, 0xffff0000, v111
 v_lshlrev_b32 v248, 16, v118
 v_and_b32 v249, 0xffff0000, v118
 v_lshlrev_b32 v250, 16, v119
 v_and_b32 v251, 0xffff0000, v119
 v_lshlrev_b32 v252, 16, v126
 v_and_b32 v253, 0xffff0000, v126
 v_lshlrev_b32 v254, 16, v127
 v_and_b32 v255, 0xffff0000, v127
 v_pk_add_f32 v[240:241], v[240:241], v[244:245]
 v_pk_add_f32 v[248:249], v[248:249], v[252:253]
 v_pk_add_f32 v[242:243], v[242:243], v[246:247]
 v_pk_add_f32 v[250:251], v[250:251], v[254:255]
 v_pk_add_f32 v[240:241], v[240:241], v[248:249]
 v_pk_add_f32 v[242:243], v[242:243], v[250:251]
 v_pk_fma_f32 v[184:185], v[176:177], v[240:241], v[184:185]
 v_pk_fma_f32 v[186:187], v[178:179], v[242:243], v[186:187]
 v_cvt_pk_bf16_f32 v188, v184, v185
 v_cvt_pk_bf16_f32 v189, v186, v187
 buffer_store_dwordx2 v[188:189], v60, s[28:31], s58 offen offset:96
m_end:
 s_endpgm
m_z:
outo_a:
 v_mfma_f32_16x16x32_bf16 v[128:131], a[0:3], a[128:131], 0
 s_add_u32 s20, s86, 67108864
 s_addc_u32 s21, s87, 0
 ds_read_b128 a[32:35], v18 offset:8192
 ds_read_b128 a[36:39], v18 offset:12288
 v_mfma_f32_16x16x32_bf16 v[128:131], a[4:7], a[132:135], v[128:131]
 s_mov_b32 s22, 16777216
 buffer_load_dword v19, v20, s[40:43], 0 offen sc1
 v_mfma_f32_16x16x32_bf16 v[132:135], a[4:7], a[140:143], 0
 s_mov_b32 s23, 0x00020000
 v_mfma_f32_16x16x32_bf16 v[132:135], a[0:3], a[136:139], v[132:135]
 s_mov_b32 s16, s64
 v_mfma_f32_16x16x32_bf16 v[140:143], a[8:11], a[136:139], 0
 s_mov_b32 s17, s65
 ds_read_b128 a[40:43], v18 offset:9216
 ds_read_b128 a[44:47], v18 offset:13312
 v_mfma_f32_16x16x32_bf16 v[140:143], a[12:15], a[140:143], v[140:143]
 s_mov_b32 s18, 2097152
 v_mfma_f32_16x16x32_bf16 v[136:139], a[12:15], a[132:135], 0
 s_mov_b32 s19, 0x00020000
 v_mfma_f32_16x16x32_bf16 v[136:139], a[8:11], a[128:131], v[136:139]
 s_waitcnt lgkmcnt(4)
 s_mov_b32 s28, s82
 v_mfma_f32_16x16x32_bf16 v[144:147], a[16:19], a[128:131], 0
 s_mov_b32 s29, s83
 ds_read_b128 a[48:51], v18 offset:10240
 ds_read_b128 a[52:55], v18 offset:14336
 v_mfma_f32_16x16x32_bf16 v[144:147], a[20:23], a[132:135], v[144:147]
 s_mov_b32 s30, 2097152
 v_mfma_f32_16x16x32_bf16 v[148:151], a[20:23], a[140:143], 0
 s_mov_b32 s31, 0x00020000
 v_mfma_f32_16x16x32_bf16 v[148:151], a[16:19], a[136:139], v[148:151]
 s_lshl_b32 s3, s53, 2
 v_mfma_f32_16x16x32_bf16 v[156:159], a[24:27], a[136:139], 0
 s_bfe_u32 s4, s2, 0x20003
 ds_read_b128 a[56:59], v18 offset:11264
 ds_read_b128 a[60:63], v18 offset:15360
 v_mfma_f32_16x16x32_bf16 v[156:159], a[28:31], a[140:143], v[156:159]
 s_add_u32 s3, s3, s4
 v_mfma_f32_16x16x32_bf16 v[152:155], a[28:31], a[132:135], 0
 s_lshl_b32 s5, s3, 2
 v_mfma_f32_16x16x32_bf16 v[152:155], a[24:27], a[128:131], v[152:155]
 s_waitcnt lgkmcnt(4)
 s_lshl_b32 s54, s3, 17
 v_mfma_f32_16x16x32_bf16 v[160:163], a[32:35], a[128:131], 0
 s_lshr_b32 s6, s44, 1
 ds_read_b128 a[0:3], v18 offset:16384
 ds_read_b128 a[4:7], v18 offset:20480
 v_mfma_f32_16x16x32_bf16 v[160:163], a[36:39], a[132:135], v[160:163]
 s_lshl_b32 s3, s6, 16
 v_mfma_f32_16x16x32_bf16 v[164:167], a[36:39], a[140:143], 0
 s_add_u32 s54, s54, s3
 v_mfma_f32_16x16x32_bf16 v[164:167], a[32:35], a[136:139], v[164:167]
 s_and_b32 s3, s47, 4096
 v_mfma_f32_16x16x32_bf16 v[172:175], a[40:43], a[136:139], 0
 s_lshl_b32 s3, s3, 2
 ds_read_b128 a[8:11], v18 offset:17408
 ds_read_b128 a[12:15], v18 offset:21504
 v_mfma_f32_16x16x32_bf16 v[172:175], a[44:47], a[140:143], v[172:175]
 s_add_u32 s54, s54, s3
 v_mfma_f32_16x16x32_bf16 v[168:171], a[44:47], a[132:135], 0
 s_lshl_b32 s3, s55, 11
 v_mfma_f32_16x16x32_bf16 v[168:171], a[40:43], a[128:131], v[168:171]
 s_waitcnt lgkmcnt(4)
 s_add_u32 s54, s54, s3
 v_mfma_f32_16x16x32_bf16 v[176:179], a[48:51], a[128:131], 0
 s_lshl_b32 s6, s6, 1
 ds_read_b128 a[16:19], v18 offset:18432
 ds_read_b128 a[20:23], v18 offset:22528
 v_mfma_f32_16x16x32_bf16 v[176:179], a[52:55], a[132:135], v[176:179]
 s_add_u32 s6, s6, s5
 v_mfma_f32_16x16x32_bf16 v[180:183], a[52:55], a[140:143], 0
 s_add_u32 s6, s6, 72
 v_mfma_f32_16x16x32_bf16 v[180:183], a[48:51], a[136:139], v[180:183]
 s_lshl_b32 s6, s6, 8
 v_mfma_f32_16x16x32_bf16 v[188:191], a[56:59], a[136:139], 0
 ds_read_b128 a[24:27], v18 offset:19456
 ds_read_b128 a[28:31], v18 offset:23552
 v_mfma_f32_16x16x32_bf16 v[188:191], a[60:63], a[140:143], v[188:191]
 v_mfma_f32_16x16x32_bf16 v[184:187], a[60:63], a[132:135], 0
 v_mfma_f32_16x16x32_bf16 v[184:187], a[56:59], a[128:131], v[184:187]
 s_waitcnt lgkmcnt(4)
 s_waitcnt vmcnt(29)
 v_mfma_f32_16x16x32_bf16 v[128:131], a[0:3], a[144:147], v[128:131]
 ds_read_b128 a[32:35], v18 offset:24576
 ds_read_b128 a[36:39], v18 offset:28672
 v_mfma_f32_16x16x32_bf16 v[128:131], a[4:7], a[148:151], v[128:131]
 v_mfma_f32_16x16x32_bf16 v[132:135], a[4:7], a[156:159], v[132:135]
 v_mfma_f32_16x16x32_bf16 v[132:135], a[0:3], a[152:155], v[132:135]
 v_mfma_f32_16x16x32_bf16 v[140:143], a[8:11], a[152:155], v[140:143]
 ds_read_b128 a[40:43], v18 offset:25600
 ds_read_b128 a[44:47], v18 offset:29696
 v_mfma_f32_16x16x32_bf16 v[140:143], a[12:15], a[156:159], v[140:143]
 v_mfma_f32_16x16x32_bf16 v[136:139], a[12:15], a[148:151], v[136:139]
 v_mfma_f32_16x16x32_bf16 v[136:139], a[8:11], a[144:147], v[136:139]
 s_waitcnt lgkmcnt(4)
 v_mfma_f32_16x16x32_bf16 v[144:147], a[16:19], a[144:147], v[144:147]
 ds_read_b128 a[48:51], v18 offset:26624
 ds_read_b128 a[52:55], v18 offset:30720
 v_mfma_f32_16x16x32_bf16 v[144:147], a[20:23], a[148:151], v[144:147]
 v_mfma_f32_16x16x32_bf16 v[148:151], a[20:23], a[156:159], v[148:151]
 v_mfma_f32_16x16x32_bf16 v[148:151], a[16:19], a[152:155], v[148:151]
 v_mfma_f32_16x16x32_bf16 v[156:159], a[24:27], a[152:155], v[156:159]
 ds_read_b128 a[56:59], v18 offset:27648
 ds_read_b128 a[60:63], v18 offset:31744
 v_mfma_f32_16x16x32_bf16 v[156:159], a[28:31], a[156:159], v[156:159]
 v_mfma_f32_16x16x32_bf16 v[152:155], a[28:31], a[148:151], v[152:155]
 s_waitcnt vmcnt(0)
 v_cmp_gt_u32 vcc, s62, v19
 v_mfma_f32_16x16x32_bf16 v[152:155], a[24:27], a[144:147], v[152:155]
 s_waitcnt lgkmcnt(4)
 s_barrier
 buffer_atomic_add v30, v29, s[40:43], 0 offen sc1
 s_cbranch_vccnz ao_spin
ao_ok:
 s_barrier
 v_mfma_f32_16x16x32_bf16 v[160:163], a[32:35], a[144:147], v[160:163]
 s_lshl_b32 s7, s53, 2
 s_add_u32 s7, s7, s44
 s_lshl_b32 s7, s7, 18
 s_lshl_b32 s52, s55, 15
 s_add_u32 s52, s52, s7
 ds_read_b128 a[0:3], v18 offset:32768
 ds_read_b128 a[4:7], v18 offset:36864
 v_mfma_f32_16x16x32_bf16 v[160:163], a[36:39], a[148:151], v[160:163]
 buffer_load_dwordx4 a[192:195], v23, s[36:39], s52 offen offset:0 sc1
 v_mfma_f32_16x16x32_bf16 v[164:167], a[36:39], a[156:159], v[164:167]
 v_add_u32 v20, 256, v20
 v_mfma_f32_16x16x32_bf16 v[164:167], a[32:35], a[152:155], v[164:167]
 buffer_load_dwordx4 a[196:199], v23, s[36:39], s52 offen offset:1024 sc1
 v_mfma_f32_16x16x32_bf16 v[172:175], a[40:43], a[152:155], v[172:175]
 ds_read_b128 a[8:11], v18 offset:33792
 ds_read_b128 a[12:15], v18 offset:37888
 v_mfma_f32_16x16x32_bf16 v[172:175], a[44:47], a[156:159], v[172:175]
 buffer_load_dwordx4 a[200:203], v24, s[36:39], s52 offen offset:0 sc1
 v_mfma_f32_16x16x32_bf16 v[168:171], a[44:47], a[148:151], v[168:171]
 v_mfma_f32_16x16x32_bf16 v[168:171], a[40:43], a[144:147], v[168:171]
 s_waitcnt lgkmcnt(4)
 buffer_load_dwordx4 a[204:207], v24, s[36:39], s52 offen offset:1024 sc1
 v_mfma_f32_16x16x32_bf16 v[176:179], a[48:51], a[144:147], v[176:179]
 s_add_u32 s52, s52, 2048
 s_add_u32 s91, s89, 24576
 s_add_u32 m0, s47, 114688
 ds_read_b128 a[16:19], v18 offset:34816
 ds_read_b128 a[20:23], v18 offset:38912
 v_mfma_f32_16x16x32_bf16 v[176:179], a[52:55], a[148:151], v[176:179]
 buffer_load_dwordx4 v18, s[24:27], s91 offen offset:0 sc1 lds
 v_mfma_f32_16x16x32_bf16 v[180:183], a[52:55], a[156:159], v[180:183]
 v_mfma_f32_16x16x32_bf16 v[180:183], a[48:51], a[152:155], v[180:183]
 buffer_load_dwordx4 v18, s[24:27], s91 offen offset:1024 sc1 lds
 v_mfma_f32_16x16x32_bf16 v[188:191], a[56:59], a[152:155], v[188:191]
 ds_read_b128 a[24:27], v18 offset:35840
 ds_read_b128 a[28:31], v18 offset:39936
 v_mfma_f32_16x16x32_bf16 v[188:191], a[60:63], a[156:159], v[188:191]
 buffer_load_dwordx4 v18, s[24:27], s91 offen offset:2048 sc1 lds
 v_mfma_f32_16x16x32_bf16 v[184:187], a[60:63], a[148:151], v[184:187]
 v_mfma_f32_16x16x32_bf16 v[184:187], a[56:59], a[144:147], v[184:187]
 s_waitcnt lgkmcnt(4)
 buffer_load_dwordx4 v18, s[24:27], s91 offen offset:3072 sc1 lds
 v_mfma_f32_16x16x32_bf16 v[128:131], a[0:3], a[160:163], v[128:131]
 s_add_u32 s5, s5, s55
 ds_read_b128 a[32:35], v18 offset:40960
 ds_read_b128 a[36:39], v18 offset:45056
 v_mfma_f32_16x16x32_bf16 v[128:131], a[4:7], a[164:167], v[128:131]
 s_lshl_b32 s59, s5, 15
 buffer_load_dwordx4 a[208:211], v23, s[36:39], s52 offen offset:0 sc1
 v_mfma_f32_16x16x32_bf16 v[132:135], a[4:7], a[172:175], v[132:135]
 s_lshl_b32 s3, s47, 1
 buffer_load_dwordx4 a[212:215], v23, s[36:39], s52 offen offset:1024 sc1
 v_mov_b32 v48, v18
 v_mfma_f32_16x16x32_bf16 v[132:135], a[0:3], a[168:171], v[132:135]
 s_add_u32 s59, s59, s3
 buffer_load_dwordx4 a[216:219], v24, s[36:39], s52 offen offset:0 sc1
 v_mfma_f32_16x16x32_bf16 v[140:143], a[8:11], a[168:171], v[140:143]
 s_add_u32 s5, s5, 72
 ds_read_b128 a[40:43], v18 offset:41984
 ds_read_b128 a[44:47], v18 offset:46080
 v_add_u32 v49, 8192, v18
 v_mfma_f32_16x16x32_bf16 v[140:143], a[12:15], a[172:175], v[140:143]
 s_lshl_b32 s5, s5, 8
 buffer_load_dwordx4 a[220:223], v24, s[36:39], s52 offen offset:1024 sc1
 v_mfma_f32_16x16x32_bf16 v[136:139], a[12:15], a[164:167], v[136:139]
 s_add_u32 s52, s52, 2048
 s_add_u32 s91, s89, 32768
 s_add_u32 m0, s47, 0
 s_lshl_b32 s3, s44, 17
 v_add_u32 v50, 32768, v18
 v_mfma_f32_16x16x32_bf16 v[136:139], a[8:11], a[160:163], v[136:139]
 s_waitcnt lgkmcnt(4)
 s_add_u32 s88, s5, s3
 buffer_load_dwordx4 v18, s[24:27], s91 offen offset:0 sc1 lds
 v_mfma_f32_16x16x32_bf16 v[144:147], a[16:19], a[160:163], v[144:147]
 s_lshl_b32 s3, s53, 1
 ds_read_b128 a[48:51], v18 offset:43008
 ds_read_b128 a[52:55], v18 offset:47104
 v_add_u32 v51, 40960, v18
 v_mfma_f32_16x16x32_bf16 v[144:147], a[20:23], a[164:167], v[144:147]
 s_lshr_b32 s5, s55, 1
 buffer_load_dwordx4 v18, s[24:27], s91 offen offset:1024 sc1 lds
 v_mfma_f32_16x16x32_bf16 v[148:151], a[20:23], a[172:175], v[148:151]
 s_add_u32 s3, s3, s5
 v_lshrrev_b32 v31, 5, v18
 v_mfma_f32_16x16x32_bf16 v[148:151], a[16:19], a[168:171], v[148:151]
 s_lshl_b32 s3, s3, 2
 buffer_load_dwordx4 v18, s[24:27], s91 offen offset:2048 sc1 lds
 v_mfma_f32_16x16x32_bf16 v[156:159], a[24:27], a[168:171], v[156:159]
 s_add_u32 s3, s3, s44
 ds_read_b128 a[56:59], v18 offset:44032
 ds_read_b128 a[60:63], v18 offset:48128
 v_lshlrev_b32 v31, 17, v31
 v_mfma_f32_16x16x32_bf16 v[156:159], a[28:31], a[172:175], v[156:159]
 s_lshl_b32 s3, s3, 14
 buffer_load_dwordx4 v18, s[24:27], s91 offen offset:3072 sc1 lds
 v_mfma_f32_16x16x32_bf16 v[152:155], a[28:31], a[164:167], v[152:155]
 s_bfe_u32 s5, s2, 0x20003
 v_lshl_add_u32 v31, v18, 4, v31
 v_mfma_f32_16x16x32_bf16 v[152:155], a[24:27], a[160:163], v[152:155]
 s_waitcnt lgkmcnt(4)
 s_lshl_b32 s5, s5, 8
 v_mfma_f32_16x16x32_bf16 v[160:163], a[32:35], a[160:163], v[160:163]
 s_add_u32 s3, s3, s5
 ds_read_b128 a[0:3], v18 offset:49152
 ds_read_b128 a[4:7], v18 offset:53248
 v_add_u32 v31, s6, v31
 v_mfma_f32_16x16x32_bf16 v[160:163], a[36:39], a[164:167], v[160:163]
 s_and_b32 s5, s55, 1
 buffer_load_dwordx4 a[224:227], v23, s[36:39], s52 offen offset:0 sc1
 v_mfma_f32_16x16x32_bf16 v[164:167], a[36:39], a[172:175], v[164:167]
 s_lshl_b32 s5, s5, 7
 v_mov_b32 v52, 256
 v_mfma_f32_16x16x32_bf16 v[164:167], a[32:35], a[168:171], v[164:167]
 s_add_u32 s58, s3, s5
 v_mfma_f32_16x16x32_bf16 v[172:175], a[40:43], a[168:171], v[172:175]
 ds_read_b128 a[8:11], v18 offset:50176
 ds_read_b128 a[12:15], v18 offset:54272
 v_add_u32 v61, 4096, v18
 v_mfma_f32_16x16x32_bf16 v[172:175], a[44:47], a[172:175], v[172:175]
 buffer_load_dwordx4 a[228:231], v23, s[36:39], s52 offen offset:1024 sc1
 v_mfma_f32_16x16x32_bf16 v[168:171], a[44:47], a[164:167], v[168:171]
 v_bfe_u32 v60, v18, 4, 4
 v_mfma_f32_16x16x32_bf16 v[168:171], a[40:43], a[160:163], v[168:171]
 s_waitcnt lgkmcnt(4)
 v_mfma_f32_16x16x32_bf16 v[176:179], a[48:51], a[160:163], v[176:179]
 ds_read_b128 a[16:19], v18 offset:51200
 ds_read_b128 a[20:23], v18 offset:55296
 v_lshrrev_b32 v62, 8, v18
 v_mfma_f32_16x16x32_bf16 v[176:179], a[52:55], a[164:167], v[176:179]
 buffer_load_dwordx4 a[232:235], v24, s[36:39], s52 offen offset:0 sc1
 v_mfma_f32_16x16x32_bf16 v[180:183], a[52:55], a[172:175], v[180:183]
 v_lshlrev_b32 v62, 3, v62
 v_mfma_f32_16x16x32_bf16 v[180:183], a[48:51], a[168:171], v[180:183]
 v_mfma_f32_16x16x32_bf16 v[188:191], a[56:59], a[168:171], v[188:191]
 ds_read_b128 a[24:27], v18 offset:52224
 ds_read_b128 a[28:31], v18 offset:56320
 v_lshl_add_u32 v60, v60, 10, v62
 v_mfma_f32_16x16x32_bf16 v[188:191], a[60:63], a[172:175], v[188:191]
 buffer_load_dwordx4 a[236:239], v24, s[36:39], s52 offen offset:1024 sc1
 v_mfma_f32_16x16x32_bf16 v[184:187], a[60:63], a[164:167], v[184:187]
 s_add_u32 s52, s52, 2048
 v_mfma_f32_16x16x32_bf16 v[184:187], a[56:59], a[160:163], v[184:187]
 s_waitcnt lgkmcnt(4)
 v_mfma_f32_16x16x32_bf16 v[128:131], a[0:3], a[176:179], v[128:131]
 s_and_b32 s3, s44, 2
 ds_read_b128 a[32:35], v18 offset:57344
 ds_read_b128 a[36:39], v18 offset:61440
 v_mfma_f32_16x16x32_bf16 v[128:131], a[4:7], a[180:183], v[128:131]
 s_and_b32 s5, s47, 4096
 buffer_load_dwordx4 a[240:243], v23, s[36:39], s52 offen offset:0 sc1
 v_mfma_f32_16x16x32_bf16 v[132:135], a[4:7], a[188:191], v[132:135]
 s_add_u32 s5, s5, 131072
 v_mfma_f32_16x16x32_bf16 v[132:135], a[0:3], a[184:187], v[132:135]
 s_mov_b32 s6, 147456
 buffer_load_dwordx4 a[244:247], v23, s[36:39], s52 offen offset:1024 sc1
 v_mfma_f32_16x16x32_bf16 v[140:143], a[8:11], a[184:187], v[140:143]
 s_cmp_eq_u32 s3, s55
 s_cselect_b32 s60, s5, s6
 s_cselect_b32 s7, 0x40000000, 0
 ds_read_b128 a[40:43], v18 offset:58368
 ds_read_b128 a[44:47], v18 offset:62464
 v_mfma_f32_16x16x32_bf16 v[140:143], a[12:15], a[188:191], v[140:143]
 s_add_u32 s3, s3, 1
 s_cmp_eq_u32 s3, s55
 s_cselect_b32 s61, s5, s6
 s_cselect_b32 s6, 0x40000000, 0
 v_mfma_f32_16x16x32_bf16 v[136:139], a[12:15], a[180:183], v[136:139]
 s_add_u32 s56, s54, s6
 v_mfma_f32_16x16x32_bf16 v[136:139], a[8:11], a[176:179], v[136:139]
 s_waitcnt lgkmcnt(4)
 s_add_u32 s54, s54, s7
 buffer_load_dwordx4 a[248:251], v24, s[36:39], s52 offen offset:0 sc1
 v_mfma_f32_16x16x32_bf16 v[144:147], a[16:19], a[176:179], v[144:147]
 s_add_u32 s5, s48, 131072
 ds_read_b128 a[48:51], v18 offset:59392
 ds_read_b128 a[52:55], v18 offset:63488
 v_mfma_f32_16x16x32_bf16 v[144:147], a[20:23], a[180:183], v[144:147]
 v_mfma_f32_16x16x32_bf16 v[148:151], a[20:23], a[188:191], v[148:151]
 v_mfma_f32_16x16x32_bf16 v[148:151], a[16:19], a[184:187], v[148:151]
 buffer_load_dwordx4 a[252:255], v24, s[36:39], s52 offen offset:1024 sc1
 v_mfma_f32_16x16x32_bf16 v[156:159], a[24:27], a[184:187], v[156:159]
 s_add_u32 s52, s52, 2048
 ds_read_b128 a[56:59], v18 offset:60416
 ds_read_b128 a[60:63], v18 offset:64512
 v_mfma_f32_16x16x32_bf16 v[156:159], a[28:31], a[188:191], v[156:159]
 v_mfma_f32_16x16x32_bf16 v[152:155], a[28:31], a[180:183], v[152:155]
 v_mfma_f32_16x16x32_bf16 v[152:155], a[24:27], a[176:179], v[152:155]
 s_waitcnt lgkmcnt(4)
 s_barrier
 v_mfma_f32_16x16x32_bf16 v[160:163], a[32:35], a[176:179], v[160:163]
 s_add_u32 s3, s55, 1
 ds_read_b128 a[0:3], v25 offset:0
 ds_read_b128 a[4:7], v25 offset:4096
 v_mfma_f32_16x16x32_bf16 v[160:163], a[36:39], a[180:183], v[160:163]
 s_and_b32 s3, s3, 3
 buffer_load_dwordx4 a[128:131], v23, s[36:39], s52 offen offset:0 sc1
 v_mfma_f32_16x16x32_bf16 v[164:167], a[36:39], a[188:191], v[164:167]
 s_lshl_b32 s3, s3, 11
 v_add_u32 v53, s60, v18
 v_mfma_f32_16x16x32_bf16 v[164:167], a[32:35], a[184:187], v[164:167]
 s_add_u32 s90, s59, s3
 buffer_load_dwordx4 a[132:135], v23, s[36:39], s52 offen offset:1024 sc1
 v_mfma_f32_16x16x32_bf16 v[172:175], a[40:43], a[184:187], v[172:175]
 s_add_u32 s3, s55, 2
 ds_read_b128 a[8:11], v25 offset:1024
 ds_read_b128 a[12:15], v25 offset:5120
 v_add_u32 v54, s61, v18
 v_mfma_f32_16x16x32_bf16 v[172:175], a[44:47], a[188:191], v[172:175]
 s_and_b32 s3, s3, 3
 buffer_load_dwordx4 a[136:139], v24, s[36:39], s52 offen offset:0 sc1
 v_mfma_f32_16x16x32_bf16 v[168:171], a[44:47], a[180:183], v[168:171]
 s_lshl_b32 s3, s3, 11
 v_add_u32 v55, s5, v18
 v_mfma_f32_16x16x32_bf16 v[168:171], a[40:43], a[176:179], v[168:171]
 s_waitcnt lgkmcnt(4)
 s_add_u32 s49, s59, s3
 buffer_load_dwordx4 a[140:143], v24, s[36:39], s52 offen offset:1024 sc1
 v_mfma_f32_16x16x32_bf16 v[176:179], a[48:51], a[176:179], v[176:179]
 s_add_u32 s52, s52, 2048
 s_add_u32 s91, s89, 40960
 s_add_u32 m0, s47, 16384
 s_add_u32 s3, s55, 3
 ds_read_b128 a[16:19], v25 offset:2048
 ds_read_b128 a[20:23], v25 offset:6144
 v_mfma_f32_16x16x32_bf16 v[176:179], a[52:55], a[180:183], v[176:179]
 s_and_b32 s3, s3, 3
 buffer_load_dwordx4 v18, s[24:27], s91 offen offset:0 sc1 lds
 v_mfma_f32_16x16x32_bf16 v[180:183], a[52:55], a[188:191], v[180:183]
 s_lshl_b32 s3, s3, 11
 v_mfma_f32_16x16x32_bf16 v[180:183], a[48:51], a[184:187], v[180:183]
 s_add_u32 s50, s59, s3
 buffer_load_dwordx4 v18, s[24:27], s91 offen offset:1024 sc1 lds
 v_mfma_f32_16x16x32_bf16 v[188:191], a[56:59], a[184:187], v[188:191]
 ds_read_b128 a[24:27], v25 offset:3072
 ds_read_b128 a[28:31], v25 offset:7168
 v_mfma_f32_16x16x32_bf16 v[188:191], a[60:63], a[188:191], v[188:191]
 buffer_load_dwordx4 v18, s[24:27], s91 offen offset:2048 sc1 lds
 v_mfma_f32_16x16x32_bf16 v[184:187], a[60:63], a[180:183], v[184:187]
 v_mfma_f32_16x16x32_bf16 v[184:187], a[56:59], a[176:179], v[184:187]
 s_waitcnt lgkmcnt(4)
 buffer_load_dwordx4 v18, s[24:27], s91 offen offset:3072 sc1 lds
 s_waitcnt vmcnt(28)
 v_mfma_f32_16x16x32_bf16 v[192:195], a[0:3], a[192:195], 0
 ds_read_b128 a[32:35], v25 offset:8192
 ds_read_b128 a[36:39], v25 offset:12288
 v_mfma_f32_16x16x32_bf16 v[192:195], a[4:7], a[196:199], v[192:195]
 buffer_load_dwordx4 a[144:147], v23, s[36:39], s52 offen offset:0 sc1
 v_cvt_pk_bf16_f32 v128, v128, v129
 v_cvt_pk_bf16_f32 v129, v130, v131
 v_mfma_f32_16x16x32_bf16 v[196:199], a[4:7], a[204:207], 0
 buffer_load_dwordx4 a[148:151], v23, s[36:39], s52 offen offset:1024 sc1
 v_cvt_pk_bf16_f32 v130, v136, v137
 v_cvt_pk_bf16_f32 v131, v138, v139
 v_mfma_f32_16x16x32_bf16 v[196:199], a[0:3], a[200:203], v[196:199]
 buffer_load_dwordx4 a[152:155], v24, s[36:39], s52 offen offset:0 sc1
 ds_write_b128 v53, v[128:131] offset:0
 v_mfma_f32_16x16x32_bf16 v[204:207], a[8:11], a[200:203], 0
 ds_read_b128 a[40:43], v25 offset:9216
 ds_read_b128 a[44:47], v25 offset:13312
 v_mfma_f32_16x16x32_bf16 v[204:207], a[12:15], a[204:207], v[204:207]
 buffer_load_dwordx4 a[156:159], v24, s[36:39], s52 offen offset:1024 sc1
 v_cvt_pk_bf16_f32 v132, v132, v133
 v_cvt_pk_bf16_f32 v133, v134, v135
 v_mfma_f32_16x16x32_bf16 v[200:203], a[12:15], a[196:199], 0
 s_add_u32 s52, s52, 2048
 s_add_u32 s91, s89, 49152
 s_add_u32 m0, s47, 32768
 v_cvt_pk_bf16_f32 v134, v140, v141
 v_cvt_pk_bf16_f32 v135, v142, v143
 v_mfma_f32_16x16x32_bf16 v[200:203], a[8:11], a[192:195], v[200:203]
 s_waitcnt lgkmcnt(5)
 buffer_load_dwordx4 v18, s[24:27], s91 offen offset:0 sc1 lds
 ds_write_b128 v53, v[132:135] offset:2048
 v_mfma_f32_16x16x32_bf16 v[208:211], a[16:19], a[192:195], 0
 ds_read_b128 a[48:51], v25 offset:10240
 ds_read_b128 a[52:55], v25 offset:14336
 v_mfma_f32_16x16x32_bf16 v[208:211], a[20:23], a[196:199], v[208:211]
 buffer_load_dwordx4 v18, s[24:27], s91 offen offset:1024 sc1 lds
 v_cvt_pk_bf16_f32 v144, v144, v145
 v_cvt_pk_bf16_f32 v145, v146, v147
 v_mfma_f32_16x16x32_bf16 v[212:215], a[20:23], a[204:207], 0
 v_cvt_pk_bf16_f32 v146, v152, v153
 v_cvt_pk_bf16_f32 v147, v154, v155
 v_mfma_f32_16x16x32_bf16 v[212:215], a[16:19], a[200:203], v[212:215]
 buffer_load_dwordx4 v18, s[24:27], s91 offen offset:2048 sc1 lds
 ds_write_b128 v53, v[144:147] offset:1024
 v_mfma_f32_16x16x32_bf16 v[220:223], a[24:27], a[200:203], 0
 ds_read_b128 a[56:59], v25 offset:11264
 ds_read_b128 a[60:63], v25 offset:15360
 v_mfma_f32_16x16x32_bf16 v[220:223], a[28:31], a[204:207], v[220:223]
 buffer_load_dwordx4 v18, s[24:27], s91 offen offset:3072 sc1 lds
 v_cvt_pk_bf16_f32 v148, v148, v149
 v_cvt_pk_bf16_f32 v149, v150, v151
 v_mfma_f32_16x16x32_bf16 v[216:219], a[28:31], a[196:199], 0
 v_cvt_pk_bf16_f32 v150, v156, v157
 v_cvt_pk_bf16_f32 v151, v158, v159
 v_mfma_f32_16x16x32_bf16 v[216:219], a[24:27], a[192:195], v[216:219]
 s_waitcnt lgkmcnt(6)
 ds_write_b128 v53, v[148:151] offset:3072
 v_mfma_f32_16x16x32_bf16 v[224:227], a[32:35], a[192:195], 0
 ds_read_b128 a[0:3], v25 offset:16384
 ds_read_b128 a[4:7], v25 offset:20480
 v_mfma_f32_16x16x32_bf16 v[224:227], a[36:39], a[196:199], v[224:227]
 v_cvt_pk_bf16_f32 v160, v160, v161
 v_cvt_pk_bf16_f32 v161, v162, v163
 v_mfma_f32_16x16x32_bf16 v[228:231], a[36:39], a[204:207], 0
 v_cvt_pk_bf16_f32 v162, v168, v169
 v_cvt_pk_bf16_f32 v163, v170, v171
 v_mfma_f32_16x16x32_bf16 v[228:231], a[32:35], a[200:203], v[228:231]
 ds_write_b128 v54, v[160:163] offset:0
 v_mfma_f32_16x16x32_bf16 v[236:239], a[40:43], a[200:203], 0
 ds_read_b128 a[8:11], v25 offset:17408
 ds_read_b128 a[12:15], v25 offset:21504
 v_mfma_f32_16x16x32_bf16 v[236:239], a[44:47], a[204:207], v[236:239]
 v_cvt_pk_bf16_f32 v164, v164, v165
 v_cvt_pk_bf16_f32 v165, v166, v167
 v_mfma_f32_16x16x32_bf16 v[232:235], a[44:47], a[196:199], 0
 v_cvt_pk_bf16_f32 v166, v172, v173
 v_cvt_pk_bf16_f32 v167, v174, v175
 v_mfma_f32_16x16x32_bf16 v[232:235], a[40:43], a[192:195], v[232:235]
 s_waitcnt lgkmcnt(6)
 ds_write_b128 v54, v[164:167] offset:2048
 v_mfma_f32_16x16x32_bf16 v[240:243], a[48:51], a[192:195], 0
 ds_read_b128 a[16:19], v25 offset:18432
 ds_read_b128 a[20:23], v25 offset:22528
 v_mfma_f32_16x16x32_bf16 v[240:243], a[52:55], a[196:199], v[240:243]
 v_cvt_pk_bf16_f32 v176, v176, v177
 v_cvt_pk_bf16_f32 v177, v178, v179
 v_mfma_f32_16x16x32_bf16 v[244:247], a[52:55], a[204:207], 0
 v_cvt_pk_bf16_f32 v178, v184, v185
 v_cvt_pk_bf16_f32 v179, v186, v187
 v_mfma_f32_16x16x32_bf16 v[244:247], a[48:51], a[200:203], v[244:247]
 ds_write_b128 v54, v[176:179] offset:1024
 v_mfma_f32_16x16x32_bf16 v[252:255], a[56:59], a[200:203], 0
 ds_read_b128 a[24:27], v25 offset:19456
 ds_read_b128 a[28:31], v25 offset:23552
 v_mfma_f32_16x16x32_bf16 v[252:255], a[60:63], a[204:207], v[252:255]
 v_cvt_pk_bf16_f32 v180, v180, v181
 v_cvt_pk_bf16_f32 v181, v182, v183
 v_mfma_f32_16x16x32_bf16 v[248:251], a[60:63], a[196:199], 0
 v_cvt_pk_bf16_f32 v182, v188, v189
 v_cvt_pk_bf16_f32 v183, v190, v191
 v_mfma_f32_16x16x32_bf16 v[248:251], a[56:59], a[192:195], v[248:251]
 s_waitcnt lgkmcnt(6)
 ds_write_b128 v54, v[180:183] offset:3072
 s_waitcnt vmcnt(28)
 v_mfma_f32_16x16x32_bf16 v[192:195], a[0:3], a[208:211], v[192:195]
 ds_read_b128 a[32:35], v25 offset:24576
 ds_read_b128 a[36:39], v25 offset:28672
 v_mfma_f32_16x16x32_bf16 v[192:195], a[4:7], a[212:215], v[192:195]
 buffer_load_dwordx4 a[160:163], v23, s[36:39], s52 offen offset:0 sc1
 v_mfma_f32_16x16x32_bf16 v[196:199], a[4:7], a[220:223], v[196:199]
 v_mfma_f32_16x16x32_bf16 v[196:199], a[0:3], a[216:219], v[196:199]
 buffer_load_dwordx4 a[164:167], v23, s[36:39], s52 offen offset:1024 sc1
 v_mfma_f32_16x16x32_bf16 v[204:207], a[8:11], a[216:219], v[204:207]
 ds_read_b128 a[40:43], v25 offset:25600
 ds_read_b128 a[44:47], v25 offset:29696
 v_mfma_f32_16x16x32_bf16 v[204:207], a[12:15], a[220:223], v[204:207]
 buffer_load_dwordx4 a[168:171], v24, s[36:39], s52 offen offset:0 sc1
 v_mfma_f32_16x16x32_bf16 v[200:203], a[12:15], a[212:215], v[200:203]
 v_mfma_f32_16x16x32_bf16 v[200:203], a[8:11], a[208:211], v[200:203]
 s_waitcnt lgkmcnt(5)
 v_mfma_f32_16x16x32_bf16 v[208:211], a[16:19], a[208:211], v[208:211]
 ds_read_b128 a[48:51], v25 offset:26624
 ds_read_b128 a[52:55], v25 offset:30720
 v_mfma_f32_16x16x32_bf16 v[208:211], a[20:23], a[212:215], v[208:211]
 buffer_load_dwordx4 a[172:175], v24, s[36:39], s52 offen offset:1024 sc1
 v_mfma_f32_16x16x32_bf16 v[212:215], a[20:23], a[220:223], v[212:215]
 s_add_u32 s52, s52, 2048
 v_mfma_f32_16x16x32_bf16 v[212:215], a[16:19], a[216:219], v[212:215]
 buffer_store_dwordx4 v[128:131], v48, s[20:23], s54 offen offset:0 sc1
 v_mfma_f32_16x16x32_bf16 v[220:223], a[24:27], a[216:219], v[220:223]
 ds_read_b128 a[56:59], v25 offset:27648
 ds_read_b128 a[60:63], v25 offset:31744
 v_mfma_f32_16x16x32_bf16 v[220:223], a[28:31], a[220:223], v[220:223]
 v_mfma_f32_16x16x32_bf16 v[216:219], a[28:31], a[212:215], v[216:219]
 v_mfma_f32_16x16x32_bf16 v[216:219], a[24:27], a[208:211], v[216:219]
 s_waitcnt lgkmcnt(4)
 s_barrier
 v_mfma_f32_16x16x32_bf16 v[224:227], a[32:35], a[208:211], v[224:227]
 s_add_u32 s91, s89, 57344
 s_add_u32 m0, s47, 49152
 ds_read_b128 a[0:3], v25 offset:32768
 ds_read_b128 a[4:7], v25 offset:36864
 v_mfma_f32_16x16x32_bf16 v[224:227], a[36:39], a[212:215], v[224:227]
 buffer_load_dwordx4 v18, s[24:27], s91 offen offset:0 sc1 lds
 v_mfma_f32_16x16x32_bf16 v[228:231], a[36:39], a[220:223], v[228:231]
 v_mfma_f32_16x16x32_bf16 v[228:231], a[32:35], a[216:219], v[228:231]
 buffer_load_dwordx4 v18, s[24:27], s91 offen offset:1024 sc1 lds
 v_mfma_f32_16x16x32_bf16 v[236:239], a[40:43], a[216:219], v[236:239]
 ds_read_b128 a[8:11], v25 offset:33792
 ds_read_b128 a[12:15], v25 offset:37888
 v_mfma_f32_16x16x32_bf16 v[236:239], a[44:47], a[220:223], v[236:239]
 v_mfma_f32_16x16x32_bf16 v[232:235], a[44:47], a[212:215], v[232:235]
 v_mfma_f32_16x16x32_bf16 v[232:235], a[40:43], a[208:211], v[232:235]
 s_waitcnt lgkmcnt(4)
 buffer_load_dwordx4 v18, s[24:27], s91 offen offset:2048 sc1 lds
 v_mfma_f32_16x16x32_bf16 v[240:243], a[48:51], a[208:211], v[240:243]
 ds_read_b128 a[16:19], v25 offset:34816
 ds_read_b128 a[20:23], v25 offset:38912
 v_mfma_f32_16x16x32_bf16 v[240:243], a[52:55], a[212:215], v[240:243]
 buffer_load_dwordx4 v18, s[24:27], s91 offen offset:3072 sc1 lds
 v_mfma_f32_16x16x32_bf16 v[244:247], a[52:55], a[220:223], v[244:247]
 v_mfma_f32_16x16x32_bf16 v[244:247], a[48:51], a[216:219], v[244:247]
 v_mfma_f32_16x16x32_bf16 v[252:255], a[56:59], a[216:219], v[252:255]
 ds_read_b128 a[24:27], v25 offset:35840
 ds_read_b128 a[28:31], v25 offset:39936
 v_mfma_f32_16x16x32_bf16 v[252:255], a[60:63], a[220:223], v[252:255]
 buffer_store_dwordx4 v[160:163], v50, s[20:23], s56 offen offset:0 sc1
 v_mfma_f32_16x16x32_bf16 v[248:251], a[60:63], a[212:215], v[248:251]
 v_mfma_f32_16x16x32_bf16 v[248:251], a[56:59], a[208:211], v[248:251]
 s_waitcnt lgkmcnt(4)
 s_waitcnt vmcnt(30)
 v_mfma_f32_16x16x32_bf16 v[192:195], a[0:3], a[224:227], v[192:195]
 ds_read_b128 a[32:35], v25 offset:40960
 ds_read_b128 a[36:39], v25 offset:45056
 v_mfma_f32_16x16x32_bf16 v[192:195], a[4:7], a[228:231], v[192:195]
 buffer_load_dwordx4 a[176:179], v23, s[36:39], s52 offen offset:0 sc1
 v_mfma_f32_16x16x32_bf16 v[196:199], a[4:7], a[236:239], v[196:199]
 buffer_load_dwordx4 a[180:183], v23, s[36:39], s52 offen offset:1024 sc1
 v_mfma_f32_16x16x32_bf16 v[196:199], a[0:3], a[232:235], v[196:199]
 buffer_load_dwordx4 a[184:187], v24, s[36:39], s52 offen offset:0 sc1
 v_mfma_f32_16x16x32_bf16 v[204:207], a[8:11], a[232:235], v[204:207]
 ds_read_b128 a[40:43], v25 offset:41984
 ds_read_b128 a[44:47], v25 offset:46080
 v_mfma_f32_16x16x32_bf16 v[204:207], a[12:15], a[236:239], v[204:207]
 buffer_load_dwordx4 a[188:191], v24, s[36:39], s52 offen offset:1024 sc1
 v_mfma_f32_16x16x32_bf16 v[200:203], a[12:15], a[228:231], v[200:203]
 s_add_u32 s52, s52, 2048
 s_add_u32 s91, s89, 65536
 s_add_u32 m0, s47, 65536
 s_nop 0
 buffer_load_dwordx4 v18, s[24:27], s91 offen offset:0 sc1 lds
 v_mfma_f32_16x16x32_bf16 v[200:203], a[8:11], a[224:227], v[200:203]
 s_waitcnt lgkmcnt(4)
 buffer_load_dwordx4 v18, s[24:27], s91 offen offset:1024 sc1 lds
 v_mfma_f32_16x16x32_bf16 v[208:211], a[16:19], a[224:227], v[208:211]
 ds_read_b128 a[48:51], v25 offset:43008
 ds_read_b128 a[52:55], v25 offset:47104
 v_mfma_f32_16x16x32_bf16 v[208:211], a[20:23], a[228:231], v[208:211]
 buffer_load_dwordx4 v18, s[24:27], s91 offen offset:2048 sc1 lds
 v_mfma_f32_16x16x32_bf16 v[212:215], a[20:23], a[236:239], v[212:215]
 v_mfma_f32_16x16x32_bf16 v[212:215], a[16:19], a[232:235], v[212:215]
 buffer_load_dwordx4 v18, s[24:27], s91 offen offset:3072 sc1 lds
 v_mfma_f32_16x16x32_bf16 v[220:223], a[24:27], a[232:235], v[220:223]
 ds_read_b128 a[56:59], v25 offset:44032
 ds_read_b128 a[60:63], v25 offset:48128
 v_mfma_f32_16x16x32_bf16 v[220:223], a[28:31], a[236:239], v[220:223]
 buffer_store_dwordx4 v[132:135], v49, s[20:23], s54 offen offset:0 sc1
 v_mfma_f32_16x16x32_bf16 v[216:219], a[28:31], a[228:231], v[216:219]
 v_mfma_f32_16x16x32_bf16 v[216:219], a[24:27], a[224:227], v[216:219]
 s_waitcnt lgkmcnt(4)
 v_mfma_f32_16x16x32_bf16 v[224:227], a[32:35], a[224:227], v[224:227]
 ds_read_b128 a[0:3], v25 offset:49152
 ds_read_b128 a[4:7], v25 offset:53248
 v_mfma_f32_16x16x32_bf16 v[224:227], a[36:39], a[228:231], v[224:227]
 buffer_store_dwordx4 v[164:167], v51, s[20:23], s56 offen offset:0 sc1
 v_mfma_f32_16x16x32_bf16 v[228:231], a[36:39], a[236:239], v[228:231]
 v_mfma_f32_16x16x32_bf16 v[228:231], a[32:35], a[232:235], v[228:231]
 v_mfma_f32_16x16x32_bf16 v[236:239], a[40:43], a[232:235], v[236:239]
 ds_read_b128 a[8:11], v25 offset:50176
 ds_read_b128 a[12:15], v25 offset:54272
 v_mfma_f32_16x16x32_bf16 v[236:239], a[44:47], a[236:239], v[236:239]
 v_mfma_f32_16x16x32_bf16 v[232:235], a[44:47], a[228:231], v[232:235]
 v_mfma_f32_16x16x32_bf16 v[232:235], a[40:43], a[224:227], v[232:235]
 s_waitcnt lgkmcnt(4)
 v_mfma_f32_16x16x32_bf16 v[240:243], a[48:51], a[224:227], v[240:243]
 ds_read_b128 a[16:19], v25 offset:51200
 ds_read_b128 a[20:23], v25 offset:55296
 v_mfma_f32_16x16x32_bf16 v[240:243], a[52:55], a[228:231], v[240:243]
 v_mfma_f32_16x16x32_bf16 v[244:247], a[52:55], a[236:239], v[244:247]
 v_mfma_f32_16x16x32_bf16 v[244:247], a[48:51], a[232:235], v[244:247]
 v_mfma_f32_16x16x32_bf16 v[252:255], a[56:59], a[232:235], v[252:255]
 ds_read_b128 a[24:27], v25 offset:52224
 ds_read_b128 a[28:31], v25 offset:56320
 v_mfma_f32_16x16x32_bf16 v[252:255], a[60:63], a[236:239], v[252:255]
 v_mfma_f32_16x16x32_bf16 v[248:251], a[60:63], a[228:231], v[248:251]
 v_mfma_f32_16x16x32_bf16 v[248:251], a[56:59], a[224:227], v[248:251]
 s_waitcnt lgkmcnt(4)
 s_waitcnt vmcnt(36)
 v_mfma_f32_16x16x32_bf16 v[192:195], a[0:3], a[240:243], v[192:195]
 ds_read_b128 a[32:35], v25 offset:57344
 ds_read_b128 a[36:39], v25 offset:61440
 v_mfma_f32_16x16x32_bf16 v[192:195], a[4:7], a[244:247], v[192:195]
 buffer_store_dwordx4 v[144:147], v48, s[20:23], s54 offen offset:1024 sc1
 v_mfma_f32_16x16x32_bf16 v[196:199], a[4:7], a[252:255], v[196:199]
 v_mfma_f32_16x16x32_bf16 v[196:199], a[0:3], a[248:251], v[196:199]
 v_mfma_f32_16x16x32_bf16 v[204:207], a[8:11], a[248:251], v[204:207]
 ds_read_b128 a[40:43], v25 offset:58368
 ds_read_b128 a[44:47], v25 offset:62464
 v_mfma_f32_16x16x32_bf16 v[204:207], a[12:15], a[252:255], v[204:207]
 v_mfma_f32_16x16x32_bf16 v[200:203], a[12:15], a[244:247], v[200:203]
 v_mfma_f32_16x16x32_bf16 v[200:203], a[8:11], a[240:243], v[200:203]
 s_waitcnt lgkmcnt(4)
 v_mfma_f32_16x16x32_bf16 v[208:211], a[16:19], a[240:243], v[208:211]
 ds_read_b128 a[48:51], v25 offset:59392
 ds_read_b128 a[52:55], v25 offset:63488
 v_mfma_f32_16x16x32_bf16 v[208:211], a[20:23], a[244:247], v[208:211]
 v_mfma_f32_16x16x32_bf16 v[212:215], a[20:23], a[252:255], v[212:215]
 v_mfma_f32_16x16x32_bf16 v[212:215], a[16:19], a[248:251], v[212:215]
 v_mfma_f32_16x16x32_bf16 v[220:223], a[24:27], a[248:251], v[220:223]
 ds_read_b128 a[56:59], v25 offset:60416
 ds_read_b128 a[60:63], v25 offset:64512
 v_mfma_f32_16x16x32_bf16 v[220:223], a[28:31], a[252:255], v[220:223]
 v_mfma_f32_16x16x32_bf16 v[216:219], a[28:31], a[244:247], v[216:219]
 s_waitcnt vmcnt(29)
 v_mfma_f32_16x16x32_bf16 v[216:219], a[24:27], a[240:243], v[216:219]
 s_waitcnt lgkmcnt(4)
 s_barrier
 v_mfma_f32_16x16x32_bf16 v[224:227], a[32:35], a[240:243], v[224:227]
 s_add_u32 s91, s89, 73728
 s_add_u32 m0, s47, 81920
 ds_read_b128 a[0:3], v18 offset:0
 ds_read_b128 a[4:7], v18 offset:4096
 v_mfma_f32_16x16x32_bf16 v[224:227], a[36:39], a[244:247], v[224:227]
 buffer_load_dwordx4 v18, s[24:27], s91 offen offset:0 sc1 lds
 v_mfma_f32_16x16x32_bf16 v[228:231], a[36:39], a[252:255], v[228:231]
 v_mfma_f32_16x16x32_bf16 v[228:231], a[32:35], a[248:251], v[228:231]
 buffer_load_dwordx4 v18, s[24:27], s91 offen offset:1024 sc1 lds
 v_mfma_f32_16x16x32_bf16 v[236:239], a[40:43], a[248:251], v[236:239]
 ds_read_b128 a[8:11], v18 offset:1024
 ds_read_b128 a[12:15], v18 offset:5120
 v_mfma_f32_16x16x32_bf16 v[236:239], a[44:47], a[252:255], v[236:239]
 v_mfma_f32_16x16x32_bf16 v[232:235], a[44:47], a[244:247], v[232:235]
 v_mfma_f32_16x16x32_bf16 v[232:235], a[40:43], a[240:243], v[232:235]
 s_waitcnt lgkmcnt(4)
 buffer_load_dwordx4 v18, s[24:27], s91 offen offset:2048 sc1 lds
 v_mfma_f32_16x16x32_bf16 v[240:243], a[48:51], a[240:243], v[240:243]
 ds_read_b128 a[16:19], v18 offset:2048
 ds_read_b128 a[20:23], v18 offset:6144
 v_mfma_f32_16x16x32_bf16 v[240:243], a[52:55], a[244:247], v[240:243]
 buffer_load_dwordx4 v18, s[24:27], s91 offen offset:3072 sc1 lds
 v_mfma_f32_16x16x32_bf16 v[244:247], a[52:55], a[252:255], v[244:247]
 v_mfma_f32_16x16x32_bf16 v[244:247], a[48:51], a[248:251], v[244:247]
 v_mfma_f32_16x16x32_bf16 v[252:255], a[56:59], a[248:251], v[252:255]
 ds_read_b128 a[24:27], v18 offset:3072
 ds_read_b128 a[28:31], v18 offset:7168
 v_mfma_f32_16x16x32_bf16 v[252:255], a[60:63], a[252:255], v[252:255]
 buffer_store_dwordx4 v[176:179], v50, s[20:23], s56 offen offset:1024 sc1
 v_mfma_f32_16x16x32_bf16 v[248:251], a[60:63], a[244:247], v[248:251]
 v_mfma_f32_16x16x32_bf16 v[248:251], a[56:59], a[240:243], v[248:251]
 s_waitcnt lgkmcnt(4)
 v_mfma_f32_16x16x32_bf16 v[192:195], a[0:3], a[128:131], v[192:195]
 ds_read_b128 a[32:35], v18 offset:8192
 ds_read_b128 a[36:39], v18 offset:12288
 v_mfma_f32_16x16x32_bf16 v[192:195], a[4:7], a[132:135], v[192:195]
 buffer_load_dword v19, v20, s[40:43], 0 offen sc1
 v_mfma_f32_16x16x32_bf16 v[196:199], a[4:7], a[140:143], v[196:199]
 s_add_u32 s91, s89, 81920
 s_add_u32 m0, s47, 98304
 v_mfma_f32_16x16x32_bf16 v[196:199], a[0:3], a[136:139], v[196:199]
 buffer_load_dwordx4 v18, s[24:27], s91 offen offset:0 sc1 lds
 v_mfma_f32_16x16x32_bf16 v[204:207], a[8:11], a[136:139], v[204:207]
 ds_read_b128 a[40:43], v18 offset:9216
 ds_read_b128 a[44:47], v18 offset:13312
 v_mfma_f32_16x16x32_bf16 v[204:207], a[12:15], a[140:143], v[204:207]
 buffer_load_dwordx4 v18, s[24:27], s91 offen offset:1024 sc1 lds
 v_mfma_f32_16x16x32_bf16 v[200:203], a[12:15], a[132:135], v[200:203]
 v_mfma_f32_16x16x32_bf16 v[200:203], a[8:11], a[128:131], v[200:203]
 s_waitcnt lgkmcnt(4)
 buffer_load_dwordx4 v18, s[24:27], s91 offen offset:2048 sc1 lds
 v_mfma_f32_16x16x32_bf16 v[208:211], a[16:19], a[128:131], v[208:211]
 ds_read_b128 a[48:51], v18 offset:10240
 ds_read_b128 a[52:55], v18 offset:14336
 v_mfma_f32_16x16x32_bf16 v[208:211], a[20:23], a[132:135], v[208:211]
 buffer_load_dwordx4 v18, s[24:27], s91 offen offset:3072 sc1 lds
 v_mfma_f32_16x16x32_bf16 v[212:215], a[20:23], a[140:143], v[212:215]
 v_mfma_f32_16x16x32_bf16 v[212:215], a[16:19], a[136:139], v[212:215]
 buffer_store_dwordx4 v[148:151], v49, s[20:23], s54 offen offset:1024 sc1
 v_mfma_f32_16x16x32_bf16 v[220:223], a[24:27], a[136:139], v[220:223]
 ds_read_b128 a[56:59], v18 offset:11264
 ds_read_b128 a[60:63], v18 offset:15360
 v_mfma_f32_16x16x32_bf16 v[220:223], a[28:31], a[140:143], v[220:223]
 v_mfma_f32_16x16x32_bf16 v[216:219], a[28:31], a[132:135], v[216:219]
 v_mfma_f32_16x16x32_bf16 v[216:219], a[24:27], a[128:131], v[216:219]
 s_waitcnt lgkmcnt(4)
 v_mfma_f32_16x16x32_bf16 v[224:227], a[32:35], a[128:131], v[224:227]
 ds_read_b128 a[0:3], v18 offset:16384
 ds_read_b128 a[4:7], v18 offset:20480
 v_mfma_f32_16x16x32_bf16 v[224:227], a[36:39], a[132:135], v[224:227]
 buffer_store_dwordx4 v[180:183], v51, s[20:23], s56 offen offset:1024 sc1
 v_mfma_f32_16x16x32_bf16 v[228:231], a[36:39], a[140:143], v[228:231]
 v_mfma_f32_16x16x32_bf16 v[228:231], a[32:35], a[136:139], v[228:231]
 v_mfma_f32_16x16x32_bf16 v[236:239], a[40:43], a[136:139], v[236:239]
 ds_read_b128 a[8:11], v18 offset:17408
 ds_read_b128 a[12:15], v18 offset:21504
 v_mfma_f32_16x16x32_bf16 v[236:239], a[44:47], a[140:143], v[236:239]
 v_mfma_f32_16x16x32_bf16 v[232:235], a[44:47], a[132:135], v[232:235]
 v_mfma_f32_16x16x32_bf16 v[232:235], a[40:43], a[128:131], v[232:235]
 s_waitcnt lgkmcnt(4)
 v_mfma_f32_16x16x32_bf16 v[240:243], a[48:51], a[128:131], v[240:243]
 ds_read_b128 a[16:19], v18 offset:18432
 ds_read_b128 a[20:23], v18 offset:22528
 v_mfma_f32_16x16x32_bf16 v[240:243], a[52:55], a[132:135], v[240:243]
 v_mfma_f32_16x16x32_bf16 v[244:247], a[52:55], a[140:143], v[244:247]
 v_mfma_f32_16x16x32_bf16 v[244:247], a[48:51], a[136:139], v[244:247]
 v_mfma_f32_16x16x32_bf16 v[252:255], a[56:59], a[136:139], v[252:255]
 ds_read_b128 a[24:27], v18 offset:19456
 ds_read_b128 a[28:31], v18 offset:23552
 v_mfma_f32_16x16x32_bf16 v[252:255], a[60:63], a[140:143], v[252:255]
 v_mfma_f32_16x16x32_bf16 v[248:251], a[60:63], a[132:135], v[248:251]
 v_mfma_f32_16x16x32_bf16 v[248:251], a[56:59], a[128:131], v[248:251]
 s_waitcnt lgkmcnt(4)
 s_waitcnt vmcnt(37)
 v_mfma_f32_16x16x32_bf16 v[192:195], a[0:3], a[144:147], v[192:195]
 ds_read_b128 a[32:35], v18 offset:24576
 ds_read_b128 a[36:39], v18 offset:28672
 v_mfma_f32_16x16x32_bf16 v[192:195], a[4:7], a[148:151], v[192:195]
 v_mfma_f32_16x16x32_bf16 v[196:199], a[4:7], a[156:159], v[196:199]
 v_mfma_f32_16x16x32_bf16 v[196:199], a[0:3], a[152:155], v[196:199]
 v_mfma_f32_16x16x32_bf16 v[204:207], a[8:11], a[152:155], v[204:207]
 ds_read_b128 a[40:43], v18 offset:25600
 ds_read_b128 a[44:47], v18 offset:29696
 v_mfma_f32_16x16x32_bf16 v[204:207], a[12:15], a[156:159], v[204:207]
 v_mfma_f32_16x16x32_bf16 v[200:203], a[12:15], a[148:151], v[200:203]
 v_mfma_f32_16x16x32_bf16 v[200:203], a[8:11], a[144:147], v[200:203]
 s_waitcnt lgkmcnt(4)
 v_mfma_f32_16x16x32_bf16 v[208:211], a[16:19], a[144:147], v[208:211]
 ds_read_b128 a[48:51], v18 offset:26624
 ds_read_b128 a[52:55], v18 offset:30720
 v_mfma_f32_16x16x32_bf16 v[208:211], a[20:23], a[148:151], v[208:211]
 v_mfma_f32_16x16x32_bf16 v[212:215], a[20:23], a[156:159], v[212:215]
 v_mfma_f32_16x16x32_bf16 v[212:215], a[16:19], a[152:155], v[212:215]
 v_mfma_f32_16x16x32_bf16 v[220:223], a[24:27], a[152:155], v[220:223]
 ds_read_b128 a[56:59], v18 offset:27648
 ds_read_b128 a[60:63], v18 offset:31744
 v_mfma_f32_16x16x32_bf16 v[220:223], a[28:31], a[156:159], v[220:223]
 v_mfma_f32_16x16x32_bf16 v[216:219], a[28:31], a[148:151], v[216:219]
 s_waitcnt vmcnt(6)
 v_cmp_gt_u32 vcc, s62, v19
 v_mfma_f32_16x16x32_bf16 v[216:219], a[24:27], a[144:147], v[216:219]
 s_waitcnt lgkmcnt(4)
 s_cbranch_vccnz bo_spin
bo_ok:
 s_barrier
 v_mfma_f32_16x16x32_bf16 v[224:227], a[32:35], a[144:147], v[224:227]
 ds_read_b128 a[0:3], v18 offset:32768
 ds_read_b128 a[4:7], v18 offset:36864
 v_mfma_f32_16x16x32_bf16 v[224:227], a[36:39], a[148:151], v[224:227]
 buffer_load_dwordx4 a[192:195], v23, s[36:39], s52 offen offset:0 sc1
 v_mfma_f32_16x16x32_bf16 v[228:231], a[36:39], a[156:159], v[228:231]
 s_lshl_b32 s62, s62, 1
 v_mov_b32 v20, s88
 v_mfma_f32_16x16x32_bf16 v[228:231], a[32:35], a[152:155], v[228:231]
 buffer_load_dwordx4 a[196:199], v23, s[36:39], s52 offen offset:1024 sc1
 v_mfma_f32_16x16x32_bf16 v[236:239], a[40:43], a[152:155], v[236:239]
 ds_read_b128 a[8:11], v18 offset:33792
 ds_read_b128 a[12:15], v18 offset:37888
 v_mfma_f32_16x16x32_bf16 v[236:239], a[44:47], a[156:159], v[236:239]
 buffer_load_dwordx4 a[200:203], v24, s[36:39], s52 offen offset:0 sc1
 v_mfma_f32_16x16x32_bf16 v[232:235], a[44:47], a[148:151], v[232:235]
 v_mfma_f32_16x16x32_bf16 v[232:235], a[40:43], a[144:147], v[232:235]
 s_waitcnt lgkmcnt(4)
 buffer_load_dwordx4 a[204:207], v24, s[36:39], s52 offen offset:1024 sc1
 v_mfma_f32_16x16x32_bf16 v[240:243], a[48:51], a[144:147], v[240:243]
 s_add_u32 s52, s52, 2048
 s_add_u32 s91, s89, 90112
 s_add_u32 m0, s47, 114688
 ds_read_b128 a[16:19], v18 offset:34816
 ds_read_b128 a[20:23], v18 offset:38912
 v_mfma_f32_16x16x32_bf16 v[240:243], a[52:55], a[148:151], v[240:243]
 buffer_load_dwordx4 v18, s[24:27], s91 offen offset:0 sc1 lds
 v_mfma_f32_16x16x32_bf16 v[244:247], a[52:55], a[156:159], v[244:247]
 v_mfma_f32_16x16x32_bf16 v[244:247], a[48:51], a[152:155], v[244:247]
 buffer_load_dwordx4 v18, s[24:27], s91 offen offset:1024 sc1 lds
 v_mfma_f32_16x16x32_bf16 v[252:255], a[56:59], a[152:155], v[252:255]
 ds_read_b128 a[24:27], v18 offset:35840
 ds_read_b128 a[28:31], v18 offset:39936
 v_mfma_f32_16x16x32_bf16 v[252:255], a[60:63], a[156:159], v[252:255]
 buffer_load_dwordx4 v18, s[24:27], s91 offen offset:2048 sc1 lds
 v_mfma_f32_16x16x32_bf16 v[248:251], a[60:63], a[148:151], v[248:251]
 v_mfma_f32_16x16x32_bf16 v[248:251], a[56:59], a[144:147], v[248:251]
 s_waitcnt lgkmcnt(4)
 buffer_load_dwordx4 v18, s[24:27], s91 offen offset:3072 sc1 lds
 v_mfma_f32_16x16x32_bf16 v[192:195], a[0:3], a[160:163], v[192:195]
 ds_read_b128 a[32:35], v18 offset:40960
 ds_read_b128 a[36:39], v18 offset:45056
 v_mfma_f32_16x16x32_bf16 v[192:195], a[4:7], a[164:167], v[192:195]
 buffer_load_dwordx4 a[208:211], v23, s[36:39], s52 offen offset:0 sc1
 v_mfma_f32_16x16x32_bf16 v[196:199], a[4:7], a[172:175], v[196:199]
 buffer_load_dwordx4 a[212:215], v23, s[36:39], s52 offen offset:1024 sc1
 v_mfma_f32_16x16x32_bf16 v[196:199], a[0:3], a[168:171], v[196:199]
 buffer_load_dwordx4 a[216:219], v24, s[36:39], s52 offen offset:0 sc1
 v_mfma_f32_16x16x32_bf16 v[204:207], a[8:11], a[168:171], v[204:207]
 ds_read_b128 a[40:43], v18 offset:41984
 ds_read_b128 a[44:47], v18 offset:46080
 v_mfma_f32_16x16x32_bf16 v[204:207], a[12:15], a[172:175], v[204:207]
 buffer_load_dwordx4 a[220:223], v24, s[36:39], s52 offen offset:1024 sc1
 v_mfma_f32_16x16x32_bf16 v[200:203], a[12:15], a[164:167], v[200:203]
 s_add_u32 s52, s52, 2048
 s_add_u32 s91, s89, 98304
 s_add_u32 m0, s47, 0
 v_mfma_f32_16x16x32_bf16 v[200:203], a[8:11], a[160:163], v[200:203]
 s_waitcnt lgkmcnt(4)
 buffer_load_dwordx4 v18, s[24:27], s91 offen offset:0 sc1 lds
 v_mfma_f32_16x16x32_bf16 v[208:211], a[16:19], a[160:163], v[208:211]
 ds_read_b128 a[48:51], v18 offset:43008
 ds_read_b128 a[52:55], v18 offset:47104
 v_mfma_f32_16x16x32_bf16 v[208:211], a[20:23], a[164:167], v[208:211]
 buffer_load_dwordx4 v18, s[24:27], s91 offen offset:1024 sc1 lds
 v_mfma_f32_16x16x32_bf16 v[212:215], a[20:23], a[172:175], v[212:215]
 v_mfma_f32_16x16x32_bf16 v[212:215], a[16:19], a[168:171], v[212:215]
 buffer_load_dwordx4 v18, s[24:27], s91 offen offset:2048 sc1 lds
 v_mfma_f32_16x16x32_bf16 v[220:223], a[24:27], a[168:171], v[220:223]
 ds_read_b128 a[56:59], v18 offset:44032
 ds_read_b128 a[60:63], v18 offset:48128
 v_mfma_f32_16x16x32_bf16 v[220:223], a[28:31], a[172:175], v[220:223]
 buffer_load_dwordx4 v18, s[24:27], s91 offen offset:3072 sc1 lds
 v_mfma_f32_16x16x32_bf16 v[216:219], a[28:31], a[164:167], v[216:219]
 v_mfma_f32_16x16x32_bf16 v[216:219], a[24:27], a[160:163], v[216:219]
 s_waitcnt lgkmcnt(4)
 v_mfma_f32_16x16x32_bf16 v[224:227], a[32:35], a[160:163], v[224:227]
 ds_read_b128 a[0:3], v18 offset:49152
 ds_read_b128 a[4:7], v18 offset:53248
 v_mfma_f32_16x16x32_bf16 v[224:227], a[36:39], a[164:167], v[224:227]
 buffer_load_dwordx4 a[224:227], v23, s[36:39], s52 offen offset:0 sc1
 v_mfma_f32_16x16x32_bf16 v[228:231], a[36:39], a[172:175], v[228:231]
 v_mfma_f32_16x16x32_bf16 v[228:231], a[32:35], a[168:171], v[228:231]
 v_mfma_f32_16x16x32_bf16 v[236:239], a[40:43], a[168:171], v[236:239]
 ds_read_b128 a[8:11], v18 offset:50176
 ds_read_b128 a[12:15], v18 offset:54272
 v_mfma_f32_16x16x32_bf16 v[236:239], a[44:47], a[172:175], v[236:239]
 buffer_load_dwordx4 a[228:231], v23, s[36:39], s52 offen offset:1024 sc1
 v_mfma_f32_16x16x32_bf16 v[232:235], a[44:47], a[164:167], v[232:235]
 v_mfma_f32_16x16x32_bf16 v[232:235], a[40:43], a[160:163], v[232:235]
 s_waitcnt lgkmcnt(4)
 v_mfma_f32_16x16x32_bf16 v[240:243], a[48:51], a[160:163], v[240:243]
 ds_read_b128 a[16:19], v18 offset:51200
 ds_read_b128 a[20:23], v18 offset:55296
 v_mfma_f32_16x16x32_bf16 v[240:243], a[52:55], a[164:167], v[240:243]
 buffer_load_dwordx4 a[232:235], v24, s[36:39], s52 offen offset:0 sc1
 v_mfma_f32_16x16x32_bf16 v[244:247], a[52:55], a[172:175], v[244:247]
 v_mfma_f32_16x16x32_bf16 v[244:247], a[48:51], a[168:171], v[244:247]
 v_mfma_f32_16x16x32_bf16 v[252:255], a[56:59], a[168:171], v[252:255]
 ds_read_b128 a[24:27], v18 offset:52224
 ds_read_b128 a[28:31], v18 offset:56320
 v_mfma_f32_16x16x32_bf16 v[252:255], a[60:63], a[172:175], v[252:255]
 buffer_load_dwordx4 a[236:239], v24, s[36:39], s52 offen offset:1024 sc1
 v_mfma_f32_16x16x32_bf16 v[248:251], a[60:63], a[164:167], v[248:251]
 s_add_u32 s52, s52, 2048
 v_mfma_f32_16x16x32_bf16 v[248:251], a[56:59], a[160:163], v[248:251]
 s_waitcnt lgkmcnt(4)
 v_mfma_f32_16x16x32_bf16 v[192:195], a[0:3], a[176:179], v[192:195]
 ds_read_b128 a[32:35], v18 offset:57344
 ds_read_b128 a[36:39], v18 offset:61440
 v_mfma_f32_16x16x32_bf16 v[192:195], a[4:7], a[180:183], v[192:195]
 buffer_load_dwordx4 a[240:243], v23, s[36:39], s52 offen offset:0 sc1
 v_mfma_f32_16x16x32_bf16 v[196:199], a[4:7], a[188:191], v[196:199]
 v_mfma_f32_16x16x32_bf16 v[196:199], a[0:3], a[184:187], v[196:199]
 buffer_load_dwordx4 a[244:247], v23, s[36:39], s52 offen offset:1024 sc1
 v_mfma_f32_16x16x32_bf16 v[204:207], a[8:11], a[184:187], v[204:207]
 ds_read_b128 a[40:43], v18 offset:58368
 ds_read_b128 a[44:47], v18 offset:62464
 v_mfma_f32_16x16x32_bf16 v[204:207], a[12:15], a[188:191], v[204:207]
 v_mfma_f32_16x16x32_bf16 v[200:203], a[12:15], a[180:183], v[200:203]
 v_mfma_f32_16x16x32_bf16 v[200:203], a[8:11], a[176:179], v[200:203]
 s_waitcnt lgkmcnt(4)
 buffer_load_dwordx4 a[248:251], v24, s[36:39], s52 offen offset:0 sc1
 v_mfma_f32_16x16x32_bf16 v[208:211], a[16:19], a[176:179], v[208:211]
 ds_read_b128 a[48:51], v18 offset:59392
 ds_read_b128 a[52:55], v18 offset:63488
 v_mfma_f32_16x16x32_bf16 v[208:211], a[20:23], a[180:183], v[208:211]
 v_mfma_f32_16x16x32_bf16 v[212:215], a[20:23], a[188:191], v[212:215]
 v_mfma_f32_16x16x32_bf16 v[212:215], a[16:19], a[184:187], v[212:215]
 buffer_load_dwordx4 a[252:255], v24, s[36:39], s52 offen offset:1024 sc1
 v_mfma_f32_16x16x32_bf16 v[220:223], a[24:27], a[184:187], v[220:223]
 s_add_u32 s52, s52, 2048
 ds_read_b128 a[56:59], v18 offset:60416
 ds_read_b128 a[60:63], v18 offset:64512
 v_mfma_f32_16x16x32_bf16 v[220:223], a[28:31], a[188:191], v[220:223]
 v_mfma_f32_16x16x32_bf16 v[216:219], a[28:31], a[180:183], v[216:219]
 v_mfma_f32_16x16x32_bf16 v[216:219], a[24:27], a[176:179], v[216:219]
 s_waitcnt lgkmcnt(4)
 s_barrier
 v_mfma_f32_16x16x32_bf16 v[224:227], a[32:35], a[176:179], v[224:227]
 ds_read_b128 a[0:3], v25 offset:0
 ds_read_b128 a[4:7], v25 offset:4096
 v_mfma_f32_16x16x32_bf16 v[224:227], a[36:39], a[180:183], v[224:227]
 buffer_load_dwordx4 a[128:131], v23, s[36:39], s52 offen offset:0 sc1
 v_mfma_f32_16x16x32_bf16 v[228:231], a[36:39], a[188:191], v[228:231]
 v_mfma_f32_16x16x32_bf16 v[228:231], a[32:35], a[184:187], v[228:231]
 buffer_load_dwordx4 a[132:135], v23, s[36:39], s52 offen offset:1024 sc1
 v_mfma_f32_16x16x32_bf16 v[236:239], a[40:43], a[184:187], v[236:239]
 ds_read_b128 a[8:11], v25 offset:1024
 ds_read_b128 a[12:15], v25 offset:5120
 v_mfma_f32_16x16x32_bf16 v[236:239], a[44:47], a[188:191], v[236:239]
 buffer_load_dwordx4 a[136:139], v24, s[36:39], s52 offen offset:0 sc1
 v_mfma_f32_16x16x32_bf16 v[232:235], a[44:47], a[180:183], v[232:235]
 v_mfma_f32_16x16x32_bf16 v[232:235], a[40:43], a[176:179], v[232:235]
 s_waitcnt lgkmcnt(4)
 buffer_load_dwordx4 a[140:143], v24, s[36:39], s52 offen offset:1024 sc1
 v_mfma_f32_16x16x32_bf16 v[240:243], a[48:51], a[176:179], v[240:243]
 s_add_u32 s52, s52, 2048
 s_add_u32 s91, s89, 106496
 s_add_u32 m0, s47, 16384
 ds_read_b128 a[16:19], v25 offset:2048
 ds_read_b128 a[20:23], v25 offset:6144
 v_mfma_f32_16x16x32_bf16 v[240:243], a[52:55], a[180:183], v[240:243]
 buffer_load_dwordx4 v18, s[24:27], s91 offen offset:0 sc1 lds
 v_mfma_f32_16x16x32_bf16 v[244:247], a[52:55], a[188:191], v[244:247]
 v_mfma_f32_16x16x32_bf16 v[244:247], a[48:51], a[184:187], v[244:247]
 buffer_load_dwordx4 v18, s[24:27], s91 offen offset:1024 sc1 lds
 v_mfma_f32_16x16x32_bf16 v[252:255], a[56:59], a[184:187], v[252:255]
 ds_read_b128 a[24:27], v25 offset:3072
 ds_read_b128 a[28:31], v25 offset:7168
 v_mfma_f32_16x16x32_bf16 v[252:255], a[60:63], a[188:191], v[252:255]
 buffer_load_dwordx4 v18, s[24:27], s91 offen offset:2048 sc1 lds
 v_mfma_f32_16x16x32_bf16 v[248:251], a[60:63], a[180:183], v[248:251]
 v_mfma_f32_16x16x32_bf16 v[248:251], a[56:59], a[176:179], v[248:251]
 s_waitcnt lgkmcnt(4)
 buffer_load_dwordx4 v18, s[24:27], s91 offen offset:3072 sc1 lds
 s_waitcnt vmcnt(31)
 v_mfma_f32_16x16x32_bf16 v[192:195], a[0:3], a[192:195], v[192:195]
 s_waitcnt vmcnt(28)
 ds_read_b128 a[32:35], v25 offset:8192
 ds_read_b128 a[36:39], v25 offset:12288
 v_mfma_f32_16x16x32_bf16 v[192:195], a[4:7], a[196:199], v[192:195]
 buffer_atomic_add v30, v31, s[40:43], 0 offen sc1
 v_mfma_f32_16x16x32_bf16 v[196:199], a[4:7], a[204:207], v[196:199]
 buffer_load_dwordx4 a[144:147], v23, s[36:39], s52 offen offset:0 sc1
 v_mfma_f32_16x16x32_bf16 v[196:199], a[0:3], a[200:203], v[196:199]
 buffer_load_dwordx4 a[148:151], v23, s[36:39], s52 offen offset:1024 sc1
 v_mfma_f32_16x16x32_bf16 v[204:207], a[8:11], a[200:203], v[204:207]
 ds_read_b128 a[40:43], v25 offset:9216
 ds_read_b128 a[44:47], v25 offset:13312
 v_mfma_f32_16x16x32_bf16 v[204:207], a[12:15], a[204:207], v[204:207]
 buffer_load_dwordx4 a[152:155], v24, s[36:39], s52 offen offset:0 sc1
 v_mfma_f32_16x16x32_bf16 v[200:203], a[12:15], a[196:199], v[200:203]
 buffer_load_dwordx4 a[156:159], v24, s[36:39], s52 offen offset:1024 sc1
 v_mfma_f32_16x16x32_bf16 v[200:203], a[8:11], a[192:195], v[200:203]
 s_waitcnt lgkmcnt(4)
 s_add_u32 s52, s52, 2048
 s_add_u32 s91, s89, 114688
 s_add_u32 m0, s47, 32768
 s_nop 0
 buffer_load_dwordx4 v18, s[24:27], s91 offen offset:0 sc1 lds
 v_mfma_f32_16x16x32_bf16 v[208:211], a[16:19], a[192:195], v[208:211]
 ds_read_b128 a[48:51], v25 offset:10240
 ds_read_b128 a[52:55], v25 offset:14336
 v_mfma_f32_16x16x32_bf16 v[208:211], a[20:23], a[196:199], v[208:211]
 buffer_load_dwordx4 v18, s[24:27], s91 offen offset:1024 sc1 lds
 v_mfma_f32_16x16x32_bf16 v[212:215], a[20:23], a[204:207], v[212:215]
 v_mfma_f32_16x16x32_bf16 v[212:215], a[16:19], a[200:203], v[212:215]
 buffer_load_dwordx4 v18, s[24:27], s91 offen offset:2048 sc1 lds
 v_mfma_f32_16x16x32_bf16 v[220:223], a[24:27], a[200:203], v[220:223]
 ds_read_b128 a[56:59], v25 offset:11264
 ds_read_b128 a[60:63], v25 offset:15360
 v_mfma_f32_16x16x32_bf16 v[220:223], a[28:31], a[204:207], v[220:223]
 buffer_load_dwordx4 v18, s[24:27], s91 offen offset:3072 sc1 lds
 v_mfma_f32_16x16x32_bf16 v[216:219], a[28:31], a[196:199], v[216:219]
 v_mfma_f32_16x16x32_bf16 v[216:219], a[24:27], a[192:195], v[216:219]
 s_waitcnt lgkmcnt(4)
 v_mfma_f32_16x16x32_bf16 v[224:227], a[32:35], a[192:195], v[224:227]
 ds_read_b128 a[0:3], v25 offset:16384
 ds_read_b128 a[4:7], v25 offset:20480
 v_mfma_f32_16x16x32_bf16 v[224:227], a[36:39], a[196:199], v[224:227]
 v_mfma_f32_16x16x32_bf16 v[228:231], a[36:39], a[204:207], v[228:231]
 v_mfma_f32_16x16x32_bf16 v[228:231], a[32:35], a[200:203], v[228:231]
 v_mfma_f32_16x16x32_bf16 v[236:239], a[40:43], a[200:203], v[236:239]
 ds_read_b128 a[8:11], v25 offset:17408
 ds_read_b128 a[12:15], v25 offset:21504
 v_mfma_f32_16x16x32_bf16 v[236:239], a[44:47], a[204:207], v[236:239]
 v_mfma_f32_16x16x32_bf16 v[232:235], a[44:47], a[196:199], v[232:235]
 v_mfma_f32_16x16x32_bf16 v[232:235], a[40:43], a[192:195], v[232:235]
 s_waitcnt lgkmcnt(4)
 v_mfma_f32_16x16x32_bf16 v[240:243], a[48:51], a[192:195], v[240:243]
 ds_read_b128 a[16:19], v25 offset:18432
 ds_read_b128 a[20:23], v25 offset:22528
 v_mfma_f32_16x16x32_bf16 v[240:243], a[52:55], a[196:199], v[240:243]
 v_mfma_f32_16x16x32_bf16 v[244:247], a[52:55], a[204:207], v[244:247]
 v_mfma_f32_16x16x32_bf16 v[244:247], a[48:51], a[200:203], v[244:247]
 v_mfma_f32_16x16x32_bf16 v[252:255], a[56:59], a[200:203], v[252:255]
 ds_read_b128 a[24:27], v25 offset:19456
 ds_read_b128 a[28:31], v25 offset:23552
 v_mfma_f32_16x16x32_bf16 v[252:255], a[60:63], a[204:207], v[252:255]
 v_mfma_f32_16x16x32_bf16 v[248:251], a[60:63], a[196:199], v[248:251]
 v_mfma_f32_16x16x32_bf16 v[248:251], a[56:59], a[192:195], v[248:251]
 s_waitcnt lgkmcnt(4)
 s_waitcnt vmcnt(29)
 v_mfma_f32_16x16x32_bf16 v[192:195], a[0:3], a[208:211], v[192:195]
 ds_read_b128 a[32:35], v25 offset:24576
 ds_read_b128 a[36:39], v25 offset:28672
 v_mfma_f32_16x16x32_bf16 v[192:195], a[4:7], a[212:215], v[192:195]
 buffer_load_dwordx4 a[160:163], v23, s[36:39], s52 offen offset:0 sc1
 v_mfma_f32_16x16x32_bf16 v[196:199], a[4:7], a[220:223], v[196:199]
 v_mfma_f32_16x16x32_bf16 v[196:199], a[0:3], a[216:219], v[196:199]
 buffer_load_dwordx4 a[164:167], v23, s[36:39], s52 offen offset:1024 sc1
 v_mfma_f32_16x16x32_bf16 v[204:207], a[8:11], a[216:219], v[204:207]
 ds_read_b128 a[40:43], v25 offset:25600
 ds_read_b128 a[44:47], v25 offset:29696
 v_mfma_f32_16x16x32_bf16 v[204:207], a[12:15], a[220:223], v[204:207]
 v_mfma_f32_16x16x32_bf16 v[200:203], a[12:15], a[212:215], v[200:203]
 v_mfma_f32_16x16x32_bf16 v[200:203], a[8:11], a[208:211], v[200:203]
 s_waitcnt lgkmcnt(4)
 buffer_load_dwordx4 a[168:171], v24, s[36:39], s52 offen offset:0 sc1
 v_mfma_f32_16x16x32_bf16 v[208:211], a[16:19], a[208:211], v[208:211]
 ds_read_b128 a[48:51], v25 offset:26624
 ds_read_b128 a[52:55], v25 offset:30720
 v_mfma_f32_16x16x32_bf16 v[208:211], a[20:23], a[212:215], v[208:211]
 v_mfma_f32_16x16x32_bf16 v[212:215], a[20:23], a[220:223], v[212:215]
 v_mfma_f32_16x16x32_bf16 v[212:215], a[16:19], a[216:219], v[212:215]
 buffer_load_dwordx4 a[172:175], v24, s[36:39], s52 offen offset:1024 sc1
 v_mfma_f32_16x16x32_bf16 v[220:223], a[24:27], a[216:219], v[220:223]
 s_add_u32 s52, s52, 2048
 ds_read_b128 a[56:59], v25 offset:27648
 ds_read_b128 a[60:63], v25 offset:31744
 v_mfma_f32_16x16x32_bf16 v[220:223], a[28:31], a[220:223], v[220:223]
 v_mfma_f32_16x16x32_bf16 v[216:219], a[28:31], a[212:215], v[216:219]
 v_mfma_f32_16x16x32_bf16 v[216:219], a[24:27], a[208:211], v[216:219]
 s_waitcnt lgkmcnt(4)
 s_barrier
 v_mfma_f32_16x16x32_bf16 v[224:227], a[32:35], a[208:211], v[224:227]
 s_add_u32 s91, s89, 122880
 s_add_u32 m0, s47, 49152
 ds_read_b128 a[0:3], v25 offset:32768
 ds_read_b128 a[4:7], v25 offset:36864
 v_mfma_f32_16x16x32_bf16 v[224:227], a[36:39], a[212:215], v[224:227]
 buffer_load_dwordx4 v18, s[24:27], s91 offen offset:0 sc1 lds
 v_mfma_f32_16x16x32_bf16 v[228:231], a[36:39], a[220:223], v[228:231]
 v_mfma_f32_16x16x32_bf16 v[228:231], a[32:35], a[216:219], v[228:231]
 v_mfma_f32_16x16x32_bf16 v[236:239], a[40:43], a[216:219], v[236:239]
 ds_read_b128 a[8:11], v25 offset:33792
 ds_read_b128 a[12:15], v25 offset:37888
 v_mfma_f32_16x16x32_bf16 v[236:239], a[44:47], a[220:223], v[236:239]
 buffer_load_dwordx4 v18, s[24:27], s91 offen offset:1024 sc1 lds
 v_mfma_f32_16x16x32_bf16 v[232:235], a[44:47], a[212:215], v[232:235]
 v_mfma_f32_16x16x32_bf16 v[232:235], a[40:43], a[208:211], v[232:235]
 s_waitcnt lgkmcnt(4)
 v_mfma_f32_16x16x32_bf16 v[240:243], a[48:51], a[208:211], v[240:243]
 ds_read_b128 a[16:19], v25 offset:34816
 ds_read_b128 a[20:23], v25 offset:38912
 v_mfma_f32_16x16x32_bf16 v[240:243], a[52:55], a[212:215], v[240:243]
 buffer_load_dwordx4 v18, s[24:27], s91 offen offset:2048 sc1 lds
 v_mfma_f32_16x16x32_bf16 v[244:247], a[52:55], a[220:223], v[244:247]
 v_mfma_f32_16x16x32_bf16 v[244:247], a[48:51], a[216:219], v[244:247]
 v_mfma_f32_16x16x32_bf16 v[252:255], a[56:59], a[216:219], v[252:255]
 ds_read_b128 a[24:27], v25 offset:35840
 ds_read_b128 a[28:31], v25 offset:39936
 v_mfma_f32_16x16x32_bf16 v[252:255], a[60:63], a[220:223], v[252:255]
 buffer_load_dwordx4 v18, s[24:27], s91 offen offset:3072 sc1 lds
 v_mfma_f32_16x16x32_bf16 v[248:251], a[60:63], a[212:215], v[248:251]
 v_mfma_f32_16x16x32_bf16 v[248:251], a[56:59], a[208:211], v[248:251]
 s_waitcnt lgkmcnt(4)
 s_waitcnt vmcnt(29)
 v_mfma_f32_16x16x32_bf16 v[192:195], a[0:3], a[224:227], v[192:195]
 ds_read_b128 a[32:35], v25 offset:40960
 ds_read_b128 a[36:39], v25 offset:45056
 v_mfma_f32_16x16x32_bf16 v[192:195], a[4:7], a[228:231], v[192:195]
 buffer_load_dword v19, v20, s[40:43], 0 offen sc1
 v_mfma_f32_16x16x32_bf16 v[196:199], a[4:7], a[236:239], v[196:199]
 buffer_load_dwordx4 a[176:179], v23, s[36:39], s52 offen offset:0 sc1
 v_mfma_f32_16x16x32_bf16 v[196:199], a[0:3], a[232:235], v[196:199]
 buffer_load_dwordx4 a[180:183], v23, s[36:39], s52 offen offset:1024 sc1
 v_mfma_f32_16x16x32_bf16 v[204:207], a[8:11], a[232:235], v[204:207]
 ds_read_b128 a[40:43], v25 offset:41984
 ds_read_b128 a[44:47], v25 offset:46080
 v_mfma_f32_16x16x32_bf16 v[204:207], a[12:15], a[236:239], v[204:207]
 buffer_load_dwordx4 a[184:187], v24, s[36:39], s52 offen offset:0 sc1
 v_mfma_f32_16x16x32_bf16 v[200:203], a[12:15], a[228:231], v[200:203]
 buffer_load_dwordx4 a[188:191], v24, s[36:39], s52 offen offset:1024 sc1
 v_mfma_f32_16x16x32_bf16 v[200:203], a[8:11], a[224:227], v[200:203]
 s_waitcnt lgkmcnt(4)
 s_add_u32 s52, s52, 2048
 buffer_load_dwordx2 v[32:33], v60, s[16:19], s58 offen offset:0
 v_mfma_f32_16x16x32_bf16 v[208:211], a[16:19], a[224:227], v[208:211]
 ds_read_b128 a[48:51], v25 offset:43008
 ds_read_b128 a[52:55], v25 offset:47104
 v_mfma_f32_16x16x32_bf16 v[208:211], a[20:23], a[228:231], v[208:211]
 buffer_load_dwordx2 v[34:35], v60, s[16:19], s58 offen offset:32
 v_mfma_f32_16x16x32_bf16 v[212:215], a[20:23], a[236:239], v[212:215]
 v_mfma_f32_16x16x32_bf16 v[212:215], a[16:19], a[232:235], v[212:215]
 buffer_load_dwordx2 v[36:37], v60, s[16:19], s58 offen offset:64
 v_mfma_f32_16x16x32_bf16 v[220:223], a[24:27], a[232:235], v[220:223]
 ds_read_b128 a[56:59], v25 offset:44032
 ds_read_b128 a[60:63], v25 offset:48128
 v_mfma_f32_16x16x32_bf16 v[220:223], a[28:31], a[236:239], v[220:223]
 buffer_load_dwordx2 v[38:39], v60, s[16:19], s58 offen offset:96
 v_mfma_f32_16x16x32_bf16 v[216:219], a[28:31], a[228:231], v[216:219]
 v_mfma_f32_16x16x32_bf16 v[216:219], a[24:27], a[224:227], v[216:219]
 s_waitcnt lgkmcnt(4)
 v_mfma_f32_16x16x32_bf16 v[224:227], a[32:35], a[224:227], v[224:227]
 ds_read_b128 a[0:3], v25 offset:49152
 ds_read_b128 a[4:7], v25 offset:53248
 v_mfma_f32_16x16x32_bf16 v[224:227], a[36:39], a[228:231], v[224:227]
 v_mfma_f32_16x16x32_bf16 v[228:231], a[36:39], a[236:239], v[228:231]
 v_mfma_f32_16x16x32_bf16 v[228:231], a[32:35], a[232:235], v[228:231]
 v_mfma_f32_16x16x32_bf16 v[236:239], a[40:43], a[232:235], v[236:239]
 s_add_u32 s54, s54, 0x800000
 s_add_u32 s56, s56, 0x800000
 ds_read_b128 a[8:11], v25 offset:50176
 ds_read_b128 a[12:15], v25 offset:54272
 v_mfma_f32_16x16x32_bf16 v[236:239], a[44:47], a[236:239], v[236:239]
 v_mfma_f32_16x16x32_bf16 v[232:235], a[44:47], a[228:231], v[232:235]
 v_mfma_f32_16x16x32_bf16 v[232:235], a[40:43], a[224:227], v[232:235]
 s_waitcnt lgkmcnt(4)
 v_mfma_f32_16x16x32_bf16 v[240:243], a[48:51], a[224:227], v[240:243]
 ds_read_b128 a[16:19], v25 offset:51200
 ds_read_b128 a[20:23], v25 offset:55296
 v_mfma_f32_16x16x32_bf16 v[240:243], a[52:55], a[228:231], v[240:243]
 v_mfma_f32_16x16x32_bf16 v[244:247], a[52:55], a[236:239], v[244:247]
 v_mfma_f32_16x16x32_bf16 v[244:247], a[48:51], a[232:235], v[244:247]
 v_mfma_f32_16x16x32_bf16 v[252:255], a[56:59], a[232:235], v[252:255]
 ds_read_b128 a[24:27], v25 offset:52224
 ds_read_b128 a[28:31], v25 offset:56320
 v_mfma_f32_16x16x32_bf16 v[252:255], a[60:63], a[236:239], v[252:255]
 v_mfma_f32_16x16x32_bf16 v[248:251], a[60:63], a[228:231], v[248:251]
 v_mfma_f32_16x16x32_bf16 v[248:251], a[56:59], a[224:227], v[248:251]
 s_waitcnt lgkmcnt(4)
 s_waitcnt vmcnt(34)
 v_mfma_f32_16x16x32_bf16 v[192:195], a[0:3], a[240:243], v[192:195]
 ds_read_b128 a[32:35], v25 offset:57344
 ds_read_b128 a[36:39], v25 offset:61440
 v_mfma_f32_16x16x32_bf16 v[192:195], a[4:7], a[244:247], v[192:195]
 v_mfma_f32_16x16x32_bf16 v[196:199], a[4:7], a[252:255], v[196:199]
 v_mfma_f32_16x16x32_bf16 v[196:199], a[0:3], a[248:251], v[196:199]
 v_mfma_f32_16x16x32_bf16 v[204:207], a[8:11], a[248:251], v[204:207]
 ds_read_b128 a[40:43], v25 offset:58368
 ds_read_b128 a[44:47], v25 offset:62464
 v_mfma_f32_16x16x32_bf16 v[204:207], a[12:15], a[252:255], v[204:207]
 v_mfma_f32_16x16x32_bf16 v[200:203], a[12:15], a[244:247], v[200:203]
 v_mfma_f32_16x16x32_bf16 v[200:203], a[8:11], a[240:243], v[200:203]
 s_waitcnt lgkmcnt(4)
 v_mfma_f32_16x16x32_bf16 v[208:211], a[16:19], a[240:243], v[208:211]
 ds_read_b128 a[48:51], v25 offset:59392
 ds_read_b128 a[52:55], v25 offset:63488
 v_mfma_f32_16x16x32_bf16 v[208:211], a[20:23], a[244:247], v[208:211]
 v_mfma_f32_16x16x32_bf16 v[212:215], a[20:23], a[252:255], v[212:215]
 v_mfma_f32_16x16x32_bf16 v[212:215], a[16:19], a[248:251], v[212:215]
 v_mfma_f32_16x16x32_bf16 v[220:223], a[24:27], a[248:251], v[220:223]
 ds_read_b128 a[56:59], v25 offset:60416
 ds_read_b128 a[60:63], v25 offset:64512
 v_mfma_f32_16x16x32_bf16 v[220:223], a[28:31], a[252:255], v[220:223]
 v_mfma_f32_16x16x32_bf16 v[216:219], a[28:31], a[244:247], v[216:219]
 s_waitcnt vmcnt(8)
 v_and_b32 v19, 0xff, v19
 v_cmp_gt_u32 vcc, s62, v19
 v_mfma_f32_16x16x32_bf16 v[216:219], a[24:27], a[240:243], v[216:219]
 s_waitcnt lgkmcnt(4)
 s_cbranch_vccnz do_spin
do_ok:
 s_barrier
 v_mfma_f32_16x16x32_bf16 v[224:227], a[32:35], a[240:243], v[224:227]
 ds_read_b128 a[0:3], v18 offset:0
 ds_read_b128 a[4:7], v18 offset:4096
 v_mfma_f32_16x16x32_bf16 v[224:227], a[36:39], a[244:247], v[224:227]
 buffer_load_dwordx4 v[72:75], v18, s[20:23], s90 offen offset:0 sc1
 v_mfma_f32_16x16x32_bf16 v[228:231], a[36:39], a[252:255], v[228:231]
 ds_read_b128 v[64:67], v55 offset:0
 ds_read_b128 v[68:71], v55 offset:1024
 v_mfma_f32_16x16x32_bf16 v[228:231], a[32:35], a[248:251], v[228:231]
 buffer_load_dwordx4 v[76:79], v18, s[20:23], s90 offen offset:1024 sc1
 v_mfma_f32_16x16x32_bf16 v[236:239], a[40:43], a[248:251], v[236:239]
 ds_read_b128 a[8:11], v18 offset:1024
 ds_read_b128 a[12:15], v18 offset:5120
 v_mfma_f32_16x16x32_bf16 v[236:239], a[44:47], a[252:255], v[236:239]
 buffer_load_dwordx4 v[80:83], v18, s[20:23], s49 offen offset:0 sc1
 v_mfma_f32_16x16x32_bf16 v[232:235], a[44:47], a[244:247], v[232:235]
 v_mfma_f32_16x16x32_bf16 v[232:235], a[40:43], a[240:243], v[232:235]
 s_waitcnt lgkmcnt(6)
 v_mfma_f32_16x16x32_bf16 v[240:243], a[48:51], a[240:243], v[240:243]
 ds_read_b128 a[16:19], v18 offset:2048
 ds_read_b128 a[20:23], v18 offset:6144
 v_mfma_f32_16x16x32_bf16 v[240:243], a[52:55], a[244:247], v[240:243]
 buffer_load_dwordx4 v[84:87], v18, s[20:23], s49 offen offset:1024 sc1
 v_mfma_f32_16x16x32_bf16 v[244:247], a[52:55], a[252:255], v[244:247]
 v_mfma_f32_16x16x32_bf16 v[244:247], a[48:51], a[248:251], v[244:247]
 buffer_load_dwordx4 v[88:91], v18, s[20:23], s50 offen offset:0 sc1
 v_mfma_f32_16x16x32_bf16 v[252:255], a[56:59], a[248:251], v[252:255]
 ds_read_b128 a[24:27], v18 offset:3072
 ds_read_b128 a[28:31], v18 offset:7168
 v_mfma_f32_16x16x32_bf16 v[252:255], a[60:63], a[252:255], v[252:255]
 buffer_load_dwordx4 v[92:95], v18, s[20:23], s50 offen offset:1024 sc1
 v_mfma_f32_16x16x32_bf16 v[248:251], a[60:63], a[244:247], v[248:251]
 v_mfma_f32_16x16x32_bf16 v[248:251], a[56:59], a[240:243], v[248:251]
 s_waitcnt lgkmcnt(4)
 v_mfma_f32_16x16x32_bf16 v[192:195], a[0:3], a[128:131], v[192:195]
 ds_read_b128 a[32:35], v18 offset:8192
 ds_read_b128 a[36:39], v18 offset:12288
 v_mfma_f32_16x16x32_bf16 v[192:195], a[4:7], a[132:135], v[192:195]
 v_mfma_f32_16x16x32_bf16 v[196:199], a[4:7], a[140:143], v[196:199]
 v_mfma_f32_16x16x32_bf16 v[196:199], a[0:3], a[136:139], v[196:199]
 v_mfma_f32_16x16x32_bf16 v[204:207], a[8:11], a[136:139], v[204:207]
 ds_read_b128 a[40:43], v18 offset:9216
 ds_read_b128 a[44:47], v18 offset:13312
 v_mfma_f32_16x16x32_bf16 v[204:207], a[12:15], a[140:143], v[204:207]
 v_mfma_f32_16x16x32_bf16 v[200:203], a[12:15], a[132:135], v[200:203]
 v_mfma_f32_16x16x32_bf16 v[200:203], a[8:11], a[128:131], v[200:203]
 s_waitcnt lgkmcnt(4)
 v_mfma_f32_16x16x32_bf16 v[208:211], a[16:19], a[128:131], v[208:211]
 ds_read_b128 a[48:51], v18 offset:10240
 ds_read_b128 a[52:55], v18 offset:14336
 v_mfma_f32_16x16x32_bf16 v[208:211], a[20:23], a[132:135], v[208:211]
 v_mfma_f32_16x16x32_bf16 v[212:215], a[20:23], a[140:143], v[212:215]
 v_mfma_f32_16x16x32_bf16 v[212:215], a[16:19], a[136:139], v[212:215]
 v_mfma_f32_16x16x32_bf16 v[220:223], a[24:27], a[136:139], v[220:223]
 ds_read_b128 a[56:59], v18 offset:11264
 ds_read_b128 a[60:63], v18 offset:15360
 v_mfma_f32_16x16x32_bf16 v[220:223], a[28:31], a[140:143], v[220:223]
 v_mfma_f32_16x16x32_bf16 v[216:219], a[28:31], a[132:135], v[216:219]
 v_mfma_f32_16x16x32_bf16 v[216:219], a[24:27], a[128:131], v[216:219]
 s_waitcnt lgkmcnt(4)
 v_mfma_f32_16x16x32_bf16 v[224:227], a[32:35], a[128:131], v[224:227]
 ds_read_b128 a[0:3], v18 offset:16384
 ds_read_b128 a[4:7], v18 offset:20480
 v_mfma_f32_16x16x32_bf16 v[224:227], a[36:39], a[132:135], v[224:227]
 v_mfma_f32_16x16x32_bf16 v[228:231], a[36:39], a[140:143], v[228:231]
 v_mfma_f32_16x16x32_bf16 v[228:231], a[32:35], a[136:139], v[228:231]
 v_mfma_f32_16x16x32_bf16 v[236:239], a[40:43], a[136:139], v[236:239]
 ds_read_b128 a[8:11], v18 offset:17408
 ds_read_b128 a[12:15], v18 offset:21504
 v_mfma_f32_16x16x32_bf16 v[236:239], a[44:47], a[140:143], v[236:239]
 v_mfma_f32_16x16x32_bf16 v[232:235], a[44:47], a[132:135], v[232:235]
 v_mfma_f32_16x16x32_bf16 v[232:235], a[40:43], a[128:131], v[232:235]
 s_waitcnt lgkmcnt(4)
 v_mfma_f32_16x16x32_bf16 v[240:243], a[48:51], a[128:131], v[240:243]
 ds_read_b128 a[16:19], v18 offset:18432
 ds_read_b128 a[20:23], v18 offset:22528
 v_mfma_f32_16x16x32_bf16 v[240:243], a[52:55], a[132:135], v[240:243]
 v_mfma_f32_16x16x32_bf16 v[244:247], a[52:55], a[140:143], v[244:247]
 v_mfma_f32_16x16x32_bf16 v[244:247], a[48:51], a[136:139], v[244:247]
 v_mfma_f32_16x16x32_bf16 v[252:255], a[56:59], a[136:139], v[252:255]
 ds_read_b128 a[24:27], v18 offset:19456
 ds_read_b128 a[28:31], v18 offset:23552
 v_mfma_f32_16x16x32_bf16 v[252:255], a[60:63], a[140:143], v[252:255]
 v_mfma_f32_16x16x32_bf16 v[248:251], a[60:63], a[132:135], v[248:251]
 v_mfma_f32_16x16x32_bf16 v[248:251], a[56:59], a[128:131], v[248:251]
 s_waitcnt lgkmcnt(4)
 v_mfma_f32_16x16x32_bf16 v[192:195], a[0:3], a[144:147], v[192:195]
 ds_read_b128 a[32:35], v18 offset:24576
 ds_read_b128 a[36:39], v18 offset:28672
 v_mfma_f32_16x16x32_bf16 v[192:195], a[4:7], a[148:151], v[192:195]
 v_mfma_f32_16x16x32_bf16 v[196:199], a[4:7], a[156:159], v[196:199]
 v_mfma_f32_16x16x32_bf16 v[196:199], a[0:3], a[152:155], v[196:199]
 v_mfma_f32_16x16x32_bf16 v[204:207], a[8:11], a[152:155], v[204:207]
 ds_read_b128 a[40:43], v18 offset:25600
 ds_read_b128 a[44:47], v18 offset:29696
 v_mfma_f32_16x16x32_bf16 v[204:207], a[12:15], a[156:159], v[204:207]
 v_mfma_f32_16x16x32_bf16 v[200:203], a[12:15], a[148:151], v[200:203]
 v_mfma_f32_16x16x32_bf16 v[200:203], a[8:11], a[144:147], v[200:203]
 s_waitcnt lgkmcnt(4)
 v_mfma_f32_16x16x32_bf16 v[208:211], a[16:19], a[144:147], v[208:211]
 ds_read_b128 a[48:51], v18 offset:26624
 ds_read_b128 a[52:55], v18 offset:30720
 v_mfma_f32_16x16x32_bf16 v[208:211], a[20:23], a[148:151], v[208:211]
 v_mfma_f32_16x16x32_bf16 v[212:215], a[20:23], a[156:159], v[212:215]
 v_mfma_f32_16x16x32_bf16 v[212:215], a[16:19], a[152:155], v[212:215]
 v_mfma_f32_16x16x32_bf16 v[220:223], a[24:27], a[152:155], v[220:223]
 ds_read_b128 a[56:59], v18 offset:27648
 ds_read_b128 a[60:63], v18 offset:31744
 v_mfma_f32_16x16x32_bf16 v[220:223], a[28:31], a[156:159], v[220:223]
 v_mfma_f32_16x16x32_bf16 v[216:219], a[28:31], a[148:151], v[216:219]
 v_mfma_f32_16x16x32_bf16 v[216:219], a[24:27], a[144:147], v[216:219]
 s_waitcnt lgkmcnt(4)
 s_barrier
 v_mfma_f32_16x16x32_bf16 v[224:227], a[32:35], a[144:147], v[224:227]
 ds_read_b128 a[0:3], v18 offset:32768
 ds_read_b128 a[4:7], v18 offset:36864
 v_mfma_f32_16x16x32_bf16 v[224:227], a[36:39], a[148:151], v[224:227]
 v_mfma_f32_16x16x32_bf16 v[228:231], a[36:39], a[156:159], v[228:231]
 v_mfma_f32_16x16x32_bf16 v[228:231], a[32:35], a[152:155], v[228:231]
 v_mfma_f32_16x16x32_bf16 v[236:239], a[40:43], a[152:155], v[236:239]
 ds_read_b128 a[8:11], v18 offset:33792
 ds_read_b128 a[12:15], v18 offset:37888
 v_mfma_f32_16x16x32_bf16 v[236:239], a[44:47], a[156:159], v[236:239]
 v_mfma_f32_16x16x32_bf16 v[232:235], a[44:47], a[148:151], v[232:235]
 v_mfma_f32_16x16x32_bf16 v[232:235], a[40:43], a[144:147], v[232:235]
 s_waitcnt lgkmcnt(4)
 v_mfma_f32_16x16x32_bf16 v[240:243], a[48:51], a[144:147], v[240:243]
 ds_read_b128 a[16:19], v18 offset:34816
 ds_read_b128 a[20:23], v18 offset:38912
 v_mfma_f32_16x16x32_bf16 v[240:243], a[52:55], a[148:151], v[240:243]
 v_mfma_f32_16x16x32_bf16 v[244:247], a[52:55], a[156:159], v[244:247]
 v_mfma_f32_16x16x32_bf16 v[244:247], a[48:51], a[152:155], v[244:247]
 v_mfma_f32_16x16x32_bf16 v[252:255], a[56:59], a[152:155], v[252:255]
 ds_read_b128 a[24:27], v18 offset:35840
 ds_read_b128 a[28:31], v18 offset:39936
 v_mfma_f32_16x16x32_bf16 v[252:255], a[60:63], a[156:159], v[252:255]
 v_mfma_f32_16x16x32_bf16 v[248:251], a[60:63], a[148:151], v[248:251]
 v_mfma_f32_16x16x32_bf16 v[248:251], a[56:59], a[144:147], v[248:251]
 s_waitcnt lgkmcnt(4)
 v_mfma_f32_16x16x32_bf16 v[192:195], a[0:3], a[160:163], v[192:195]
 ds_read_b128 a[32:35], v18 offset:40960
 ds_read_b128 a[36:39], v18 offset:45056
 v_mfma_f32_16x16x32_bf16 v[192:195], a[4:7], a[164:167], v[192:195]
 v_mfma_f32_16x16x32_bf16 v[196:199], a[4:7], a[172:175], v[196:199]
 v_mfma_f32_16x16x32_bf16 v[196:199], a[0:3], a[168:171], v[196:199]
 v_mfma_f32_16x16x32_bf16 v[204:207], a[8:11], a[168:171], v[204:207]
 ds_read_b128 a[40:43], v18 offset:41984
 ds_read_b128 a[44:47], v18 offset:46080
 v_mfma_f32_16x16x32_bf16 v[204:207], a[12:15], a[172:175], v[204:207]
 v_mfma_f32_16x16x32_bf16 v[200:203], a[12:15], a[164:167], v[200:203]
 v_mfma_f32_16x16x32_bf16 v[200:203], a[8:11], a[160:163], v[200:203]
 s_waitcnt lgkmcnt(4)
 v_mfma_f32_16x16x32_bf16 v[208:211], a[16:19], a[160:163], v[208:211]
 ds_read_b128 a[48:51], v18 offset:43008
 ds_read_b128 a[52:55], v18 offset:47104
 v_mfma_f32_16x16x32_bf16 v[208:211], a[20:23], a[164:167], v[208:211]
 v_mfma_f32_16x16x32_bf16 v[212:215], a[20:23], a[172:175], v[212:215]
 v_mfma_f32_16x16x32_bf16 v[212:215], a[16:19], a[168:171], v[212:215]
 v_mfma_f32_16x16x32_bf16 v[220:223], a[24:27], a[168:171], v[220:223]
 ds_read_b128 a[56:59], v18 offset:44032
 ds_read_b128 a[60:63], v18 offset:48128
 v_mfma_f32_16x16x32_bf16 v[220:223], a[28:31], a[172:175], v[220:223]
 v_mfma_f32_16x16x32_bf16 v[216:219], a[28:31], a[164:167], v[216:219]
 v_mfma_f32_16x16x32_bf16 v[216:219], a[24:27], a[160:163], v[216:219]
 s_waitcnt lgkmcnt(4)
 v_mfma_f32_16x16x32_bf16 v[224:227], a[32:35], a[160:163], v[224:227]
 ds_read_b128 a[0:3], v18 offset:49152
 ds_read_b128 a[4:7], v18 offset:53248
 v_mfma_f32_16x16x32_bf16 v[224:227], a[36:39], a[164:167], v[224:227]
 v_mfma_f32_16x16x32_bf16 v[228:231], a[36:39], a[172:175], v[228:231]
 v_mfma_f32_16x16x32_bf16 v[228:231], a[32:35], a[168:171], v[228:231]
 v_mfma_f32_16x16x32_bf16 v[236:239], a[40:43], a[168:171], v[236:239]
 ds_read_b128 a[8:11], v18 offset:50176
 ds_read_b128 a[12:15], v18 offset:54272
 v_mfma_f32_16x16x32_bf16 v[236:239], a[44:47], a[172:175], v[236:239]
 v_mfma_f32_16x16x32_bf16 v[232:235], a[44:47], a[164:167], v[232:235]
 v_mfma_f32_16x16x32_bf16 v[232:235], a[40:43], a[160:163], v[232:235]
 s_waitcnt lgkmcnt(4)
 v_mfma_f32_16x16x32_bf16 v[240:243], a[48:51], a[160:163], v[240:243]
 ds_read_b128 a[16:19], v18 offset:51200
 ds_read_b128 a[20:23], v18 offset:55296
 v_mfma_f32_16x16x32_bf16 v[240:243], a[52:55], a[164:167], v[240:243]
 v_mfma_f32_16x16x32_bf16 v[244:247], a[52:55], a[172:175], v[244:247]
 v_mfma_f32_16x16x32_bf16 v[244:247], a[48:51], a[168:171], v[244:247]
 v_mfma_f32_16x16x32_bf16 v[252:255], a[56:59], a[168:171], v[252:255]
 ds_read_b128 a[24:27], v18 offset:52224
 ds_read_b128 a[28:31], v18 offset:56320
 v_mfma_f32_16x16x32_bf16 v[252:255], a[60:63], a[172:175], v[252:255]
 v_mfma_f32_16x16x32_bf16 v[248:251], a[60:63], a[164:167], v[248:251]
 v_mfma_f32_16x16x32_bf16 v[248:251], a[56:59], a[160:163], v[248:251]
 s_waitcnt lgkmcnt(4)
 s_waitcnt vmcnt(10)
 v_mfma_f32_16x16x32_bf16 v[192:195], a[0:3], a[176:179], v[192:195]
 ds_read_b128 a[32:35], v18 offset:57344
 ds_read_b128 a[36:39], v18 offset:61440
 v_mfma_f32_16x16x32_bf16 v[192:195], a[4:7], a[180:183], v[192:195]
 v_mfma_f32_16x16x32_bf16 v[196:199], a[4:7], a[188:191], v[196:199]
 v_mfma_f32_16x16x32_bf16 v[196:199], a[0:3], a[184:187], v[196:199]
 v_mfma_f32_16x16x32_bf16 v[204:207], a[8:11], a[184:187], v[204:207]
 ds_read_b128 a[40:43], v18 offset:58368
 ds_read_b128 a[44:47], v18 offset:62464
 v_mfma_f32_16x16x32_bf16 v[204:207], a[12:15], a[188:191], v[204:207]
 v_mfma_f32_16x16x32_bf16 v[200:203], a[12:15], a[180:183], v[200:203]
 v_mfma_f32_16x16x32_bf16 v[200:203], a[8:11], a[176:179], v[200:203]
 s_waitcnt lgkmcnt(4)
 v_mfma_f32_16x16x32_bf16 v[208:211], a[16:19], a[176:179], v[208:211]
 ds_read_b128 a[48:51], v18 offset:59392
 ds_read_b128 a[52:55], v18 offset:63488
 v_mfma_f32_16x16x32_bf16 v[208:211], a[20:23], a[180:183], v[208:211]
 v_mfma_f32_16x16x32_bf16 v[212:215], a[20:23], a[188:191], v[212:215]
 v_mfma_f32_16x16x32_bf16 v[212:215], a[16:19], a[184:187], v[212:215]
 v_mfma_f32_16x16x32_bf16 v[220:223], a[24:27], a[184:187], v[220:223]
 ds_read_b128 a[56:59], v18 offset:60416
 ds_read_b128 a[60:63], v18 offset:64512
 v_cvt_pk_bf16_f32 v192, v192, v193
 v_cvt_pk_bf16_f32 v193, v194, v195
 v_cvt_pk_bf16_f32 v196, v196, v197
 v_cvt_pk_bf16_f32 v197, v198, v199
 v_mfma_f32_16x16x32_bf16 v[220:223], a[28:31], a[188:191], v[220:223]
 v_cvt_pk_bf16_f32 v194, v200, v201
 v_cvt_pk_bf16_f32 v195, v202, v203
 v_cvt_pk_bf16_f32 v198, v204, v205
 v_cvt_pk_bf16_f32 v199, v206, v207
 v_mfma_f32_16x16x32_bf16 v[216:219], a[28:31], a[180:183], v[216:219]
 ds_write_b128 v53, v[192:195] offset:8192
 buffer_store_dwordx4 v[192:195], v48, s[20:23], s54 offen offset:0 sc1
 ds_write_b128 v53, v[196:199] offset:10240
 buffer_store_dwordx4 v[196:199], v49, s[20:23], s54 offen offset:0 sc1
 v_mfma_f32_16x16x32_bf16 v[216:219], a[24:27], a[176:179], v[216:219]
 s_waitcnt lgkmcnt(6)
 v_mfma_f32_16x16x32_bf16 v[224:227], a[32:35], a[176:179], v[224:227]
 v_mfma_f32_16x16x32_bf16 v[224:227], a[36:39], a[180:183], v[224:227]
 v_mfma_f32_16x16x32_bf16 v[228:231], a[36:39], a[188:191], v[228:231]
 v_mfma_f32_16x16x32_bf16 v[228:231], a[32:35], a[184:187], v[228:231]
 v_mfma_f32_16x16x32_bf16 v[236:239], a[40:43], a[184:187], v[236:239]
 v_cvt_pk_bf16_f32 v208, v208, v209
 v_cvt_pk_bf16_f32 v209, v210, v211
 v_cvt_pk_bf16_f32 v212, v212, v213
 v_cvt_pk_bf16_f32 v213, v214, v215
 v_mfma_f32_16x16x32_bf16 v[236:239], a[44:47], a[188:191], v[236:239]
 v_cvt_pk_bf16_f32 v210, v216, v217
 v_cvt_pk_bf16_f32 v211, v218, v219
 v_cvt_pk_bf16_f32 v214, v220, v221
 v_cvt_pk_bf16_f32 v215, v222, v223
 v_mfma_f32_16x16x32_bf16 v[232:235], a[44:47], a[180:183], v[232:235]
 ds_write_b128 v53, v[208:211] offset:9216
 buffer_store_dwordx4 v[208:211], v48, s[20:23], s54 offen offset:1024 sc1
 ds_write_b128 v53, v[212:215] offset:11264
 buffer_store_dwordx4 v[212:215], v49, s[20:23], s54 offen offset:1024 sc1
 v_mfma_f32_16x16x32_bf16 v[232:235], a[40:43], a[176:179], v[232:235]
 s_waitcnt lgkmcnt(4)
 v_mfma_f32_16x16x32_bf16 v[240:243], a[48:51], a[176:179], v[240:243]
 v_mfma_f32_16x16x32_bf16 v[240:243], a[52:55], a[180:183], v[240:243]
 v_mfma_f32_16x16x32_bf16 v[244:247], a[52:55], a[188:191], v[244:247]
 v_mfma_f32_16x16x32_bf16 v[244:247], a[48:51], a[184:187], v[244:247]
 v_mfma_f32_16x16x32_bf16 v[252:255], a[56:59], a[184:187], v[252:255]
 v_cvt_pk_bf16_f32 v224, v224, v225
 v_cvt_pk_bf16_f32 v225, v226, v227
 v_cvt_pk_bf16_f32 v228, v228, v229
 v_cvt_pk_bf16_f32 v229, v230, v231
 v_mfma_f32_16x16x32_bf16 v[252:255], a[60:63], a[188:191], v[252:255]
 v_cvt_pk_bf16_f32 v226, v232, v233
 v_cvt_pk_bf16_f32 v227, v234, v235
 v_cvt_pk_bf16_f32 v230, v236, v237
 v_cvt_pk_bf16_f32 v231, v238, v239
 v_mfma_f32_16x16x32_bf16 v[248:251], a[60:63], a[180:183], v[248:251]
 ds_write_b128 v54, v[224:227] offset:8192
 buffer_store_dwordx4 v[224:227], v50, s[20:23], s56 offen offset:0 sc1
 ds_write_b128 v54, v[228:231] offset:10240
 buffer_store_dwordx4 v[228:231], v51, s[20:23], s56 offen offset:0 sc1
 v_mfma_f32_16x16x32_bf16 v[248:251], a[56:59], a[176:179], v[248:251]
 v_cvt_pk_bf16_f32 v240, v240, v241
 v_cvt_pk_bf16_f32 v241, v242, v243
 s_nop 5
 v_cvt_pk_bf16_f32 v242, v248, v249
 v_cvt_pk_bf16_f32 v243, v250, v251
 ds_write_b128 v54, v[240:243] offset:9216
 buffer_store_dwordx4 v[240:243], v50, s[20:23], s56 offen offset:1024 sc1
 v_cvt_pk_bf16_f32 v244, v244, v245
 v_cvt_pk_bf16_f32 v245, v246, v247
 v_cvt_pk_bf16_f32 v246, v252, v253
 v_cvt_pk_bf16_f32 v247, v254, v255
 ds_write_b128 v54, v[244:247] offset:11264
 buffer_store_dwordx4 v[244:247], v51, s[20:23], s56 offen offset:1024 sc1
 s_branch fin_a
outo_z:
h_spin:
 s_mov_b32 s4, 0
 v_add_u32 v20, 131072, v20
h_spin1:
 buffer_load_dword v19, v20, s[92:95], 0 offen sc1
 s_add_u32 s4, s4, 1
 s_waitcnt vmcnt(0)
 v_and_b32 v19, -1, v19
 v_cmp_gt_u32 vcc, s62, v19
 s_nop 0
 s_cmp_eq_u64 vcc, 0
 s_cbranch_scc1 h_ok
 s_cmp_lt_u32 s4, 0x40000
 s_cbranch_scc1 h_spin1
 s_branch h_ok
h_spinz:
s_spin:
 s_mov_b32 s4, 0
s_spin1:
 buffer_load_dword v19, v20, s[40:43], 0 offen sc1
 s_add_u32 s4, s4, 1
 s_waitcnt vmcnt(0)
 v_and_b32 v19, -1, v19
 v_cmp_gt_u32 vcc, s62, v19
 s_nop 0
 s_cmp_eq_u64 vcc, 0
 s_cbranch_scc1 s_ok
 s_cmp_lt_u32 s4, 0x40000
 s_cbranch_scc1 s_spin1
 s_branch s_ok
s_spinz:
ae_spin:
 s_mov_b32 s4, 0
ae_spin1:
 buffer_load_dword v19, v20, s[40:43], 0 offen sc1
 s_add_u32 s4, s4, 1
 s_waitcnt vmcnt(0)
 v_and_b32 v19, -1, v19
 v_cmp_gt_u32 vcc, s62, v19
 s_nop 0
 s_cmp_eq_u64 vcc, 0
 s_cbranch_scc1 ae_ok
 s_cmp_lt_u32 s4, 0x40000
 s_cbranch_scc1 ae_spin1
 s_branch ae_ok
ae_spinz:
be_spin:
 s_mov_b32 s4, 0
be_spin1:
 buffer_load_dword v19, v20, s[40:43], 0 offen sc1
 s_add_u32 s4, s4, 1
 s_waitcnt vmcnt(0)
 v_and_b32 v19, -1, v19
 v_cmp_gt_u32 vcc, s62, v19
 s_nop 0
 s_cmp_eq_u64 vcc, 0
 s_cbranch_scc1 be_ok
 s_cmp_lt_u32 s4, 0x40000
 s_cbranch_scc1 be_spin1
 s_branch be_ok
be_spinz:
de_spin:
 s_mov_b32 s4, 0
de_spin1:
 buffer_load_dword v19, v20, s[40:43], 0 offen sc1
 s_add_u32 s4, s4, 1
 s_waitcnt vmcnt(0)
 v_and_b32 v19, 255, v19
 v_cmp_gt_u32 vcc, s62, v19
 s_nop 0
 s_cmp_eq_u64 vcc, 0
 s_cbranch_scc1 de_ok
 s_cmp_lt_u32 s4, 0x40000
 s_cbranch_scc1 de_spin1
 s_branch de_ok
de_spinz:
ao_spin:
 s_mov_b32 s4, 0
ao_spin1:
 buffer_load_dword v19, v20, s[40:43], 0 offen sc1
 s_add_u32 s4, s4, 1
 s_waitcnt vmcnt(0)
 v_and_b32 v19, -1, v19
 v_cmp_gt_u32 vcc, s62, v19
 s_nop 0
 s_cmp_eq_u64 vcc, 0
 s_cbranch_scc1 ao_ok
 s_cmp_lt_u32 s4, 0x40000
 s_cbranch_scc1 ao_spin1
 s_branch ao_ok
ao_spinz:
bo_spin:
 s_mov_b32 s4, 0
bo_spin1:
 buffer_load_dword v19, v20, s[40:43], 0 offen sc1
 s_add_u32 s4, s4, 1
 s_waitcnt vmcnt(0)
 v_and_b32 v19, -1, v19
 v_cmp_gt_u32 vcc, s62, v19
 s_nop 0
 s_cmp_eq_u64 vcc, 0
 s_cbranch_scc1 bo_ok
 s_cmp_lt_u32 s4, 0x40000
 s_cbranch_scc1 bo_spin1
 s_branch bo_ok
bo_spinz:
do_spin:
 s_mov_b32 s4, 0
do_spin1:
 buffer_load_dword v19, v20, s[40:43], 0 offen sc1
 s_add_u32 s4, s4, 1
 s_waitcnt vmcnt(0)
 v_and_b32 v19, 255, v19
 v_cmp_gt_u32 vcc, s62, v19
 s_nop 0
 s_cmp_eq_u64 vcc, 0
 s_cbranch_scc1 do_ok
 s_cmp_lt_u32 s4, 0x40000
 s_cbranch_scc1 do_spin1
 s_branch do_ok
do_spinz:
fb_restart:
 s_mov_b32 s57, 1
 s_waitcnt vmcnt(0) lgkmcnt(0)
 s_barrier
 s_branch m_restart
fb_a:
 s_mov_b32 s57, 2
 s_mov_b32 s49, s47
 s_mov_b32 s56, 0
 s_waitcnt vmcnt(0) lgkmcnt(0)
 v_mov_b32 v32, 0xff800000
 v_mov_b32 v33, 0xff800000
 v_mov_b32 v34, 0xff800000
 v_mov_b32 v35, 0xff800000
fb_loop:
 s_barrier
 s_add_u32 m0, s47, 16384
 s_nop 0
 buffer_load_dwordx4 v1, s[8:11], s49 offen offset:0 lds
 buffer_load_dwordx4 v2, s[8:11], s49 offen offset:1024 lds
 buffer_load_dwordx4 v3, s[8:11], s49 offen offset:2048 lds
 buffer_load_dwordx4 v4, s[8:11], s49 offen offset:3072 lds
 s_add_u32 s49, s49, 16384
 s_waitcnt vmcnt(0)
 s_barrier
 ds_read_b128 a[128:131], v5 offset:0
 ds_read_b128 a[132:135], v6 offset:0
 ds_read_b128 a[136:139], v7 offset:0
 ds_read_b128 a[140:143], v8 offset:0
 s_waitcnt lgkmcnt(0)
 ds_read_b128 a[144:147], v5 offset:4096
 ds_read_b128 a[148:151], v6 offset:4096
 ds_read_b128 a[152:155], v7 offset:4096
 ds_read_b128 a[156:159], v8 offset:4096
 s_waitcnt lgkmcnt(0)
 ds_read_b128 a[160:163], v5 offset:8192
 ds_read_b128 a[164:167], v6 offset:8192
 ds_read_b128 a[168:171], v7 offset:8192
 ds_read_b128 a[172:175], v8 offset:8192
 s_waitcnt lgkmcnt(0)
 ds_read_b128 a[176:179], v5 offset:12288
 ds_read_b128 a[180:183], v6 offset:12288
 ds_read_b128 a[184:187], v7 offset:12288
 ds_read_b128 a[188:191], v8 offset:12288
 s_waitcnt lgkmcnt(0)
 v_mfma_f32_16x16x32_bf16 v[128:131], a[128:131], v[192:195], 0
 v_mfma_f32_16x16x32_bf16 v[128:131], a[132:135], v[208:211], v[128:131]
 v_mfma_f32_16x16x32_bf16 v[128:131], a[136:139], v[224:227], v[128:131]
 v_mfma_f32_16x16x32_bf16 v[128:131], a[140:143], v[240:243], v[128:131]
 v_mfma_f32_16x16x32_bf16 v[132:135], a[128:131], v[196:199], 0
 v_mfma_f32_16x16x32_bf16 v[132:135], a[132:135], v[212:215], v[132:135]
 v_mfma_f32_16x16x32_bf16 v[132:135], a[136:139], v[228:231], v[132:135]
 v_mfma_f32_16x16x32_bf16 v[132:135], a[140:143], v[244:247], v[132:135]
 v_mfma_f32_16x16x32_bf16 v[136:139], a[128:131], v[200:203], 0
 v_mfma_f32_16x16x32_bf16 v[136:139], a[132:135], v[216:219], v[136:139]
 v_mfma_f32_16x16x32_bf16 v[136:139], a[136:139], v[232:235], v[136:139]
 v_mfma_f32_16x16x32_bf16 v[136:139], a[140:143], v[248:251], v[136:139]
 v_mfma_f32_16x16x32_bf16 v[140:143], a[128:131], v[204:207], 0
 v_mfma_f32_16x16x32_bf16 v[140:143], a[132:135], v[220:223], v[140:143]
 v_mfma_f32_16x16x32_bf16 v[140:143], a[136:139], v[236:239], v[140:143]
 v_mfma_f32_16x16x32_bf16 v[140:143], a[140:143], v[252:255], v[140:143]
 v_mfma_f32_16x16x32_bf16 v[144:147], a[144:147], v[192:195], 0
 v_mfma_f32_16x16x32_bf16 v[144:147], a[148:151], v[208:211], v[144:147]
 v_mfma_f32_16x16x32_bf16 v[144:147], a[152:155], v[224:227], v[144:147]
 v_mfma_f32_16x16x32_bf16 v[144:147], a[156:159], v[240:243], v[144:147]
 v_mfma_f32_16x16x32_bf16 v[148:151], a[144:147], v[196:199], 0
 v_mfma_f32_16x16x32_bf16 v[148:151], a[148:151], v[212:215], v[148:151]
 v_mfma_f32_16x16x32_bf16 v[148:151], a[152:155], v[228:231], v[148:151]
 v_mfma_f32_16x16x32_bf16 v[148:151], a[156:159], v[244:247], v[148:151]
 v_mfma_f32_16x16x32_bf16 v[152:155], a[144:147], v[200:203], 0
 v_mfma_f32_16x16x32_bf16 v[152:155], a[148:151], v[216:219], v[152:155]
 v_mfma_f32_16x16x32_bf16 v[152:155], a[152:155], v[232:235], v[152:155]
 v_mfma_f32_16x16x32_bf16 v[152:155], a[156:159], v[248:251], v[152:155]
 v_mfma_f32_16x16x32_bf16 v[156:159], a[144:147], v[204:207], 0
 v_mfma_f32_16x16x32_bf16 v[156:159], a[148:151], v[220:223], v[156:159]
 v_mfma_f32_16x16x32_bf16 v[156:159], a[152:155], v[236:239], v[156:159]
 v_mfma_f32_16x16x32_bf16 v[156:159], a[156:159], v[252:255], v[156:159]
 v_mfma_f32_16x16x32_bf16 v[160:163], a[160:163], v[192:195], 0
 v_mfma_f32_16x16x32_bf16 v[160:163], a[164:167], v[208:211], v[160:163]
 v_mfma_f32_16x16x32_bf16 v[160:163], a[168:171], v[224:227], v[160:163]
 v_mfma_f32_16x16x32_bf16 v[160:163], a[172:175], v[240:243], v[160:163]
 v_mfma_f32_16x16x32_bf16 v[164:167], a[160:163], v[196:199], 0
 v_mfma_f32_16x16x32_bf16 v[164:167], a[164:167], v[212:215], v[164:167]
 v_mfma_f32_16x16x32_bf16 v[164:167], a[168:171], v[228:231], v[164:167]
 v_mfma_f32_16x16x32_bf16 v[164:167], a[172:175], v[244:247], v[164:167]
 v_mfma_f32_16x16x32_bf16 v[168:171], a[160:163], v[200:203], 0
 v_mfma_f32_16x16x32_bf16 v[168:171], a[164:167], v[216:219], v[168:171]
 v_mfma_f32_16x16x32_bf16 v[168:171], a[168:171], v[232:235], v[168:171]
 v_mfma_f32_16x16x32_bf16 v[168:171], a[172:175], v[248:251], v[168:171]
 v_mfma_f32_16x16x32_bf16 v[172:175], a[160:163], v[204:207], 0
 v_mfma_f32_16x16x32_bf16 v[172:175], a[164:167], v[220:223], v[172:175]
 v_mfma_f32_16x16x32_bf16 v[172:175], a[168:171], v[236:239], v[172:175]
 v_mfma_f32_16x16x32_bf16 v[172:175], a[172:175], v[252:255], v[172:175]
 v_mfma_f32_16x16x32_bf16 v[176:179], a[176:179], v[192:195], 0
 v_mfma_f32_16x16x32_bf16 v[176:179], a[180:183], v[208:211], v[176:179]
 v_mfma_f32_16x16x32_bf16 v[176:179], a[184:187], v[224:227], v[176:179]
 v_mfma_f32_16x16x32_bf16 v[176:179], a[188:191], v[240:243], v[176:179]
 v_mfma_f32_16x16x32_bf16 v[180:183], a[176:179], v[196:199], 0
 v_mfma_f32_16x16x32_bf16 v[180:183], a[180:183], v[212:215], v[180:183]
 v_mfma_f32_16x16x32_bf16 v[180:183], a[184:187], v[228:231], v[180:183]
 v_mfma_f32_16x16x32_bf16 v[180:183], a[188:191], v[244:247], v[180:183]
 v_mfma_f32_16x16x32_bf16 v[184:187], a[176:179], v[200:203], 0
 v_mfma_f32_16x16x32_bf16 v[184:187], a[180:183], v[216:219], v[184:187]
 v_mfma_f32_16x16x32_bf16 v[184:187], a[184:187], v[232:235], v[184:187]
 v_mfma_f32_16x16x32_bf16 v[184:187], a[188:191], v[248:251], v[184:187]
 v_mfma_f32_16x16x32_bf16 v[188:191], a[176:179], v[204:207], 0
 v_mfma_f32_16x16x32_bf16 v[188:191], a[180:183], v[220:223], v[188:191]
 v_mfma_f32_16x16x32_bf16 v[188:191], a[184:187], v[236:239], v[188:191]
 v_mfma_f32_16x16x32_bf16 v[188:191], a[188:191], v[252:255], v[188:191]
 v_max3_f32 v32, v32, v128, v129
 v_max3_f32 v32, v32, v130, v131
 v_max3_f32 v33, v33, v132, v133
 v_max3_f32 v33, v33, v134, v135
 v_max3_f32 v34, v34, v136, v137
 v_max3_f32 v34, v34, v138, v139
 v_max3_f32 v35, v35, v140, v141
 v_max3_f32 v35, v35, v142, v143
 v_max3_f32 v32, v32, v144, v145
 v_max3_f32 v32, v32, v146, v147
 v_max3_f32 v33, v33, v148, v149
 v_max3_f32 v33, v33, v150, v151
 v_max3_f32 v34, v34, v152, v153
 v_max3_f32 v34, v34, v154, v155
 v_max3_f32 v35, v35, v156, v157
 v_max3_f32 v35, v35, v158, v159
 v_max3_f32 v32, v32, v160, v161
 v_max3_f32 v32, v32, v162, v163
 v_max3_f32 v33, v33, v164, v165
 v_max3_f32 v33, v33, v166, v167
 v_max3_f32 v34, v34, v168, v169
 v_max3_f32 v34, v34, v170, v171
 v_max3_f32 v35, v35, v172, v173
 v_max3_f32 v35, v35, v174, v175
 v_max3_f32 v32, v32, v176, v177
 v_max3_f32 v32, v32, v178, v179
 v_max3_f32 v33, v33, v180, v181
 v_max3_f32 v33, v33, v182, v183
 v_max3_f32 v34, v34, v184, v185
 v_max3_f32 v34, v34, v186, v187
 v_max3_f32 v35, v35, v188, v189
 v_max3_f32 v35, v35, v190, v191
 s_add_u32 s56, s56, 1
 s_cmp_lt_u32 s56, 32
 s_cbranch_scc1 fb_loop
fb_b:
 v_mov_b32 v36, v32
 s_nop 1
 v_permlane32_swap_b32 v32, v36
 v_max_f32 v32, v32, v36
 v_mov_b32 v36, v32
 s_nop 1
 v_permlane16_swap_b32 v32, v36
 v_max_f32 v32, v32, v36
 v_sub_f32 v48, 0, v32
 v_sub_f32 v49, 0, v32
 v_sub_f32 v50, 0, v32
 v_sub_f32 v51, 0, v32
 v_mov_b32 v37, v33
 s_nop 1
 v_permlane32_swap_b32 v33, v37
 v_max_f32 v33, v33, v37
 v_mov_b32 v37, v33
 s_nop 1
 v_permlane16_swap_b32 v33, v37
 v_max_f32 v33, v33, v37
 v_sub_f32 v52, 0, v33
 v_sub_f32 v53, 0, v33
 v_sub_f32 v54, 0, v33
 v_sub_f32 v55, 0, v33
 v_mov_b32 v38, v34
 s_nop 1
 v_permlane32_swap_b32 v34, v38
 v_max_f32 v34, v34, v38
 v_mov_b32 v38, v34
 s_nop 1
 v_permlane16_swap_b32 v34, v38
 v_max_f32 v34, v34, v38
 v_sub_f32 v56, 0, v34
 v_sub_f32 v57, 0, v34
 v_sub_f32 v58, 0, v34
 v_sub_f32 v59, 0, v34
 v_mov_b32 v39, v35
 s_nop 1
 v_permlane32_swap_b32 v35, v39
 v_max_f32 v35, v35, v39
 v_mov_b32 v39, v35
 s_nop 1
 v_permlane16_swap_b32 v35, v39
 v_max_f32 v35, v35, v39
 v_sub_f32 v60, 0, v35
 v_sub_f32 v61, 0, v35
 v_sub_f32 v62, 0, v35
 v_sub_f32 v63, 0, v35
 v_mov_b32 v32, 0
 v_mov_b32 v33, 0
 v_mov_b32 v34, 0
 v_mov_b32 v35, 0
 v_mov_b32 v36, 0
 v_mov_b32 v37, 0
 v_mov_b32 v38, 0
 v_mov_b32 v39, 0
 v_mov_b32 v40, 0
 v_mov_b32 v41, 0
 v_mov_b32 v42, 0
 v_mov_b32 v43, 0
 v_mov_b32 v44, 0
 v_mov_b32 v45, 0
 v_mov_b32 v46, 0
 v_mov_b32 v47, 0
 s_mov_b32 s49, s47
 s_mov_b32 s50, s47
 s_barrier
 s_add_u32 m0, s47, 65536
 s_nop 0
 buffer_load_dwordx4 v1, s[8:11], s49 offen offset:0 lds
 buffer_load_dwordx4 v2, s[8:11], s49 offen offset:1024 lds
 buffer_load_dwordx4 v3, s[8:11], s49 offen offset:2048 lds
 buffer_load_dwordx4 v4, s[8:11], s49 offen offset:3072 lds
 s_add_u32 s49, s49, 16384
 s_add_u32 m0, s47, 147456
 s_nop 0
 buffer_load_dwordx4 v1, s[12:15], s50 offen offset:0 lds
 buffer_load_dwordx4 v2, s[12:15], s50 offen offset:1024 lds
 buffer_load_dwordx4 v3, s[12:15], s50 offen offset:2048 lds
 buffer_load_dwordx4 v4, s[12:15], s50 offen offset:3072 lds
 s_add_u32 s50, s50, 16384
 s_add_u32 m0, s47, 16384
 s_nop 0
 buffer_load_dwordx4 v1, s[8:11], s49 offen offset:0 lds
 buffer_load_dwordx4 v2, s[8:11], s49 offen offset:1024 lds
 buffer_load_dwordx4 v3, s[8:11], s49 offen offset:2048 lds
 buffer_load_dwordx4 v4, s[8:11], s49 offen offset:3072 lds
 s_add_u32 s49, s49, 16384
 s_add_u32 m0, s47, 98304
 s_nop 0
 buffer_load_dwordx4 v1, s[12:15], s50 offen offset:0 lds
 buffer_load_dwordx4 v2, s[12:15], s50 offen offset:1024 lds
 buffer_load_dwordx4 v3, s[12:15], s50 offen offset:2048 lds
 buffer_load_dwordx4 v4, s[12:15], s50 offen offset:3072 lds
 s_add_u32 s50, s50, 16384
 s_add_u32 m0, s47, 32768
 s_nop 0
 buffer_load_dwordx4 v1, s[8:11], s49 offen offset:0 lds
 buffer_load_dwordx4 v2, s[8:11], s49 offen offset:1024 lds
 buffer_load_dwordx4 v3, s[8:11], s49 offen offset:2048 lds
 buffer_load_dwordx4 v4, s[8:11], s49 offen offset:3072 lds
 s_add_u32 s49, s49, 16384
 s_add_u32 m0, s47, 114688
 s_nop 0
 buffer_load_dwordx4 v1, s[12:15], s50 offen offset:0 lds
 buffer_load_dwordx4 v2, s[12:15], s50 offen offset:1024 lds
 buffer_load_dwordx4 v3, s[12:15], s50 offen offset:2048 lds
 buffer_load_dwordx4 v4, s[12:15], s50 offen offset:3072 lds
 s_add_u32 s50, s50, 16384
 s_add_u32 m0, s47, 49152
 s_nop 0
 buffer_load_dwordx4 v1, s[8:11], s49 offen offset:0 lds
 buffer_load_dwordx4 v2, s[8:11], s49 offen offset:1024 lds
 buffer_load_dwordx4 v3, s[8:11], s49 offen offset:2048 lds
 buffer_load_dwordx4 v4, s[8:11], s49 offen offset:3072 lds
 s_add_u32 s49, s49, 16384
 s_add_u32 m0, s47, 131072
 s_nop 0
 buffer_load_dwordx4 v1, s[12:15], s50 offen offset:0 lds
 buffer_load_dwordx4 v2, s[12:15], s50 offen offset:1024 lds
 buffer_load_dwordx4 v3, s[12:15], s50 offen offset:2048 lds
 buffer_load_dwordx4 v4, s[12:15], s50 offen offset:3072 lds
 s_add_u32 s50, s50, 16384
 s_waitcnt vmcnt(0)
 s_barrier
 ds_read_b128 a[128:131], v5 offset:49152
 ds_read_b128 a[132:135], v6 offset:49152
 ds_read_b128 a[136:139], v7 offset:49152
 ds_read_b128 a[140:143], v8 offset:49152
 ds_read_b128 a[144:147], v5 offset:53248
 ds_read_b128 a[148:151], v6 offset:53248
 ds_read_b128 a[152:155], v7 offset:53248
 ds_read_b128 a[156:159], v8 offset:53248
 s_waitcnt lgkmcnt(0)
 s_branch mq_att
fb_z:
mq_pre:
 s_add_u32 m0, s47, 16384
 s_nop 0
 buffer_load_dwordx4 v19, s[16:19], s51 offen offset:0 lds
 buffer_load_dwordx4 v20, s[16:19], s51 offen offset:1024 lds
 buffer_load_dwordx4 v21, s[16:19], s51 offen offset:2048 lds
 buffer_load_dwordx4 v22, s[16:19], s51 offen offset:3072 lds
 s_add_u32 s51, s51, 524288
 v_lshrrev_b32 v131, 2, v128
 v_lshlrev_b32 v131, 9, v131
 v_and_b32 v132, 1, v128
 v_lshl_add_u32 v131, v132, 8, v131
 v_bfe_u32 v132, v128, 1, 1
 v_lshl_add_u32 v131, v132, 3, v131
 v_lshl_add_u32 v131, v129, 4, v131
 s_lshl_b32 s3, s44, 5
 v_add_u32 v131, s3, v131
 v_add_u32 v132, s48, v18
 v_lshrrev_b32 v133, 3, v46
 v_lshlrev_b32 v133, 8, v133
 v_and_b32 v130, 7, v46
 v_lshl_add_u32 v133, v130, 4, v133
 s_lshl_b32 s3, s46, 4
 s_lshr_b32 s4, s45, 1
 s_add_u32 s3, s3, s4
 s_lshl_b32 s3, s3, 14
 s_add_u32 s3, s3, s47
 s_and_b32 s4, s45, 1
 s_lshl_b32 s4, s4, 7
 s_add_u32 s3, s3, s4
 s_add_u32 s12, s86, 42467328
 s_addc_u32 s13, s87, 0
 s_mov_b32 s14, 8192
 s_mov_b32 s15, 0x00020000
 s_lshl_b32 s4, s44, 16
 s_mul_i32 s5, s46, 1024
 s_add_u32 s89, s4, s5
 s_mul_i32 s4, s45, 32
 s_add_u32 s88, s89, s4
 v_mov_b32 v161, 128
 s_waitcnt vmcnt(5)
 v_lshlrev_b32 v144, 16, v136
 v_and_b32 v145, 0xffff0000, v136
 v_lshlrev_b32 v146, 16, v137
 v_and_b32 v147, 0xffff0000, v137
 v_lshlrev_b32 v148, 16, v138
 v_and_b32 v149, 0xffff0000, v138
 v_lshlrev_b32 v150, 16, v139
 v_and_b32 v151, 0xffff0000, v139
 v_lshlrev_b32 v152, 16, v140
 v_and_b32 v153, 0xffff0000, v140
 v_lshlrev_b32 v154, 16, v141
 v_and_b32 v155, 0xffff0000, v141
 v_lshlrev_b32 v156, 16, v142
 v_and_b32 v157, 0xffff0000, v142
 v_lshlrev_b32 v158, 16, v143
 v_and_b32 v159, 0xffff0000, v143
 v_pk_add_f32 v[168:169], v[144:145], v[146:147]
 v_pk_add_f32 v[170:171], v[148:149], v[150:151]
 v_pk_add_f32 v[172:173], v[152:153], v[154:155]
 v_pk_add_f32 v[174:175], v[156:157], v[158:159]
 v_pk_add_f32 v[168:169], v[168:169], v[170:171]
 v_pk_add_f32 v[172:173], v[172:173], v[174:175]
 v_pk_add_f32 v[134:135], v[168:169], v[172:173]
 v_add_f32 v134, v134, v135
 s_nop 1
 v_add_f32_dpp v134, v134, v134 quad_perm:[1,0,3,2] row_mask:0xf bank_mask:0xf
 s_nop 1
 v_add_f32_dpp v134, v134, v134 quad_perm:[2,3,0,1] row_mask:0xf bank_mask:0xf
 s_nop 1
 v_add_f32_dpp v134, v134, v134 row_half_mirror row_mask:0xf bank_mask:0xf
 s_nop 1
 v_add_f32_dpp v134, v134, v134 row_mirror row_mask:0xf bank_mask:0xf
 v_mov_b32 v135, v134
 s_nop 1
 v_permlane16_swap_b32 v134, v135
 v_add_f32 v134, v134, v135
 v_mul_f32 v134, 0xbb000000, v134
 v_pk_add_f32 v[144:145], v[144:145], v[134:135] op_sel_hi:[1,0]
 v_pk_add_f32 v[146:147], v[146:147], v[134:135] op_sel_hi:[1,0]
 v_pk_add_f32 v[148:149], v[148:149], v[134:135] op_sel_hi:[1,0]
 v_pk_add_f32 v[150:151], v[150:151], v[134:135] op_sel_hi:[1,0]
 v_pk_add_f32 v[152:153], v[152:153], v[134:135] op_sel_hi:[1,0]
 v_pk_add_f32 v[154:155], v[154:155], v[134:135] op_sel_hi:[1,0]
 v_pk_add_f32 v[156:157], v[156:157], v[134:135] op_sel_hi:[1,0]
 v_pk_add_f32 v[158:159], v[158:159], v[134:135] op_sel_hi:[1,0]
 v_pk_mul_f32 v[168:169], v[144:145], v[144:145]
 v_pk_mul_f32 v[170:171], v[146:147], v[146:147]
 v_pk_mul_f32 v[172:173], v[148:149], v[148:149]
 v_pk_mul_f32 v[174:175], v[150:151], v[150:151]
 v_pk_fma_f32 v[168:169], v[152:153], v[152:153], v[168:169]
 v_pk_fma_f32 v[170:171], v[154:155], v[154:155], v[170:171]
 v_pk_fma_f32 v[172:173], v[156:157], v[156:157], v[172:173]
 v_pk_fma_f32 v[174:175], v[158:159], v[158:159], v[174:175]
 v_pk_add_f32 v[168:169], v[168:169], v[170:171]
 v_pk_add_f32 v[172:173], v[172:173], v[174:175]
 v_pk_add_f32 v[134:135], v[168:169], v[172:173]
 v_add_f32 v134, v134, v135
 s_nop 1
 v_add_f32_dpp v134, v134, v134 quad_perm:[1,0,3,2] row_mask:0xf bank_mask:0xf
 s_nop 1
 v_add_f32_dpp v134, v134, v134 quad_perm:[2,3,0,1] row_mask:0xf bank_mask:0xf
 s_nop 1
 v_add_f32_dpp v134, v134, v134 row_half_mirror row_mask:0xf bank_mask:0xf
 s_nop 1
 v_add_f32_dpp v134, v134, v134 row_mirror row_mask:0xf bank_mask:0xf
 v_mov_b32 v135, v134
 s_nop 1
 v_permlane16_swap_b32 v134, v135
 v_add_f32 v134, v134, v135
 v_mov_b32 v135, 0x3727c5ac
 v_fmac_f32 v135, 0x3b000000, v134
 v_rsq_f32 v135, v135
 s_nop 0
 v_mul_f32 v134, 0x3e0293ee, v135
 v_pk_mul_f32 v[144:145], v[144:145], v[134:135] op_sel_hi:[1,0]
 v_pk_mul_f32 v[146:147], v[146:147], v[134:135] op_sel_hi:[1,0]
 v_pk_mul_f32 v[148:149], v[148:149], v[134:135] op_sel_hi:[1,0]
 v_pk_mul_f32 v[150:151], v[150:151], v[134:135] op_sel_hi:[1,0]
 v_pk_mul_f32 v[152:153], v[152:153], v[134:135] op_sel_hi:[1,0]
 v_pk_mul_f32 v[154:155], v[154:155], v[134:135] op_sel_hi:[1,0]
 v_pk_mul_f32 v[156:157], v[156:157], v[134:135] op_sel_hi:[1,0]
 v_pk_mul_f32 v[158:159], v[158:159], v[134:135] op_sel_hi:[1,0]
 v_cvt_pk_bf16_f32 v136, v144, v145
 v_cvt_pk_bf16_f32 v137, v146, v147
 v_cvt_pk_bf16_f32 v138, v148, v149
 v_cvt_pk_bf16_f32 v139, v150, v151
 v_cvt_pk_bf16_f32 v140, v152, v153
 v_cvt_pk_bf16_f32 v141, v154, v155
 v_cvt_pk_bf16_f32 v142, v156, v157
 v_cvt_pk_bf16_f32 v143, v158, v159
 ds_write_b64 v131, v[136:137] offset:0
 ds_write_b64 v131, v[138:139] offset:128
 ds_write_b64 v131, v[140:141] offset:4096
 ds_write_b64 v131, v[142:143] offset:4224
 s_waitcnt lgkmcnt(0)
 s_barrier
 ds_read_b128 v[136:139], v132
 ds_read_b128 v[140:143], v132 offset:1024
 s_waitcnt lgkmcnt(0)
 buffer_store_dwordx4 v[136:139], v133, s[28:31], s3 offen offset:0 sc1
 buffer_store_dwordx4 v[140:143], v133, s[28:31], s3 offen offset:2048 sc1
 buffer_load_dwordx2 a[128:129], v161, s[92:95], 0 offen sc1
 v_lshlrev_b32 v160, 12, v18
 s_mov_b32 s4, 0
 s_waitcnt vmcnt(0)
 v_accvgpr_read_b32 v164, a128
 v_accvgpr_read_b32 v165, a129
mq_nonce:
 v_readfirstlane_b32 s100, v164
 v_readfirstlane_b32 s101, v165
 s_add_u32 s4, s4, 1
 s_cmp_ge_u32 s4, 0x40000
 s_cbranch_scc1 mq_go
 s_cmp_lg_u32 s100, 0
 s_cbranch_scc1 mq_go
mq_n1:
 buffer_load_dwordx2 v[164:165], v161, s[92:95], 0 offen sc1
 s_waitcnt vmcnt(0)
 s_branch mq_nonce
mq_go:
 s_barrier
 buffer_store_dwordx2 v[164:165], v160, s[12:15], s88 offen sc1
 s_add_u32 m0, s47, 32768
 s_nop 0
 buffer_load_dwordx4 v19, s[16:19], s51 offen offset:0 lds
 buffer_load_dwordx4 v20, s[16:19], s51 offen offset:1024 lds
 buffer_load_dwordx4 v21, s[16:19], s51 offen offset:2048 lds
 buffer_load_dwordx4 v22, s[16:19], s51 offen offset:3072 lds
 s_add_u32 s51, s51, 524288
 s_mov_b32 s49, s47
 s_mov_b32 s50, s47
 s_add_u32 s32, s86, 4194304
 s_addc_u32 s33, s87, 0
 s_mov_b32 s34, 7340032
 s_mov_b32 s35, 0x00020000
 s_add_u32 s36, s86, 16777216
 s_addc_u32 s37, s87, 0
 s_mov_b32 s38, 16777216
 s_mov_b32 s39, 0x00020000
 s_add_u32 s40, s86, 41943040
 s_addc_u32 s41, s87, 0
 s_mov_b32 s42, 83968
 s_mov_b32 s43, 0x00020000
 s_mov_b32 s54, s47
 s_add_u32 s55, s48, 81920
 v_and_b32 v39, 7, v38
 v_lshlrev_b32 v39, 1, v39
 v_lshrrev_b32 v40, 3, v38
 v_mul_u32_u24 v40, 9, v40
 v_xor_b32 v39, v39, v40
 v_xor_b32 v39, v39, v37
 v_lshlrev_b32 v40, 8, v38
 v_add_u32 v40, 16384, v40
 v_xor_b32 v41, 0, v39
 v_lshl_add_u32 v5, v41, 4, v40
 v_xor_b32 v41, 4, v39
 v_lshl_add_u32 v6, v41, 4, v40
 v_xor_b32 v41, 8, v39
 v_lshl_add_u32 v7, v41, 4, v40
 v_xor_b32 v41, 12, v39
 v_lshl_add_u32 v8, v41, 4, v40
 v_lshrrev_b32 v39, 2, v46
 v_and_b32 v40, 7, v39
 v_lshlrev_b32 v40, 1, v40
 v_lshrrev_b32 v41, 3, v39
 v_mul_u32_u24 v41, 9, v41
 v_xor_b32 v40, v40, v41
 v_and_b32 v41, 3, v46
 v_xor_b32 v42, v40, v41
 v_lshlrev_b32 v43, 8, v39
 v_xor_b32 v44, 0, v42
 v_lshl_add_u32 v29, v44, 4, v43
 v_xor_b32 v44, 4, v42
 v_lshl_add_u32 v30, v44, 4, v43
 v_xor_b32 v44, 8, v42
 v_lshl_add_u32 v31, v44, 4, v43
 v_xor_b32 v44, 12, v42
 v_lshl_add_u32 v32, v44, 4, v43
 v_bfe_u32 v41, v46, 1, 1
 v_xor_b32 v42, v40, v41
 v_and_b32 v44, 1, v46
 v_lshl_add_u32 v43, v44, 3, v43
 v_add_u32 v43, 98304, v43
 v_xor_b32 v45, 0, v42
 v_lshl_add_u32 v9, v45, 4, v43
 v_xor_b32 v45, 2, v42
 v_lshl_add_u32 v10, v45, 4, v43
 v_xor_b32 v45, 4, v42
 v_lshl_add_u32 v11, v45, 4, v43
 v_xor_b32 v45, 6, v42
 v_lshl_add_u32 v12, v45, 4, v43
 v_xor_b32 v45, 8, v42
 v_lshl_add_u32 v13, v45, 4, v43
 v_xor_b32 v45, 10, v42
 v_lshl_add_u32 v14, v45, 4, v43
 v_xor_b32 v45, 12, v42
 v_lshl_add_u32 v15, v45, 4, v43
 v_xor_b32 v45, 14, v42
 v_lshl_add_u32 v16, v45, 4, v43
 v_mov_b32 v41, 0xaaaaaaaa
 v_mul_lo_u32 v40, v44, v41
 v_add_u32 v17, 0x44444444, v40
 v_mov_b32 v41, 0x3f803f80
 v_cmp_gt_u32 vcc, 2, v38
 s_nop 1
 v_cndmask_b32 v41, 0, v41, vcc
 v_accvgpr_write_b32 a224, v41
 v_accvgpr_write_b32 a225, v41
 v_accvgpr_write_b32 a226, v41
 v_accvgpr_write_b32 a227, v41
 v_mov_b32 v48, 0
 v_mov_b32 v49, 0
 v_mov_b32 v50, 0
 v_mov_b32 v51, 0
 v_mov_b32 v52, 0
 v_mov_b32 v53, 0
 v_mov_b32 v54, 0
 v_mov_b32 v55, 0
 v_mov_b32 v56, 0
 v_mov_b32 v57, 0
 v_mov_b32 v58, 0
 v_mov_b32 v59, 0
 v_mov_b32 v60, 0
 v_mov_b32 v61, 0
 v_mov_b32 v62, 0
 v_mov_b32 v63, 0
 v_pk_mov_b32 v[128:129], v[48:49], v[48:49]
 v_pk_mov_b32 v[130:131], v[48:49], v[48:49]
 v_pk_mov_b32 v[132:133], v[48:49], v[48:49]
 v_pk_mov_b32 v[134:135], v[48:49], v[48:49]
 v_pk_mov_b32 v[136:137], v[48:49], v[48:49]
 v_pk_mov_b32 v[138:139], v[48:49], v[48:49]
 v_pk_mov_b32 v[140:141], v[48:49], v[48:49]
 v_pk_mov_b32 v[142:143], v[48:49], v[48:49]
 v_pk_mov_b32 v[144:145], v[48:49], v[48:49]
 v_pk_mov_b32 v[146:147], v[48:49], v[48:49]
 v_pk_mov_b32 v[148:149], v[48:49], v[48:49]
 v_pk_mov_b32 v[150:151], v[48:49], v[48:49]
 v_pk_mov_b32 v[152:153], v[48:49], v[48:49]
 v_pk_mov_b32 v[154:155], v[48:49], v[48:49]
 v_pk_mov_b32 v[156:157], v[48:49], v[48:49]
 v_pk_mov_b32 v[158:159], v[48:49], v[48:49]
 v_pk_mov_b32 v[160:161], v[48:49], v[48:49]
 v_pk_mov_b32 v[162:163], v[48:49], v[48:49]
 v_pk_mov_b32 v[164:165], v[48:49], v[48:49]
 v_pk_mov_b32 v[166:167], v[48:49], v[48:49]
 v_pk_mov_b32 v[168:169], v[48:49], v[48:49]
 v_pk_mov_b32 v[170:171], v[48:49], v[48:49]
 v_pk_mov_b32 v[172:173], v[48:49], v[48:49]
 v_pk_mov_b32 v[174:175], v[48:49], v[48:49]
 v_pk_mov_b32 v[176:177], v[48:49], v[48:49]
 v_pk_mov_b32 v[178:179], v[48:49], v[48:49]
 v_pk_mov_b32 v[180:181], v[48:49], v[48:49]
 v_pk_mov_b32 v[182:183], v[48:49], v[48:49]
 v_pk_mov_b32 v[184:185], v[48:49], v[48:49]
 v_pk_mov_b32 v[186:187], v[48:49], v[48:49]
 v_pk_mov_b32 v[188:189], v[48:49], v[48:49]
 v_pk_mov_b32 v[190:191], v[48:49], v[48:49]
 v_pk_mov_b32 v[192:193], v[48:49], v[48:49]
 v_pk_mov_b32 v[194:195], v[48:49], v[48:49]
 v_pk_mov_b32 v[196:197], v[48:49], v[48:49]
 v_pk_mov_b32 v[198:199], v[48:49], v[48:49]
 v_pk_mov_b32 v[200:201], v[48:49], v[48:49]
 v_pk_mov_b32 v[202:203], v[48:49], v[48:49]
 v_pk_mov_b32 v[204:205], v[48:49], v[48:49]
 v_pk_mov_b32 v[206:207], v[48:49], v[48:49]
 v_pk_mov_b32 v[208:209], v[48:49], v[48:49]
 v_pk_mov_b32 v[210:211], v[48:49], v[48:49]
 v_pk_mov_b32 v[212:213], v[48:49], v[48:49]
 v_pk_mov_b32 v[214:215], v[48:49], v[48:49]
 v_pk_mov_b32 v[216:217], v[48:49], v[48:49]
 v_pk_mov_b32 v[218:219], v[48:49], v[48:49]
 v_pk_mov_b32 v[220:221], v[48:49], v[48:49]
 v_pk_mov_b32 v[222:223], v[48:49], v[48:49]
 v_pk_mov_b32 v[224:225], v[48:49], v[48:49]
 v_pk_mov_b32 v[226:227], v[48:49], v[48:49]
 v_pk_mov_b32 v[228:229], v[48:49], v[48:49]
 v_pk_mov_b32 v[230:231], v[48:49], v[48:49]
 v_pk_mov_b32 v[232:233], v[48:49], v[48:49]
 v_pk_mov_b32 v[234:235], v[48:49], v[48:49]
 v_pk_mov_b32 v[236:237], v[48:49], v[48:49]
 v_pk_mov_b32 v[238:239], v[48:49], v[48:49]
 v_pk_mov_b32 v[240:241], v[48:49], v[48:49]
 v_pk_mov_b32 v[242:243], v[48:49], v[48:49]
 v_pk_mov_b32 v[244:245], v[48:49], v[48:49]
 v_pk_mov_b32 v[246:247], v[48:49], v[48:49]
 v_pk_mov_b32 v[248:249], v[48:49], v[48:49]
 v_pk_mov_b32 v[250:251], v[48:49], v[48:49]
 v_pk_mov_b32 v[252:253], v[48:49], v[48:49]
 v_pk_mov_b32 v[254:255], v[48:49], v[48:49]
 v_bfe_u32 v40, v18, 4, 5
 v_mul_u32_u24 v40, 32, v40
 s_mov_b32 s4, 0
 s_cmp_lg_u32 s44, 0
 s_cbranch_scc1 mq_seen
mq_poll:
 buffer_load_dwordx2 v[38:39], v40, s[12:15], s89 offen sc1
 s_add_u32 s4, s4, 1
 s_cmp_ge_u32 s4, 0x40000
 s_waitcnt vmcnt(0)
 s_cbranch_scc1 mq_seen
 v_cmp_ne_u64 vcc, s[100:101], v[38:39]
 s_nop 0
 s_cbranch_vccnz mq_poll
mq_seen:
 s_barrier
 s_lshl_b32 s3, s45, 19
 s_add_u32 s8, s66, s3
 s_addc_u32 s9, s67, 0
 s_mov_b32 s10, 524288
 s_mov_b32 s11, 0x00020000
 s_add_u32 s12, s68, s3
 s_addc_u32 s13, s69, 0
 s_mov_b32 s14, 524288
 s_mov_b32 s15, 0x00020000
 buffer_load_dwordx4 a[0:3], v25, s[28:31], s53 offen offset:0 sc1
 buffer_load_dwordx4 a[4:7], v25, s[28:31], s53 offen offset:1024 sc1
 buffer_load_dwordx4 a[8:11], v26, s[28:31], s53 offen offset:0 sc1
 buffer_load_dwordx4 a[12:15], v26, s[28:31], s53 offen offset:1024 sc1
 buffer_load_dwordx4 a[16:19], v27, s[28:31], s53 offen offset:0 sc1
 buffer_load_dwordx4 a[20:23], v27, s[28:31], s53 offen offset:1024 sc1
 buffer_load_dwordx4 a[24:27], v28, s[28:31], s53 offen offset:0 sc1
 buffer_load_dwordx4 a[28:31], v28, s[28:31], s53 offen offset:1024 sc1
 s_add_u32 s53, s53, 2048
 s_add_u32 m0, s47, 49152
 s_nop 0
 buffer_load_dwordx4 v19, s[16:19], s51 offen offset:0 lds
 buffer_load_dwordx4 v20, s[16:19], s51 offen offset:1024 lds
 buffer_load_dwordx4 v21, s[16:19], s51 offen offset:2048 lds
 buffer_load_dwordx4 v22, s[16:19], s51 offen offset:3072 lds
 s_add_u32 s51, s51, 524288
 ds_read_b64_tr_b16 a[192:193], v29 offset:16384
 ds_read_b64_tr_b16 a[194:195], v29 offset:20480
 ds_read_b64_tr_b16 a[196:197], v29 offset:24576
 ds_read_b64_tr_b16 a[198:199], v29 offset:28672
 ds_read_b64_tr_b16 a[200:201], v29 offset:16392
 ds_read_b64_tr_b16 a[202:203], v29 offset:20488
 ds_read_b64_tr_b16 a[204:205], v29 offset:24584
 ds_read_b64_tr_b16 a[206:207], v29 offset:28680
 s_mov_b32 s56, 0
 s_waitcnt lgkmcnt(4)
 s_waitcnt vmcnt(4)
.p2align 3
mq_loop:
mq_loop_:
 v_mfma_f32_16x16x32_bf16 v[192:195], a[192:195], a[0:3], v[192:195]
 ds_read_b64_tr_b16 a[208:209], v30 offset:16384
 ds_read_b64_tr_b16 a[210:211], v30 offset:20480
 v_mfma_f32_16x16x32_bf16 v[192:195], a[196:199], a[4:7], v[192:195]
 buffer_load_dwordx4 a[32:35], v25, s[28:31], s53 offen offset:0 sc1
 v_mfma_f32_16x16x32_bf16 v[196:199], a[196:199], a[12:15], v[196:199]
 ds_read_b64_tr_b16 a[212:213], v30 offset:24576
 ds_read_b64_tr_b16 a[214:215], v30 offset:28672
 v_mfma_f32_16x16x32_bf16 v[196:199], a[192:195], a[8:11], v[196:199]
 v_xor_b32 v29, 0x8000, v29
 v_mfma_f32_16x16x32_bf16 v[200:203], a[192:195], a[16:19], v[200:203]
 buffer_load_dwordx4 a[36:39], v25, s[28:31], s53 offen offset:1024 sc1
 v_mfma_f32_16x16x32_bf16 v[200:203], a[196:199], a[20:23], v[200:203]
 v_mfma_f32_16x16x32_bf16 v[204:207], a[196:199], a[28:31], v[204:207]
 buffer_load_dwordx4 a[40:43], v26, s[28:31], s53 offen offset:0 sc1
 v_mfma_f32_16x16x32_bf16 v[204:207], a[192:195], a[24:27], v[204:207]
 s_waitcnt lgkmcnt(4)
 v_mfma_f32_16x16x32_bf16 v[140:143], a[200:203], a[24:27], v[140:143]
 ds_read_b64_tr_b16 a[216:217], v30 offset:16392
 ds_read_b64_tr_b16 a[218:219], v30 offset:20488
 v_mfma_f32_16x16x32_bf16 v[140:143], a[204:207], a[28:31], v[140:143]
 buffer_load_dwordx4 a[44:47], v26, s[28:31], s53 offen offset:1024 sc1
 v_mfma_f32_16x16x32_bf16 v[136:139], a[204:207], a[20:23], v[136:139]
 ds_read_b64_tr_b16 a[220:221], v30 offset:24584
 ds_read_b64_tr_b16 a[222:223], v30 offset:28680
 v_mfma_f32_16x16x32_bf16 v[136:139], a[200:203], a[16:19], v[136:139]
 v_xor_b32 v30, 0x8000, v30
 v_mfma_f32_16x16x32_bf16 v[132:135], a[200:203], a[8:11], v[132:135]
 buffer_load_dwordx4 a[48:51], v27, s[28:31], s53 offen offset:0 sc1
 v_mfma_f32_16x16x32_bf16 v[132:135], a[204:207], a[12:15], v[132:135]
 v_mfma_f32_16x16x32_bf16 v[128:131], a[204:207], a[4:7], v[128:131]
 buffer_load_dwordx4 a[52:55], v27, s[28:31], s53 offen offset:1024 sc1
 v_mfma_f32_16x16x32_bf16 v[128:131], a[200:203], a[0:3], v[128:131]
 s_waitcnt lgkmcnt(4)
 v_mfma_f32_16x16x32_bf16 v[208:211], a[208:211], a[0:3], v[208:211]
 ds_read_b64_tr_b16 a[192:193], v31 offset:16384
 ds_read_b64_tr_b16 a[194:195], v31 offset:20480
 v_mfma_f32_16x16x32_bf16 v[208:211], a[212:215], a[4:7], v[208:211]
 buffer_load_dwordx4 a[56:59], v28, s[28:31], s53 offen offset:0 sc1
 v_mfma_f32_16x16x32_bf16 v[212:215], a[212:215], a[12:15], v[212:215]
 ds_read_b64_tr_b16 a[196:197], v31 offset:24576
 ds_read_b64_tr_b16 a[198:199], v31 offset:28672
 v_mfma_f32_16x16x32_bf16 v[212:215], a[208:211], a[8:11], v[212:215]
 v_mfma_f32_16x16x32_bf16 v[216:219], a[208:211], a[16:19], v[216:219]
 buffer_load_dwordx4 a[60:63], v28, s[28:31], s53 offen offset:1024 sc1
 v_mfma_f32_16x16x32_bf16 v[216:219], a[212:215], a[20:23], v[216:219]
 s_add_u32 s53, s53, 2048
 v_mfma_f32_16x16x32_bf16 v[220:223], a[212:215], a[28:31], v[220:223]
 v_mfma_f32_16x16x32_bf16 v[220:223], a[208:211], a[24:27], v[220:223]
 s_waitcnt lgkmcnt(4)
 v_mfma_f32_16x16x32_bf16 v[156:159], a[216:219], a[24:27], v[156:159]
 ds_read_b64_tr_b16 a[200:201], v31 offset:16392
 ds_read_b64_tr_b16 a[202:203], v31 offset:20488
 v_mfma_f32_16x16x32_bf16 v[156:159], a[220:223], a[28:31], v[156:159]
 v_mfma_f32_16x16x32_bf16 v[152:155], a[220:223], a[20:23], v[152:155]
 ds_read_b64_tr_b16 a[204:205], v31 offset:24584
 ds_read_b64_tr_b16 a[206:207], v31 offset:28680
 v_mfma_f32_16x16x32_bf16 v[152:155], a[216:219], a[16:19], v[152:155]
 v_xor_b32 v31, 0x8000, v31
 v_mfma_f32_16x16x32_bf16 v[148:151], a[216:219], a[8:11], v[148:151]
 v_mfma_f32_16x16x32_bf16 v[148:151], a[220:223], a[12:15], v[148:151]
 v_mfma_f32_16x16x32_bf16 v[144:147], a[220:223], a[4:7], v[144:147]
 v_mfma_f32_16x16x32_bf16 v[144:147], a[216:219], a[0:3], v[144:147]
 s_waitcnt lgkmcnt(4)
 v_mfma_f32_16x16x32_bf16 v[224:227], a[192:195], a[0:3], v[224:227]
 s_barrier
 ds_read_b64_tr_b16 a[208:209], v32 offset:16384
 ds_read_b64_tr_b16 a[210:211], v32 offset:20480
 v_mfma_f32_16x16x32_bf16 v[224:227], a[196:199], a[4:7], v[224:227]
 v_mfma_f32_16x16x32_bf16 v[228:231], a[196:199], a[12:15], v[228:231]
 ds_read_b64_tr_b16 a[212:213], v32 offset:24576
 ds_read_b64_tr_b16 a[214:215], v32 offset:28672
 v_mfma_f32_16x16x32_bf16 v[228:231], a[192:195], a[8:11], v[228:231]
 s_mov_b32 m0, s54
 v_mfma_f32_16x16x32_bf16 v[232:235], a[192:195], a[16:19], v[232:235]
 buffer_load_dwordx4 v19, s[16:19], s51 offen offset:0 lds
 v_mfma_f32_16x16x32_bf16 v[232:235], a[196:199], a[20:23], v[232:235]
 v_mfma_f32_16x16x32_bf16 v[236:239], a[196:199], a[28:31], v[236:239]
 v_mfma_f32_16x16x32_bf16 v[236:239], a[192:195], a[24:27], v[236:239]
 s_waitcnt lgkmcnt(4)
 v_mfma_f32_16x16x32_bf16 v[172:175], a[200:203], a[24:27], v[172:175]
 ds_read_b64_tr_b16 a[216:217], v32 offset:16392
 ds_read_b64_tr_b16 a[218:219], v32 offset:20488
 v_mfma_f32_16x16x32_bf16 v[172:175], a[204:207], a[28:31], v[172:175]
 buffer_load_dwordx4 v20, s[16:19], s51 offen offset:1024 lds
 v_mfma_f32_16x16x32_bf16 v[168:171], a[204:207], a[20:23], v[168:171]
 ds_read_b64_tr_b16 a[220:221], v32 offset:24584
 ds_read_b64_tr_b16 a[222:223], v32 offset:28680
 v_mfma_f32_16x16x32_bf16 v[168:171], a[200:203], a[16:19], v[168:171]
 v_xor_b32 v32, 0x8000, v32
 v_mfma_f32_16x16x32_bf16 v[164:167], a[200:203], a[8:11], v[164:167]
 v_mfma_f32_16x16x32_bf16 v[164:167], a[204:207], a[12:15], v[164:167]
 v_mfma_f32_16x16x32_bf16 v[160:163], a[204:207], a[4:7], v[160:163]
 buffer_load_dwordx4 v21, s[16:19], s51 offen offset:2048 lds
 v_mfma_f32_16x16x32_bf16 v[160:163], a[200:203], a[0:3], v[160:163]
 s_waitcnt lgkmcnt(4)
 v_mfma_f32_16x16x32_bf16 v[240:243], a[208:211], a[0:3], v[240:243]
 ds_read_b64_tr_b16 a[192:193], v29 offset:0
 ds_read_b64_tr_b16 a[194:195], v29 offset:4096
 v_mfma_f32_16x16x32_bf16 v[240:243], a[212:215], a[4:7], v[240:243]
 v_mfma_f32_16x16x32_bf16 v[244:247], a[212:215], a[12:15], v[244:247]
 ds_read_b64_tr_b16 a[196:197], v29 offset:8192
 ds_read_b64_tr_b16 a[198:199], v29 offset:12288
 v_mfma_f32_16x16x32_bf16 v[244:247], a[208:211], a[8:11], v[244:247]
 v_mfma_f32_16x16x32_bf16 v[248:251], a[208:211], a[16:19], v[248:251]
 buffer_load_dwordx4 v22, s[16:19], s51 offen offset:3072 lds
 v_mfma_f32_16x16x32_bf16 v[248:251], a[212:215], a[20:23], v[248:251]
 s_add_u32 s51, s51, 524288
 s_add_u32 s54, s54, 16384
 s_and_b32 s54, s54, 0xffff
 v_mfma_f32_16x16x32_bf16 v[252:255], a[212:215], a[28:31], v[252:255]
 v_mfma_f32_16x16x32_bf16 v[252:255], a[208:211], a[24:27], v[252:255]
 s_waitcnt lgkmcnt(4)
 v_mfma_f32_16x16x32_bf16 v[188:191], a[216:219], a[24:27], v[188:191]
 ds_read_b64_tr_b16 a[200:201], v29 offset:8
 ds_read_b64_tr_b16 a[202:203], v29 offset:4104
 v_mfma_f32_16x16x32_bf16 v[188:191], a[220:223], a[28:31], v[188:191]
 v_mfma_f32_16x16x32_bf16 v[184:187], a[220:223], a[20:23], v[184:187]
 ds_read_b64_tr_b16 a[204:205], v29 offset:8200
 ds_read_b64_tr_b16 a[206:207], v29 offset:12296
 v_mfma_f32_16x16x32_bf16 v[184:187], a[216:219], a[16:19], v[184:187]
 v_mfma_f32_16x16x32_bf16 v[180:183], a[216:219], a[8:11], v[180:183]
 v_mfma_f32_16x16x32_bf16 v[180:183], a[220:223], a[12:15], v[180:183]
 v_mfma_f32_16x16x32_bf16 v[176:179], a[220:223], a[4:7], v[176:179]
 s_waitcnt vmcnt(4)
 v_mfma_f32_16x16x32_bf16 v[176:179], a[216:219], a[0:3], v[176:179]
 s_waitcnt lgkmcnt(4)
 v_mfma_f32_16x16x32_bf16 v[192:195], a[192:195], a[32:35], v[192:195]
 ds_read_b64_tr_b16 a[208:209], v30 offset:0
 ds_read_b64_tr_b16 a[210:211], v30 offset:4096
 v_mfma_f32_16x16x32_bf16 v[192:195], a[196:199], a[36:39], v[192:195]
 buffer_load_dwordx4 a[0:3], v25, s[28:31], s53 offen offset:0 sc1
 v_mfma_f32_16x16x32_bf16 v[196:199], a[196:199], a[44:47], v[196:199]
 ds_read_b64_tr_b16 a[212:213], v30 offset:8192
 ds_read_b64_tr_b16 a[214:215], v30 offset:12288
 v_mfma_f32_16x16x32_bf16 v[196:199], a[192:195], a[40:43], v[196:199]
 v_mfma_f32_16x16x32_bf16 v[200:203], a[192:195], a[48:51], v[200:203]
 buffer_load_dwordx4 a[4:7], v25, s[28:31], s53 offen offset:1024 sc1
 v_mfma_f32_16x16x32_bf16 v[200:203], a[196:199], a[52:55], v[200:203]
 v_mfma_f32_16x16x32_bf16 v[204:207], a[196:199], a[60:63], v[204:207]
 buffer_load_dwordx4 a[8:11], v26, s[28:31], s53 offen offset:0 sc1
 v_mfma_f32_16x16x32_bf16 v[204:207], a[192:195], a[56:59], v[204:207]
 s_waitcnt lgkmcnt(4)
 v_mfma_f32_16x16x32_bf16 v[140:143], a[200:203], a[56:59], v[140:143]
 s_add_u32 s56, s56, 1
 ds_read_b64_tr_b16 a[216:217], v30 offset:8
 ds_read_b64_tr_b16 a[218:219], v30 offset:4104
 v_mfma_f32_16x16x32_bf16 v[140:143], a[204:207], a[60:63], v[140:143]
 buffer_load_dwordx4 a[12:15], v26, s[28:31], s53 offen offset:1024 sc1
 v_mfma_f32_16x16x32_bf16 v[136:139], a[204:207], a[52:55], v[136:139]
 ds_read_b64_tr_b16 a[220:221], v30 offset:8200
 ds_read_b64_tr_b16 a[222:223], v30 offset:12296
 v_mfma_f32_16x16x32_bf16 v[136:139], a[200:203], a[48:51], v[136:139]
 v_mfma_f32_16x16x32_bf16 v[132:135], a[200:203], a[40:43], v[132:135]
 buffer_load_dwordx4 a[16:19], v27, s[28:31], s53 offen offset:0 sc1
 v_mfma_f32_16x16x32_bf16 v[132:135], a[204:207], a[44:47], v[132:135]
 v_mfma_f32_16x16x32_bf16 v[128:131], a[204:207], a[36:39], v[128:131]
 buffer_load_dwordx4 a[20:23], v27, s[28:31], s53 offen offset:1024 sc1
 v_mfma_f32_16x16x32_bf16 v[128:131], a[200:203], a[32:35], v[128:131]
 s_waitcnt lgkmcnt(4)
 v_mfma_f32_16x16x32_bf16 v[208:211], a[208:211], a[32:35], v[208:211]
 ds_read_b64_tr_b16 a[192:193], v31 offset:0
 ds_read_b64_tr_b16 a[194:195], v31 offset:4096
 v_mfma_f32_16x16x32_bf16 v[208:211], a[212:215], a[36:39], v[208:211]
 buffer_load_dwordx4 a[24:27], v28, s[28:31], s53 offen offset:0 sc1
 v_mfma_f32_16x16x32_bf16 v[212:215], a[212:215], a[44:47], v[212:215]
 ds_read_b64_tr_b16 a[196:197], v31 offset:8192
 ds_read_b64_tr_b16 a[198:199], v31 offset:12288
 v_mfma_f32_16x16x32_bf16 v[212:215], a[208:211], a[40:43], v[212:215]
 v_mfma_f32_16x16x32_bf16 v[216:219], a[208:211], a[48:51], v[216:219]
 buffer_load_dwordx4 a[28:31], v28, s[28:31], s53 offen offset:1024 sc1
 v_mfma_f32_16x16x32_bf16 v[216:219], a[212:215], a[52:55], v[216:219]
 s_add_u32 s53, s53, 2048
 v_mfma_f32_16x16x32_bf16 v[220:223], a[212:215], a[60:63], v[220:223]
 v_mfma_f32_16x16x32_bf16 v[220:223], a[208:211], a[56:59], v[220:223]
 s_waitcnt lgkmcnt(4)
 v_mfma_f32_16x16x32_bf16 v[156:159], a[216:219], a[56:59], v[156:159]
 ds_read_b64_tr_b16 a[200:201], v31 offset:8
 ds_read_b64_tr_b16 a[202:203], v31 offset:4104
 v_mfma_f32_16x16x32_bf16 v[156:159], a[220:223], a[60:63], v[156:159]
 v_mfma_f32_16x16x32_bf16 v[152:155], a[220:223], a[52:55], v[152:155]
 ds_read_b64_tr_b16 a[204:205], v31 offset:8200
 ds_read_b64_tr_b16 a[206:207], v31 offset:12296
 v_mfma_f32_16x16x32_bf16 v[152:155], a[216:219], a[48:51], v[152:155]
 v_mfma_f32_16x16x32_bf16 v[148:151], a[216:219], a[40:43], v[148:151]
 v_mfma_f32_16x16x32_bf16 v[148:151], a[220:223], a[44:47], v[148:151]
 v_mfma_f32_16x16x32_bf16 v[144:147], a[220:223], a[36:39], v[144:147]
 v_mfma_f32_16x16x32_bf16 v[144:147], a[216:219], a[32:35], v[144:147]
 s_waitcnt lgkmcnt(4)
 v_mfma_f32_16x16x32_bf16 v[224:227], a[192:195], a[32:35], v[224:227]
 s_barrier
 ds_read_b64_tr_b16 a[208:209], v32 offset:0
 ds_read_b64_tr_b16 a[210:211], v32 offset:4096
 v_mfma_f32_16x16x32_bf16 v[224:227], a[196:199], a[36:39], v[224:227]
 v_mfma_f32_16x16x32_bf16 v[228:231], a[196:199], a[44:47], v[228:231]
 ds_read_b64_tr_b16 a[212:213], v32 offset:8192
 ds_read_b64_tr_b16 a[214:215], v32 offset:12288
 v_mfma_f32_16x16x32_bf16 v[228:231], a[192:195], a[40:43], v[228:231]
 s_mov_b32 m0, s54
 v_mfma_f32_16x16x32_bf16 v[232:235], a[192:195], a[48:51], v[232:235]
 buffer_load_dwordx4 v19, s[16:19], s51 offen offset:0 lds
 v_mfma_f32_16x16x32_bf16 v[232:235], a[196:199], a[52:55], v[232:235]
 v_mfma_f32_16x16x32_bf16 v[236:239], a[196:199], a[60:63], v[236:239]
 v_mfma_f32_16x16x32_bf16 v[236:239], a[192:195], a[56:59], v[236:239]
 s_waitcnt lgkmcnt(4)
 v_mfma_f32_16x16x32_bf16 v[172:175], a[200:203], a[56:59], v[172:175]
 ds_read_b64_tr_b16 a[216:217], v32 offset:8
 ds_read_b64_tr_b16 a[218:219], v32 offset:4104
 v_mfma_f32_16x16x32_bf16 v[172:175], a[204:207], a[60:63], v[172:175]
 buffer_load_dwordx4 v20, s[16:19], s51 offen offset:1024 lds
 v_mfma_f32_16x16x32_bf16 v[168:171], a[204:207], a[52:55], v[168:171]
 ds_read_b64_tr_b16 a[220:221], v32 offset:8200
 ds_read_b64_tr_b16 a[222:223], v32 offset:12296
 v_mfma_f32_16x16x32_bf16 v[168:171], a[200:203], a[48:51], v[168:171]
 v_mfma_f32_16x16x32_bf16 v[164:167], a[200:203], a[40:43], v[164:167]
 v_mfma_f32_16x16x32_bf16 v[164:167], a[204:207], a[44:47], v[164:167]
 v_mfma_f32_16x16x32_bf16 v[160:163], a[204:207], a[36:39], v[160:163]
 buffer_load_dwordx4 v21, s[16:19], s51 offen offset:2048 lds
 v_mfma_f32_16x16x32_bf16 v[160:163], a[200:203], a[32:35], v[160:163]
 s_waitcnt lgkmcnt(4)
 v_mfma_f32_16x16x32_bf16 v[240:243], a[208:211], a[32:35], v[240:243]
 ds_read_b64_tr_b16 a[192:193], v29 offset:16384
 ds_read_b64_tr_b16 a[194:195], v29 offset:20480
 v_mfma_f32_16x16x32_bf16 v[240:243], a[212:215], a[36:39], v[240:243]
 v_mfma_f32_16x16x32_bf16 v[244:247], a[212:215], a[44:47], v[244:247]
 ds_read_b64_tr_b16 a[196:197], v29 offset:24576
 ds_read_b64_tr_b16 a[198:199], v29 offset:28672
 v_mfma_f32_16x16x32_bf16 v[244:247], a[208:211], a[40:43], v[244:247]
 v_mfma_f32_16x16x32_bf16 v[248:251], a[208:211], a[48:51], v[248:251]
 buffer_load_dwordx4 v22, s[16:19], s51 offen offset:3072 lds
 v_mfma_f32_16x16x32_bf16 v[248:251], a[212:215], a[52:55], v[248:251]
 s_add_u32 s51, s51, 524288
 s_add_u32 s54, s54, 16384
 s_and_b32 s54, s54, 0xffff
 v_mfma_f32_16x16x32_bf16 v[252:255], a[212:215], a[60:63], v[252:255]
 v_mfma_f32_16x16x32_bf16 v[252:255], a[208:211], a[56:59], v[252:255]
 s_waitcnt lgkmcnt(4)
 v_mfma_f32_16x16x32_bf16 v[188:191], a[216:219], a[56:59], v[188:191]
 ds_read_b64_tr_b16 a[200:201], v29 offset:16392
 ds_read_b64_tr_b16 a[202:203], v29 offset:20488
 v_mfma_f32_16x16x32_bf16 v[188:191], a[220:223], a[60:63], v[188:191]
 v_mfma_f32_16x16x32_bf16 v[184:187], a[220:223], a[52:55], v[184:187]
 ds_read_b64_tr_b16 a[204:205], v29 offset:24584
 ds_read_b64_tr_b16 a[206:207], v29 offset:28680
 v_mfma_f32_16x16x32_bf16 v[184:187], a[216:219], a[48:51], v[184:187]
 v_mfma_f32_16x16x32_bf16 v[180:183], a[216:219], a[40:43], v[180:183]
 v_mfma_f32_16x16x32_bf16 v[180:183], a[220:223], a[44:47], v[180:183]
 v_mfma_f32_16x16x32_bf16 v[176:179], a[220:223], a[36:39], v[176:179]
 s_waitcnt vmcnt(4)
 v_mfma_f32_16x16x32_bf16 v[176:179], a[216:219], a[32:35], v[176:179]
 s_waitcnt lgkmcnt(4)
 s_cmp_lt_u32 s56, 2
 s_cbranch_scc1 mq_loop
mq_tail:
 v_mfma_f32_16x16x32_bf16 v[192:195], a[192:195], a[0:3], v[192:195]
 ds_read_b64_tr_b16 a[208:209], v30 offset:16384
 ds_read_b64_tr_b16 a[210:211], v30 offset:20480
 v_mfma_f32_16x16x32_bf16 v[192:195], a[196:199], a[4:7], v[192:195]
 buffer_load_dwordx4 a[32:35], v25, s[28:31], s53 offen offset:0 sc1
 v_mfma_f32_16x16x32_bf16 v[196:199], a[196:199], a[12:15], v[196:199]
 ds_read_b64_tr_b16 a[212:213], v30 offset:24576
 ds_read_b64_tr_b16 a[214:215], v30 offset:28672
 v_mfma_f32_16x16x32_bf16 v[196:199], a[192:195], a[8:11], v[196:199]
 v_xor_b32 v29, 0x8000, v29
 v_mfma_f32_16x16x32_bf16 v[200:203], a[192:195], a[16:19], v[200:203]
 buffer_load_dwordx4 a[36:39], v25, s[28:31], s53 offen offset:1024 sc1
 v_mfma_f32_16x16x32_bf16 v[200:203], a[196:199], a[20:23], v[200:203]
 v_mfma_f32_16x16x32_bf16 v[204:207], a[196:199], a[28:31], v[204:207]
 buffer_load_dwordx4 a[40:43], v26, s[28:31], s53 offen offset:0 sc1
 v_mfma_f32_16x16x32_bf16 v[204:207], a[192:195], a[24:27], v[204:207]
 s_waitcnt lgkmcnt(4)
 v_mfma_f32_16x16x32_bf16 v[140:143], a[200:203], a[24:27], v[140:143]
 ds_read_b64_tr_b16 a[216:217], v30 offset:16392
 ds_read_b64_tr_b16 a[218:219], v30 offset:20488
 v_mfma_f32_16x16x32_bf16 v[140:143], a[204:207], a[28:31], v[140:143]
 buffer_load_dwordx4 a[44:47], v26, s[28:31], s53 offen offset:1024 sc1
 v_mfma_f32_16x16x32_bf16 v[136:139], a[204:207], a[20:23], v[136:139]
 ds_read_b64_tr_b16 a[220:221], v30 offset:24584
 ds_read_b64_tr_b16 a[222:223], v30 offset:28680
 v_mfma_f32_16x16x32_bf16 v[136:139], a[200:203], a[16:19], v[136:139]
 v_xor_b32 v30, 0x8000, v30
 v_mfma_f32_16x16x32_bf16 v[132:135], a[200:203], a[8:11], v[132:135]
 buffer_load_dwordx4 a[48:51], v27, s[28:31], s53 offen offset:0 sc1
 v_mfma_f32_16x16x32_bf16 v[132:135], a[204:207], a[12:15], v[132:135]
 v_mfma_f32_16x16x32_bf16 v[128:131], a[204:207], a[4:7], v[128:131]
 buffer_load_dwordx4 a[52:55], v27, s[28:31], s53 offen offset:1024 sc1
 v_mfma_f32_16x16x32_bf16 v[128:131], a[200:203], a[0:3], v[128:131]
 s_waitcnt lgkmcnt(4)
 v_mfma_f32_16x16x32_bf16 v[208:211], a[208:211], a[0:3], v[208:211]
 ds_read_b64_tr_b16 a[192:193], v31 offset:16384
 ds_read_b64_tr_b16 a[194:195], v31 offset:20480
 v_mfma_f32_16x16x32_bf16 v[208:211], a[212:215], a[4:7], v[208:211]
 buffer_load_dwordx4 a[56:59], v28, s[28:31], s53 offen offset:0 sc1
 v_mfma_f32_16x16x32_bf16 v[212:215], a[212:215], a[12:15], v[212:215]
 ds_read_b64_tr_b16 a[196:197], v31 offset:24576
 ds_read_b64_tr_b16 a[198:199], v31 offset:28672
 v_mfma_f32_16x16x32_bf16 v[212:215], a[208:211], a[8:11], v[212:215]
 v_mfma_f32_16x16x32_bf16 v[216:219], a[208:211], a[16:19], v[216:219]
 buffer_load_dwordx4 a[60:63], v28, s[28:31], s53 offen offset:1024 sc1
 v_mfma_f32_16x16x32_bf16 v[216:219], a[212:215], a[20:23], v[216:219]
 s_add_u32 s53, s53, 2048
 s_add_u32 m0, s47, 65536
 v_mfma_f32_16x16x32_bf16 v[220:223], a[212:215], a[28:31], v[220:223]
 buffer_load_dwordx4 v1, s[8:11], s49 offen offset:0 lds
 v_mfma_f32_16x16x32_bf16 v[220:223], a[208:211], a[24:27], v[220:223]
 s_waitcnt lgkmcnt(4)
 buffer_load_dwordx4 v2, s[8:11], s49 offen offset:1024 lds
 v_mfma_f32_16x16x32_bf16 v[156:159], a[216:219], a[24:27], v[156:159]
 ds_read_b64_tr_b16 a[200:201], v31 offset:16392
 ds_read_b64_tr_b16 a[202:203], v31 offset:20488
 v_mfma_f32_16x16x32_bf16 v[156:159], a[220:223], a[28:31], v[156:159]
 buffer_load_dwordx4 v3, s[8:11], s49 offen offset:2048 lds
 v_mfma_f32_16x16x32_bf16 v[152:155], a[220:223], a[20:23], v[152:155]
 ds_read_b64_tr_b16 a[204:205], v31 offset:24584
 ds_read_b64_tr_b16 a[206:207], v31 offset:28680
 v_mfma_f32_16x16x32_bf16 v[152:155], a[216:219], a[16:19], v[152:155]
 buffer_load_dwordx4 v4, s[8:11], s49 offen offset:3072 lds
 v_mfma_f32_16x16x32_bf16 v[148:151], a[216:219], a[8:11], v[148:151]
 s_add_u32 s49, s49, 16384
 s_add_u32 m0, s47, 147456
 s_nop 0
 buffer_load_dwordx4 v1, s[12:15], s50 offen offset:0 lds
 v_mfma_f32_16x16x32_bf16 v[148:151], a[220:223], a[12:15], v[148:151]
 buffer_load_dwordx4 v2, s[12:15], s50 offen offset:1024 lds
 v_mfma_f32_16x16x32_bf16 v[144:147], a[220:223], a[4:7], v[144:147]
 buffer_load_dwordx4 v3, s[12:15], s50 offen offset:2048 lds
 v_mfma_f32_16x16x32_bf16 v[144:147], a[216:219], a[0:3], v[144:147]
 s_waitcnt lgkmcnt(4)
 buffer_load_dwordx4 v4, s[12:15], s50 offen offset:3072 lds
 v_mfma_f32_16x16x32_bf16 v[224:227], a[192:195], a[0:3], v[224:227]
 s_barrier
 s_add_u32 s50, s50, 16384
 ds_read_b64_tr_b16 a[208:209], v32 offset:16384
 ds_read_b64_tr_b16 a[210:211], v32 offset:20480
 v_mfma_f32_16x16x32_bf16 v[224:227], a[196:199], a[4:7], v[224:227]
 v_xor_b32 v31, 0x8000, v31
 v_mfma_f32_16x16x32_bf16 v[228:231], a[196:199], a[12:15], v[228:231]
 ds_read_b64_tr_b16 a[212:213], v32 offset:24576
 ds_read_b64_tr_b16 a[214:215], v32 offset:28672
 v_mfma_f32_16x16x32_bf16 v[228:231], a[192:195], a[8:11], v[228:231]
 s_mov_b32 m0, s54
 v_mfma_f32_16x16x32_bf16 v[232:235], a[192:195], a[16:19], v[232:235]
 buffer_load_dwordx4 v19, s[16:19], s51 offen offset:0 lds
 v_mfma_f32_16x16x32_bf16 v[232:235], a[196:199], a[20:23], v[232:235]
 v_mfma_f32_16x16x32_bf16 v[236:239], a[196:199], a[28:31], v[236:239]
 v_mfma_f32_16x16x32_bf16 v[236:239], a[192:195], a[24:27], v[236:239]
 s_waitcnt lgkmcnt(4)
 v_mfma_f32_16x16x32_bf16 v[172:175], a[200:203], a[24:27], v[172:175]
 ds_read_b64_tr_b16 a[216:217], v32 offset:16392
 ds_read_b64_tr_b16 a[218:219], v32 offset:20488
 v_mfma_f32_16x16x32_bf16 v[172:175], a[204:207], a[28:31], v[172:175]
 buffer_load_dwordx4 v20, s[16:19], s51 offen offset:1024 lds
 v_mfma_f32_16x16x32_bf16 v[168:171], a[204:207], a[20:23], v[168:171]
 ds_read_b64_tr_b16 a[220:221], v32 offset:24584
 ds_read_b64_tr_b16 a[222:223], v32 offset:28680
 v_mfma_f32_16x16x32_bf16 v[168:171], a[200:203], a[16:19], v[168:171]
 v_xor_b32 v32, 0x8000, v32
 v_mfma_f32_16x16x32_bf16 v[164:167], a[200:203], a[8:11], v[164:167]
 v_mfma_f32_16x16x32_bf16 v[164:167], a[204:207], a[12:15], v[164:167]
 v_mfma_f32_16x16x32_bf16 v[160:163], a[204:207], a[4:7], v[160:163]
 buffer_load_dwordx4 v21, s[16:19], s51 offen offset:2048 lds
 v_mfma_f32_16x16x32_bf16 v[160:163], a[200:203], a[0:3], v[160:163]
 s_waitcnt lgkmcnt(4)
 v_mfma_f32_16x16x32_bf16 v[240:243], a[208:211], a[0:3], v[240:243]
 ds_read_b64_tr_b16 a[192:193], v29 offset:0
 ds_read_b64_tr_b16 a[194:195], v29 offset:4096
 v_mfma_f32_16x16x32_bf16 v[240:243], a[212:215], a[4:7], v[240:243]
 v_mfma_f32_16x16x32_bf16 v[244:247], a[212:215], a[12:15], v[244:247]
 ds_read_b64_tr_b16 a[196:197], v29 offset:8192
 ds_read_b64_tr_b16 a[198:199], v29 offset:12288
 v_mfma_f32_16x16x32_bf16 v[244:247], a[208:211], a[8:11], v[244:247]
 v_mfma_f32_16x16x32_bf16 v[248:251], a[208:211], a[16:19], v[248:251]
 buffer_load_dwordx4 v22, s[16:19], s51 offen offset:3072 lds
 v_mfma_f32_16x16x32_bf16 v[248:251], a[212:215], a[20:23], v[248:251]
 s_add_u32 s51, s51, 524288
 s_add_u32 s54, s54, 16384
 s_and_b32 s54, s54, 0xffff
 v_mfma_f32_16x16x32_bf16 v[252:255], a[212:215], a[28:31], v[252:255]
 v_mfma_f32_16x16x32_bf16 v[252:255], a[208:211], a[24:27], v[252:255]
 s_waitcnt lgkmcnt(4)
 v_mfma_f32_16x16x32_bf16 v[188:191], a[216:219], a[24:27], v[188:191]
 ds_read_b64_tr_b16 a[200:201], v29 offset:8
 ds_read_b64_tr_b16 a[202:203], v29 offset:4104
 v_mfma_f32_16x16x32_bf16 v[188:191], a[220:223], a[28:31], v[188:191]
 v_mfma_f32_16x16x32_bf16 v[184:187], a[220:223], a[20:23], v[184:187]
 ds_read_b64_tr_b16 a[204:205], v29 offset:8200
 ds_read_b64_tr_b16 a[206:207], v29 offset:12296
 v_mfma_f32_16x16x32_bf16 v[184:187], a[216:219], a[16:19], v[184:187]
 v_mfma_f32_16x16x32_bf16 v[180:183], a[216:219], a[8:11], v[180:183]
 v_mfma_f32_16x16x32_bf16 v[180:183], a[220:223], a[12:15], v[180:183]
 v_mfma_f32_16x16x32_bf16 v[176:179], a[220:223], a[4:7], v[176:179]
 s_waitcnt vmcnt(12)
 v_mfma_f32_16x16x32_bf16 v[176:179], a[216:219], a[0:3], v[176:179]
 s_waitcnt lgkmcnt(4)
 v_mfma_f32_16x16x32_bf16 v[192:195], a[192:195], a[32:35], v[192:195]
 ds_read_b64_tr_b16 a[208:209], v30 offset:0
 ds_read_b64_tr_b16 a[210:211], v30 offset:4096
 v_mfma_f32_16x16x32_bf16 v[192:195], a[196:199], a[36:39], v[192:195]
 buffer_load_dwordx4 a[0:3], v25, s[28:31], s53 offen offset:0 sc1
 v_mfma_f32_16x16x32_bf16 v[196:199], a[196:199], a[44:47], v[196:199]
 ds_read_b64_tr_b16 a[212:213], v30 offset:8192
 ds_read_b64_tr_b16 a[214:215], v30 offset:12288
 v_mfma_f32_16x16x32_bf16 v[196:199], a[192:195], a[40:43], v[196:199]
 v_mfma_f32_16x16x32_bf16 v[200:203], a[192:195], a[48:51], v[200:203]
 buffer_load_dwordx4 a[4:7], v25, s[28:31], s53 offen offset:1024 sc1
 v_mfma_f32_16x16x32_bf16 v[200:203], a[196:199], a[52:55], v[200:203]
 v_mfma_f32_16x16x32_bf16 v[204:207], a[196:199], a[60:63], v[204:207]
 buffer_load_dwordx4 a[8:11], v26, s[28:31], s53 offen offset:0 sc1
 v_mfma_f32_16x16x32_bf16 v[204:207], a[192:195], a[56:59], v[204:207]
 s_waitcnt lgkmcnt(4)
 v_mfma_f32_16x16x32_bf16 v[140:143], a[200:203], a[56:59], v[140:143]
 ds_read_b64_tr_b16 a[216:217], v30 offset:8
 ds_read_b64_tr_b16 a[218:219], v30 offset:4104
 v_mfma_f32_16x16x32_bf16 v[140:143], a[204:207], a[60:63], v[140:143]
 buffer_load_dwordx4 a[12:15], v26, s[28:31], s53 offen offset:1024 sc1
 v_mfma_f32_16x16x32_bf16 v[136:139], a[204:207], a[52:55], v[136:139]
 ds_read_b64_tr_b16 a[220:221], v30 offset:8200
 ds_read_b64_tr_b16 a[222:223], v30 offset:12296
 v_mfma_f32_16x16x32_bf16 v[136:139], a[200:203], a[48:51], v[136:139]
 v_mfma_f32_16x16x32_bf16 v[132:135], a[200:203], a[40:43], v[132:135]
 buffer_load_dwordx4 a[16:19], v27, s[28:31], s53 offen offset:0 sc1
 v_mfma_f32_16x16x32_bf16 v[132:135], a[204:207], a[44:47], v[132:135]
 v_mfma_f32_16x16x32_bf16 v[128:131], a[204:207], a[36:39], v[128:131]
 buffer_load_dwordx4 a[20:23], v27, s[28:31], s53 offen offset:1024 sc1
 v_mfma_f32_16x16x32_bf16 v[128:131], a[200:203], a[32:35], v[128:131]
 s_waitcnt lgkmcnt(4)
 v_mfma_f32_16x16x32_bf16 v[208:211], a[208:211], a[32:35], v[208:211]
 ds_read_b64_tr_b16 a[192:193], v31 offset:0
 ds_read_b64_tr_b16 a[194:195], v31 offset:4096
 v_mfma_f32_16x16x32_bf16 v[208:211], a[212:215], a[36:39], v[208:211]
 buffer_load_dwordx4 a[24:27], v28, s[28:31], s53 offen offset:0 sc1
 v_mfma_f32_16x16x32_bf16 v[212:215], a[212:215], a[44:47], v[212:215]
 ds_read_b64_tr_b16 a[196:197], v31 offset:8192
 ds_read_b64_tr_b16 a[198:199], v31 offset:12288
 v_mfma_f32_16x16x32_bf16 v[212:215], a[208:211], a[40:43], v[212:215]
 v_mfma_f32_16x16x32_bf16 v[216:219], a[208:211], a[48:51], v[216:219]
 buffer_load_dwordx4 a[28:31], v28, s[28:31], s53 offen offset:1024 sc1
 v_mfma_f32_16x16x32_bf16 v[216:219], a[212:215], a[52:55], v[216:219]
 s_add_u32 s53, s53, 2048
 v_mfma_f32_16x16x32_bf16 v[220:223], a[212:215], a[60:63], v[220:223]
 v_mfma_f32_16x16x32_bf16 v[220:223], a[208:211], a[56:59], v[220:223]
 s_waitcnt lgkmcnt(4)
 v_mfma_f32_16x16x32_bf16 v[156:159], a[216:219], a[56:59], v[156:159]
 ds_read_b64_tr_b16 a[200:201], v31 offset:8
 ds_read_b64_tr_b16 a[202:203], v31 offset:4104
 v_mfma_f32_16x16x32_bf16 v[156:159], a[220:223], a[60:63], v[156:159]
 v_mfma_f32_16x16x32_bf16 v[152:155], a[220:223], a[52:55], v[152:155]
 ds_read_b64_tr_b16 a[204:205], v31 offset:8200
 ds_read_b64_tr_b16 a[206:207], v31 offset:12296
 v_mfma_f32_16x16x32_bf16 v[152:155], a[216:219], a[48:51], v[152:155]
 v_mfma_f32_16x16x32_bf16 v[148:151], a[216:219], a[40:43], v[148:151]
 v_mfma_f32_16x16x32_bf16 v[148:151], a[220:223], a[44:47], v[148:151]
 v_mfma_f32_16x16x32_bf16 v[144:147], a[220:223], a[36:39], v[144:147]
 v_mfma_f32_16x16x32_bf16 v[144:147], a[216:219], a[32:35], v[144:147]
 s_waitcnt lgkmcnt(4)
 v_mfma_f32_16x16x32_bf16 v[224:227], a[192:195], a[32:35], v[224:227]
 s_barrier
 ds_read_b64_tr_b16 a[208:209], v32 offset:0
 ds_read_b64_tr_b16 a[210:211], v32 offset:4096
 v_mfma_f32_16x16x32_bf16 v[224:227], a[196:199], a[36:39], v[224:227]
 v_mfma_f32_16x16x32_bf16 v[228:231], a[196:199], a[44:47], v[228:231]
 s_add_u32 m0, s47, 16384
 ds_read_b64_tr_b16 a[212:213], v32 offset:8192
 ds_read_b64_tr_b16 a[214:215], v32 offset:12288
 v_mfma_f32_16x16x32_bf16 v[228:231], a[192:195], a[40:43], v[228:231]
 buffer_load_dwordx4 v1, s[8:11], s49 offen offset:0 lds
 v_mfma_f32_16x16x32_bf16 v[232:235], a[192:195], a[48:51], v[232:235]
 v_mfma_f32_16x16x32_bf16 v[232:235], a[196:199], a[52:55], v[232:235]
 buffer_load_dwordx4 v2, s[8:11], s49 offen offset:1024 lds
 v_mfma_f32_16x16x32_bf16 v[236:239], a[196:199], a[60:63], v[236:239]
 v_mfma_f32_16x16x32_bf16 v[236:239], a[192:195], a[56:59], v[236:239]
 s_waitcnt lgkmcnt(4)
 buffer_load_dwordx4 v3, s[8:11], s49 offen offset:2048 lds
 v_mfma_f32_16x16x32_bf16 v[172:175], a[200:203], a[56:59], v[172:175]
 ds_read_b64_tr_b16 a[216:217], v32 offset:8
 ds_read_b64_tr_b16 a[218:219], v32 offset:4104
 v_mfma_f32_16x16x32_bf16 v[172:175], a[204:207], a[60:63], v[172:175]
 buffer_load_dwordx4 v4, s[8:11], s49 offen offset:3072 lds
 v_mfma_f32_16x16x32_bf16 v[168:171], a[204:207], a[52:55], v[168:171]
 s_add_u32 s49, s49, 16384
 s_add_u32 m0, s47, 98304
 ds_read_b64_tr_b16 a[220:221], v32 offset:8200
 ds_read_b64_tr_b16 a[222:223], v32 offset:12296
 v_mfma_f32_16x16x32_bf16 v[168:171], a[200:203], a[48:51], v[168:171]
 v_mfma_f32_16x16x32_bf16 v[164:167], a[200:203], a[40:43], v[164:167]
 buffer_load_dwordx4 v1, s[12:15], s50 offen offset:0 lds
 v_mfma_f32_16x16x32_bf16 v[164:167], a[204:207], a[44:47], v[164:167]
 v_mfma_f32_16x16x32_bf16 v[160:163], a[204:207], a[36:39], v[160:163]
 buffer_load_dwordx4 v2, s[12:15], s50 offen offset:1024 lds
 v_mfma_f32_16x16x32_bf16 v[160:163], a[200:203], a[32:35], v[160:163]
 s_waitcnt lgkmcnt(4)
 v_mfma_f32_16x16x32_bf16 v[240:243], a[208:211], a[32:35], v[240:243]
 ds_read_b64_tr_b16 a[192:193], v29 offset:16384
 ds_read_b64_tr_b16 a[194:195], v29 offset:20480
 v_mfma_f32_16x16x32_bf16 v[240:243], a[212:215], a[36:39], v[240:243]
 buffer_load_dwordx4 v3, s[12:15], s50 offen offset:2048 lds
 v_mfma_f32_16x16x32_bf16 v[244:247], a[212:215], a[44:47], v[244:247]
 ds_read_b64_tr_b16 a[196:197], v29 offset:24576
 ds_read_b64_tr_b16 a[198:199], v29 offset:28672
 v_mfma_f32_16x16x32_bf16 v[244:247], a[208:211], a[40:43], v[244:247]
 v_mfma_f32_16x16x32_bf16 v[248:251], a[208:211], a[48:51], v[248:251]
 buffer_load_dwordx4 v4, s[12:15], s50 offen offset:3072 lds
 v_mfma_f32_16x16x32_bf16 v[248:251], a[212:215], a[52:55], v[248:251]
 s_add_u32 s50, s50, 16384
 v_mfma_f32_16x16x32_bf16 v[252:255], a[212:215], a[60:63], v[252:255]
 v_mfma_f32_16x16x32_bf16 v[252:255], a[208:211], a[56:59], v[252:255]
 s_waitcnt lgkmcnt(4)
 v_mfma_f32_16x16x32_bf16 v[188:191], a[216:219], a[56:59], v[188:191]
 ds_read_b64_tr_b16 a[200:201], v29 offset:16392
 ds_read_b64_tr_b16 a[202:203], v29 offset:20488
 v_mfma_f32_16x16x32_bf16 v[188:191], a[220:223], a[60:63], v[188:191]
 v_mfma_f32_16x16x32_bf16 v[184:187], a[220:223], a[52:55], v[184:187]
 ds_read_b64_tr_b16 a[204:205], v29 offset:24584
 ds_read_b64_tr_b16 a[206:207], v29 offset:28680
 v_mfma_f32_16x16x32_bf16 v[184:187], a[216:219], a[48:51], v[184:187]
 v_mfma_f32_16x16x32_bf16 v[180:183], a[216:219], a[40:43], v[180:183]
 v_mfma_f32_16x16x32_bf16 v[180:183], a[220:223], a[44:47], v[180:183]
 v_mfma_f32_16x16x32_bf16 v[176:179], a[220:223], a[36:39], v[176:179]
 s_waitcnt vmcnt(8)
 v_mfma_f32_16x16x32_bf16 v[176:179], a[216:219], a[32:35], v[176:179]
 s_waitcnt lgkmcnt(4)
 v_mfma_f32_16x16x32_bf16 v[192:195], a[192:195], a[0:3], v[192:195]
 ds_read_b64_tr_b16 a[208:209], v30 offset:16384
 ds_read_b64_tr_b16 a[210:211], v30 offset:20480
 v_mfma_f32_16x16x32_bf16 v[192:195], a[196:199], a[4:7], v[192:195]
 buffer_load_dwordx4 a[32:35], v25, s[28:31], s53 offen offset:0 sc1
 v_mfma_f32_16x16x32_bf16 v[196:199], a[196:199], a[12:15], v[196:199]
 ds_read_b64_tr_b16 a[212:213], v30 offset:24576
 ds_read_b64_tr_b16 a[214:215], v30 offset:28672
 v_mfma_f32_16x16x32_bf16 v[196:199], a[192:195], a[8:11], v[196:199]
 v_xor_b32 v29, 0x8000, v29
 v_mfma_f32_16x16x32_bf16 v[200:203], a[192:195], a[16:19], v[200:203]
 buffer_load_dwordx4 a[36:39], v25, s[28:31], s53 offen offset:1024 sc1
 v_mfma_f32_16x16x32_bf16 v[200:203], a[196:199], a[20:23], v[200:203]
 v_mfma_f32_16x16x32_bf16 v[204:207], a[196:199], a[28:31], v[204:207]
 buffer_load_dwordx4 a[40:43], v26, s[28:31], s53 offen offset:0 sc1
 v_mfma_f32_16x16x32_bf16 v[204:207], a[192:195], a[24:27], v[204:207]
 s_waitcnt lgkmcnt(4)
 v_mfma_f32_16x16x32_bf16 v[140:143], a[200:203], a[24:27], v[140:143]
 ds_read_b64_tr_b16 a[216:217], v30 offset:16392
 ds_read_b64_tr_b16 a[218:219], v30 offset:20488
 v_mfma_f32_16x16x32_bf16 v[140:143], a[204:207], a[28:31], v[140:143]
 buffer_load_dwordx4 a[44:47], v26, s[28:31], s53 offen offset:1024 sc1
 v_mfma_f32_16x16x32_bf16 v[136:139], a[204:207], a[20:23], v[136:139]
 ds_read_b64_tr_b16 a[220:221], v30 offset:24584
 ds_read_b64_tr_b16 a[222:223], v30 offset:28680
 v_mfma_f32_16x16x32_bf16 v[136:139], a[200:203], a[16:19], v[136:139]
 v_xor_b32 v30, 0x8000, v30
 v_mfma_f32_16x16x32_bf16 v[132:135], a[200:203], a[8:11], v[132:135]
 buffer_load_dwordx4 a[48:51], v27, s[28:31], s53 offen offset:0 sc1
 v_mfma_f32_16x16x32_bf16 v[132:135], a[204:207], a[12:15], v[132:135]
 v_mfma_f32_16x16x32_bf16 v[128:131], a[204:207], a[4:7], v[128:131]
 buffer_load_dwordx4 a[52:55], v27, s[28:31], s53 offen offset:1024 sc1
 v_mfma_f32_16x16x32_bf16 v[128:131], a[200:203], a[0:3], v[128:131]
 s_waitcnt lgkmcnt(4)
 v_mfma_f32_16x16x32_bf16 v[208:211], a[208:211], a[0:3], v[208:211]
 ds_read_b64_tr_b16 a[192:193], v31 offset:16384
 ds_read_b64_tr_b16 a[194:195], v31 offset:20480
 v_mfma_f32_16x16x32_bf16 v[208:211], a[212:215], a[4:7], v[208:211]
 buffer_load_dwordx4 a[56:59], v28, s[28:31], s53 offen offset:0 sc1
 v_mfma_f32_16x16x32_bf16 v[212:215], a[212:215], a[12:15], v[212:215]
 ds_read_b64_tr_b16 a[196:197], v31 offset:24576
 ds_read_b64_tr_b16 a[198:199], v31 offset:28672
 v_mfma_f32_16x16x32_bf16 v[212:215], a[208:211], a[8:11], v[212:215]
 v_mfma_f32_16x16x32_bf16 v[216:219], a[208:211], a[16:19], v[216:219]
 buffer_load_dwordx4 a[60:63], v28, s[28:31], s53 offen offset:1024 sc1
 v_mfma_f32_16x16x32_bf16 v[216:219], a[212:215], a[20:23], v[216:219]
 s_add_u32 s53, s53, 2048
 v_mfma_f32_16x16x32_bf16 v[220:223], a[212:215], a[28:31], v[220:223]
 v_mfma_f32_16x16x32_bf16 v[220:223], a[208:211], a[24:27], v[220:223]
 s_waitcnt lgkmcnt(4)
 v_mfma_f32_16x16x32_bf16 v[156:159], a[216:219], a[24:27], v[156:159]
 ds_read_b64_tr_b16 a[200:201], v31 offset:16392
 ds_read_b64_tr_b16 a[202:203], v31 offset:20488
 v_mfma_f32_16x16x32_bf16 v[156:159], a[220:223], a[28:31], v[156:159]
 v_mfma_f32_16x16x32_bf16 v[152:155], a[220:223], a[20:23], v[152:155]
 ds_read_b64_tr_b16 a[204:205], v31 offset:24584
 ds_read_b64_tr_b16 a[206:207], v31 offset:28680
 v_mfma_f32_16x16x32_bf16 v[152:155], a[216:219], a[16:19], v[152:155]
 v_xor_b32 v31, 0x8000, v31
 v_mfma_f32_16x16x32_bf16 v[148:151], a[216:219], a[8:11], v[148:151]
 v_mfma_f32_16x16x32_bf16 v[148:151], a[220:223], a[12:15], v[148:151]
 v_mfma_f32_16x16x32_bf16 v[144:147], a[220:223], a[4:7], v[144:147]
 v_mfma_f32_16x16x32_bf16 v[144:147], a[216:219], a[0:3], v[144:147]
 s_waitcnt lgkmcnt(4)
 v_mfma_f32_16x16x32_bf16 v[224:227], a[192:195], a[0:3], v[224:227]
 s_barrier
 ds_read_b64_tr_b16 a[208:209], v32 offset:16384
 ds_read_b64_tr_b16 a[210:211], v32 offset:20480
 v_mfma_f32_16x16x32_bf16 v[224:227], a[196:199], a[4:7], v[224:227]
 v_mfma_f32_16x16x32_bf16 v[228:231], a[196:199], a[12:15], v[228:231]
 s_add_u32 m0, s47, 32768
 ds_read_b64_tr_b16 a[212:213], v32 offset:24576
 ds_read_b64_tr_b16 a[214:215], v32 offset:28672
 v_mfma_f32_16x16x32_bf16 v[228:231], a[192:195], a[8:11], v[228:231]
 buffer_load_dwordx4 v1, s[8:11], s49 offen offset:0 lds
 v_mfma_f32_16x16x32_bf16 v[232:235], a[192:195], a[16:19], v[232:235]
 v_mfma_f32_16x16x32_bf16 v[232:235], a[196:199], a[20:23], v[232:235]
 buffer_load_dwordx4 v2, s[8:11], s49 offen offset:1024 lds
 v_mfma_f32_16x16x32_bf16 v[236:239], a[196:199], a[28:31], v[236:239]
 v_mfma_f32_16x16x32_bf16 v[236:239], a[192:195], a[24:27], v[236:239]
 s_waitcnt lgkmcnt(4)
 buffer_load_dwordx4 v3, s[8:11], s49 offen offset:2048 lds
 v_mfma_f32_16x16x32_bf16 v[172:175], a[200:203], a[24:27], v[172:175]
 ds_read_b64_tr_b16 a[216:217], v32 offset:16392
 ds_read_b64_tr_b16 a[218:219], v32 offset:20488
 v_mfma_f32_16x16x32_bf16 v[172:175], a[204:207], a[28:31], v[172:175]
 buffer_load_dwordx4 v4, s[8:11], s49 offen offset:3072 lds
 v_mfma_f32_16x16x32_bf16 v[168:171], a[204:207], a[20:23], v[168:171]
 s_add_u32 s49, s49, 16384
 s_add_u32 m0, s47, 114688
 ds_read_b64_tr_b16 a[220:221], v32 offset:24584
 ds_read_b64_tr_b16 a[222:223], v32 offset:28680
 v_mfma_f32_16x16x32_bf16 v[168:171], a[200:203], a[16:19], v[168:171]
 v_xor_b32 v32, 0x8000, v32
 v_mfma_f32_16x16x32_bf16 v[164:167], a[200:203], a[8:11], v[164:167]
 buffer_load_dwordx4 v1, s[12:15], s50 offen offset:0 lds
 v_mfma_f32_16x16x32_bf16 v[164:167], a[204:207], a[12:15], v[164:167]
 v_mfma_f32_16x16x32_bf16 v[160:163], a[204:207], a[4:7], v[160:163]
 buffer_load_dwordx4 v2, s[12:15], s50 offen offset:1024 lds
 v_mfma_f32_16x16x32_bf16 v[160:163], a[200:203], a[0:3], v[160:163]
 s_waitcnt lgkmcnt(4)
 v_mfma_f32_16x16x32_bf16 v[240:243], a[208:211], a[0:3], v[240:243]
 ds_read_b64_tr_b16 a[192:193], v29 offset:0
 ds_read_b64_tr_b16 a[194:195], v29 offset:4096
 v_mfma_f32_16x16x32_bf16 v[240:243], a[212:215], a[4:7], v[240:243]
 buffer_load_dwordx4 v3, s[12:15], s50 offen offset:2048 lds
 v_mfma_f32_16x16x32_bf16 v[244:247], a[212:215], a[12:15], v[244:247]
 ds_read_b64_tr_b16 a[196:197], v29 offset:8192
 ds_read_b64_tr_b16 a[198:199], v29 offset:12288
 v_mfma_f32_16x16x32_bf16 v[244:247], a[208:211], a[8:11], v[244:247]
 v_mfma_f32_16x16x32_bf16 v[248:251], a[208:211], a[16:19], v[248:251]
 buffer_load_dwordx4 v4, s[12:15], s50 offen offset:3072 lds
 v_mfma_f32_16x16x32_bf16 v[248:251], a[212:215], a[20:23], v[248:251]
 s_add_u32 s50, s50, 16384
 v_mfma_f32_16x16x32_bf16 v[252:255], a[212:215], a[28:31], v[252:255]
 v_mfma_f32_16x16x32_bf16 v[252:255], a[208:211], a[24:27], v[252:255]
 s_waitcnt lgkmcnt(4)
 v_mfma_f32_16x16x32_bf16 v[188:191], a[216:219], a[24:27], v[188:191]
 ds_read_b64_tr_b16 a[200:201], v29 offset:8
 ds_read_b64_tr_b16 a[202:203], v29 offset:4104
 v_mfma_f32_16x16x32_bf16 v[188:191], a[220:223], a[28:31], v[188:191]
 v_mfma_f32_16x16x32_bf16 v[184:187], a[220:223], a[20:23], v[184:187]
 ds_read_b64_tr_b16 a[204:205], v29 offset:8200
 ds_read_b64_tr_b16 a[206:207], v29 offset:12296
 v_mfma_f32_16x16x32_bf16 v[184:187], a[216:219], a[16:19], v[184:187]
 v_mfma_f32_16x16x32_bf16 v[180:183], a[216:219], a[8:11], v[180:183]
 v_mfma_f32_16x16x32_bf16 v[180:183], a[220:223], a[12:15], v[180:183]
 v_mfma_f32_16x16x32_bf16 v[176:179], a[220:223], a[4:7], v[176:179]
 s_waitcnt vmcnt(8)
 v_mfma_f32_16x16x32_bf16 v[176:179], a[216:219], a[0:3], v[176:179]
 s_waitcnt lgkmcnt(4)
 v_mfma_f32_16x16x32_bf16 v[192:195], a[192:195], a[32:35], v[192:195]
 ds_read_b64_tr_b16 a[208:209], v30 offset:0
 ds_read_b64_tr_b16 a[210:211], v30 offset:4096
 v_mfma_f32_16x16x32_bf16 v[192:195], a[196:199], a[36:39], v[192:195]
 v_mfma_f32_16x16x32_bf16 v[196:199], a[196:199], a[44:47], v[196:199]
 ds_read_b64_tr_b16 a[212:213], v30 offset:8192
 ds_read_b64_tr_b16 a[214:215], v30 offset:12288
 v_mfma_f32_16x16x32_bf16 v[196:199], a[192:195], a[40:43], v[196:199]
 v_mfma_f32_16x16x32_bf16 v[200:203], a[192:195], a[48:51], v[200:203]
 v_mfma_f32_16x16x32_bf16 v[200:203], a[196:199], a[52:55], v[200:203]
 v_mfma_f32_16x16x32_bf16 v[204:207], a[196:199], a[60:63], v[204:207]
 v_mfma_f32_16x16x32_bf16 v[204:207], a[192:195], a[56:59], v[204:207]
 s_waitcnt lgkmcnt(4)
 v_mfma_f32_16x16x32_bf16 v[140:143], a[200:203], a[56:59], v[140:143]
 ds_read_b64_tr_b16 a[216:217], v30 offset:8
 ds_read_b64_tr_b16 a[218:219], v30 offset:4104
 v_mfma_f32_16x16x32_bf16 v[140:143], a[204:207], a[60:63], v[140:143]
 v_mfma_f32_16x16x32_bf16 v[136:139], a[204:207], a[52:55], v[136:139]
 ds_read_b64_tr_b16 a[220:221], v30 offset:8200
 ds_read_b64_tr_b16 a[222:223], v30 offset:12296
 v_mfma_f32_16x16x32_bf16 v[136:139], a[200:203], a[48:51], v[136:139]
 v_mfma_f32_16x16x32_bf16 v[132:135], a[200:203], a[40:43], v[132:135]
 v_mfma_f32_16x16x32_bf16 v[132:135], a[204:207], a[44:47], v[132:135]
 v_mfma_f32_16x16x32_bf16 v[128:131], a[204:207], a[36:39], v[128:131]
 v_mfma_f32_16x16x32_bf16 v[128:131], a[200:203], a[32:35], v[128:131]
 s_waitcnt lgkmcnt(4)
 v_mfma_f32_16x16x32_bf16 v[208:211], a[208:211], a[32:35], v[208:211]
 ds_read_b64_tr_b16 a[192:193], v31 offset:0
 ds_read_b64_tr_b16 a[194:195], v31 offset:4096
 v_mfma_f32_16x16x32_bf16 v[208:211], a[212:215], a[36:39], v[208:211]
 v_mfma_f32_16x16x32_bf16 v[212:215], a[212:215], a[44:47], v[212:215]
 ds_read_b64_tr_b16 a[196:197], v31 offset:8192
 ds_read_b64_tr_b16 a[198:199], v31 offset:12288
 v_mfma_f32_16x16x32_bf16 v[212:215], a[208:211], a[40:43], v[212:215]
 v_mfma_f32_16x16x32_bf16 v[216:219], a[208:211], a[48:51], v[216:219]
 v_cvt_pk_bf16_f32 v192, v192, v193
 v_cvt_pk_bf16_f32 v193, v194, v195
 v_mfma_f32_16x16x32_bf16 v[216:219], a[212:215], a[52:55], v[216:219]
 v_cvt_pk_bf16_f32 v194, v128, v129
 v_cvt_pk_bf16_f32 v195, v130, v131
 v_mfma_f32_16x16x32_bf16 v[220:223], a[212:215], a[60:63], v[220:223]
 v_cvt_pk_bf16_f32 v196, v196, v197
 v_cvt_pk_bf16_f32 v197, v198, v199
 v_mfma_f32_16x16x32_bf16 v[220:223], a[208:211], a[56:59], v[220:223]
 s_waitcnt lgkmcnt(4)
 v_cvt_pk_bf16_f32 v198, v132, v133
 v_cvt_pk_bf16_f32 v199, v134, v135
 v_mfma_f32_16x16x32_bf16 v[156:159], a[216:219], a[56:59], v[156:159]
 ds_read_b64_tr_b16 a[200:201], v31 offset:8
 ds_read_b64_tr_b16 a[202:203], v31 offset:4104
 v_mfma_f32_16x16x32_bf16 v[156:159], a[220:223], a[60:63], v[156:159]
 v_cvt_pk_bf16_f32 v200, v200, v201
 v_cvt_pk_bf16_f32 v201, v202, v203
 v_mfma_f32_16x16x32_bf16 v[152:155], a[220:223], a[52:55], v[152:155]
 ds_read_b64_tr_b16 a[204:205], v31 offset:8200
 ds_read_b64_tr_b16 a[206:207], v31 offset:12296
 v_mfma_f32_16x16x32_bf16 v[152:155], a[216:219], a[48:51], v[152:155]
 v_cvt_pk_bf16_f32 v202, v136, v137
 v_cvt_pk_bf16_f32 v203, v138, v139
 v_mfma_f32_16x16x32_bf16 v[148:151], a[216:219], a[40:43], v[148:151]
 v_cvt_pk_bf16_f32 v204, v204, v205
 v_cvt_pk_bf16_f32 v205, v206, v207
 v_mfma_f32_16x16x32_bf16 v[148:151], a[220:223], a[44:47], v[148:151]
 v_cvt_pk_bf16_f32 v206, v140, v141
 v_cvt_pk_bf16_f32 v207, v142, v143
 v_mfma_f32_16x16x32_bf16 v[144:147], a[220:223], a[36:39], v[144:147]
 v_mfma_f32_16x16x32_bf16 v[144:147], a[216:219], a[32:35], v[144:147]
 s_waitcnt lgkmcnt(4)
 v_mfma_f32_16x16x32_bf16 v[224:227], a[192:195], a[32:35], v[224:227]
 s_barrier
 ds_read_b64_tr_b16 a[208:209], v32 offset:0
 ds_read_b64_tr_b16 a[210:211], v32 offset:4096
 v_mfma_f32_16x16x32_bf16 v[224:227], a[196:199], a[36:39], v[224:227]
 v_mfma_f32_16x16x32_bf16 v[228:231], a[196:199], a[44:47], v[228:231]
 s_add_u32 m0, s47, 49152
 ds_read_b64_tr_b16 a[212:213], v32 offset:8192
 ds_read_b64_tr_b16 a[214:215], v32 offset:12288
 v_mfma_f32_16x16x32_bf16 v[228:231], a[192:195], a[40:43], v[228:231]
 buffer_load_dwordx4 v1, s[8:11], s49 offen offset:0 lds
 v_mfma_f32_16x16x32_bf16 v[232:235], a[192:195], a[48:51], v[232:235]
 v_cvt_pk_bf16_f32 v208, v208, v209
 v_mfma_f32_16x16x32_bf16 v[232:235], a[196:199], a[52:55], v[232:235]
 buffer_load_dwordx4 v2, s[8:11], s49 offen offset:1024 lds
 v_mfma_f32_16x16x32_bf16 v[236:239], a[196:199], a[60:63], v[236:239]
 v_cvt_pk_bf16_f32 v209, v210, v211
 v_mfma_f32_16x16x32_bf16 v[236:239], a[192:195], a[56:59], v[236:239]
 s_waitcnt lgkmcnt(4)
 buffer_load_dwordx4 v3, s[8:11], s49 offen offset:2048 lds
 v_mfma_f32_16x16x32_bf16 v[172:175], a[200:203], a[56:59], v[172:175]
 ds_read_b64_tr_b16 a[216:217], v32 offset:8
 ds_read_b64_tr_b16 a[218:219], v32 offset:4104
 v_mfma_f32_16x16x32_bf16 v[172:175], a[204:207], a[60:63], v[172:175]
 buffer_load_dwordx4 v4, s[8:11], s49 offen offset:3072 lds
 v_mfma_f32_16x16x32_bf16 v[168:171], a[204:207], a[52:55], v[168:171]
 s_add_u32 s49, s49, 16384
 s_add_u32 m0, s47, 131072
 ds_read_b64_tr_b16 a[220:221], v32 offset:8200
 ds_read_b64_tr_b16 a[222:223], v32 offset:12296
 v_mfma_f32_16x16x32_bf16 v[168:171], a[200:203], a[48:51], v[168:171]
 v_cvt_pk_bf16_f32 v210, v144, v145
 v_mfma_f32_16x16x32_bf16 v[164:167], a[200:203], a[40:43], v[164:167]
 buffer_load_dwordx4 v1, s[12:15], s50 offen offset:0 lds
 v_mfma_f32_16x16x32_bf16 v[164:167], a[204:207], a[44:47], v[164:167]
 v_cvt_pk_bf16_f32 v211, v146, v147
 v_mfma_f32_16x16x32_bf16 v[160:163], a[204:207], a[36:39], v[160:163]
 buffer_load_dwordx4 v2, s[12:15], s50 offen offset:1024 lds
 v_mfma_f32_16x16x32_bf16 v[160:163], a[200:203], a[32:35], v[160:163]
 s_waitcnt lgkmcnt(4)
 v_cvt_pk_bf16_f32 v212, v212, v213
 v_cvt_pk_bf16_f32 v213, v214, v215
 v_mfma_f32_16x16x32_bf16 v[240:243], a[208:211], a[32:35], v[240:243]
 ds_read_b128 a[128:131], v5 offset:49152
 ds_read_b128 a[132:135], v6 offset:49152
 v_mfma_f32_16x16x32_bf16 v[240:243], a[212:215], a[36:39], v[240:243]
 buffer_load_dwordx4 v3, s[12:15], s50 offen offset:2048 lds
 v_mfma_f32_16x16x32_bf16 v[244:247], a[212:215], a[44:47], v[244:247]
 ds_read_b128 a[136:139], v7 offset:49152
 ds_read_b128 a[140:143], v8 offset:49152
 v_mfma_f32_16x16x32_bf16 v[244:247], a[208:211], a[40:43], v[244:247]
 v_cvt_pk_bf16_f32 v214, v148, v149
 v_mfma_f32_16x16x32_bf16 v[248:251], a[208:211], a[48:51], v[248:251]
 buffer_load_dwordx4 v4, s[12:15], s50 offen offset:3072 lds
 v_mfma_f32_16x16x32_bf16 v[248:251], a[212:215], a[52:55], v[248:251]
 s_add_u32 s50, s50, 16384
 v_cvt_pk_bf16_f32 v215, v150, v151
 v_cvt_pk_bf16_f32 v216, v216, v217
 v_mfma_f32_16x16x32_bf16 v[252:255], a[212:215], a[60:63], v[252:255]
 v_cvt_pk_bf16_f32 v217, v218, v219
 v_cvt_pk_bf16_f32 v218, v152, v153
 v_mfma_f32_16x16x32_bf16 v[252:255], a[208:211], a[56:59], v[252:255]
 s_waitcnt lgkmcnt(4)
 v_cvt_pk_bf16_f32 v219, v154, v155
 v_cvt_pk_bf16_f32 v220, v220, v221
 v_mfma_f32_16x16x32_bf16 v[188:191], a[216:219], a[56:59], v[188:191]
 ds_read_b128 a[144:147], v5 offset:53248
 ds_read_b128 a[148:151], v6 offset:53248
 v_mfma_f32_16x16x32_bf16 v[188:191], a[220:223], a[60:63], v[188:191]
 v_cvt_pk_bf16_f32 v221, v222, v223
 v_cvt_pk_bf16_f32 v222, v156, v157
 v_mfma_f32_16x16x32_bf16 v[184:187], a[220:223], a[52:55], v[184:187]
 ds_read_b128 a[152:155], v7 offset:53248
 ds_read_b128 a[156:159], v8 offset:53248
 v_mfma_f32_16x16x32_bf16 v[184:187], a[216:219], a[48:51], v[184:187]
 v_cvt_pk_bf16_f32 v223, v158, v159
 v_cvt_pk_bf16_f32 v224, v224, v225
 v_mfma_f32_16x16x32_bf16 v[180:183], a[216:219], a[40:43], v[180:183]
 v_cvt_pk_bf16_f32 v225, v226, v227
 v_cvt_pk_bf16_f32 v226, v160, v161
 v_mfma_f32_16x16x32_bf16 v[180:183], a[220:223], a[44:47], v[180:183]
 v_cvt_pk_bf16_f32 v227, v162, v163
 v_cvt_pk_bf16_f32 v228, v228, v229
 v_mfma_f32_16x16x32_bf16 v[176:179], a[220:223], a[36:39], v[176:179]
 v_cvt_pk_bf16_f32 v229, v230, v231
 v_cvt_pk_bf16_f32 v230, v164, v165
 v_mfma_f32_16x16x32_bf16 v[176:179], a[216:219], a[32:35], v[176:179]
 v_cvt_pk_bf16_f32 v231, v166, v167
 v_cvt_pk_bf16_f32 v232, v232, v233
 v_cvt_pk_bf16_f32 v233, v234, v235
 v_cvt_pk_bf16_f32 v234, v168, v169
 v_cvt_pk_bf16_f32 v235, v170, v171
 v_cvt_pk_bf16_f32 v236, v236, v237
 v_cvt_pk_bf16_f32 v237, v238, v239
 v_cvt_pk_bf16_f32 v238, v172, v173
 v_cvt_pk_bf16_f32 v239, v174, v175
 v_cvt_pk_bf16_f32 v240, v240, v241
 v_cvt_pk_bf16_f32 v241, v242, v243
 v_cvt_pk_bf16_f32 v242, v176, v177
 v_cvt_pk_bf16_f32 v243, v178, v179
 v_cvt_pk_bf16_f32 v244, v244, v245
 v_cvt_pk_bf16_f32 v245, v246, v247
 v_cvt_pk_bf16_f32 v246, v180, v181
 v_cvt_pk_bf16_f32 v247, v182, v183
 v_cvt_pk_bf16_f32 v248, v248, v249
 v_cvt_pk_bf16_f32 v249, v250, v251
 v_cvt_pk_bf16_f32 v250, v184, v185
 v_cvt_pk_bf16_f32 v251, v186, v187
 v_cvt_pk_bf16_f32 v252, v252, v253
 v_cvt_pk_bf16_f32 v253, v254, v255
 v_cvt_pk_bf16_f32 v254, v188, v189
 v_cvt_pk_bf16_f32 v255, v190, v191
mq_done:
 s_mov_b32 s58, 0x7ff00000
 s_cmp_eq_u32 s57, 1
 s_cbranch_scc1 fb_a
mq_att:
 s_waitcnt lgkmcnt(4)
 v_mfma_f32_16x16x32_bf16 v[128:131], a[128:131], v[192:195], v[48:51]
 s_mov_b32 s20, s72
 v_mfma_f32_16x16x32_bf16 v[128:131], a[132:135], v[208:211], v[128:131]
 s_mov_b32 s21, s73
 v_mfma_f32_16x16x32_bf16 v[128:131], a[136:139], v[224:227], v[128:131]
 s_mov_b32 s22, 4194304
 v_mfma_f32_16x16x32_bf16 v[132:135], a[136:139], v[228:231], v[52:55]
 s_mov_b32 s23, 0x00020000
 v_mfma_f32_16x16x32_bf16 v[132:135], a[132:135], v[212:215], v[132:135]
 s_mov_b32 s16, s80
 v_mfma_f32_16x16x32_bf16 v[132:135], a[128:131], v[196:199], v[132:135]
 s_mov_b32 s17, s81
 v_mfma_f32_16x16x32_bf16 v[136:139], a[128:131], v[200:203], v[56:59]
 s_mov_b32 s18, 1835008
 v_mfma_f32_16x16x32_bf16 v[136:139], a[132:135], v[216:219], v[136:139]
 s_mov_b32 s19, 0x00020000
 v_mfma_f32_16x16x32_bf16 v[136:139], a[136:139], v[232:235], v[136:139]
 s_add_u32 s24, s86, 33554432
 s_addc_u32 s25, s87, 0
 v_mfma_f32_16x16x32_bf16 v[140:143], a[136:139], v[236:239], v[60:63]
 s_mov_b32 s26, 6029312
 v_mfma_f32_16x16x32_bf16 v[140:143], a[132:135], v[220:223], v[140:143]
 s_mov_b32 s27, 0x00020000
 ds_read_b128 a[160:163], v5 offset:57344
 ds_read_b128 a[164:167], v6 offset:57344
 v_mfma_f32_16x16x32_bf16 v[140:143], a[128:131], v[204:207], v[140:143]
 s_lshl_b32 s3, s2, 2
 ds_read_b128 a[168:171], v7 offset:57344
 ds_read_b128 a[172:175], v8 offset:57344
 v_mfma_f32_16x16x32_bf16 v[128:131], a[140:143], v[240:243], v[128:131]
 s_add_u32 s3, s3, s44
 ds_read_b128 a[176:179], v5 offset:61440
 ds_read_b128 a[180:183], v6 offset:61440
 v_mfma_f32_16x16x32_bf16 v[132:135], a[140:143], v[244:247], v[132:135]
 s_and_b32 s4, s3, 7
 ds_read_b128 a[184:187], v7 offset:61440
 ds_read_b128 a[188:191], v8 offset:61440
 v_mfma_f32_16x16x32_bf16 v[136:139], a[140:143], v[248:251], v[136:139]
 s_lshr_b32 s3, s3, 3
 v_lshrrev_b32 v29, 7, v18
 v_bfe_u32 v30, v18, 4, 3
 v_mfma_f32_16x16x32_bf16 v[140:143], a[140:143], v[252:255], v[140:143]
 s_waitcnt lgkmcnt(8)
 s_lshl_b32 s5, s3, 15
 v_and_b32 v31, 6, v29
 v_xor_b32 v30, v30, v31
 v_mfma_f32_16x16x32_bf16 v[144:147], a[144:147], v[204:207], v[60:63]
 s_lshl_b32 s6, s4, 7
 v_lshlrev_b32 v30, 4, v30
 v_lshl_add_u32 v21, v29, 10, v30
 v_mfma_f32_16x16x32_bf16 v[144:147], a[148:151], v[220:223], v[144:147]
 s_add_u32 s51, s5, s6
 v_add_u32 v22, 7168, v21
 v_add_u32 v23, 14336, v21
 v_mfma_f32_16x16x32_bf16 v[144:147], a[152:155], v[236:239], v[144:147]
 s_mul_i32 s4, s4, 753664
 v_add_u32 v24, 21504, v21
 v_mfma_f32_16x16x32_bf16 v[144:147], a[156:159], v[252:255], v[144:147]
 s_lshl_b32 s5, s3, 12
 v_mfma_f32_16x16x32_bf16 v[148:151], a[156:159], v[248:251], v[56:59]
 s_add_u32 s52, s4, s5
 v_exp_f32 v128, v128
 v_mfma_f32_16x16x32_bf16 v[148:151], a[152:155], v[232:235], v[148:151]
 s_add_u32 s53, s52, 229376
 v_exp_f32 v129, v129
 v_mfma_f32_16x16x32_bf16 v[148:151], a[148:151], v[216:219], v[148:151]
 s_cmp_lt_u32 s3, 56
 s_cselect_b32 s52, s52, 0x7ff00000
 v_exp_f32 v130, v130
 v_mfma_f32_16x16x32_bf16 v[148:151], a[144:147], v[200:203], v[148:151]
 v_exp_f32 v131, v131
 v_mfma_f32_16x16x32_bf16 v[152:155], a[144:147], v[196:199], v[52:55]
 v_exp_f32 v132, v132
 v_mfma_f32_16x16x32_bf16 v[152:155], a[148:151], v[212:215], v[152:155]
 v_exp_f32 v133, v133
 v_mfma_f32_16x16x32_bf16 v[152:155], a[152:155], v[228:231], v[152:155]
 v_exp_f32 v134, v134
 v_mfma_f32_16x16x32_bf16 v[152:155], a[156:159], v[244:247], v[152:155]
 v_exp_f32 v135, v135
 v_mfma_f32_16x16x32_bf16 v[156:159], a[156:159], v[240:243], v[48:51]
 v_exp_f32 v136, v136
 v_mfma_f32_16x16x32_bf16 v[156:159], a[152:155], v[224:227], v[156:159]
 v_exp_f32 v137, v137
 v_mfma_f32_16x16x32_bf16 v[156:159], a[148:151], v[208:211], v[156:159]
 v_exp_f32 v138, v138
 v_mfma_f32_16x16x32_bf16 v[156:159], a[144:147], v[192:195], v[156:159]
 s_waitcnt lgkmcnt(4)
 v_exp_f32 v139, v139
 v_mfma_f32_16x16x32_bf16 v[160:163], a[160:163], v[192:195], v[48:51]
 v_exp_f32 v140, v140
 v_mfma_f32_16x16x32_bf16 v[160:163], a[164:167], v[208:211], v[160:163]
 v_exp_f32 v141, v141
 v_mfma_f32_16x16x32_bf16 v[160:163], a[168:171], v[224:227], v[160:163]
 v_exp_f32 v142, v142
 v_mfma_f32_16x16x32_bf16 v[160:163], a[172:175], v[240:243], v[160:163]
 v_exp_f32 v143, v143
 v_mfma_f32_16x16x32_bf16 v[164:167], a[172:175], v[244:247], v[52:55]
 v_exp_f32 v144, v144
 v_mfma_f32_16x16x32_bf16 v[164:167], a[168:171], v[228:231], v[164:167]
 v_exp_f32 v145, v145
 v_mfma_f32_16x16x32_bf16 v[164:167], a[164:167], v[212:215], v[164:167]
 v_exp_f32 v146, v146
 v_mfma_f32_16x16x32_bf16 v[164:167], a[160:163], v[196:199], v[164:167]
 v_exp_f32 v147, v147
 v_mfma_f32_16x16x32_bf16 v[168:171], a[160:163], v[200:203], v[56:59]
 v_exp_f32 v148, v148
 v_mfma_f32_16x16x32_bf16 v[168:171], a[164:167], v[216:219], v[168:171]
 v_exp_f32 v149, v149
 v_mfma_f32_16x16x32_bf16 v[168:171], a[168:171], v[232:235], v[168:171]
 v_exp_f32 v150, v150
 v_mfma_f32_16x16x32_bf16 v[168:171], a[172:175], v[248:251], v[168:171]
 v_exp_f32 v151, v151
 v_mfma_f32_16x16x32_bf16 v[172:175], a[172:175], v[252:255], v[60:63]
 v_exp_f32 v152, v152
 v_mfma_f32_16x16x32_bf16 v[172:175], a[168:171], v[236:239], v[172:175]
 v_exp_f32 v153, v153
 v_mfma_f32_16x16x32_bf16 v[172:175], a[164:167], v[220:223], v[172:175]
 v_exp_f32 v154, v154
 v_mfma_f32_16x16x32_bf16 v[172:175], a[160:163], v[204:207], v[172:175]
 s_waitcnt lgkmcnt(0)
 v_exp_f32 v155, v155
 v_mfma_f32_16x16x32_bf16 v[176:179], a[176:179], v[204:207], v[60:63]
 v_exp_f32 v156, v156
 v_mfma_f32_16x16x32_bf16 v[176:179], a[180:183], v[220:223], v[176:179]
 v_exp_f32 v157, v157
 v_mfma_f32_16x16x32_bf16 v[176:179], a[184:187], v[236:239], v[176:179]
 v_exp_f32 v158, v158
 v_mfma_f32_16x16x32_bf16 v[176:179], a[188:191], v[252:255], v[176:179]
 v_exp_f32 v159, v159
 v_mfma_f32_16x16x32_bf16 v[180:183], a[188:191], v[248:251], v[56:59]
 v_exp_f32 v160, v160
 v_mfma_f32_16x16x32_bf16 v[180:183], a[184:187], v[232:235], v[180:183]
 v_exp_f32 v161, v161
 v_mfma_f32_16x16x32_bf16 v[180:183], a[180:183], v[216:219], v[180:183]
 v_exp_f32 v162, v162
 v_mfma_f32_16x16x32_bf16 v[180:183], a[176:179], v[200:203], v[180:183]
 v_exp_f32 v163, v163
 v_mfma_f32_16x16x32_bf16 v[184:187], a[176:179], v[196:199], v[52:55]
 v_exp_f32 v164, v164
 v_mfma_f32_16x16x32_bf16 v[184:187], a[180:183], v[212:215], v[184:187]
 v_exp_f32 v165, v165
 v_mfma_f32_16x16x32_bf16 v[184:187], a[184:187], v[228:231], v[184:187]
 v_exp_f32 v166, v166
 v_mfma_f32_16x16x32_bf16 v[184:187], a[188:191], v[244:247], v[184:187]
 v_exp_f32 v167, v167
 v_mfma_f32_16x16x32_bf16 v[188:191], a[188:191], v[240:243], v[48:51]
 v_exp_f32 v168, v168
 v_mfma_f32_16x16x32_bf16 v[188:191], a[184:187], v[224:227], v[188:191]
 v_exp_f32 v169, v169
 v_mfma_f32_16x16x32_bf16 v[188:191], a[180:183], v[208:211], v[188:191]
 v_exp_f32 v170, v170
 v_mov_b32 v32, 0
 v_mov_b32 v33, 0
 v_mfma_f32_16x16x32_bf16 v[188:191], a[176:179], v[192:195], v[188:191]
 s_barrier
 v_exp_f32 v171, v171
 ds_read_b128 a[128:131], v5 offset:0
 ds_read_b128 a[132:135], v6 offset:0
 ds_read_b128 a[136:139], v7 offset:0
 ds_read_b128 a[140:143], v8 offset:0
 ds_read_b128 a[144:147], v5 offset:4096
 ds_read_b128 a[148:151], v6 offset:4096
 ds_read_b128 a[152:155], v7 offset:4096
 ds_read_b128 a[156:159], v8 offset:4096
 v_exp_f32 v172, v172
 v_cvt_pk_bf16_f32 v64, v128, v129
 v_cvt_pk_bf16_f32 v65, v130, v131
 v_cvt_pk_bf16_f32 v72, v132, v133
 v_cvt_pk_bf16_f32 v73, v134, v135
 v_cvt_pk_bf16_f32 v80, v136, v137
 v_cvt_pk_bf16_f32 v81, v138, v139
 v_cvt_pk_bf16_f32 v88, v140, v141
 v_cvt_pk_bf16_f32 v89, v142, v143
 v_cvt_pk_bf16_f32 v90, v144, v145
 v_cvt_pk_bf16_f32 v91, v146, v147
 v_cvt_pk_bf16_f32 v82, v148, v149
 v_cvt_pk_bf16_f32 v83, v150, v151
 v_cvt_pk_bf16_f32 v74, v152, v153
 v_cvt_pk_bf16_f32 v75, v154, v155
 v_cvt_pk_bf16_f32 v66, v156, v157
 v_cvt_pk_bf16_f32 v67, v158, v159
 v_cvt_pk_bf16_f32 v68, v160, v161
 v_cvt_pk_bf16_f32 v69, v162, v163
 v_cvt_pk_bf16_f32 v76, v164, v165
 v_cvt_pk_bf16_f32 v77, v166, v167
 v_cvt_pk_bf16_f32 v84, v168, v169
 v_cvt_pk_bf16_f32 v85, v170, v171
 v_exp_f32 v173, v173
 v_exp_f32 v174, v174
 v_cvt_pk_bf16_f32 v92, v172, v173
 v_exp_f32 v175, v175
 v_exp_f32 v176, v176
 v_cvt_pk_bf16_f32 v93, v174, v175
 v_exp_f32 v177, v177
 v_exp_f32 v178, v178
 v_cvt_pk_bf16_f32 v94, v176, v177
 v_exp_f32 v179, v179
 v_exp_f32 v180, v180
 v_cvt_pk_bf16_f32 v95, v178, v179
 v_exp_f32 v181, v181
 v_exp_f32 v182, v182
 v_cvt_pk_bf16_f32 v86, v180, v181
 v_exp_f32 v183, v183
 v_exp_f32 v184, v184
 v_cvt_pk_bf16_f32 v87, v182, v183
 v_exp_f32 v185, v185
 v_exp_f32 v186, v186
 v_cvt_pk_bf16_f32 v78, v184, v185
 v_exp_f32 v187, v187
 v_exp_f32 v188, v188
 v_cvt_pk_bf16_f32 v79, v186, v187
 v_exp_f32 v189, v189
 v_exp_f32 v190, v190
 v_cvt_pk_bf16_f32 v70, v188, v189
 v_exp_f32 v191, v191
 s_nop 0
 v_cvt_pk_bf16_f32 v71, v190, v191
 v_pk_mov_b32 v[32:33], v[32:33], v[32:33]
 v_pk_mov_b32 v[34:35], v[32:33], v[32:33]
 v_pk_mov_b32 v[36:37], v[32:33], v[32:33]
 v_pk_mov_b32 v[38:39], v[32:33], v[32:33]
 v_pk_mov_b32 v[40:41], v[32:33], v[32:33]
 v_pk_mov_b32 v[42:43], v[32:33], v[32:33]
 v_pk_mov_b32 v[44:45], v[32:33], v[32:33]
 v_pk_mov_b32 v[46:47], v[32:33], v[32:33]
 s_waitcnt lgkmcnt(4)
 s_branch att_it0
mq_z:
.section .rodata,"a"
.p2align 6
.amdhsa_kernel recurrent_scan__mha_block_cached__glu_gated_bilinear__prompt_kernel
  .amdhsa_next_free_vgpr 512
  .amdhsa_next_free_sgpr 102
  .amdhsa_accum_offset 256
  .amdhsa_group_segment_fixed_size 0
  .amdhsa_kernarg_size 96
  .amdhsa_user_sgpr_count 2
  .amdhsa_user_sgpr_kernarg_segment_ptr 1
  .amdhsa_system_sgpr_workgroup_id_x 1
.end_amdhsa_kernel
```
